```python
import torch

def _softmax(x, axis=-1):
    return torch.softmax(x, dim=axis)

def _gelu(x):
    return torch.nn.functional.gelu(x, approximate='tanh')

def _silu(x):
    return torch.nn.functional.silu(x)

def _sigmoid(x):
    return torch.sigmoid(x)

def _layernorm(x, axis=-1, eps=1e-05):
    m = x.mean(dim=axis, keepdim=True)
    v = x.var(dim=axis, keepdim=True, unbiased=False)
    return (x - m) / torch.sqrt(v + eps)

def _scatter_add(tgt, idx, src, axis=0):
    return tgt.clone().index_add_(axis, idx, src)

def _segment_sum(src, seg, n):
    out = torch.zeros((n,) + src.shape[1:], dtype=src.dtype)
    return out.index_add_(0, seg, src)

def _pad(x, pw):
    flat = tuple((v for pair in reversed(pw) for v in pair))
    return torch.nn.functional.pad(x, flat)
kernel_name = 'parallel_sum__memory_aug_recurrent_mem_tr__dense_activation_gelu__prompt'

def setup_inputs():

    _w = lambda a: (lambda t: t.to(torch.bfloat16) if t.is_floating_point() else t)(torch.as_tensor(a))

    def _A_setup():
        B, S, Dm = (1, 2048, 640)
        H, Dh = (32, 128)
        M, seg = (8, 32)
        seg = min(seg, S)
        S = S // seg * seg
        return {'x': _w((lambda *s: torch.randn(*s, dtype=torch.bfloat16) * 0.05)(B, S, Dm)), 'mem0': _w((lambda *s: torch.randn(*s, dtype=torch.bfloat16) * 0.2)(B, M, Dm)), 'Wq': _w((lambda *s: torch.randn(*s, dtype=torch.bfloat16) * 1.6)(Dm, H, Dh) * Dm ** (-0.5)), 'Wk': _w((lambda *s: torch.randn(*s, dtype=torch.bfloat16) * 1.6)(Dm, H, Dh) * Dm ** (-0.5)), 'Wv': _w((lambda *s: torch.randn(*s, dtype=torch.bfloat16) * 0.2)(Dm, H, Dh) * Dm ** (-0.5)), 'Wo': _w((lambda *s: torch.randn(*s, dtype=torch.bfloat16) * 0.2)(H, Dh, Dm) * (H * Dh) ** (-0.5)), 'seg_len': seg}
    _A_in = _A_setup()

    def _B_setup():
        B, S, D, F = (1, 2048, 640, 1728)
        return {'x': _w((lambda *s: torch.randn(*s, dtype=torch.bfloat16) * 0.05)(B, S, D)), 'w1': _w((lambda *s: torch.randn(*s, dtype=torch.bfloat16) * 0.4)(D, F) * D ** (-0.5)), 'b1': _w((lambda *s: torch.randn(*s, dtype=torch.bfloat16) * 12.8)(F) * 0.01), 'w2': _w((lambda *s: torch.randn(*s, dtype=torch.bfloat16) * 0.2)(F, D) * F ** (-0.5)), 'b2': _w((lambda *s: torch.randn(*s, dtype=torch.bfloat16) * 1.6)(D) * 0.01)}
    _B_in = _B_setup()
    return {'A_x': _A_in['x'], 'A_mem0': _A_in['mem0'], 'A_Wq': _A_in['Wq'], 'A_Wk': _A_in['Wk'], 'A_Wv': _A_in['Wv'], 'A_Wo': _A_in['Wo'], 'A_seg_len': _A_in['seg_len'], 'B_x': _B_in['x'], 'B_w1': _B_in['w1'], 'B_b1': _B_in['b1'], 'B_w2': _B_in['w2'], 'B_b2': _B_in['b2']}

def reference(A_x, A_mem0, A_Wq, A_Wk, A_Wv, A_Wo, A_seg_len, B_x, B_w1, B_b1, B_w2, B_b2):

    def _A_ref(x, mem0, Wq, Wk, Wv, Wo, seg_len):
        B, S, Dm = x.shape
        H, Dh = (Wq.shape[1], Wq.shape[2])
        M = mem0.shape[1]
        scale = Dh ** (-0.5)
        n_seg = S // seg_len
        L = M + seg_len
        idx = torch.arange(L)
        mask = (idx[:, None] < M) | (idx[:, None] >= idx[None, :])
        mem = mem0
        outs = []
        for s in range(n_seg):
            xs = x[:, s * seg_len:(s + 1) * seg_len, :].clone()
            h = torch.concatenate([mem, xs], axis=1)
            q = torch.einsum('btd,dhe->bhte', h, Wq)
            k = torch.einsum('btd,dhe->bhte', h, Wk)
            v = torch.einsum('btd,dhe->bhte', h, Wv)
            scores = torch.einsum('bhqe,bhke->bhqk', q, k) * scale
            scores = torch.where(mask[None, None], scores, -1000000000.0)
            p = _softmax(scores, axis=-1)
            o = torch.einsum('bhqk,bhke->bhqe', p, v)
            o = torch.einsum('bhte,hed->btd', o, Wo)
            mem = o[:, :M, :].clone()
            outs.append(o[:, M:, :])
        return torch.concatenate(outs, axis=1)

    def _B_ref(x, w1, b1, w2, b2):
        h = torch.einsum('bsd,df->bsf', x, w1) + b1
        h = _gelu(h)
        return torch.einsum('bsf,fd->bsd', h, w2) + b2
    x = A_x
    xn = _layernorm(x, axis=-1)
    return x + _A_ref(xn, A_mem0, A_Wq, A_Wk, A_Wv, A_Wo, A_seg_len) + _B_ref(xn, B_w1, B_b1, B_w2, B_b2)
```

```asm
; @launch grid=(256,1,1) block=(256,1,1) lds=163840
.amdgcn_target "amdgcn-amd-amdhsa--gfx950"
.text
.globl parallel_sum__memory_aug_recurrent_mem_tr__dense_activation_gelu__prompt_kernel
.p2align 8
.type parallel_sum__memory_aug_recurrent_mem_tr__dense_activation_gelu__prompt_kernel,@function
parallel_sum__memory_aug_recurrent_mem_tr__dense_activation_gelu__prompt_kernel:
s_cmp_ge_u32 s2, 256
s_cbranch_scc1 L_end
s_load_dwordx4 s[4:7], s[0:1], 104
v_lshrrev_b32 v2, 6, v0
v_and_b32 v1, 63, v0
v_readfirstlane_b32 s17, v2
s_mov_b32 s57, 0
s_waitcnt lgkmcnt(0)
s_mov_b32 s8, s6
s_mov_b32 s9, s7
s_mov_b32 s10, 268435456
s_mov_b32 s11, 0x20000
s_mov_b32 s60, s4
s_mov_b32 s61, s5
s_mov_b32 s62, 256
s_mov_b32 s63, 0x20000
s_cmp_eq_u32 s17, 0
s_cbranch_scc1 L_w0
s_cmp_lg_u32 s17, 1
s_cbranch_scc1 L_role
s_sleep 4
s_getpc_b64 s[4:5]
s_lshr_b32 s3, s2, 3
s_mul_i32 s3, s3, 2560
v_min_u32 v4, 19, v1
v_lshlrev_b32 v4, 7, v4
v_add_u32 v4, s3, v4
global_load_dword v5, v4, s[4:5]
s_cmp_lg_u32 s2, 0
s_cbranch_scc1 L_w1e
v_lshlrev_b32 v2, 4, v1
v_mov_b32 v8, 0
v_mov_b32 v9, 0
v_mov_b32 v10, 0
v_mov_b32 v11, 0
s_mov_b32 s3, 1048576
buffer_store_dwordx4 v[8:11], v2, s[8:11], s3 offen sc1
s_mov_b32 s3, 1049600
buffer_store_dwordx4 v[8:11], v2, s[8:11], s3 offen sc1
s_mov_b32 s3, 1050624
buffer_store_dwordx4 v[8:11], v2, s[8:11], s3 offen sc1
s_mov_b32 s3, 1051648
buffer_store_dwordx4 v[8:11], v2, s[8:11], s3 offen sc1
s_mov_b32 s3, 1052672
buffer_store_dwordx4 v[8:11], v2, s[8:11], s3 offen sc1
s_mov_b32 s3, 1053696
buffer_store_dwordx4 v[8:11], v2, s[8:11], s3 offen sc1
s_mov_b32 s3, 1054720
buffer_store_dwordx4 v[8:11], v2, s[8:11], s3 offen sc1
s_mov_b32 s3, 1055744
buffer_store_dwordx4 v[8:11], v2, s[8:11], s3 offen sc1
s_mov_b32 s3, 1056768
buffer_store_dwordx4 v[8:11], v2, s[8:11], s3 offen sc1
s_mov_b32 s3, 1057792
buffer_store_dwordx4 v[8:11], v2, s[8:11], s3 offen sc1
s_mov_b32 s3, 1058816
buffer_store_dwordx4 v[8:11], v2, s[8:11], s3 offen sc1
s_mov_b32 s3, 1059840
buffer_store_dwordx4 v[8:11], v2, s[8:11], s3 offen sc1
s_mov_b32 s3, 1060864
buffer_store_dwordx4 v[8:11], v2, s[8:11], s3 offen sc1
s_mov_b32 s3, 1061888
buffer_store_dwordx4 v[8:11], v2, s[8:11], s3 offen sc1
s_mov_b32 s3, 1062912
buffer_store_dwordx4 v[8:11], v2, s[8:11], s3 offen sc1
s_mov_b32 s3, 1063936
buffer_store_dwordx4 v[8:11], v2, s[8:11], s3 offen sc1
s_mov_b32 s3, 1064960
buffer_store_dwordx4 v[8:11], v2, s[8:11], s3 offen sc1
s_mov_b32 s3, 1065984
buffer_store_dwordx4 v[8:11], v2, s[8:11], s3 offen sc1
v_mov_b32 v2, 64
v_mov_b32 v3, 1
s_waitcnt vmcnt(0)
s_mov_b64 exec, 1
buffer_store_dword v3, v2, s[60:63], 0 offen sc1
s_mov_b64 exec, -1
L_w1e:
s_waitcnt vmcnt(0)
s_branch L_role
L_w0:
s_getreg_b32 s33, hwreg(HW_REG_XCC_ID, 0, 4)
s_sub_u32 s3, s33, 1
s_cmp_lt_u32 s3, 2
s_cselect_b32 s3, 3, 0
s_xor_b32 s33, s33, s3
s_and_b32 s3, s33, 1
s_lshl_b32 s3, s3, 7
s_lshr_b32 s4, s33, 1
s_lshl_b32 s4, s4, 2
s_add_u32 s3, s3, s4
v_mov_b32 v2, s3
s_getreg_b32 s4, hwreg(HW_REG_HW_ID, 13, 2)
s_lshl_b32 s4, s4, 3
s_lshl_b32 s4, 1, s4
v_mov_b32 v3, s4
s_mov_b64 exec, 1
buffer_atomic_add v3, v2, s[60:63], 0 offen sc0
s_waitcnt vmcnt(0)
s_mov_b64 exec, -1
v_sad_u8 v3, v3, 0, 0
s_nop 0
v_readfirstlane_b32 s34, v3
s_cmp_ge_u32 s33, 2
s_cbranch_scc1 L_other
s_cmp_ge_u32 s34, 32
s_cbranch_scc1 L_other
s_lshl_b32 s35, s33, 5
s_add_u32 s35, s35, s34
s_branch L_tell
L_other:
v_and_b32 v2, 1, v1
v_lshlrev_b32 v2, 7, v2
v_bfe_u32 v3, v1, 1, 3
v_lshl_add_u32 v2, v3, 2, v2
s_sleep 16
L_cen:
buffer_load_dword v3, v2, s[60:63], 0 offen sc1
s_waitcnt vmcnt(0)
v_sad_u8 v3, v3, 0, 0
s_mov_b32 s32, 0
v_readlane_b32 s64, v3, 0
v_readlane_b32 s65, v3, 1
v_readlane_b32 s66, v3, 2
v_readlane_b32 s67, v3, 3
v_readlane_b32 s68, v3, 4
v_readlane_b32 s69, v3, 5
v_readlane_b32 s70, v3, 6
v_readlane_b32 s71, v3, 7
v_readlane_b32 s72, v3, 8
v_readlane_b32 s73, v3, 9
v_readlane_b32 s74, v3, 10
v_readlane_b32 s75, v3, 11
v_readlane_b32 s76, v3, 12
v_readlane_b32 s77, v3, 13
v_readlane_b32 s78, v3, 14
v_readlane_b32 s79, v3, 15
s_add_u32 s32, s32, s64
s_add_u32 s32, s32, s65
s_add_u32 s32, s32, s66
s_add_u32 s32, s32, s67
s_add_u32 s32, s32, s68
s_add_u32 s32, s32, s69
s_add_u32 s32, s32, s70
s_add_u32 s32, s32, s71
s_add_u32 s32, s32, s72
s_add_u32 s32, s32, s73
s_add_u32 s32, s32, s74
s_add_u32 s32, s32, s75
s_add_u32 s32, s32, s76
s_add_u32 s32, s32, s77
s_add_u32 s32, s32, s78
s_add_u32 s32, s32, s79
s_cmp_ge_u32 s32, 256
s_cbranch_scc1 L_cen_ok
s_add_u32 s57, s57, 1
s_cmp_gt_u32 s57, 0x40000
s_cbranch_scc1 L_fail
s_sleep 16
s_branch L_cen
L_cen_ok:
s_min_u32 s36, s64, 32
s_min_u32 s37, s65, 32
s_sub_u32 s64, s64, s36
s_sub_u32 s65, s65, s37
s_cmp_lt_u32 s33, 2
s_cselect_b32 s3, 32, 0
s_sub_u32 s35, s34, s3
s_cmp_gt_u32 s33, 0
s_cselect_b32 s3, s64, 0
s_add_u32 s35, s35, s3
s_cmp_gt_u32 s33, 1
s_cselect_b32 s3, s65, 0
s_add_u32 s35, s35, s3
s_cmp_gt_u32 s33, 2
s_cselect_b32 s3, s66, 0
s_add_u32 s35, s35, s3
s_cmp_gt_u32 s33, 3
s_cselect_b32 s3, s67, 0
s_add_u32 s35, s35, s3
s_cmp_gt_u32 s33, 4
s_cselect_b32 s3, s68, 0
s_add_u32 s35, s35, s3
s_cmp_gt_u32 s33, 5
s_cselect_b32 s3, s69, 0
s_add_u32 s35, s35, s3
s_cmp_gt_u32 s33, 6
s_cselect_b32 s3, s70, 0
s_add_u32 s35, s35, s3
s_cmp_gt_u32 s33, 7
s_cselect_b32 s3, s71, 0
s_add_u32 s35, s35, s3
s_cmp_gt_u32 s33, 8
s_cselect_b32 s3, s72, 0
s_add_u32 s35, s35, s3
s_cmp_gt_u32 s33, 9
s_cselect_b32 s3, s73, 0
s_add_u32 s35, s35, s3
s_cmp_gt_u32 s33, 10
s_cselect_b32 s3, s74, 0
s_add_u32 s35, s35, s3
s_cmp_gt_u32 s33, 11
s_cselect_b32 s3, s75, 0
s_add_u32 s35, s35, s3
s_cmp_gt_u32 s33, 12
s_cselect_b32 s3, s76, 0
s_add_u32 s35, s35, s3
s_cmp_gt_u32 s33, 13
s_cselect_b32 s3, s77, 0
s_add_u32 s35, s35, s3
s_cmp_gt_u32 s33, 14
s_cselect_b32 s3, s78, 0
s_add_u32 s35, s35, s3
s_add_u32 s35, s35, s36
s_cmp_lt_u32 s35, 32
s_cbranch_scc1 L_tell
s_add_u32 s35, s35, s37
L_tell:
v_mov_b32 v2, 0
v_mov_b32 v3, s35
ds_write_b32 v2, v3
s_waitcnt lgkmcnt(0)
L_role:
s_barrier
v_mov_b32 v2, 0
ds_read_b32 v3, v2
s_waitcnt lgkmcnt(0)
v_readfirstlane_b32 s35, v3
s_barrier
s_cmp_lt_u32 s35, 64
s_cbranch_scc1 L_chain
v_mov_b32 v0, v1
s_sub_u32 s35, s35, 64
s_lshr_b32 s36, s35, 5
s_and_b32 s37, s35, 31
s_cmp_ge_u32 s36, 3
s_cbranch_scc1 L_far
s_cmp_ge_u32 s37, 20
s_cbranch_scc1 L_rest
s_mul_i32 s16, s36, 20
s_add_u32 s16, s16, s37
s_mov_b32 s18, s16
s_mov_b32 s19, 0
s_branch L_ln
L_rest:
s_mul_i32 s36, s36, 12
s_add_u32 s36, s36, s37
s_sub_u32 s16, s36, 20
s_branch L_g1
L_far:
s_sub_u32 s36, s36, 3
s_cmp_eq_u32 s36, 2
s_cselect_b32 s38, 8, 10
s_cmp_ge_u32 s37, s38
s_cbranch_scc1 L_split
s_mul_i32 s36, s36, 10
s_add_u32 s36, s36, s37
s_add_u32 s16, s36, 36
s_branch L_g1
L_split:
s_mul_i32 s36, s36, 22
s_add_u32 s36, s36, s37
s_sub_u32 s36, s36, s38
s_add_u32 s16, s36, 64
s_cmp_lt_u32 s36, 46
s_cbranch_scc1 L_g1
s_sub_u32 s16, s36, 46
s_add_u32 s18, s36, 14
s_mov_b32 s19, 1
s_cmp_ge_u32 s18, 64
s_cbranch_scc1 L_att
L_ln:
s_load_dwordx2 s[12:13], s[0:1], 0
s_mov_b32 s14, 2621440
s_mov_b32 s15, 0x20000
v_lshrrev_b32 v1, 4, v0
v_and_b32 v2, 15, v0
v_mul_u32_u24 v3, 1280, v1
v_lshl_add_u32 v3, v2, 4, v3
v_lshrrev_b32 v4, 2, v2
v_lshlrev_b32 v4, 10, v4
v_and_b32 v5, 3, v2
v_lshl_add_u32 v4, v5, 8, v4
v_lshl_add_u32 v4, v1, 4, v4
s_lshl_b32 s32, s18, 5
s_lshl_b32 s33, s17, 3
s_add_u32 s32, s32, s33
s_mul_i32 s33, s32, 1280
s_lshr_b32 s34, s32, 4
s_mul_i32 s34, s34, 20480
s_and_b32 s35, s32, 15
s_lshl_b32 s35, s35, 4
s_add_u32 s34, s34, s35
s_add_u32 s34, s34, 4194304
s_add_u32 s35, s33, 5120
s_mov_b32 s36, 0xffff0000
s_waitcnt lgkmcnt(0)
buffer_load_dwordx4 v[8:11], v3, s[12:15], s33 offen offset:0
buffer_load_dwordx4 v[12:15], v3, s[12:15], s33 offen offset:256
buffer_load_dwordx4 v[16:19], v3, s[12:15], s33 offen offset:512
buffer_load_dwordx4 v[20:23], v3, s[12:15], s33 offen offset:768
buffer_load_dwordx4 v[24:27], v3, s[12:15], s33 offen offset:1024
buffer_load_dwordx4 v[28:31], v3, s[12:15], s35 offen offset:0
buffer_load_dwordx4 v[32:35], v3, s[12:15], s35 offen offset:256
buffer_load_dwordx4 v[36:39], v3, s[12:15], s35 offen offset:512
buffer_load_dwordx4 v[40:43], v3, s[12:15], s35 offen offset:768
buffer_load_dwordx4 v[44:47], v3, s[12:15], s35 offen offset:1024
s_waitcnt vmcnt(9)
v_lshlrev_b32 v48, 16, v8
v_and_b32 v49, s36, v8
v_lshlrev_b32 v50, 16, v9
v_and_b32 v51, s36, v9
v_lshlrev_b32 v52, 16, v10
v_and_b32 v53, s36, v10
v_lshlrev_b32 v54, 16, v11
v_and_b32 v55, s36, v11
s_waitcnt vmcnt(8)
v_lshlrev_b32 v56, 16, v12
v_and_b32 v57, s36, v12
v_lshlrev_b32 v58, 16, v13
v_and_b32 v59, s36, v13
v_lshlrev_b32 v60, 16, v14
v_and_b32 v61, s36, v14
v_lshlrev_b32 v62, 16, v15
v_and_b32 v63, s36, v15
s_waitcnt vmcnt(7)
v_lshlrev_b32 v64, 16, v16
v_and_b32 v65, s36, v16
v_lshlrev_b32 v66, 16, v17
v_and_b32 v67, s36, v17
v_lshlrev_b32 v68, 16, v18
v_and_b32 v69, s36, v18
v_lshlrev_b32 v70, 16, v19
v_and_b32 v71, s36, v19
s_waitcnt vmcnt(6)
v_lshlrev_b32 v72, 16, v20
v_and_b32 v73, s36, v20
v_lshlrev_b32 v74, 16, v21
v_and_b32 v75, s36, v21
v_lshlrev_b32 v76, 16, v22
v_and_b32 v77, s36, v22
v_lshlrev_b32 v78, 16, v23
v_and_b32 v79, s36, v23
s_waitcnt vmcnt(5)
v_lshlrev_b32 v80, 16, v24
v_and_b32 v81, s36, v24
v_lshlrev_b32 v82, 16, v25
v_and_b32 v83, s36, v25
v_lshlrev_b32 v84, 16, v26
v_and_b32 v85, s36, v26
v_lshlrev_b32 v86, 16, v27
v_and_b32 v87, s36, v27
v_add_f32 v5, v48, v49
v_add_f32 v6, v50, v51
v_add_f32 v5, v5, v52
v_add_f32 v6, v6, v53
v_add_f32 v5, v5, v54
v_add_f32 v6, v6, v55
v_add_f32 v5, v5, v56
v_add_f32 v6, v6, v57
v_add_f32 v5, v5, v58
v_add_f32 v6, v6, v59
v_add_f32 v5, v5, v60
v_add_f32 v6, v6, v61
v_add_f32 v5, v5, v62
v_add_f32 v6, v6, v63
v_add_f32 v5, v5, v64
v_add_f32 v6, v6, v65
v_add_f32 v5, v5, v66
v_add_f32 v6, v6, v67
v_add_f32 v5, v5, v68
v_add_f32 v6, v6, v69
v_add_f32 v5, v5, v70
v_add_f32 v6, v6, v71
v_add_f32 v5, v5, v72
v_add_f32 v6, v6, v73
v_add_f32 v5, v5, v74
v_add_f32 v6, v6, v75
v_add_f32 v5, v5, v76
v_add_f32 v6, v6, v77
v_add_f32 v5, v5, v78
v_add_f32 v6, v6, v79
v_add_f32 v5, v5, v80
v_add_f32 v6, v6, v81
v_add_f32 v5, v5, v82
v_add_f32 v6, v6, v83
v_add_f32 v5, v5, v84
v_add_f32 v6, v6, v85
v_add_f32 v5, v5, v86
v_add_f32 v6, v6, v87
v_add_f32 v5, v5, v6
s_nop 1
v_add_f32_dpp v5, v5, v5 row_ror:8 row_mask:0xf bank_mask:0xf
s_nop 1
v_add_f32_dpp v5, v5, v5 row_ror:4 row_mask:0xf bank_mask:0xf
s_nop 1
v_add_f32_dpp v5, v5, v5 row_ror:2 row_mask:0xf bank_mask:0xf
s_nop 1
v_add_f32_dpp v5, v5, v5 row_ror:1 row_mask:0xf bank_mask:0xf
v_mul_f32 v5, 0x3acccccd, v5
v_mov_b32 v6, 0
v_mov_b32 v7, 0
v_sub_f32 v88, v48, v5
v_sub_f32 v89, v49, v5
v_fmac_f32 v6, v88, v88
v_fmac_f32 v7, v89, v89
v_sub_f32 v88, v50, v5
v_sub_f32 v89, v51, v5
v_fmac_f32 v6, v88, v88
v_fmac_f32 v7, v89, v89
v_sub_f32 v88, v52, v5
v_sub_f32 v89, v53, v5
v_fmac_f32 v6, v88, v88
v_fmac_f32 v7, v89, v89
v_sub_f32 v88, v54, v5
v_sub_f32 v89, v55, v5
v_fmac_f32 v6, v88, v88
v_fmac_f32 v7, v89, v89
v_sub_f32 v88, v56, v5
v_sub_f32 v89, v57, v5
v_fmac_f32 v6, v88, v88
v_fmac_f32 v7, v89, v89
v_sub_f32 v88, v58, v5
v_sub_f32 v89, v59, v5
v_fmac_f32 v6, v88, v88
v_fmac_f32 v7, v89, v89
v_sub_f32 v88, v60, v5
v_sub_f32 v89, v61, v5
v_fmac_f32 v6, v88, v88
v_fmac_f32 v7, v89, v89
v_sub_f32 v88, v62, v5
v_sub_f32 v89, v63, v5
v_fmac_f32 v6, v88, v88
v_fmac_f32 v7, v89, v89
v_sub_f32 v88, v64, v5
v_sub_f32 v89, v65, v5
v_fmac_f32 v6, v88, v88
v_fmac_f32 v7, v89, v89
v_sub_f32 v88, v66, v5
v_sub_f32 v89, v67, v5
v_fmac_f32 v6, v88, v88
v_fmac_f32 v7, v89, v89
v_sub_f32 v88, v68, v5
v_sub_f32 v89, v69, v5
v_fmac_f32 v6, v88, v88
v_fmac_f32 v7, v89, v89
v_sub_f32 v88, v70, v5
v_sub_f32 v89, v71, v5
v_fmac_f32 v6, v88, v88
v_fmac_f32 v7, v89, v89
v_sub_f32 v88, v72, v5
v_sub_f32 v89, v73, v5
v_fmac_f32 v6, v88, v88
v_fmac_f32 v7, v89, v89
v_sub_f32 v88, v74, v5
v_sub_f32 v89, v75, v5
v_fmac_f32 v6, v88, v88
v_fmac_f32 v7, v89, v89
v_sub_f32 v88, v76, v5
v_sub_f32 v89, v77, v5
v_fmac_f32 v6, v88, v88
v_fmac_f32 v7, v89, v89
v_sub_f32 v88, v78, v5
v_sub_f32 v89, v79, v5
v_fmac_f32 v6, v88, v88
v_fmac_f32 v7, v89, v89
v_sub_f32 v88, v80, v5
v_sub_f32 v89, v81, v5
v_fmac_f32 v6, v88, v88
v_fmac_f32 v7, v89, v89
v_sub_f32 v88, v82, v5
v_sub_f32 v89, v83, v5
v_fmac_f32 v6, v88, v88
v_fmac_f32 v7, v89, v89
v_sub_f32 v88, v84, v5
v_sub_f32 v89, v85, v5
v_fmac_f32 v6, v88, v88
v_fmac_f32 v7, v89, v89
v_sub_f32 v88, v86, v5
v_sub_f32 v89, v87, v5
v_fmac_f32 v6, v88, v88
v_fmac_f32 v7, v89, v89
v_add_f32 v6, v6, v7
s_nop 1
v_add_f32_dpp v6, v6, v6 row_ror:8 row_mask:0xf bank_mask:0xf
s_nop 1
v_add_f32_dpp v6, v6, v6 row_ror:4 row_mask:0xf bank_mask:0xf
s_nop 1
v_add_f32_dpp v6, v6, v6 row_ror:2 row_mask:0xf bank_mask:0xf
s_nop 1
v_add_f32_dpp v6, v6, v6 row_ror:1 row_mask:0xf bank_mask:0xf
v_mul_f32 v6, 0x3acccccd, v6
v_cvt_pk_bf16_f32 v7, v5, v6
v_lshlrev_b32 v5, 16, v7
v_and_b32 v6, s36, v7
v_add_f32 v6, 0x3727c5ac, v6
v_cvt_pk_bf16_f32 v6, v6, v6
v_and_b32 v6, s36, v6
v_sqrt_f32 v6, v6
s_nop 0
v_cvt_pk_bf16_f32 v6, v6, v6
v_and_b32 v6, s36, v6
v_rcp_f32 v6, v6
v_sub_f32 v48, v48, v5
v_sub_f32 v49, v49, v5
v_cvt_pk_bf16_f32 v49, v48, v49
v_lshlrev_b32 v48, 16, v49
v_and_b32 v49, s36, v49
v_mul_f32 v48, v48, v6
v_mul_f32 v49, v49, v6
v_cvt_pk_bf16_f32 v8, v48, v49
v_sub_f32 v50, v50, v5
v_sub_f32 v51, v51, v5
v_cvt_pk_bf16_f32 v51, v50, v51
v_lshlrev_b32 v50, 16, v51
v_and_b32 v51, s36, v51
v_mul_f32 v50, v50, v6
v_mul_f32 v51, v51, v6
v_cvt_pk_bf16_f32 v9, v50, v51
v_sub_f32 v52, v52, v5
v_sub_f32 v53, v53, v5
v_cvt_pk_bf16_f32 v53, v52, v53
v_lshlrev_b32 v52, 16, v53
v_and_b32 v53, s36, v53
v_mul_f32 v52, v52, v6
v_mul_f32 v53, v53, v6
v_cvt_pk_bf16_f32 v10, v52, v53
v_sub_f32 v54, v54, v5
v_sub_f32 v55, v55, v5
v_cvt_pk_bf16_f32 v55, v54, v55
v_lshlrev_b32 v54, 16, v55
v_and_b32 v55, s36, v55
v_mul_f32 v54, v54, v6
v_mul_f32 v55, v55, v6
v_cvt_pk_bf16_f32 v11, v54, v55
v_sub_f32 v56, v56, v5
v_sub_f32 v57, v57, v5
v_cvt_pk_bf16_f32 v57, v56, v57
v_lshlrev_b32 v56, 16, v57
v_and_b32 v57, s36, v57
v_mul_f32 v56, v56, v6
v_mul_f32 v57, v57, v6
v_cvt_pk_bf16_f32 v12, v56, v57
v_sub_f32 v58, v58, v5
v_sub_f32 v59, v59, v5
v_cvt_pk_bf16_f32 v59, v58, v59
v_lshlrev_b32 v58, 16, v59
v_and_b32 v59, s36, v59
v_mul_f32 v58, v58, v6
v_mul_f32 v59, v59, v6
v_cvt_pk_bf16_f32 v13, v58, v59
v_sub_f32 v60, v60, v5
v_sub_f32 v61, v61, v5
v_cvt_pk_bf16_f32 v61, v60, v61
v_lshlrev_b32 v60, 16, v61
v_and_b32 v61, s36, v61
v_mul_f32 v60, v60, v6
v_mul_f32 v61, v61, v6
v_cvt_pk_bf16_f32 v14, v60, v61
v_sub_f32 v62, v62, v5
v_sub_f32 v63, v63, v5
v_cvt_pk_bf16_f32 v63, v62, v63
v_lshlrev_b32 v62, 16, v63
v_and_b32 v63, s36, v63
v_mul_f32 v62, v62, v6
v_mul_f32 v63, v63, v6
v_cvt_pk_bf16_f32 v15, v62, v63
v_sub_f32 v64, v64, v5
v_sub_f32 v65, v65, v5
v_cvt_pk_bf16_f32 v65, v64, v65
v_lshlrev_b32 v64, 16, v65
v_and_b32 v65, s36, v65
v_mul_f32 v64, v64, v6
v_mul_f32 v65, v65, v6
v_cvt_pk_bf16_f32 v16, v64, v65
v_sub_f32 v66, v66, v5
v_sub_f32 v67, v67, v5
v_cvt_pk_bf16_f32 v67, v66, v67
v_lshlrev_b32 v66, 16, v67
v_and_b32 v67, s36, v67
v_mul_f32 v66, v66, v6
v_mul_f32 v67, v67, v6
v_cvt_pk_bf16_f32 v17, v66, v67
v_sub_f32 v68, v68, v5
v_sub_f32 v69, v69, v5
v_cvt_pk_bf16_f32 v69, v68, v69
v_lshlrev_b32 v68, 16, v69
v_and_b32 v69, s36, v69
v_mul_f32 v68, v68, v6
v_mul_f32 v69, v69, v6
v_cvt_pk_bf16_f32 v18, v68, v69
v_sub_f32 v70, v70, v5
v_sub_f32 v71, v71, v5
v_cvt_pk_bf16_f32 v71, v70, v71
v_lshlrev_b32 v70, 16, v71
v_and_b32 v71, s36, v71
v_mul_f32 v70, v70, v6
v_mul_f32 v71, v71, v6
v_cvt_pk_bf16_f32 v19, v70, v71
v_sub_f32 v72, v72, v5
v_sub_f32 v73, v73, v5
v_cvt_pk_bf16_f32 v73, v72, v73
v_lshlrev_b32 v72, 16, v73
v_and_b32 v73, s36, v73
v_mul_f32 v72, v72, v6
v_mul_f32 v73, v73, v6
v_cvt_pk_bf16_f32 v20, v72, v73
v_sub_f32 v74, v74, v5
v_sub_f32 v75, v75, v5
v_cvt_pk_bf16_f32 v75, v74, v75
v_lshlrev_b32 v74, 16, v75
v_and_b32 v75, s36, v75
v_mul_f32 v74, v74, v6
v_mul_f32 v75, v75, v6
v_cvt_pk_bf16_f32 v21, v74, v75
v_sub_f32 v76, v76, v5
v_sub_f32 v77, v77, v5
v_cvt_pk_bf16_f32 v77, v76, v77
v_lshlrev_b32 v76, 16, v77
v_and_b32 v77, s36, v77
v_mul_f32 v76, v76, v6
v_mul_f32 v77, v77, v6
v_cvt_pk_bf16_f32 v22, v76, v77
v_sub_f32 v78, v78, v5
v_sub_f32 v79, v79, v5
v_cvt_pk_bf16_f32 v79, v78, v79
v_lshlrev_b32 v78, 16, v79
v_and_b32 v79, s36, v79
v_mul_f32 v78, v78, v6
v_mul_f32 v79, v79, v6
v_cvt_pk_bf16_f32 v23, v78, v79
v_sub_f32 v80, v80, v5
v_sub_f32 v81, v81, v5
v_cvt_pk_bf16_f32 v81, v80, v81
v_lshlrev_b32 v80, 16, v81
v_and_b32 v81, s36, v81
v_mul_f32 v80, v80, v6
v_mul_f32 v81, v81, v6
v_cvt_pk_bf16_f32 v24, v80, v81
v_sub_f32 v82, v82, v5
v_sub_f32 v83, v83, v5
v_cvt_pk_bf16_f32 v83, v82, v83
v_lshlrev_b32 v82, 16, v83
v_and_b32 v83, s36, v83
v_mul_f32 v82, v82, v6
v_mul_f32 v83, v83, v6
v_cvt_pk_bf16_f32 v25, v82, v83
v_sub_f32 v84, v84, v5
v_sub_f32 v85, v85, v5
v_cvt_pk_bf16_f32 v85, v84, v85
v_lshlrev_b32 v84, 16, v85
v_and_b32 v85, s36, v85
v_mul_f32 v84, v84, v6
v_mul_f32 v85, v85, v6
v_cvt_pk_bf16_f32 v26, v84, v85
v_sub_f32 v86, v86, v5
v_sub_f32 v87, v87, v5
v_cvt_pk_bf16_f32 v87, v86, v87
v_lshlrev_b32 v86, 16, v87
v_and_b32 v87, s36, v87
v_mul_f32 v86, v86, v6
v_mul_f32 v87, v87, v6
v_cvt_pk_bf16_f32 v27, v86, v87
s_add_u32 s37, s34, 0
buffer_store_dwordx4 v[8:11], v4, s[8:11], s37 offen sc1
s_add_u32 s37, s34, 4096
buffer_store_dwordx4 v[12:15], v4, s[8:11], s37 offen sc1
s_add_u32 s37, s34, 8192
buffer_store_dwordx4 v[16:19], v4, s[8:11], s37 offen sc1
s_add_u32 s37, s34, 12288
buffer_store_dwordx4 v[20:23], v4, s[8:11], s37 offen sc1
s_add_u32 s37, s34, 16384
buffer_store_dwordx4 v[24:27], v4, s[8:11], s37 offen sc1
s_waitcnt vmcnt(9)
v_lshlrev_b32 v48, 16, v28
v_and_b32 v49, s36, v28
v_lshlrev_b32 v50, 16, v29
v_and_b32 v51, s36, v29
v_lshlrev_b32 v52, 16, v30
v_and_b32 v53, s36, v30
v_lshlrev_b32 v54, 16, v31
v_and_b32 v55, s36, v31
s_waitcnt vmcnt(8)
v_lshlrev_b32 v56, 16, v32
v_and_b32 v57, s36, v32
v_lshlrev_b32 v58, 16, v33
v_and_b32 v59, s36, v33
v_lshlrev_b32 v60, 16, v34
v_and_b32 v61, s36, v34
v_lshlrev_b32 v62, 16, v35
v_and_b32 v63, s36, v35
s_waitcnt vmcnt(7)
v_lshlrev_b32 v64, 16, v36
v_and_b32 v65, s36, v36
v_lshlrev_b32 v66, 16, v37
v_and_b32 v67, s36, v37
v_lshlrev_b32 v68, 16, v38
v_and_b32 v69, s36, v38
v_lshlrev_b32 v70, 16, v39
v_and_b32 v71, s36, v39
s_waitcnt vmcnt(6)
v_lshlrev_b32 v72, 16, v40
v_and_b32 v73, s36, v40
v_lshlrev_b32 v74, 16, v41
v_and_b32 v75, s36, v41
v_lshlrev_b32 v76, 16, v42
v_and_b32 v77, s36, v42
v_lshlrev_b32 v78, 16, v43
v_and_b32 v79, s36, v43
s_waitcnt vmcnt(5)
v_lshlrev_b32 v80, 16, v44
v_and_b32 v81, s36, v44
v_lshlrev_b32 v82, 16, v45
v_and_b32 v83, s36, v45
v_lshlrev_b32 v84, 16, v46
v_and_b32 v85, s36, v46
v_lshlrev_b32 v86, 16, v47
v_and_b32 v87, s36, v47
v_add_f32 v5, v48, v49
v_add_f32 v6, v50, v51
v_add_f32 v5, v5, v52
v_add_f32 v6, v6, v53
v_add_f32 v5, v5, v54
v_add_f32 v6, v6, v55
v_add_f32 v5, v5, v56
v_add_f32 v6, v6, v57
v_add_f32 v5, v5, v58
v_add_f32 v6, v6, v59
v_add_f32 v5, v5, v60
v_add_f32 v6, v6, v61
v_add_f32 v5, v5, v62
v_add_f32 v6, v6, v63
v_add_f32 v5, v5, v64
v_add_f32 v6, v6, v65
v_add_f32 v5, v5, v66
v_add_f32 v6, v6, v67
v_add_f32 v5, v5, v68
v_add_f32 v6, v6, v69
v_add_f32 v5, v5, v70
v_add_f32 v6, v6, v71
v_add_f32 v5, v5, v72
v_add_f32 v6, v6, v73
v_add_f32 v5, v5, v74
v_add_f32 v6, v6, v75
v_add_f32 v5, v5, v76
v_add_f32 v6, v6, v77
v_add_f32 v5, v5, v78
v_add_f32 v6, v6, v79
v_add_f32 v5, v5, v80
v_add_f32 v6, v6, v81
v_add_f32 v5, v5, v82
v_add_f32 v6, v6, v83
v_add_f32 v5, v5, v84
v_add_f32 v6, v6, v85
v_add_f32 v5, v5, v86
v_add_f32 v6, v6, v87
v_add_f32 v5, v5, v6
s_nop 1
v_add_f32_dpp v5, v5, v5 row_ror:8 row_mask:0xf bank_mask:0xf
s_nop 1
v_add_f32_dpp v5, v5, v5 row_ror:4 row_mask:0xf bank_mask:0xf
s_nop 1
v_add_f32_dpp v5, v5, v5 row_ror:2 row_mask:0xf bank_mask:0xf
s_nop 1
v_add_f32_dpp v5, v5, v5 row_ror:1 row_mask:0xf bank_mask:0xf
v_mul_f32 v5, 0x3acccccd, v5
v_mov_b32 v6, 0
v_mov_b32 v7, 0
v_sub_f32 v88, v48, v5
v_sub_f32 v89, v49, v5
v_fmac_f32 v6, v88, v88
v_fmac_f32 v7, v89, v89
v_sub_f32 v88, v50, v5
v_sub_f32 v89, v51, v5
v_fmac_f32 v6, v88, v88
v_fmac_f32 v7, v89, v89
v_sub_f32 v88, v52, v5
v_sub_f32 v89, v53, v5
v_fmac_f32 v6, v88, v88
v_fmac_f32 v7, v89, v89
v_sub_f32 v88, v54, v5
v_sub_f32 v89, v55, v5
v_fmac_f32 v6, v88, v88
v_fmac_f32 v7, v89, v89
v_sub_f32 v88, v56, v5
v_sub_f32 v89, v57, v5
v_fmac_f32 v6, v88, v88
v_fmac_f32 v7, v89, v89
v_sub_f32 v88, v58, v5
v_sub_f32 v89, v59, v5
v_fmac_f32 v6, v88, v88
v_fmac_f32 v7, v89, v89
v_sub_f32 v88, v60, v5
v_sub_f32 v89, v61, v5
v_fmac_f32 v6, v88, v88
v_fmac_f32 v7, v89, v89
v_sub_f32 v88, v62, v5
v_sub_f32 v89, v63, v5
v_fmac_f32 v6, v88, v88
v_fmac_f32 v7, v89, v89
v_sub_f32 v88, v64, v5
v_sub_f32 v89, v65, v5
v_fmac_f32 v6, v88, v88
v_fmac_f32 v7, v89, v89
v_sub_f32 v88, v66, v5
v_sub_f32 v89, v67, v5
v_fmac_f32 v6, v88, v88
v_fmac_f32 v7, v89, v89
v_sub_f32 v88, v68, v5
v_sub_f32 v89, v69, v5
v_fmac_f32 v6, v88, v88
v_fmac_f32 v7, v89, v89
v_sub_f32 v88, v70, v5
v_sub_f32 v89, v71, v5
v_fmac_f32 v6, v88, v88
v_fmac_f32 v7, v89, v89
v_sub_f32 v88, v72, v5
v_sub_f32 v89, v73, v5
v_fmac_f32 v6, v88, v88
v_fmac_f32 v7, v89, v89
v_sub_f32 v88, v74, v5
v_sub_f32 v89, v75, v5
v_fmac_f32 v6, v88, v88
v_fmac_f32 v7, v89, v89
v_sub_f32 v88, v76, v5
v_sub_f32 v89, v77, v5
v_fmac_f32 v6, v88, v88
v_fmac_f32 v7, v89, v89
v_sub_f32 v88, v78, v5
v_sub_f32 v89, v79, v5
v_fmac_f32 v6, v88, v88
v_fmac_f32 v7, v89, v89
v_sub_f32 v88, v80, v5
v_sub_f32 v89, v81, v5
v_fmac_f32 v6, v88, v88
v_fmac_f32 v7, v89, v89
v_sub_f32 v88, v82, v5
v_sub_f32 v89, v83, v5
v_fmac_f32 v6, v88, v88
v_fmac_f32 v7, v89, v89
v_sub_f32 v88, v84, v5
v_sub_f32 v89, v85, v5
v_fmac_f32 v6, v88, v88
v_fmac_f32 v7, v89, v89
v_sub_f32 v88, v86, v5
v_sub_f32 v89, v87, v5
v_fmac_f32 v6, v88, v88
v_fmac_f32 v7, v89, v89
v_add_f32 v6, v6, v7
s_nop 1
v_add_f32_dpp v6, v6, v6 row_ror:8 row_mask:0xf bank_mask:0xf
s_nop 1
v_add_f32_dpp v6, v6, v6 row_ror:4 row_mask:0xf bank_mask:0xf
s_nop 1
v_add_f32_dpp v6, v6, v6 row_ror:2 row_mask:0xf bank_mask:0xf
s_nop 1
v_add_f32_dpp v6, v6, v6 row_ror:1 row_mask:0xf bank_mask:0xf
v_mul_f32 v6, 0x3acccccd, v6
v_cvt_pk_bf16_f32 v7, v5, v6
v_lshlrev_b32 v5, 16, v7
v_and_b32 v6, s36, v7
v_add_f32 v6, 0x3727c5ac, v6
v_cvt_pk_bf16_f32 v6, v6, v6
v_and_b32 v6, s36, v6
v_sqrt_f32 v6, v6
s_nop 0
v_cvt_pk_bf16_f32 v6, v6, v6
v_and_b32 v6, s36, v6
v_rcp_f32 v6, v6
v_sub_f32 v48, v48, v5
v_sub_f32 v49, v49, v5
v_cvt_pk_bf16_f32 v49, v48, v49
v_lshlrev_b32 v48, 16, v49
v_and_b32 v49, s36, v49
v_mul_f32 v48, v48, v6
v_mul_f32 v49, v49, v6
v_cvt_pk_bf16_f32 v28, v48, v49
v_sub_f32 v50, v50, v5
v_sub_f32 v51, v51, v5
v_cvt_pk_bf16_f32 v51, v50, v51
v_lshlrev_b32 v50, 16, v51
v_and_b32 v51, s36, v51
v_mul_f32 v50, v50, v6
v_mul_f32 v51, v51, v6
v_cvt_pk_bf16_f32 v29, v50, v51
v_sub_f32 v52, v52, v5
v_sub_f32 v53, v53, v5
v_cvt_pk_bf16_f32 v53, v52, v53
v_lshlrev_b32 v52, 16, v53
v_and_b32 v53, s36, v53
v_mul_f32 v52, v52, v6
v_mul_f32 v53, v53, v6
v_cvt_pk_bf16_f32 v30, v52, v53
v_sub_f32 v54, v54, v5
v_sub_f32 v55, v55, v5
v_cvt_pk_bf16_f32 v55, v54, v55
v_lshlrev_b32 v54, 16, v55
v_and_b32 v55, s36, v55
v_mul_f32 v54, v54, v6
v_mul_f32 v55, v55, v6
v_cvt_pk_bf16_f32 v31, v54, v55
v_sub_f32 v56, v56, v5
v_sub_f32 v57, v57, v5
v_cvt_pk_bf16_f32 v57, v56, v57
v_lshlrev_b32 v56, 16, v57
v_and_b32 v57, s36, v57
v_mul_f32 v56, v56, v6
v_mul_f32 v57, v57, v6
v_cvt_pk_bf16_f32 v32, v56, v57
v_sub_f32 v58, v58, v5
v_sub_f32 v59, v59, v5
v_cvt_pk_bf16_f32 v59, v58, v59
v_lshlrev_b32 v58, 16, v59
v_and_b32 v59, s36, v59
v_mul_f32 v58, v58, v6
v_mul_f32 v59, v59, v6
v_cvt_pk_bf16_f32 v33, v58, v59
v_sub_f32 v60, v60, v5
v_sub_f32 v61, v61, v5
v_cvt_pk_bf16_f32 v61, v60, v61
v_lshlrev_b32 v60, 16, v61
v_and_b32 v61, s36, v61
v_mul_f32 v60, v60, v6
v_mul_f32 v61, v61, v6
v_cvt_pk_bf16_f32 v34, v60, v61
v_sub_f32 v62, v62, v5
v_sub_f32 v63, v63, v5
v_cvt_pk_bf16_f32 v63, v62, v63
v_lshlrev_b32 v62, 16, v63
v_and_b32 v63, s36, v63
v_mul_f32 v62, v62, v6
v_mul_f32 v63, v63, v6
v_cvt_pk_bf16_f32 v35, v62, v63
v_sub_f32 v64, v64, v5
v_sub_f32 v65, v65, v5
v_cvt_pk_bf16_f32 v65, v64, v65
v_lshlrev_b32 v64, 16, v65
v_and_b32 v65, s36, v65
v_mul_f32 v64, v64, v6
v_mul_f32 v65, v65, v6
v_cvt_pk_bf16_f32 v36, v64, v65
v_sub_f32 v66, v66, v5
v_sub_f32 v67, v67, v5
v_cvt_pk_bf16_f32 v67, v66, v67
v_lshlrev_b32 v66, 16, v67
v_and_b32 v67, s36, v67
v_mul_f32 v66, v66, v6
v_mul_f32 v67, v67, v6
v_cvt_pk_bf16_f32 v37, v66, v67
v_sub_f32 v68, v68, v5
v_sub_f32 v69, v69, v5
v_cvt_pk_bf16_f32 v69, v68, v69
v_lshlrev_b32 v68, 16, v69
v_and_b32 v69, s36, v69
v_mul_f32 v68, v68, v6
v_mul_f32 v69, v69, v6
v_cvt_pk_bf16_f32 v38, v68, v69
v_sub_f32 v70, v70, v5
v_sub_f32 v71, v71, v5
v_cvt_pk_bf16_f32 v71, v70, v71
v_lshlrev_b32 v70, 16, v71
v_and_b32 v71, s36, v71
v_mul_f32 v70, v70, v6
v_mul_f32 v71, v71, v6
v_cvt_pk_bf16_f32 v39, v70, v71
v_sub_f32 v72, v72, v5
v_sub_f32 v73, v73, v5
v_cvt_pk_bf16_f32 v73, v72, v73
v_lshlrev_b32 v72, 16, v73
v_and_b32 v73, s36, v73
v_mul_f32 v72, v72, v6
v_mul_f32 v73, v73, v6
v_cvt_pk_bf16_f32 v40, v72, v73
v_sub_f32 v74, v74, v5
v_sub_f32 v75, v75, v5
v_cvt_pk_bf16_f32 v75, v74, v75
v_lshlrev_b32 v74, 16, v75
v_and_b32 v75, s36, v75
v_mul_f32 v74, v74, v6
v_mul_f32 v75, v75, v6
v_cvt_pk_bf16_f32 v41, v74, v75
v_sub_f32 v76, v76, v5
v_sub_f32 v77, v77, v5
v_cvt_pk_bf16_f32 v77, v76, v77
v_lshlrev_b32 v76, 16, v77
v_and_b32 v77, s36, v77
v_mul_f32 v76, v76, v6
v_mul_f32 v77, v77, v6
v_cvt_pk_bf16_f32 v42, v76, v77
v_sub_f32 v78, v78, v5
v_sub_f32 v79, v79, v5
v_cvt_pk_bf16_f32 v79, v78, v79
v_lshlrev_b32 v78, 16, v79
v_and_b32 v79, s36, v79
v_mul_f32 v78, v78, v6
v_mul_f32 v79, v79, v6
v_cvt_pk_bf16_f32 v43, v78, v79
v_sub_f32 v80, v80, v5
v_sub_f32 v81, v81, v5
v_cvt_pk_bf16_f32 v81, v80, v81
v_lshlrev_b32 v80, 16, v81
v_and_b32 v81, s36, v81
v_mul_f32 v80, v80, v6
v_mul_f32 v81, v81, v6
v_cvt_pk_bf16_f32 v44, v80, v81
v_sub_f32 v82, v82, v5
v_sub_f32 v83, v83, v5
v_cvt_pk_bf16_f32 v83, v82, v83
v_lshlrev_b32 v82, 16, v83
v_and_b32 v83, s36, v83
v_mul_f32 v82, v82, v6
v_mul_f32 v83, v83, v6
v_cvt_pk_bf16_f32 v45, v82, v83
v_sub_f32 v84, v84, v5
v_sub_f32 v85, v85, v5
v_cvt_pk_bf16_f32 v85, v84, v85
v_lshlrev_b32 v84, 16, v85
v_and_b32 v85, s36, v85
v_mul_f32 v84, v84, v6
v_mul_f32 v85, v85, v6
v_cvt_pk_bf16_f32 v46, v84, v85
v_sub_f32 v86, v86, v5
v_sub_f32 v87, v87, v5
v_cvt_pk_bf16_f32 v87, v86, v87
v_lshlrev_b32 v86, 16, v87
v_and_b32 v87, s36, v87
v_mul_f32 v86, v86, v6
v_mul_f32 v87, v87, v6
v_cvt_pk_bf16_f32 v47, v86, v87
s_add_u32 s37, s34, 64
buffer_store_dwordx4 v[28:31], v4, s[8:11], s37 offen sc1
s_add_u32 s37, s34, 4160
buffer_store_dwordx4 v[32:35], v4, s[8:11], s37 offen sc1
s_add_u32 s37, s34, 8256
buffer_store_dwordx4 v[36:39], v4, s[8:11], s37 offen sc1
s_add_u32 s37, s34, 12352
buffer_store_dwordx4 v[40:43], v4, s[8:11], s37 offen sc1
s_add_u32 s37, s34, 16448
buffer_store_dwordx4 v[44:47], v4, s[8:11], s37 offen sc1
s_waitcnt vmcnt(0)
s_barrier
s_cmp_lg_u32 s17, 0
s_cbranch_scc1 L_lnsig
v_mov_b32 v2, 0x40
L_lnsig_z:
buffer_load_dword v3, v2, s[60:63], 0 offen sc1
s_waitcnt vmcnt(0)
v_cmp_gt_u32 vcc, 0x1, v3
s_cbranch_vccz L_lnsig_z_ok
s_add_u32 s57, s57, 1
s_cmp_gt_u32 s57, 0x40000
s_cbranch_scc1 L_fail
s_sleep 8
s_branch L_lnsig_z
L_lnsig_z_ok:
v_mov_b32 v2, 0x102500
v_mov_b32 v3, 1
s_mov_b64 exec, 1
buffer_atomic_add v3, v2, s[8:11], 0 offen
s_mov_b64 exec, -1
L_lnsig:
s_cmp_eq_u32 s19, 0
s_cbranch_scc1 L_out
L_att:
v_lshlrev_b32 v1, 4, v0
s_cmp_lg_u32 s16, 11
s_cbranch_scc1 AT_nocal
s_cmp_lg_u32 s17, 0
s_cbranch_scc1 AT_cal
v_mov_b32 v2, 0
s_mov_b64 exec, 1
s_mov_b32 s36, 0
s_mov_b32 s40, -1
s_mov_b32 s41, -1
s_mov_b32 s42, -1
s_mov_b32 s43, -1
AT_call:
s_mov_b32 s3, 121634816
s_memtime s[4:5]
s_waitcnt lgkmcnt(0)
buffer_store_dword v2, v2, s[8:11], s3 offen sc1
s_waitcnt vmcnt(0)
s_memtime s[6:7]
s_waitcnt lgkmcnt(0)
s_sub_u32 s6, s6, s4
s_min_u32 s40, s40, s6
s_mov_b32 s3, 121643008
s_memtime s[4:5]
s_waitcnt lgkmcnt(0)
buffer_store_dword v2, v2, s[8:11], s3 offen sc1
s_waitcnt vmcnt(0)
s_memtime s[6:7]
s_waitcnt lgkmcnt(0)
s_sub_u32 s6, s6, s4
s_min_u32 s41, s41, s6
s_mov_b32 s3, 121651200
s_memtime s[4:5]
s_waitcnt lgkmcnt(0)
buffer_store_dword v2, v2, s[8:11], s3 offen sc1
s_waitcnt vmcnt(0)
s_memtime s[6:7]
s_waitcnt lgkmcnt(0)
s_sub_u32 s6, s6, s4
s_min_u32 s42, s42, s6
s_mov_b32 s3, 121659392
s_memtime s[4:5]
s_waitcnt lgkmcnt(0)
buffer_store_dword v2, v2, s[8:11], s3 offen sc1
s_waitcnt vmcnt(0)
s_memtime s[6:7]
s_waitcnt lgkmcnt(0)
s_sub_u32 s6, s6, s4
s_min_u32 s43, s43, s6
s_add_u32 s36, s36, 1
s_cmp_lt_u32 s36, 5
s_cbranch_scc1 AT_call
s_mov_b32 s3, 0
s_cmp_lt_u32 s41, s40
s_cselect_b32 s3, 1, s3
s_min_u32 s40, s40, s41
s_cmp_lt_u32 s42, s40
s_cselect_b32 s3, 2, s3
s_min_u32 s40, s40, s42
s_cmp_lt_u32 s43, s40
s_cselect_b32 s3, 3, s3
s_min_u32 s40, s40, s43
s_getreg_b32 s4, hwreg(HW_REG_XCC_ID, 2, 1)
s_xor_b32 s3, s3, s4
s_getreg_b32 s4, hwreg(HW_REG_XCC_ID, 0, 1)
s_lshl_b32 s4, s4, 1
s_xor_b32 s3, s3, s4
s_add_u32 s3, s3, 4
s_mov_b64 exec, -1
v_mov_b32 v2, 0x40
AT_calz:
buffer_load_dword v3, v2, s[60:63], 0 offen sc1
s_waitcnt vmcnt(0)
v_cmp_gt_u32 vcc, 0x1, v3
s_cbranch_vccz AT_calz_ok
s_add_u32 s57, s57, 1
s_cmp_gt_u32 s57, 0x40000
s_cbranch_scc1 L_fail
s_sleep 8
s_branch AT_calz
AT_calz_ok:
v_mov_b32 v3, s3
v_mov_b32 v2, 0x102480
s_mov_b64 exec, 1
buffer_store_dword v3, v2, s[8:11], 0 offen sc1
s_mov_b64 exec, -1
AT_cal:
s_barrier
AT_nocal:
v_mov_b32 v8, -1
v_mov_b32 v9, -1
v_mov_b32 v10, -1
v_mov_b32 v11, -1
s_lshl_b32 s18, s16, 2
s_add_u32 s18, s18, s17
s_add_u32 s32, s18, 0
AT_p0:
s_cmp_ge_u32 s32, 102
s_cbranch_scc1 AT_p0_e
s_lshl_b32 s33, s32, 12
s_add_u32 s33, s33, 0
buffer_store_dwordx4 v[8:11], v1, s[8:11], s33 offen offset:0 sc1
buffer_store_dwordx4 v[8:11], v1, s[8:11], s33 offen offset:1024 sc1
buffer_store_dwordx4 v[8:11], v1, s[8:11], s33 offen offset:2048 sc1
buffer_store_dwordx4 v[8:11], v1, s[8:11], s33 offen offset:3072 sc1
s_add_u32 s32, s32, 88
s_branch AT_p0
AT_p0_e:
s_add_u32 s32, s18, 0
AT_p1:
s_cmp_ge_u32 s32, 102
s_cbranch_scc1 AT_p1_e
s_lshl_b32 s33, s32, 12
s_add_u32 s33, s33, 524288
buffer_store_dwordx4 v[8:11], v1, s[8:11], s33 offen offset:0 sc1
buffer_store_dwordx4 v[8:11], v1, s[8:11], s33 offen offset:1024 sc1
buffer_store_dwordx4 v[8:11], v1, s[8:11], s33 offen offset:2048 sc1
buffer_store_dwordx4 v[8:11], v1, s[8:11], s33 offen offset:3072 sc1
s_add_u32 s32, s32, 88
s_branch AT_p1
AT_p1_e:
s_add_u32 s32, s18, 0
AT_f:
s_cmp_ge_u32 s32, 64
s_cbranch_scc1 AT_f_e
s_lshl_b32 s33, s32, 12
s_add_u32 s33, s33, 1310720
buffer_store_dwordx4 v[8:11], v1, s[8:11], s33 offen offset:0 sc1
buffer_store_dwordx4 v[8:11], v1, s[8:11], s33 offen offset:1024 sc1
buffer_store_dwordx4 v[8:11], v1, s[8:11], s33 offen offset:2048 sc1
buffer_store_dwordx4 v[8:11], v1, s[8:11], s33 offen offset:3072 sc1
s_add_u32 s32, s32, 88
s_branch AT_f
AT_f_e:
v_mov_b32 v2, 0x40
AT_z:
buffer_load_dword v3, v2, s[60:63], 0 offen sc1
s_waitcnt vmcnt(0)
v_cmp_gt_u32 vcc, 0x1, v3
s_cbranch_vccz AT_z_ok
s_add_u32 s57, s57, 1
s_cmp_gt_u32 s57, 0x40000
s_cbranch_scc1 L_fail
s_sleep 8
s_branch AT_z
AT_z_ok:
v_mov_b32 v2, 0x102480
AT_par:
buffer_load_dword v3, v2, s[8:11], 0 offen sc1
s_waitcnt vmcnt(0)
v_cmp_gt_u32 vcc, 0x4, v3
s_cbranch_vccz AT_par_ok
s_add_u32 s57, s57, 1
s_cmp_gt_u32 s57, 0x40000
s_cbranch_scc1 L_fail
s_sleep 16
s_branch AT_par
AT_par_ok:
v_readfirstlane_b32 s26, v3
s_and_b32 s26, s26, 3
s_lshl_b32 s25, s26, 16
s_lshl_b32 s26, s26, 13
s_cmp_eq_u32 s16, 11
s_cselect_b32 s25, s25, 0
s_add_u32 s25, s25, 1
s_mov_b32 s32, s18
AT_r:
s_cmp_ge_u32 s32, 32
s_cbranch_scc1 AT_r_e
s_lshr_b32 s34, s32, 2
s_add_u32 s34, s34, 0
s_lshl_b32 s34, s34, 15
s_and_b32 s35, s32, 2
s_lshl_b32 s35, s35, 20
s_add_u32 s34, s34, s35
s_add_u32 s34, s34, 117440512
s_lshr_b32 s35, s34, 5
s_and_b32 s35, s35, 0x4000
s_lshr_b32 s33, s34, 8
s_and_b32 s33, s33, 0x2000
s_or_b32 s35, s35, s33
s_xor_b32 s35, s35, s26
s_add_u32 s33, s34, s35
s_and_b32 s35, s32, 1
s_lshl_b32 s35, s35, 12
s_add_u32 s33, s33, s35
buffer_store_dwordx4 v[8:11], v1, s[8:11], s33 offen offset:0 sc1
buffer_store_dwordx4 v[8:11], v1, s[8:11], s33 offen offset:1024 sc1
buffer_store_dwordx4 v[8:11], v1, s[8:11], s33 offen offset:2048 sc1
buffer_store_dwordx4 v[8:11], v1, s[8:11], s33 offen offset:3072 sc1
s_add_u32 s32, s32, 88
s_branch AT_r
AT_r_e:
s_waitcnt vmcnt(0)
s_barrier
s_cmp_lg_u32 s17, 0
s_cbranch_scc1 AT_sig
v_mov_b32 v2, 0x40
AT_sig_z:
buffer_load_dword v3, v2, s[60:63], 0 offen sc1
s_waitcnt vmcnt(0)
v_cmp_gt_u32 vcc, 0x1, v3
s_cbranch_vccz AT_sig_z_ok
s_add_u32 s57, s57, 1
s_cmp_gt_u32 s57, 0x40000
s_cbranch_scc1 L_fail
s_sleep 8
s_branch AT_sig_z
AT_sig_z_ok:
v_mov_b32 v2, 0x102580
v_mov_b32 v3, s25
s_mov_b64 exec, 1
buffer_atomic_add v3, v2, s[8:11], 0 offen
s_mov_b64 exec, -1
AT_sig:
s_cmp_lg_u32 s17, 0
s_cbranch_scc1 AT_d_all
v_mov_b32 v2, 0x102400
AT_d_0:
buffer_load_dword v3, v2, s[8:11], 0 offen sc1
s_waitcnt vmcnt(0)
v_cmp_gt_u32 vcc, 0x3c, v3
s_cbranch_vccz AT_d_0_ok
s_add_u32 s57, s57, 1
s_cmp_gt_u32 s57, 0x40000
s_cbranch_scc1 L_fail
s_sleep 8
s_branch AT_d_0
AT_d_0_ok:
AT_d_all:
s_barrier
s_mov_b32 s32, s18
AT_s:
s_cmp_ge_u32 s32, 220
s_cbranch_scc1 AT_s_e
s_lshr_b32 s34, s32, 2
s_add_u32 s34, s34, 8
s_lshl_b32 s34, s34, 15
s_and_b32 s35, s32, 2
s_lshl_b32 s35, s35, 20
s_add_u32 s34, s34, s35
s_add_u32 s34, s34, 117440512
s_lshr_b32 s35, s34, 5
s_and_b32 s35, s35, 0x4000
s_lshr_b32 s33, s34, 8
s_and_b32 s33, s33, 0x2000
s_or_b32 s35, s35, s33
s_xor_b32 s35, s35, s26
s_add_u32 s33, s34, s35
s_and_b32 s35, s32, 1
s_lshl_b32 s35, s35, 12
s_add_u32 s33, s33, s35
buffer_store_dwordx4 v[8:11], v1, s[8:11], s33 offen offset:0 sc1
buffer_store_dwordx4 v[8:11], v1, s[8:11], s33 offen offset:1024 sc1
buffer_store_dwordx4 v[8:11], v1, s[8:11], s33 offen offset:2048 sc1
buffer_store_dwordx4 v[8:11], v1, s[8:11], s33 offen offset:3072 sc1
s_add_u32 s32, s32, 88
s_branch AT_s
AT_s_e:
s_add_u32 s32, s18, 1984
AT_l:
s_cmp_ge_u32 s32, 2048
s_cbranch_scc1 AT_l_e
s_lshl_b32 s33, s32, 12
s_add_u32 s33, s33, 16777216
buffer_store_dwordx4 v[8:11], v1, s[8:11], s33 offen offset:0 sc1
buffer_store_dwordx4 v[8:11], v1, s[8:11], s33 offen offset:1024 sc1
buffer_store_dwordx4 v[8:11], v1, s[8:11], s33 offen offset:2048 sc1
buffer_store_dwordx4 v[8:11], v1, s[8:11], s33 offen offset:3072 sc1
s_add_u32 s32, s32, 88
s_branch AT_l
AT_l_e:
s_waitcnt vmcnt(0)
s_barrier
s_cmp_lg_u32 s17, 0
s_cbranch_scc1 AT_sig2
v_mov_b32 v2, 0x102600
v_mov_b32 v3, 1
s_mov_b64 exec, 1
buffer_atomic_add v3, v2, s[8:11], 0 offen sc0
s_waitcnt vmcnt(0)
s_mov_b64 exec, -1
v_readfirstlane_b32 s3, v3
s_cmp_lg_u32 s3, 21
s_cbranch_scc1 AT_sig2
v_lshlrev_b32 v2, 7, v0
v_mov_b32 v3, 1
s_mov_b32 s3, 1062928
s_mov_b64 exec, 0xffffffff
buffer_store_dword v3, v2, s[8:11], s3 offen sc1
s_mov_b64 exec, -1
AT_sig2:
s_mov_b32 s27, s18
AT_setup:
v_lshlrev_b32 v1, 4, v0
s_lshl_b32 s24, s17, 11
v_lshlrev_b32 v4, 3, v0
v_add_u32 v4, s24, v4
v_lshrrev_b32 v11, 4, v0
v_and_b32 v12, 15, v0
v_and_b32 v14, 1, v12
v_lshlrev_b32 v14, 7, v14
v_lshrrev_b32 v15, 2, v12
v_lshl_add_u32 v15, v11, 2, v15
v_lshl_add_u32 v5, v15, 3, v14
v_add_u32 v5, s24, v5
s_mov_b32 s28, 0x3e0293ee
s_mov_b32 s29, 0xbe0293ee
s_mov_b32 s30, -1
s_mov_b32 s31, 0
v_lshlrev_b32 v13, 2, v11
v_add_u32 v14, 0, v13
v_cmp_le_u32 s[44:45], v14, v12
v_add_u32 v14, 1, v13
v_cmp_le_u32 s[46:47], v14, v12
v_add_u32 v14, 2, v13
v_cmp_le_u32 s[48:49], v14, v12
v_add_u32 v14, 3, v13
v_cmp_le_u32 s[50:51], v14, v12
v_mov_b32 v8, 0x3f803f80
v_mov_b32 v9, 0x3f803f80
v_mov_b32 v10, 0x3f803f80
v_mov_b32 v11, 0x3f803f80
v_mov_b32 v12, 0x3f003f00
v_mov_b32 v13, 0x3f003f00
v_mov_b32 v7, 0xd028965f
AT_job:
s_lshr_b32 s19, s18, 5
s_and_b32 s20, s18, 31
s_and_b32 s32, s19, 1
s_lshl_b32 s32, s32, 8
s_add_u32 s32, s32, 1048576
s_lshr_b32 s33, s20, 1
s_add_u32 s33, s33, 32
s_lshl_b32 s33, s33, 2
s_lshl_b32 s34, s20, 2
v_mov_b32 v6, s34
v_mov_b32 v2, s33
v_cmp_eq_u32 vcc, 1, v0
s_nop 1
v_cndmask_b32 v6, v6, v2, vcc
s_lshr_b32 s33, s19, 1
AT_w1:
buffer_load_dword v2, v6, s[8:11], s32 offen sc1
s_waitcnt vmcnt(0)
v_cmp_ge_u32 vcc, s33, v2
s_cbranch_vccz AT_w1ok
s_add_u32 s57, s57, 1
s_cmp_gt_u32 s57, 0x40000
s_cbranch_scc1 L_fail
s_sleep 8
s_branch AT_w1
AT_w1ok:
s_lshl_b32 s21, s18, 13
s_add_u32 s35, s21, 33554432
buffer_load_dwordx4 v[16:19], v1, s[8:11], s35 offen offset:0 sc1
buffer_load_dwordx4 v[20:23], v1, s[8:11], s35 offen offset:1024 sc1
buffer_load_dwordx4 v[24:27], v1, s[8:11], s35 offen offset:2048 sc1
buffer_load_dwordx4 v[28:31], v1, s[8:11], s35 offen offset:3072 sc1
s_add_u32 s35, s21, 33558528
buffer_load_dwordx4 v[32:35], v1, s[8:11], s35 offen offset:0 sc1
buffer_load_dwordx4 v[36:39], v1, s[8:11], s35 offen offset:1024 sc1
buffer_load_dwordx4 v[40:43], v1, s[8:11], s35 offen offset:2048 sc1
buffer_load_dwordx4 v[44:47], v1, s[8:11], s35 offen offset:3072 sc1
s_add_u32 s35, s21, 50331648
buffer_load_dwordx4 v[48:51], v1, s[8:11], s35 offen offset:0 sc1
buffer_load_dwordx4 v[52:55], v1, s[8:11], s35 offen offset:1024 sc1
buffer_load_dwordx4 v[56:59], v1, s[8:11], s35 offen offset:2048 sc1
buffer_load_dwordx4 v[60:63], v1, s[8:11], s35 offen offset:3072 sc1
s_add_u32 s35, s21, 50335744
buffer_load_dwordx4 v[64:67], v1, s[8:11], s35 offen offset:0 sc1
buffer_load_dwordx4 v[68:71], v1, s[8:11], s35 offen offset:1024 sc1
buffer_load_dwordx4 v[72:75], v1, s[8:11], s35 offen offset:2048 sc1
buffer_load_dwordx4 v[76:79], v1, s[8:11], s35 offen offset:3072 sc1
s_add_u32 s35, s21, 67108864
buffer_load_dwordx4 v[80:83], v1, s[8:11], s35 offen offset:0 sc1
buffer_load_dwordx4 v[84:87], v1, s[8:11], s35 offen offset:1024 sc1
buffer_load_dwordx4 v[88:91], v1, s[8:11], s35 offen offset:2048 sc1
buffer_load_dwordx4 v[92:95], v1, s[8:11], s35 offen offset:3072 sc1
s_add_u32 s35, s21, 67112960
buffer_load_dwordx4 v[96:99], v1, s[8:11], s35 offen offset:0 sc1
buffer_load_dwordx4 v[100:103], v1, s[8:11], s35 offen offset:1024 sc1
buffer_load_dwordx4 v[104:107], v1, s[8:11], s35 offen offset:2048 sc1
buffer_load_dwordx4 v[108:111], v1, s[8:11], s35 offen offset:3072 sc1
s_lshl_b32 s22, s18, 12
s_add_u32 s22, s22, 16777216
s_lshl_b32 s23, s19, 18
s_lshl_b32 s32, s20, 12
s_add_u32 s23, s23, s32
s_add_u32 s23, s23, 83886080
s_waitcnt vmcnt(15)
v_mfma_f32_16x16x32_bf16 v[144:147], v[48:51], v[16:19], 0
v_mfma_f32_16x16x32_bf16 v[148:151], v[48:51], v[20:23], 0
s_waitcnt vmcnt(14)
v_mfma_f32_16x16x32_bf16 v[152:155], v[52:55], v[20:23], 0
s_waitcnt vmcnt(13)
v_mfma_f32_16x16x32_bf16 v[144:147], v[56:59], v[24:27], v[144:147]
v_mfma_f32_16x16x32_bf16 v[148:151], v[56:59], v[28:31], v[148:151]
s_waitcnt vmcnt(12)
v_mfma_f32_16x16x32_bf16 v[152:155], v[60:63], v[28:31], v[152:155]
s_waitcnt vmcnt(11)
v_mfma_f32_16x16x32_bf16 v[144:147], v[64:67], v[32:35], v[144:147]
v_mfma_f32_16x16x32_bf16 v[148:151], v[64:67], v[36:39], v[148:151]
s_waitcnt vmcnt(10)
v_mfma_f32_16x16x32_bf16 v[152:155], v[68:71], v[36:39], v[152:155]
s_waitcnt vmcnt(9)
v_mfma_f32_16x16x32_bf16 v[144:147], v[72:75], v[40:43], v[144:147]
v_mfma_f32_16x16x32_bf16 v[148:151], v[72:75], v[44:47], v[148:151]
s_waitcnt vmcnt(8)
v_mfma_f32_16x16x32_bf16 v[152:155], v[76:79], v[44:47], v[152:155]
v_cndmask_b32 v144, v7, v144, s[44:45]
v_cndmask_b32 v145, v7, v145, s[46:47]
v_cndmask_b32 v146, v7, v146, s[48:49]
v_cndmask_b32 v147, v7, v147, s[50:51]
s_nop 3
v_cndmask_b32 v152, v7, v152, s[44:45]
v_cndmask_b32 v153, v7, v153, s[46:47]
v_cndmask_b32 v154, v7, v154, s[48:49]
v_cndmask_b32 v155, v7, v155, s[50:51]
s_waitcnt vmcnt(0)
s_cmp_ge_u32 s19, 62
s_cbranch_scc1 AT_w2
s_lshl_b32 s32, s20, 7
s_add_u32 s32, s32, 1058816
AT_w3:
buffer_load_dword v2, off, s[8:11], s32 sc1
s_waitcnt vmcnt(0)
v_cmp_ge_u32 vcc, s19, v2
s_cbranch_vccz AT_w2
s_add_u32 s57, s57, 1
s_cmp_gt_u32 s57, 0x40000
s_cbranch_scc1 L_fail
s_sleep 8
s_branch AT_w3
AT_w2:
buffer_load_dwordx4 v[112:115], v1, s[8:11], s22 offen offset:0 sc1
buffer_load_dwordx4 v[116:119], v1, s[8:11], s22 offen offset:1024 sc1
buffer_load_dwordx4 v[120:123], v1, s[8:11], s22 offen offset:2048 sc1
buffer_load_dwordx4 v[124:127], v1, s[8:11], s22 offen offset:3072 sc1
s_waitcnt vmcnt(3)
v_max3_u32 v2, v112, v113, v114
v_max_u32 v2, v2, v115
s_waitcnt vmcnt(2)
v_max3_u32 v2, v2, v116, v117
v_max3_u32 v2, v2, v118, v119
s_waitcnt vmcnt(1)
v_max3_u32 v2, v2, v120, v121
v_max3_u32 v2, v2, v122, v123
s_waitcnt vmcnt(0)
v_max3_u32 v2, v2, v124, v125
v_max3_u32 v2, v2, v126, v127
v_cmp_eq_u32 vcc, -1, v2
s_cbranch_vccz AT_w2ok
s_add_u32 s57, s57, 1
s_cmp_gt_u32 s57, 0x40000
s_cbranch_scc1 L_fail
s_sleep 2
s_branch AT_w2
AT_w2ok:
ds_write_b64 v4, v[112:113] offset:0
ds_write_b64 v4, v[116:117] offset:512
ds_write_b64 v4, v[120:121] offset:1024
ds_write_b64 v4, v[124:125] offset:1536
v_cndmask_b32 v176, 0, v114, s[30:31]
v_cndmask_b32 v178, v114, 0, s[30:31]
v_cndmask_b32 v177, 0, v115, s[30:31]
v_cndmask_b32 v179, v115, 0, s[30:31]
v_cndmask_b32 v180, 0, v118, s[30:31]
v_cndmask_b32 v182, v118, 0, s[30:31]
v_cndmask_b32 v181, 0, v119, s[30:31]
v_cndmask_b32 v183, v119, 0, s[30:31]
v_cndmask_b32 v184, 0, v122, s[30:31]
v_cndmask_b32 v186, v122, 0, s[30:31]
v_cndmask_b32 v185, 0, v123, s[30:31]
v_cndmask_b32 v187, v123, 0, s[30:31]
v_cndmask_b32 v188, 0, v126, s[30:31]
v_cndmask_b32 v190, v126, 0, s[30:31]
v_cndmask_b32 v189, 0, v127, s[30:31]
v_cndmask_b32 v191, v127, 0, s[30:31]
s_waitcnt lgkmcnt(0)
ds_read_b64_tr_b16 v[128:129], v5 offset:0
ds_read_b64_tr_b16 v[130:131], v5 offset:256
ds_read_b64_tr_b16 v[132:133], v5 offset:512
ds_read_b64_tr_b16 v[134:135], v5 offset:768
ds_read_b64_tr_b16 v[136:137], v5 offset:1024
ds_read_b64_tr_b16 v[138:139], v5 offset:1280
ds_read_b64_tr_b16 v[140:141], v5 offset:1536
ds_read_b64_tr_b16 v[142:143], v5 offset:1792
s_waitcnt lgkmcnt(6)
v_mfma_f32_16x16x32_bf16 v[156:159], v[128:131], v[16:19], 0
v_mfma_f32_16x16x32_bf16 v[160:163], v[128:131], v[20:23], 0
s_waitcnt lgkmcnt(4)
v_mfma_f32_16x16x32_bf16 v[156:159], v[132:135], v[24:27], v[156:159]
v_mfma_f32_16x16x32_bf16 v[160:163], v[132:135], v[28:31], v[160:163]
s_waitcnt lgkmcnt(2)
v_mfma_f32_16x16x32_bf16 v[156:159], v[136:139], v[32:35], v[156:159]
v_mfma_f32_16x16x32_bf16 v[160:163], v[136:139], v[36:39], v[160:163]
s_waitcnt lgkmcnt(0)
v_mfma_f32_16x16x32_bf16 v[156:159], v[140:143], v[40:43], v[156:159]
v_mfma_f32_16x16x32_bf16 v[160:163], v[140:143], v[44:47], v[160:163]
v_max3_f32 v208, v144, v145, v146
s_nop 2
v_max3_f32 v208, v208, v147, v156
v_max3_f32 v208, v208, v157, v158
v_max_f32 v208, v208, v159
v_mov_b32 v209, v208
s_nop 1
v_permlane32_swap_b32 v208, v209
v_max_f32 v208, v208, v209
v_mov_b32 v209, v208
s_nop 1
v_permlane16_swap_b32 v208, v209
v_max_f32 v208, v208, v209
v_mul_f32 v208, s29, v208
v_fma_f32 v144, v144, s28, v208
v_fma_f32 v145, v145, s28, v208
v_fma_f32 v146, v146, s28, v208
v_fma_f32 v147, v147, s28, v208
v_fma_f32 v156, v156, s28, v208
v_fma_f32 v157, v157, s28, v208
v_fma_f32 v158, v158, s28, v208
v_fma_f32 v159, v159, s28, v208
v_exp_f32 v144, v144
v_exp_f32 v145, v145
v_exp_f32 v146, v146
v_exp_f32 v147, v147
v_exp_f32 v156, v156
v_exp_f32 v157, v157
v_exp_f32 v158, v158
v_exp_f32 v159, v159
v_cvt_pk_bf16_f32 v164, v144, v145
v_cvt_pk_bf16_f32 v165, v146, v147
v_mov_b32 v166, 0
v_mov_b32 v167, 0
v_cvt_pk_bf16_f32 v168, v156, v157
v_cvt_pk_bf16_f32 v169, v158, v159
v_max3_f32 v210, v148, v149, v150
v_max3_f32 v210, v210, v151, v152
v_max3_f32 v210, v210, v153, v154
v_max3_f32 v210, v210, v155, v160
v_max3_f32 v210, v210, v161, v162
v_max_f32 v210, v210, v163
v_mov_b32 v211, v210
s_nop 1
v_permlane32_swap_b32 v210, v211
v_max_f32 v210, v210, v211
v_mov_b32 v211, v210
s_nop 1
v_permlane16_swap_b32 v210, v211
v_max_f32 v210, v210, v211
v_mul_f32 v210, s29, v210
v_fma_f32 v148, v148, s28, v210
v_fma_f32 v149, v149, s28, v210
v_fma_f32 v150, v150, s28, v210
v_fma_f32 v151, v151, s28, v210
v_fma_f32 v152, v152, s28, v210
v_fma_f32 v153, v153, s28, v210
v_fma_f32 v154, v154, s28, v210
v_fma_f32 v155, v155, s28, v210
v_fma_f32 v160, v160, s28, v210
v_fma_f32 v161, v161, s28, v210
v_fma_f32 v162, v162, s28, v210
v_fma_f32 v163, v163, s28, v210
v_exp_f32 v148, v148
v_exp_f32 v149, v149
v_exp_f32 v150, v150
v_exp_f32 v151, v151
v_exp_f32 v152, v152
v_exp_f32 v153, v153
v_exp_f32 v154, v154
v_exp_f32 v155, v155
v_exp_f32 v160, v160
v_exp_f32 v161, v161
v_exp_f32 v162, v162
v_exp_f32 v163, v163
v_cvt_pk_bf16_f32 v170, v148, v149
v_cvt_pk_bf16_f32 v171, v150, v151
v_cvt_pk_bf16_f32 v172, v152, v153
v_cvt_pk_bf16_f32 v173, v154, v155
v_cvt_pk_bf16_f32 v174, v160, v161
v_cvt_pk_bf16_f32 v175, v162, v163
v_mfma_f32_16x16x32_bf16 v[200:203], v[8:11], v[164:167], 0
v_mfma_f32_16x16x32_bf16 v[204:207], v[8:11], v[170:173], 0
v_mfma_f32_16x16x16_bf16 v[200:203], v[12:13], v[168:169], v[200:203]
s_nop 1
v_mfma_f32_16x16x16_bf16 v[204:207], v[12:13], v[174:175], v[204:207]
v_mfma_f32_16x16x32_bf16 v[48:51], v[80:83], v[164:167], 0
v_mfma_f32_16x16x32_bf16 v[52:55], v[84:87], v[164:167], 0
v_mfma_f32_16x16x32_bf16 v[56:59], v[80:83], v[170:173], 0
v_mfma_f32_16x16x32_bf16 v[60:63], v[84:87], v[170:173], 0
v_mfma_f32_16x16x32_bf16 v[64:67], v[88:91], v[164:167], 0
v_mfma_f32_16x16x32_bf16 v[68:71], v[92:95], v[164:167], 0
v_mfma_f32_16x16x32_bf16 v[72:75], v[88:91], v[170:173], 0
v_mfma_f32_16x16x32_bf16 v[76:79], v[92:95], v[170:173], 0
v_rcp_f32 v208, v200
v_rcp_f32 v209, v204
v_mfma_f32_16x16x16_bf16 v[48:51], v[176:177], v[168:169], v[48:51]
v_mfma_f32_16x16x16_bf16 v[52:55], v[178:179], v[168:169], v[52:55]
v_mfma_f32_16x16x16_bf16 v[56:59], v[176:177], v[174:175], v[56:59]
v_mfma_f32_16x16x16_bf16 v[60:63], v[178:179], v[174:175], v[60:63]
v_mfma_f32_16x16x16_bf16 v[64:67], v[180:181], v[168:169], v[64:67]
v_mfma_f32_16x16x16_bf16 v[68:71], v[182:183], v[168:169], v[68:71]
v_mfma_f32_16x16x16_bf16 v[72:75], v[180:181], v[174:175], v[72:75]
v_mfma_f32_16x16x16_bf16 v[76:79], v[182:183], v[174:175], v[76:79]
v_mul_f32 v48, v48, v208
v_mul_f32 v49, v49, v208
v_mul_f32 v50, v50, v208
v_mul_f32 v51, v51, v208
v_mul_f32 v52, v52, v208
v_mul_f32 v53, v53, v208
v_mul_f32 v54, v54, v208
v_mul_f32 v55, v55, v208
v_cvt_pk_bf16_f32 v192, v48, v52
v_cvt_pk_bf16_f32 v193, v49, v53
v_cvt_pk_bf16_f32 v194, v50, v54
v_cvt_pk_bf16_f32 v195, v51, v55
buffer_store_dwordx4 v[192:195], v1, s[8:11], s23 offen offset:0 sc1
v_mul_f32 v56, v56, v209
v_mul_f32 v57, v57, v209
v_mul_f32 v58, v58, v209
v_mul_f32 v59, v59, v209
v_mul_f32 v60, v60, v209
v_mul_f32 v61, v61, v209
v_mul_f32 v62, v62, v209
v_mul_f32 v63, v63, v209
v_cvt_pk_bf16_f32 v196, v56, v60
v_cvt_pk_bf16_f32 v197, v57, v61
v_cvt_pk_bf16_f32 v198, v58, v62
v_cvt_pk_bf16_f32 v199, v59, v63
s_add_u32 s32, s23, 131072
buffer_store_dwordx4 v[196:199], v1, s[8:11], s32 offen offset:0 sc1
v_mul_f32 v64, v64, v208
v_mul_f32 v65, v65, v208
v_mul_f32 v66, v66, v208
v_mul_f32 v67, v67, v208
v_mul_f32 v68, v68, v208
v_mul_f32 v69, v69, v208
v_mul_f32 v70, v70, v208
v_mul_f32 v71, v71, v208
v_cvt_pk_bf16_f32 v192, v64, v68
v_cvt_pk_bf16_f32 v193, v65, v69
v_cvt_pk_bf16_f32 v194, v66, v70
v_cvt_pk_bf16_f32 v195, v67, v71
buffer_store_dwordx4 v[192:195], v1, s[8:11], s23 offen offset:1024 sc1
v_mul_f32 v72, v72, v209
v_mul_f32 v73, v73, v209
v_mul_f32 v74, v74, v209
v_mul_f32 v75, v75, v209
v_mul_f32 v76, v76, v209
v_mul_f32 v77, v77, v209
v_mul_f32 v78, v78, v209
v_mul_f32 v79, v79, v209
v_cvt_pk_bf16_f32 v196, v72, v76
v_cvt_pk_bf16_f32 v197, v73, v77
v_cvt_pk_bf16_f32 v198, v74, v78
v_cvt_pk_bf16_f32 v199, v75, v79
s_add_u32 s32, s23, 131072
buffer_store_dwordx4 v[196:199], v1, s[8:11], s32 offen offset:1024 sc1
v_mfma_f32_16x16x32_bf16 v[48:51], v[96:99], v[164:167], 0
v_mfma_f32_16x16x32_bf16 v[52:55], v[100:103], v[164:167], 0
v_mfma_f32_16x16x32_bf16 v[56:59], v[96:99], v[170:173], 0
v_mfma_f32_16x16x32_bf16 v[60:63], v[100:103], v[170:173], 0
v_mfma_f32_16x16x32_bf16 v[64:67], v[104:107], v[164:167], 0
v_mfma_f32_16x16x32_bf16 v[68:71], v[108:111], v[164:167], 0
v_mfma_f32_16x16x32_bf16 v[72:75], v[104:107], v[170:173], 0
v_mfma_f32_16x16x32_bf16 v[76:79], v[108:111], v[170:173], 0
v_mfma_f32_16x16x16_bf16 v[48:51], v[184:185], v[168:169], v[48:51]
v_mfma_f32_16x16x16_bf16 v[52:55], v[186:187], v[168:169], v[52:55]
v_mfma_f32_16x16x16_bf16 v[56:59], v[184:185], v[174:175], v[56:59]
v_mfma_f32_16x16x16_bf16 v[60:63], v[186:187], v[174:175], v[60:63]
v_mfma_f32_16x16x16_bf16 v[64:67], v[188:189], v[168:169], v[64:67]
v_mfma_f32_16x16x16_bf16 v[68:71], v[190:191], v[168:169], v[68:71]
v_mfma_f32_16x16x16_bf16 v[72:75], v[188:189], v[174:175], v[72:75]
v_mfma_f32_16x16x16_bf16 v[76:79], v[190:191], v[174:175], v[76:79]
v_mul_f32 v48, v48, v208
v_mul_f32 v49, v49, v208
v_mul_f32 v50, v50, v208
v_mul_f32 v51, v51, v208
v_mul_f32 v52, v52, v208
v_mul_f32 v53, v53, v208
v_mul_f32 v54, v54, v208
v_mul_f32 v55, v55, v208
v_cvt_pk_bf16_f32 v192, v48, v52
v_cvt_pk_bf16_f32 v193, v49, v53
v_cvt_pk_bf16_f32 v194, v50, v54
v_cvt_pk_bf16_f32 v195, v51, v55
buffer_store_dwordx4 v[192:195], v1, s[8:11], s23 offen offset:2048 sc1
v_mul_f32 v56, v56, v209
v_mul_f32 v57, v57, v209
v_mul_f32 v58, v58, v209
v_mul_f32 v59, v59, v209
v_mul_f32 v60, v60, v209
v_mul_f32 v61, v61, v209
v_mul_f32 v62, v62, v209
v_mul_f32 v63, v63, v209
v_cvt_pk_bf16_f32 v196, v56, v60
v_cvt_pk_bf16_f32 v197, v57, v61
v_cvt_pk_bf16_f32 v198, v58, v62
v_cvt_pk_bf16_f32 v199, v59, v63
s_add_u32 s32, s23, 131072
buffer_store_dwordx4 v[196:199], v1, s[8:11], s32 offen offset:2048 sc1
v_mul_f32 v64, v64, v208
v_mul_f32 v65, v65, v208
v_mul_f32 v66, v66, v208
v_mul_f32 v67, v67, v208
v_mul_f32 v68, v68, v208
v_mul_f32 v69, v69, v208
v_mul_f32 v70, v70, v208
v_mul_f32 v71, v71, v208
v_cvt_pk_bf16_f32 v192, v64, v68
v_cvt_pk_bf16_f32 v193, v65, v69
v_cvt_pk_bf16_f32 v194, v66, v70
v_cvt_pk_bf16_f32 v195, v67, v71
buffer_store_dwordx4 v[192:195], v1, s[8:11], s23 offen offset:3072 sc1
v_mul_f32 v72, v72, v209
v_mul_f32 v73, v73, v209
v_mul_f32 v74, v74, v209
v_mul_f32 v75, v75, v209
v_mul_f32 v76, v76, v209
v_mul_f32 v77, v77, v209
v_mul_f32 v78, v78, v209
v_mul_f32 v79, v79, v209
v_cvt_pk_bf16_f32 v196, v72, v76
v_cvt_pk_bf16_f32 v197, v73, v77
v_cvt_pk_bf16_f32 v198, v74, v78
v_cvt_pk_bf16_f32 v199, v75, v79
s_add_u32 s32, s23, 131072
buffer_store_dwordx4 v[196:199], v1, s[8:11], s32 offen offset:3072 sc1
s_lshl_b32 s32, s18, 7
s_add_u32 s32, s32, 1310720
v_mov_b32 v2, 1
v_mov_b32 v3, 0
s_waitcnt vmcnt(0)
s_mov_b64 exec, 1
buffer_store_dword v2, v3, s[8:11], s32 offen sc1
s_mov_b64 exec, -1
s_cmp_lt_u32 s18, 1152
s_cselect_b32 s32, 0, 128
s_cselect_b32 s33, 1, 0
s_add_u32 s18, s18, s32
s_add_u32 s18, s18, 88
s_cmp_ge_u32 s18, 1152
s_cselect_b32 s33, s33, 0
s_add_u32 s32, s27, 1152
s_cmp_eq_u32 s33, 1
s_cselect_b32 s18, s32, s18
s_cmp_lt_u32 s18, 2048
s_cbranch_scc1 AT_job
s_waitcnt vmcnt(0)
s_branch L_wend
L_out:
s_mul_i32 s18, s16, 3277
s_lshr_b32 s18, s18, 16
s_mul_i32 s32, s18, 20
s_sub_u32 s19, s16, s32
s_load_dwordx2 s[12:13], s[0:1], 40
s_mov_b32 s14, 5242880
s_mov_b32 s15, 0x20000
s_load_dwordx2 s[44:45], s[0:1], 80
s_mov_b32 s46, 2211840
s_mov_b32 s47, 0x20000
s_load_dwordx2 s[48:49], s[0:1], 88
s_mov_b32 s50, 1280
s_mov_b32 s51, 0x20000
s_load_dwordx2 s[52:53], s[0:1], 0
s_mov_b32 s54, 2621440
s_mov_b32 s55, 0x20000
s_load_dwordx2 s[64:65], s[0:1], 96
s_mov_b32 s66, 2621440
s_mov_b32 s67, 0x20000
s_mov_b32 s40, 0x05040100
s_mov_b32 s41, 0x07060302
v_lshlrev_b32 v1, 4, v0
v_lshrrev_b32 v7, 4, v0
v_and_b32 v8, 15, v0
v_lshrrev_b32 v9, 2, v0
v_mul_u32_u24 v4, 1280, v9
v_and_b32 v9, 3, v0
v_lshl_add_u32 v4, v9, 4, v4
v_mul_u32_u24 v6, 1280, v8
v_lshl_add_u32 v6, v7, 4, v6
s_mul_i32 s27, s17, 40960
v_lshlrev_b32 v9, 9, v7
v_lshl_add_u32 v9, v8, 2, v9
v_add_u32 v29, s27, v9
v_and_b32 v28, 7, v0
v_lshlrev_b32 v28, 7, v28
v_and_b32 v9, 7, v0
v_min_u32 v9, 6, v9
v_lshlrev_b32 v9, 2, v9
v_bfe_u32 v5, v0, 3, 1
v_lshl_add_u32 v5, v5, 8, v9
s_lshl_b32 s19, s19, 6
s_mul_i32 s23, s17, 14
s_cmp_eq_u32 s17, 3
s_cselect_b32 s23, 41, s23
s_mul_i32 s42, s17, 1310720
s_add_u32 s42, s42, s19
s_mul_i32 s43, s23, 40960
s_add_u32 s43, s43, s19
s_waitcnt lgkmcnt(0)
s_cmp_lg_u32 s17, 0
s_cbranch_scc1 OP_d_all
v_mov_b32 v2, 0x40
OP_d_0:
buffer_load_dword v3, v2, s[60:63], 0 offen sc1
s_waitcnt vmcnt(0)
v_cmp_gt_u32 vcc, 0x1, v3
s_cbranch_vccz OP_d_0_ok
s_add_u32 s57, s57, 1
s_cmp_gt_u32 s57, 0x40000
s_cbranch_scc1 L_fail
s_sleep 8
s_branch OP_d_0
OP_d_0_ok:
v_mov_b32 v2, 0x102400
OP_d_1:
buffer_load_dword v3, v2, s[8:11], 0 offen sc1
s_waitcnt vmcnt(0)
v_cmp_gt_u32 vcc, 0x3c, v3
s_cbranch_vccz OP_d_1_ok
s_add_u32 s57, s57, 1
s_cmp_gt_u32 s57, 0x40000
s_cbranch_scc1 L_fail
s_sleep 8
s_branch OP_d_1
OP_d_1_ok:
OP_d_all:
s_barrier
s_add_u32 s39, s42, 0
s_add_u32 m0, s27, 0
s_nop 0
buffer_load_dwordx4 v4, s[12:15], s39 offen lds
s_add_u32 s39, s42, 20480
s_add_u32 m0, s27, 1024
s_nop 0
buffer_load_dwordx4 v4, s[12:15], s39 offen lds
s_add_u32 s39, s42, 40960
s_add_u32 m0, s27, 2048
s_nop 0
buffer_load_dwordx4 v4, s[12:15], s39 offen lds
s_add_u32 s39, s42, 61440
s_add_u32 m0, s27, 3072
s_nop 0
buffer_load_dwordx4 v4, s[12:15], s39 offen lds
s_add_u32 s39, s42, 81920
s_add_u32 m0, s27, 4096
s_nop 0
buffer_load_dwordx4 v4, s[12:15], s39 offen lds
s_add_u32 s39, s42, 102400
s_add_u32 m0, s27, 5120
s_nop 0
buffer_load_dwordx4 v4, s[12:15], s39 offen lds
s_add_u32 s39, s42, 122880
s_add_u32 m0, s27, 6144
s_nop 0
buffer_load_dwordx4 v4, s[12:15], s39 offen lds
s_add_u32 s39, s42, 143360
s_add_u32 m0, s27, 7168
s_nop 0
buffer_load_dwordx4 v4, s[12:15], s39 offen lds
s_add_u32 s39, s42, 163840
s_add_u32 m0, s27, 8192
s_nop 0
buffer_load_dwordx4 v4, s[12:15], s39 offen lds
s_add_u32 s39, s42, 184320
s_add_u32 m0, s27, 9216
s_nop 0
buffer_load_dwordx4 v4, s[12:15], s39 offen lds
s_add_u32 s39, s42, 204800
s_add_u32 m0, s27, 10240
s_nop 0
buffer_load_dwordx4 v4, s[12:15], s39 offen lds
s_add_u32 s39, s42, 225280
s_add_u32 m0, s27, 11264
s_nop 0
buffer_load_dwordx4 v4, s[12:15], s39 offen lds
s_add_u32 s39, s42, 245760
s_add_u32 m0, s27, 12288
s_nop 0
buffer_load_dwordx4 v4, s[12:15], s39 offen lds
s_add_u32 s39, s42, 266240
s_add_u32 m0, s27, 13312
s_nop 0
buffer_load_dwordx4 v4, s[12:15], s39 offen lds
s_add_u32 s39, s42, 286720
s_add_u32 m0, s27, 14336
s_nop 0
buffer_load_dwordx4 v4, s[12:15], s39 offen lds
s_add_u32 s39, s42, 307200
s_add_u32 m0, s27, 15360
s_nop 0
buffer_load_dwordx4 v4, s[12:15], s39 offen lds
s_add_u32 s39, s42, 327680
s_add_u32 m0, s27, 16384
s_nop 0
buffer_load_dwordx4 v4, s[12:15], s39 offen lds
s_add_u32 s39, s42, 348160
s_add_u32 m0, s27, 17408
s_nop 0
buffer_load_dwordx4 v4, s[12:15], s39 offen lds
s_add_u32 s39, s42, 368640
s_add_u32 m0, s27, 18432
s_nop 0
buffer_load_dwordx4 v4, s[12:15], s39 offen lds
s_add_u32 s39, s42, 389120
s_add_u32 m0, s27, 19456
s_nop 0
buffer_load_dwordx4 v4, s[12:15], s39 offen lds
s_add_u32 s39, s42, 409600
s_add_u32 m0, s27, 20480
s_nop 0
buffer_load_dwordx4 v4, s[12:15], s39 offen lds
s_add_u32 s39, s42, 430080
s_add_u32 m0, s27, 21504
s_nop 0
buffer_load_dwordx4 v4, s[12:15], s39 offen lds
s_add_u32 s39, s42, 450560
s_add_u32 m0, s27, 22528
s_nop 0
buffer_load_dwordx4 v4, s[12:15], s39 offen lds
s_add_u32 s39, s42, 471040
s_add_u32 m0, s27, 23552
s_nop 0
buffer_load_dwordx4 v4, s[12:15], s39 offen lds
s_add_u32 s39, s42, 491520
s_add_u32 m0, s27, 24576
s_nop 0
buffer_load_dwordx4 v4, s[12:15], s39 offen lds
s_add_u32 s39, s42, 512000
s_add_u32 m0, s27, 25600
s_nop 0
buffer_load_dwordx4 v4, s[12:15], s39 offen lds
s_add_u32 s39, s42, 532480
s_add_u32 m0, s27, 26624
s_nop 0
buffer_load_dwordx4 v4, s[12:15], s39 offen lds
s_add_u32 s39, s42, 552960
s_add_u32 m0, s27, 27648
s_nop 0
buffer_load_dwordx4 v4, s[12:15], s39 offen lds
s_add_u32 s39, s42, 573440
s_add_u32 m0, s27, 28672
s_nop 0
buffer_load_dwordx4 v4, s[12:15], s39 offen lds
s_add_u32 s39, s42, 593920
s_add_u32 m0, s27, 29696
s_nop 0
buffer_load_dwordx4 v4, s[12:15], s39 offen lds
s_add_u32 s39, s42, 614400
s_add_u32 m0, s27, 30720
s_nop 0
buffer_load_dwordx4 v4, s[12:15], s39 offen lds
s_add_u32 s39, s42, 634880
s_add_u32 m0, s27, 31744
s_nop 0
buffer_load_dwordx4 v4, s[12:15], s39 offen lds
s_add_u32 s39, s42, 655360
s_add_u32 m0, s27, 32768
s_nop 0
buffer_load_dwordx4 v4, s[12:15], s39 offen lds
s_add_u32 s39, s42, 675840
s_add_u32 m0, s27, 33792
s_nop 0
buffer_load_dwordx4 v4, s[12:15], s39 offen lds
s_add_u32 s39, s42, 696320
s_add_u32 m0, s27, 34816
s_nop 0
buffer_load_dwordx4 v4, s[12:15], s39 offen lds
s_add_u32 s39, s42, 716800
s_add_u32 m0, s27, 35840
s_nop 0
buffer_load_dwordx4 v4, s[12:15], s39 offen lds
s_add_u32 s39, s42, 737280
s_add_u32 m0, s27, 36864
s_nop 0
buffer_load_dwordx4 v4, s[12:15], s39 offen lds
s_add_u32 s39, s42, 757760
s_add_u32 m0, s27, 37888
s_nop 0
buffer_load_dwordx4 v4, s[12:15], s39 offen lds
s_add_u32 s39, s42, 778240
s_add_u32 m0, s27, 38912
s_nop 0
buffer_load_dwordx4 v4, s[12:15], s39 offen lds
s_add_u32 s39, s42, 798720
s_add_u32 m0, s27, 39936
s_nop 0
buffer_load_dwordx4 v4, s[12:15], s39 offen lds
s_waitcnt vmcnt(38)
v_add_u32 v9, 0, v29
ds_read2_b32 v[32:33], v9 offset0:0 offset1:16
ds_read2_b32 v[34:35], v9 offset0:32 offset1:48
ds_read2_b32 v[36:37], v9 offset0:64 offset1:80
ds_read2_b32 v[38:39], v9 offset0:96 offset1:112
s_waitcnt vmcnt(36)
v_add_u32 v9, 2048, v29
ds_read2_b32 v[40:41], v9 offset0:0 offset1:16
ds_read2_b32 v[42:43], v9 offset0:32 offset1:48
ds_read2_b32 v[44:45], v9 offset0:64 offset1:80
ds_read2_b32 v[46:47], v9 offset0:96 offset1:112
s_waitcnt lgkmcnt(7)
v_perm_b32 v2, v33, v32, s40
v_accvgpr_write_b32 a0, v2
s_waitcnt lgkmcnt(6)
v_perm_b32 v3, v35, v34, s40
v_accvgpr_write_b32 a1, v3
s_waitcnt lgkmcnt(5)
v_perm_b32 v2, v37, v36, s40
v_accvgpr_write_b32 a2, v2
s_waitcnt lgkmcnt(4)
v_perm_b32 v3, v39, v38, s40
v_accvgpr_write_b32 a3, v3
v_perm_b32 v2, v33, v32, s41
v_accvgpr_write_b32 a4, v2
v_perm_b32 v3, v35, v34, s41
v_accvgpr_write_b32 a5, v3
v_perm_b32 v2, v37, v36, s41
v_accvgpr_write_b32 a6, v2
v_perm_b32 v3, v39, v38, s41
v_accvgpr_write_b32 a7, v3
s_add_u32 s39, s42, 819200
s_add_u32 m0, s27, 0
s_nop 0
buffer_load_dwordx4 v4, s[12:15], s39 offen lds
s_add_u32 s39, s42, 839680
s_add_u32 m0, s27, 1024
s_nop 0
buffer_load_dwordx4 v4, s[12:15], s39 offen lds
s_waitcnt vmcnt(36)
v_add_u32 v9, 4096, v29
ds_read2_b32 v[32:33], v9 offset0:0 offset1:16
ds_read2_b32 v[34:35], v9 offset0:32 offset1:48
ds_read2_b32 v[36:37], v9 offset0:64 offset1:80
ds_read2_b32 v[38:39], v9 offset0:96 offset1:112
s_waitcnt lgkmcnt(7)
v_perm_b32 v2, v41, v40, s40
v_accvgpr_write_b32 a8, v2
s_waitcnt lgkmcnt(6)
v_perm_b32 v3, v43, v42, s40
v_accvgpr_write_b32 a9, v3
s_waitcnt lgkmcnt(5)
v_perm_b32 v2, v45, v44, s40
v_accvgpr_write_b32 a10, v2
s_waitcnt lgkmcnt(4)
v_perm_b32 v3, v47, v46, s40
v_accvgpr_write_b32 a11, v3
v_perm_b32 v2, v41, v40, s41
v_accvgpr_write_b32 a12, v2
v_perm_b32 v3, v43, v42, s41
v_accvgpr_write_b32 a13, v3
v_perm_b32 v2, v45, v44, s41
v_accvgpr_write_b32 a14, v2
v_perm_b32 v3, v47, v46, s41
v_accvgpr_write_b32 a15, v3
s_add_u32 s39, s42, 860160
s_add_u32 m0, s27, 2048
s_nop 0
buffer_load_dwordx4 v4, s[12:15], s39 offen lds
s_add_u32 s39, s42, 880640
s_add_u32 m0, s27, 3072
s_nop 0
buffer_load_dwordx4 v4, s[12:15], s39 offen lds
s_waitcnt vmcnt(36)
v_add_u32 v9, 6144, v29
ds_read2_b32 v[40:41], v9 offset0:0 offset1:16
ds_read2_b32 v[42:43], v9 offset0:32 offset1:48
ds_read2_b32 v[44:45], v9 offset0:64 offset1:80
ds_read2_b32 v[46:47], v9 offset0:96 offset1:112
s_waitcnt lgkmcnt(7)
v_perm_b32 v2, v33, v32, s40
v_accvgpr_write_b32 a16, v2
s_waitcnt lgkmcnt(6)
v_perm_b32 v3, v35, v34, s40
v_accvgpr_write_b32 a17, v3
s_waitcnt lgkmcnt(5)
v_perm_b32 v2, v37, v36, s40
v_accvgpr_write_b32 a18, v2
s_waitcnt lgkmcnt(4)
v_perm_b32 v3, v39, v38, s40
v_accvgpr_write_b32 a19, v3
v_perm_b32 v2, v33, v32, s41
v_accvgpr_write_b32 a20, v2
v_perm_b32 v3, v35, v34, s41
v_accvgpr_write_b32 a21, v3
v_perm_b32 v2, v37, v36, s41
v_accvgpr_write_b32 a22, v2
v_perm_b32 v3, v39, v38, s41
v_accvgpr_write_b32 a23, v3
s_add_u32 s39, s42, 901120
s_add_u32 m0, s27, 4096
s_nop 0
buffer_load_dwordx4 v4, s[12:15], s39 offen lds
s_add_u32 s39, s42, 921600
s_add_u32 m0, s27, 5120
s_nop 0
buffer_load_dwordx4 v4, s[12:15], s39 offen lds
s_waitcnt vmcnt(36)
v_add_u32 v9, 8192, v29
ds_read2_b32 v[32:33], v9 offset0:0 offset1:16
ds_read2_b32 v[34:35], v9 offset0:32 offset1:48
ds_read2_b32 v[36:37], v9 offset0:64 offset1:80
ds_read2_b32 v[38:39], v9 offset0:96 offset1:112
s_waitcnt lgkmcnt(7)
v_perm_b32 v2, v41, v40, s40
v_accvgpr_write_b32 a24, v2
s_waitcnt lgkmcnt(6)
v_perm_b32 v3, v43, v42, s40
v_accvgpr_write_b32 a25, v3
s_waitcnt lgkmcnt(5)
v_perm_b32 v2, v45, v44, s40
v_accvgpr_write_b32 a26, v2
s_waitcnt lgkmcnt(4)
v_perm_b32 v3, v47, v46, s40
v_accvgpr_write_b32 a27, v3
v_perm_b32 v2, v41, v40, s41
v_accvgpr_write_b32 a28, v2
v_perm_b32 v3, v43, v42, s41
v_accvgpr_write_b32 a29, v3
v_perm_b32 v2, v45, v44, s41
v_accvgpr_write_b32 a30, v2
v_perm_b32 v3, v47, v46, s41
v_accvgpr_write_b32 a31, v3
s_add_u32 s39, s42, 942080
s_add_u32 m0, s27, 6144
s_nop 0
buffer_load_dwordx4 v4, s[12:15], s39 offen lds
s_add_u32 s39, s42, 962560
s_add_u32 m0, s27, 7168
s_nop 0
buffer_load_dwordx4 v4, s[12:15], s39 offen lds
s_waitcnt vmcnt(36)
v_add_u32 v9, 10240, v29
ds_read2_b32 v[40:41], v9 offset0:0 offset1:16
ds_read2_b32 v[42:43], v9 offset0:32 offset1:48
ds_read2_b32 v[44:45], v9 offset0:64 offset1:80
ds_read2_b32 v[46:47], v9 offset0:96 offset1:112
s_waitcnt lgkmcnt(7)
v_perm_b32 v2, v33, v32, s40
v_accvgpr_write_b32 a32, v2
s_waitcnt lgkmcnt(6)
v_perm_b32 v3, v35, v34, s40
v_accvgpr_write_b32 a33, v3
s_waitcnt lgkmcnt(5)
v_perm_b32 v2, v37, v36, s40
v_accvgpr_write_b32 a34, v2
s_waitcnt lgkmcnt(4)
v_perm_b32 v3, v39, v38, s40
v_accvgpr_write_b32 a35, v3
v_perm_b32 v2, v33, v32, s41
v_accvgpr_write_b32 a36, v2
v_perm_b32 v3, v35, v34, s41
v_accvgpr_write_b32 a37, v3
v_perm_b32 v2, v37, v36, s41
v_accvgpr_write_b32 a38, v2
v_perm_b32 v3, v39, v38, s41
v_accvgpr_write_b32 a39, v3
s_add_u32 s39, s42, 983040
s_add_u32 m0, s27, 8192
s_nop 0
buffer_load_dwordx4 v4, s[12:15], s39 offen lds
s_add_u32 s39, s42, 1003520
s_add_u32 m0, s27, 9216
s_nop 0
buffer_load_dwordx4 v4, s[12:15], s39 offen lds
s_waitcnt vmcnt(36)
v_add_u32 v9, 12288, v29
ds_read2_b32 v[32:33], v9 offset0:0 offset1:16
ds_read2_b32 v[34:35], v9 offset0:32 offset1:48
ds_read2_b32 v[36:37], v9 offset0:64 offset1:80
ds_read2_b32 v[38:39], v9 offset0:96 offset1:112
s_waitcnt lgkmcnt(7)
v_perm_b32 v2, v41, v40, s40
v_accvgpr_write_b32 a40, v2
s_waitcnt lgkmcnt(6)
v_perm_b32 v3, v43, v42, s40
v_accvgpr_write_b32 a41, v3
s_waitcnt lgkmcnt(5)
v_perm_b32 v2, v45, v44, s40
v_accvgpr_write_b32 a42, v2
s_waitcnt lgkmcnt(4)
v_perm_b32 v3, v47, v46, s40
v_accvgpr_write_b32 a43, v3
v_perm_b32 v2, v41, v40, s41
v_accvgpr_write_b32 a44, v2
v_perm_b32 v3, v43, v42, s41
v_accvgpr_write_b32 a45, v3
v_perm_b32 v2, v45, v44, s41
v_accvgpr_write_b32 a46, v2
v_perm_b32 v3, v47, v46, s41
v_accvgpr_write_b32 a47, v3
s_add_u32 s39, s42, 1024000
s_add_u32 m0, s27, 10240
s_nop 0
buffer_load_dwordx4 v4, s[12:15], s39 offen lds
s_add_u32 s39, s42, 1044480
s_add_u32 m0, s27, 11264
s_nop 0
buffer_load_dwordx4 v4, s[12:15], s39 offen lds
s_waitcnt vmcnt(36)
v_add_u32 v9, 14336, v29
ds_read2_b32 v[40:41], v9 offset0:0 offset1:16
ds_read2_b32 v[42:43], v9 offset0:32 offset1:48
ds_read2_b32 v[44:45], v9 offset0:64 offset1:80
ds_read2_b32 v[46:47], v9 offset0:96 offset1:112
s_waitcnt lgkmcnt(7)
v_perm_b32 v2, v33, v32, s40
v_accvgpr_write_b32 a48, v2
s_waitcnt lgkmcnt(6)
v_perm_b32 v3, v35, v34, s40
v_accvgpr_write_b32 a49, v3
s_waitcnt lgkmcnt(5)
v_perm_b32 v2, v37, v36, s40
v_accvgpr_write_b32 a50, v2
s_waitcnt lgkmcnt(4)
v_perm_b32 v3, v39, v38, s40
v_accvgpr_write_b32 a51, v3
v_perm_b32 v2, v33, v32, s41
v_accvgpr_write_b32 a52, v2
v_perm_b32 v3, v35, v34, s41
v_accvgpr_write_b32 a53, v3
v_perm_b32 v2, v37, v36, s41
v_accvgpr_write_b32 a54, v2
v_perm_b32 v3, v39, v38, s41
v_accvgpr_write_b32 a55, v3
s_add_u32 s39, s42, 1064960
s_add_u32 m0, s27, 12288
s_nop 0
buffer_load_dwordx4 v4, s[12:15], s39 offen lds
s_add_u32 s39, s42, 1085440
s_add_u32 m0, s27, 13312
s_nop 0
buffer_load_dwordx4 v4, s[12:15], s39 offen lds
s_waitcnt vmcnt(36)
v_add_u32 v9, 16384, v29
ds_read2_b32 v[32:33], v9 offset0:0 offset1:16
ds_read2_b32 v[34:35], v9 offset0:32 offset1:48
ds_read2_b32 v[36:37], v9 offset0:64 offset1:80
ds_read2_b32 v[38:39], v9 offset0:96 offset1:112
s_waitcnt lgkmcnt(7)
v_perm_b32 v2, v41, v40, s40
v_accvgpr_write_b32 a56, v2
s_waitcnt lgkmcnt(6)
v_perm_b32 v3, v43, v42, s40
v_accvgpr_write_b32 a57, v3
s_waitcnt lgkmcnt(5)
v_perm_b32 v2, v45, v44, s40
v_accvgpr_write_b32 a58, v2
s_waitcnt lgkmcnt(4)
v_perm_b32 v3, v47, v46, s40
v_accvgpr_write_b32 a59, v3
v_perm_b32 v2, v41, v40, s41
v_accvgpr_write_b32 a60, v2
v_perm_b32 v3, v43, v42, s41
v_accvgpr_write_b32 a61, v3
v_perm_b32 v2, v45, v44, s41
v_accvgpr_write_b32 a62, v2
v_perm_b32 v3, v47, v46, s41
v_accvgpr_write_b32 a63, v3
s_add_u32 s39, s42, 1105920
s_add_u32 m0, s27, 14336
s_nop 0
buffer_load_dwordx4 v4, s[12:15], s39 offen lds
s_add_u32 s39, s42, 1126400
s_add_u32 m0, s27, 15360
s_nop 0
buffer_load_dwordx4 v4, s[12:15], s39 offen lds
s_waitcnt vmcnt(36)
v_add_u32 v9, 18432, v29
ds_read2_b32 v[40:41], v9 offset0:0 offset1:16
ds_read2_b32 v[42:43], v9 offset0:32 offset1:48
ds_read2_b32 v[44:45], v9 offset0:64 offset1:80
ds_read2_b32 v[46:47], v9 offset0:96 offset1:112
s_waitcnt lgkmcnt(7)
v_perm_b32 v2, v33, v32, s40
v_accvgpr_write_b32 a64, v2
s_waitcnt lgkmcnt(6)
v_perm_b32 v3, v35, v34, s40
v_accvgpr_write_b32 a65, v3
s_waitcnt lgkmcnt(5)
v_perm_b32 v2, v37, v36, s40
v_accvgpr_write_b32 a66, v2
s_waitcnt lgkmcnt(4)
v_perm_b32 v3, v39, v38, s40
v_accvgpr_write_b32 a67, v3
v_perm_b32 v2, v33, v32, s41
v_accvgpr_write_b32 a68, v2
v_perm_b32 v3, v35, v34, s41
v_accvgpr_write_b32 a69, v3
v_perm_b32 v2, v37, v36, s41
v_accvgpr_write_b32 a70, v2
v_perm_b32 v3, v39, v38, s41
v_accvgpr_write_b32 a71, v3
s_add_u32 s39, s42, 1146880
s_add_u32 m0, s27, 16384
s_nop 0
buffer_load_dwordx4 v4, s[12:15], s39 offen lds
s_add_u32 s39, s42, 1167360
s_add_u32 m0, s27, 17408
s_nop 0
buffer_load_dwordx4 v4, s[12:15], s39 offen lds
s_waitcnt vmcnt(36)
v_add_u32 v9, 20480, v29
ds_read2_b32 v[32:33], v9 offset0:0 offset1:16
ds_read2_b32 v[34:35], v9 offset0:32 offset1:48
ds_read2_b32 v[36:37], v9 offset0:64 offset1:80
ds_read2_b32 v[38:39], v9 offset0:96 offset1:112
s_waitcnt lgkmcnt(7)
v_perm_b32 v2, v41, v40, s40
v_accvgpr_write_b32 a72, v2
s_waitcnt lgkmcnt(6)
v_perm_b32 v3, v43, v42, s40
v_accvgpr_write_b32 a73, v3
s_waitcnt lgkmcnt(5)
v_perm_b32 v2, v45, v44, s40
v_accvgpr_write_b32 a74, v2
s_waitcnt lgkmcnt(4)
v_perm_b32 v3, v47, v46, s40
v_accvgpr_write_b32 a75, v3
v_perm_b32 v2, v41, v40, s41
v_accvgpr_write_b32 a76, v2
v_perm_b32 v3, v43, v42, s41
v_accvgpr_write_b32 a77, v3
v_perm_b32 v2, v45, v44, s41
v_accvgpr_write_b32 a78, v2
v_perm_b32 v3, v47, v46, s41
v_accvgpr_write_b32 a79, v3
s_add_u32 s39, s42, 1187840
s_add_u32 m0, s27, 18432
s_nop 0
buffer_load_dwordx4 v4, s[12:15], s39 offen lds
s_add_u32 s39, s42, 1208320
s_add_u32 m0, s27, 19456
s_nop 0
buffer_load_dwordx4 v4, s[12:15], s39 offen lds
s_waitcnt vmcnt(36)
v_add_u32 v9, 22528, v29
ds_read2_b32 v[40:41], v9 offset0:0 offset1:16
ds_read2_b32 v[42:43], v9 offset0:32 offset1:48
ds_read2_b32 v[44:45], v9 offset0:64 offset1:80
ds_read2_b32 v[46:47], v9 offset0:96 offset1:112
s_waitcnt lgkmcnt(7)
v_perm_b32 v2, v33, v32, s40
v_accvgpr_write_b32 a80, v2
s_waitcnt lgkmcnt(6)
v_perm_b32 v3, v35, v34, s40
v_accvgpr_write_b32 a81, v3
s_waitcnt lgkmcnt(5)
v_perm_b32 v2, v37, v36, s40
v_accvgpr_write_b32 a82, v2
s_waitcnt lgkmcnt(4)
v_perm_b32 v3, v39, v38, s40
v_accvgpr_write_b32 a83, v3
v_perm_b32 v2, v33, v32, s41
v_accvgpr_write_b32 a84, v2
v_perm_b32 v3, v35, v34, s41
v_accvgpr_write_b32 a85, v3
v_perm_b32 v2, v37, v36, s41
v_accvgpr_write_b32 a86, v2
v_perm_b32 v3, v39, v38, s41
v_accvgpr_write_b32 a87, v3
s_add_u32 s39, s42, 1228800
s_add_u32 m0, s27, 20480
s_nop 0
buffer_load_dwordx4 v4, s[12:15], s39 offen lds
s_add_u32 s39, s42, 1249280
s_add_u32 m0, s27, 21504
s_nop 0
buffer_load_dwordx4 v4, s[12:15], s39 offen lds
s_waitcnt vmcnt(36)
v_add_u32 v9, 24576, v29
ds_read2_b32 v[32:33], v9 offset0:0 offset1:16
ds_read2_b32 v[34:35], v9 offset0:32 offset1:48
ds_read2_b32 v[36:37], v9 offset0:64 offset1:80
ds_read2_b32 v[38:39], v9 offset0:96 offset1:112
s_waitcnt lgkmcnt(7)
v_perm_b32 v2, v41, v40, s40
v_accvgpr_write_b32 a88, v2
s_waitcnt lgkmcnt(6)
v_perm_b32 v3, v43, v42, s40
v_accvgpr_write_b32 a89, v3
s_waitcnt lgkmcnt(5)
v_perm_b32 v2, v45, v44, s40
v_accvgpr_write_b32 a90, v2
s_waitcnt lgkmcnt(4)
v_perm_b32 v3, v47, v46, s40
v_accvgpr_write_b32 a91, v3
v_perm_b32 v2, v41, v40, s41
v_accvgpr_write_b32 a92, v2
v_perm_b32 v3, v43, v42, s41
v_accvgpr_write_b32 a93, v3
v_perm_b32 v2, v45, v44, s41
v_accvgpr_write_b32 a94, v2
v_perm_b32 v3, v47, v46, s41
v_accvgpr_write_b32 a95, v3
s_add_u32 s39, s42, 1269760
s_add_u32 m0, s27, 22528
s_nop 0
buffer_load_dwordx4 v4, s[12:15], s39 offen lds
s_add_u32 s39, s42, 1290240
s_add_u32 m0, s27, 23552
s_nop 0
buffer_load_dwordx4 v4, s[12:15], s39 offen lds
s_waitcnt vmcnt(36)
v_add_u32 v9, 26624, v29
ds_read2_b32 v[40:41], v9 offset0:0 offset1:16
ds_read2_b32 v[42:43], v9 offset0:32 offset1:48
ds_read2_b32 v[44:45], v9 offset0:64 offset1:80
ds_read2_b32 v[46:47], v9 offset0:96 offset1:112
s_waitcnt lgkmcnt(7)
v_perm_b32 v2, v33, v32, s40
v_accvgpr_write_b32 a96, v2
s_waitcnt lgkmcnt(6)
v_perm_b32 v3, v35, v34, s40
v_accvgpr_write_b32 a97, v3
s_waitcnt lgkmcnt(5)
v_perm_b32 v2, v37, v36, s40
v_accvgpr_write_b32 a98, v2
s_waitcnt lgkmcnt(4)
v_perm_b32 v3, v39, v38, s40
v_accvgpr_write_b32 a99, v3
v_perm_b32 v2, v33, v32, s41
v_accvgpr_write_b32 a100, v2
v_perm_b32 v3, v35, v34, s41
v_accvgpr_write_b32 a101, v3
v_perm_b32 v2, v37, v36, s41
v_accvgpr_write_b32 a102, v2
v_perm_b32 v3, v39, v38, s41
v_accvgpr_write_b32 a103, v3
s_add_u32 s39, s43, 0
s_add_u32 m0, s27, 24576
s_nop 0
buffer_load_dwordx4 v4, s[44:47], s39 offen lds
s_add_u32 s39, s43, 20480
s_add_u32 m0, s27, 25600
s_nop 0
buffer_load_dwordx4 v4, s[44:47], s39 offen lds
s_waitcnt vmcnt(36)
v_add_u32 v9, 28672, v29
ds_read2_b32 v[32:33], v9 offset0:0 offset1:16
ds_read2_b32 v[34:35], v9 offset0:32 offset1:48
ds_read2_b32 v[36:37], v9 offset0:64 offset1:80
ds_read2_b32 v[38:39], v9 offset0:96 offset1:112
s_waitcnt lgkmcnt(7)
v_perm_b32 v2, v41, v40, s40
v_accvgpr_write_b32 a104, v2
s_waitcnt lgkmcnt(6)
v_perm_b32 v3, v43, v42, s40
v_accvgpr_write_b32 a105, v3
s_waitcnt lgkmcnt(5)
v_perm_b32 v2, v45, v44, s40
v_accvgpr_write_b32 a106, v2
s_waitcnt lgkmcnt(4)
v_perm_b32 v3, v47, v46, s40
v_accvgpr_write_b32 a107, v3
v_perm_b32 v2, v41, v40, s41
v_accvgpr_write_b32 a108, v2
v_perm_b32 v3, v43, v42, s41
v_accvgpr_write_b32 a109, v3
v_perm_b32 v2, v45, v44, s41
v_accvgpr_write_b32 a110, v2
v_perm_b32 v3, v47, v46, s41
v_accvgpr_write_b32 a111, v3
s_add_u32 s39, s43, 40960
s_add_u32 m0, s27, 26624
s_nop 0
buffer_load_dwordx4 v4, s[44:47], s39 offen lds
s_add_u32 s39, s43, 61440
s_add_u32 m0, s27, 27648
s_nop 0
buffer_load_dwordx4 v4, s[44:47], s39 offen lds
s_waitcnt vmcnt(36)
v_add_u32 v9, 30720, v29
ds_read2_b32 v[40:41], v9 offset0:0 offset1:16
ds_read2_b32 v[42:43], v9 offset0:32 offset1:48
ds_read2_b32 v[44:45], v9 offset0:64 offset1:80
ds_read2_b32 v[46:47], v9 offset0:96 offset1:112
s_waitcnt lgkmcnt(7)
v_perm_b32 v2, v33, v32, s40
v_accvgpr_write_b32 a112, v2
s_waitcnt lgkmcnt(6)
v_perm_b32 v3, v35, v34, s40
v_accvgpr_write_b32 a113, v3
s_waitcnt lgkmcnt(5)
v_perm_b32 v2, v37, v36, s40
v_accvgpr_write_b32 a114, v2
s_waitcnt lgkmcnt(4)
v_perm_b32 v3, v39, v38, s40
v_accvgpr_write_b32 a115, v3
v_perm_b32 v2, v33, v32, s41
v_accvgpr_write_b32 a116, v2
v_perm_b32 v3, v35, v34, s41
v_accvgpr_write_b32 a117, v3
v_perm_b32 v2, v37, v36, s41
v_accvgpr_write_b32 a118, v2
v_perm_b32 v3, v39, v38, s41
v_accvgpr_write_b32 a119, v3
s_add_u32 s39, s43, 81920
s_add_u32 m0, s27, 28672
s_nop 0
buffer_load_dwordx4 v4, s[44:47], s39 offen lds
s_add_u32 s39, s43, 102400
s_add_u32 m0, s27, 29696
s_nop 0
buffer_load_dwordx4 v4, s[44:47], s39 offen lds
s_waitcnt vmcnt(36)
v_add_u32 v9, 32768, v29
ds_read2_b32 v[32:33], v9 offset0:0 offset1:16
ds_read2_b32 v[34:35], v9 offset0:32 offset1:48
ds_read2_b32 v[36:37], v9 offset0:64 offset1:80
ds_read2_b32 v[38:39], v9 offset0:96 offset1:112
s_waitcnt lgkmcnt(7)
v_perm_b32 v2, v41, v40, s40
v_accvgpr_write_b32 a120, v2
s_waitcnt lgkmcnt(6)
v_perm_b32 v3, v43, v42, s40
v_accvgpr_write_b32 a121, v3
s_waitcnt lgkmcnt(5)
v_perm_b32 v2, v45, v44, s40
v_accvgpr_write_b32 a122, v2
s_waitcnt lgkmcnt(4)
v_perm_b32 v3, v47, v46, s40
v_accvgpr_write_b32 a123, v3
v_perm_b32 v2, v41, v40, s41
v_accvgpr_write_b32 a124, v2
v_perm_b32 v3, v43, v42, s41
v_accvgpr_write_b32 a125, v3
v_perm_b32 v2, v45, v44, s41
v_accvgpr_write_b32 a126, v2
v_perm_b32 v3, v47, v46, s41
v_accvgpr_write_b32 a127, v3
s_add_u32 s39, s43, 122880
s_add_u32 m0, s27, 30720
s_nop 0
buffer_load_dwordx4 v4, s[44:47], s39 offen lds
s_add_u32 s39, s43, 143360
s_add_u32 m0, s27, 31744
s_nop 0
buffer_load_dwordx4 v4, s[44:47], s39 offen lds
s_waitcnt vmcnt(36)
v_add_u32 v9, 34816, v29
ds_read2_b32 v[40:41], v9 offset0:0 offset1:16
ds_read2_b32 v[42:43], v9 offset0:32 offset1:48
ds_read2_b32 v[44:45], v9 offset0:64 offset1:80
ds_read2_b32 v[46:47], v9 offset0:96 offset1:112
s_waitcnt lgkmcnt(7)
v_perm_b32 v2, v33, v32, s40
v_accvgpr_write_b32 a128, v2
s_waitcnt lgkmcnt(6)
v_perm_b32 v3, v35, v34, s40
v_accvgpr_write_b32 a129, v3
s_waitcnt lgkmcnt(5)
v_perm_b32 v2, v37, v36, s40
v_accvgpr_write_b32 a130, v2
s_waitcnt lgkmcnt(4)
v_perm_b32 v3, v39, v38, s40
v_accvgpr_write_b32 a131, v3
v_perm_b32 v2, v33, v32, s41
v_accvgpr_write_b32 a132, v2
v_perm_b32 v3, v35, v34, s41
v_accvgpr_write_b32 a133, v3
v_perm_b32 v2, v37, v36, s41
v_accvgpr_write_b32 a134, v2
v_perm_b32 v3, v39, v38, s41
v_accvgpr_write_b32 a135, v3
s_add_u32 s39, s43, 163840
s_add_u32 m0, s27, 32768
s_nop 0
buffer_load_dwordx4 v4, s[44:47], s39 offen lds
s_add_u32 s39, s43, 184320
s_add_u32 m0, s27, 33792
s_nop 0
buffer_load_dwordx4 v4, s[44:47], s39 offen lds
s_waitcnt vmcnt(36)
v_add_u32 v9, 36864, v29
ds_read2_b32 v[32:33], v9 offset0:0 offset1:16
ds_read2_b32 v[34:35], v9 offset0:32 offset1:48
ds_read2_b32 v[36:37], v9 offset0:64 offset1:80
ds_read2_b32 v[38:39], v9 offset0:96 offset1:112
s_waitcnt lgkmcnt(7)
v_perm_b32 v2, v41, v40, s40
v_accvgpr_write_b32 a136, v2
s_waitcnt lgkmcnt(6)
v_perm_b32 v3, v43, v42, s40
v_accvgpr_write_b32 a137, v3
s_waitcnt lgkmcnt(5)
v_perm_b32 v2, v45, v44, s40
v_accvgpr_write_b32 a138, v2
s_waitcnt lgkmcnt(4)
v_perm_b32 v3, v47, v46, s40
v_accvgpr_write_b32 a139, v3
v_perm_b32 v2, v41, v40, s41
v_accvgpr_write_b32 a140, v2
v_perm_b32 v3, v43, v42, s41
v_accvgpr_write_b32 a141, v3
v_perm_b32 v2, v45, v44, s41
v_accvgpr_write_b32 a142, v2
v_perm_b32 v3, v47, v46, s41
v_accvgpr_write_b32 a143, v3
s_add_u32 s39, s43, 204800
s_add_u32 m0, s27, 34816
s_nop 0
buffer_load_dwordx4 v4, s[44:47], s39 offen lds
s_add_u32 s39, s43, 225280
s_add_u32 m0, s27, 35840
s_nop 0
buffer_load_dwordx4 v4, s[44:47], s39 offen lds
s_waitcnt vmcnt(36)
v_add_u32 v9, 38912, v29
ds_read2_b32 v[40:41], v9 offset0:0 offset1:16
ds_read2_b32 v[42:43], v9 offset0:32 offset1:48
ds_read2_b32 v[44:45], v9 offset0:64 offset1:80
ds_read2_b32 v[46:47], v9 offset0:96 offset1:112
s_waitcnt lgkmcnt(7)
v_perm_b32 v2, v33, v32, s40
v_accvgpr_write_b32 a144, v2
s_waitcnt lgkmcnt(6)
v_perm_b32 v3, v35, v34, s40
v_accvgpr_write_b32 a145, v3
s_waitcnt lgkmcnt(5)
v_perm_b32 v2, v37, v36, s40
v_accvgpr_write_b32 a146, v2
s_waitcnt lgkmcnt(4)
v_perm_b32 v3, v39, v38, s40
v_accvgpr_write_b32 a147, v3
v_perm_b32 v2, v33, v32, s41
v_accvgpr_write_b32 a148, v2
v_perm_b32 v3, v35, v34, s41
v_accvgpr_write_b32 a149, v3
v_perm_b32 v2, v37, v36, s41
v_accvgpr_write_b32 a150, v2
v_perm_b32 v3, v39, v38, s41
v_accvgpr_write_b32 a151, v3
s_add_u32 s39, s43, 245760
s_add_u32 m0, s27, 36864
s_nop 0
buffer_load_dwordx4 v4, s[44:47], s39 offen lds
s_add_u32 s39, s43, 266240
s_add_u32 m0, s27, 37888
s_nop 0
buffer_load_dwordx4 v4, s[44:47], s39 offen lds
s_waitcnt vmcnt(36)
v_add_u32 v9, 0, v29
ds_read2_b32 v[32:33], v9 offset0:0 offset1:16
ds_read2_b32 v[34:35], v9 offset0:32 offset1:48
ds_read2_b32 v[36:37], v9 offset0:64 offset1:80
ds_read2_b32 v[38:39], v9 offset0:96 offset1:112
s_waitcnt lgkmcnt(7)
v_perm_b32 v2, v41, v40, s40
v_accvgpr_write_b32 a152, v2
s_waitcnt lgkmcnt(6)
v_perm_b32 v3, v43, v42, s40
v_accvgpr_write_b32 a153, v3
s_waitcnt lgkmcnt(5)
v_perm_b32 v2, v45, v44, s40
v_accvgpr_write_b32 a154, v2
s_waitcnt lgkmcnt(4)
v_perm_b32 v3, v47, v46, s40
v_accvgpr_write_b32 a155, v3
v_perm_b32 v2, v41, v40, s41
v_accvgpr_write_b32 a156, v2
v_perm_b32 v3, v43, v42, s41
v_accvgpr_write_b32 a157, v3
v_perm_b32 v2, v45, v44, s41
v_accvgpr_write_b32 a158, v2
v_perm_b32 v3, v47, v46, s41
v_accvgpr_write_b32 a159, v3
s_add_u32 s39, s43, 286720
s_add_u32 m0, s27, 38912
s_nop 0
buffer_load_dwordx4 v4, s[44:47], s39 offen lds
s_add_u32 s39, s43, 307200
s_add_u32 m0, s27, 39936
s_nop 0
buffer_load_dwordx4 v4, s[44:47], s39 offen lds
s_waitcnt vmcnt(36)
v_add_u32 v9, 2048, v29
ds_read2_b32 v[40:41], v9 offset0:0 offset1:16
ds_read2_b32 v[42:43], v9 offset0:32 offset1:48
ds_read2_b32 v[44:45], v9 offset0:64 offset1:80
ds_read2_b32 v[46:47], v9 offset0:96 offset1:112
s_waitcnt lgkmcnt(7)
v_perm_b32 v2, v33, v32, s40
v_accvgpr_write_b32 a160, v2
s_waitcnt lgkmcnt(6)
v_perm_b32 v3, v35, v34, s40
v_accvgpr_write_b32 a161, v3
s_waitcnt lgkmcnt(5)
v_perm_b32 v2, v37, v36, s40
v_accvgpr_write_b32 a162, v2
s_waitcnt lgkmcnt(4)
v_perm_b32 v3, v39, v38, s40
v_accvgpr_write_b32 a163, v3
v_perm_b32 v2, v33, v32, s41
v_accvgpr_write_b32 a164, v2
v_perm_b32 v3, v35, v34, s41
v_accvgpr_write_b32 a165, v3
v_perm_b32 v2, v37, v36, s41
v_accvgpr_write_b32 a166, v2
v_perm_b32 v3, v39, v38, s41
v_accvgpr_write_b32 a167, v3
s_add_u32 s39, s43, 327680
s_add_u32 m0, s27, 0
s_nop 0
buffer_load_dwordx4 v4, s[44:47], s39 offen lds
s_add_u32 s39, s43, 348160
s_add_u32 m0, s27, 1024
s_nop 0
buffer_load_dwordx4 v4, s[44:47], s39 offen lds
s_waitcnt vmcnt(36)
v_add_u32 v9, 4096, v29
ds_read2_b32 v[32:33], v9 offset0:0 offset1:16
ds_read2_b32 v[34:35], v9 offset0:32 offset1:48
ds_read2_b32 v[36:37], v9 offset0:64 offset1:80
ds_read2_b32 v[38:39], v9 offset0:96 offset1:112
s_waitcnt lgkmcnt(7)
v_perm_b32 v2, v41, v40, s40
v_accvgpr_write_b32 a168, v2
s_waitcnt lgkmcnt(6)
v_perm_b32 v3, v43, v42, s40
v_accvgpr_write_b32 a169, v3
s_waitcnt lgkmcnt(5)
v_perm_b32 v2, v45, v44, s40
v_accvgpr_write_b32 a170, v2
s_waitcnt lgkmcnt(4)
v_perm_b32 v3, v47, v46, s40
v_accvgpr_write_b32 a171, v3
v_perm_b32 v2, v41, v40, s41
v_accvgpr_write_b32 a172, v2
v_perm_b32 v3, v43, v42, s41
v_accvgpr_write_b32 a173, v3
v_perm_b32 v2, v45, v44, s41
v_accvgpr_write_b32 a174, v2
v_perm_b32 v3, v47, v46, s41
v_accvgpr_write_b32 a175, v3
s_add_u32 s39, s43, 368640
s_add_u32 m0, s27, 2048
s_nop 0
buffer_load_dwordx4 v4, s[44:47], s39 offen lds
s_add_u32 s39, s43, 389120
s_add_u32 m0, s27, 3072
s_nop 0
buffer_load_dwordx4 v4, s[44:47], s39 offen lds
s_waitcnt vmcnt(36)
v_add_u32 v9, 6144, v29
ds_read2_b32 v[40:41], v9 offset0:0 offset1:16
ds_read2_b32 v[42:43], v9 offset0:32 offset1:48
ds_read2_b32 v[44:45], v9 offset0:64 offset1:80
ds_read2_b32 v[46:47], v9 offset0:96 offset1:112
s_waitcnt lgkmcnt(7)
v_perm_b32 v2, v33, v32, s40
v_accvgpr_write_b32 a176, v2
s_waitcnt lgkmcnt(6)
v_perm_b32 v3, v35, v34, s40
v_accvgpr_write_b32 a177, v3
s_waitcnt lgkmcnt(5)
v_perm_b32 v2, v37, v36, s40
v_accvgpr_write_b32 a178, v2
s_waitcnt lgkmcnt(4)
v_perm_b32 v3, v39, v38, s40
v_accvgpr_write_b32 a179, v3
v_perm_b32 v2, v33, v32, s41
v_accvgpr_write_b32 a180, v2
v_perm_b32 v3, v35, v34, s41
v_accvgpr_write_b32 a181, v3
v_perm_b32 v2, v37, v36, s41
v_accvgpr_write_b32 a182, v2
v_perm_b32 v3, v39, v38, s41
v_accvgpr_write_b32 a183, v3
s_add_u32 s39, s43, 409600
s_add_u32 m0, s27, 4096
s_nop 0
buffer_load_dwordx4 v4, s[44:47], s39 offen lds
s_add_u32 s39, s43, 430080
s_add_u32 m0, s27, 5120
s_nop 0
buffer_load_dwordx4 v4, s[44:47], s39 offen lds
s_waitcnt vmcnt(36)
v_add_u32 v9, 8192, v29
ds_read2_b32 v[32:33], v9 offset0:0 offset1:16
ds_read2_b32 v[34:35], v9 offset0:32 offset1:48
ds_read2_b32 v[36:37], v9 offset0:64 offset1:80
ds_read2_b32 v[38:39], v9 offset0:96 offset1:112
s_waitcnt lgkmcnt(7)
v_perm_b32 v2, v41, v40, s40
v_accvgpr_write_b32 a184, v2
s_waitcnt lgkmcnt(6)
v_perm_b32 v3, v43, v42, s40
v_accvgpr_write_b32 a185, v3
s_waitcnt lgkmcnt(5)
v_perm_b32 v2, v45, v44, s40
v_accvgpr_write_b32 a186, v2
s_waitcnt lgkmcnt(4)
v_perm_b32 v3, v47, v46, s40
v_accvgpr_write_b32 a187, v3
v_perm_b32 v2, v41, v40, s41
v_accvgpr_write_b32 a188, v2
v_perm_b32 v3, v43, v42, s41
v_accvgpr_write_b32 a189, v3
v_perm_b32 v2, v45, v44, s41
v_accvgpr_write_b32 a190, v2
v_perm_b32 v3, v47, v46, s41
v_accvgpr_write_b32 a191, v3
s_add_u32 s39, s43, 450560
s_add_u32 m0, s27, 6144
s_nop 0
buffer_load_dwordx4 v4, s[44:47], s39 offen lds
s_add_u32 s39, s43, 471040
s_add_u32 m0, s27, 7168
s_nop 0
buffer_load_dwordx4 v4, s[44:47], s39 offen lds
s_waitcnt vmcnt(36)
v_add_u32 v9, 10240, v29
ds_read2_b32 v[40:41], v9 offset0:0 offset1:16
ds_read2_b32 v[42:43], v9 offset0:32 offset1:48
ds_read2_b32 v[44:45], v9 offset0:64 offset1:80
ds_read2_b32 v[46:47], v9 offset0:96 offset1:112
s_waitcnt lgkmcnt(7)
v_perm_b32 v2, v33, v32, s40
v_accvgpr_write_b32 a192, v2
s_waitcnt lgkmcnt(6)
v_perm_b32 v3, v35, v34, s40
v_accvgpr_write_b32 a193, v3
s_waitcnt lgkmcnt(5)
v_perm_b32 v2, v37, v36, s40
v_accvgpr_write_b32 a194, v2
s_waitcnt lgkmcnt(4)
v_perm_b32 v3, v39, v38, s40
v_accvgpr_write_b32 a195, v3
v_perm_b32 v2, v33, v32, s41
v_accvgpr_write_b32 a196, v2
v_perm_b32 v3, v35, v34, s41
v_accvgpr_write_b32 a197, v3
v_perm_b32 v2, v37, v36, s41
v_accvgpr_write_b32 a198, v2
v_perm_b32 v3, v39, v38, s41
v_accvgpr_write_b32 a199, v3
s_add_u32 s39, s43, 491520
s_add_u32 m0, s27, 8192
s_nop 0
buffer_load_dwordx4 v4, s[44:47], s39 offen lds
s_add_u32 s39, s43, 512000
s_add_u32 m0, s27, 9216
s_nop 0
buffer_load_dwordx4 v4, s[44:47], s39 offen lds
s_waitcnt vmcnt(36)
v_add_u32 v9, 12288, v29
ds_read2_b32 v[32:33], v9 offset0:0 offset1:16
ds_read2_b32 v[34:35], v9 offset0:32 offset1:48
ds_read2_b32 v[36:37], v9 offset0:64 offset1:80
ds_read2_b32 v[38:39], v9 offset0:96 offset1:112
s_waitcnt lgkmcnt(7)
v_perm_b32 v2, v41, v40, s40
v_accvgpr_write_b32 a200, v2
s_waitcnt lgkmcnt(6)
v_perm_b32 v3, v43, v42, s40
v_accvgpr_write_b32 a201, v3
s_waitcnt lgkmcnt(5)
v_perm_b32 v2, v45, v44, s40
v_accvgpr_write_b32 a202, v2
s_waitcnt lgkmcnt(4)
v_perm_b32 v3, v47, v46, s40
v_accvgpr_write_b32 a203, v3
v_perm_b32 v2, v41, v40, s41
v_accvgpr_write_b32 a204, v2
v_perm_b32 v3, v43, v42, s41
v_accvgpr_write_b32 a205, v3
v_perm_b32 v2, v45, v44, s41
v_accvgpr_write_b32 a206, v2
v_perm_b32 v3, v47, v46, s41
v_accvgpr_write_b32 a207, v3
s_add_u32 s39, s43, 532480
s_add_u32 m0, s27, 10240
s_nop 0
buffer_load_dwordx4 v4, s[44:47], s39 offen lds
s_add_u32 s39, s43, 552960
s_add_u32 m0, s27, 11264
s_nop 0
buffer_load_dwordx4 v4, s[44:47], s39 offen lds
s_waitcnt vmcnt(36)
v_add_u32 v9, 14336, v29
ds_read2_b32 v[40:41], v9 offset0:0 offset1:16
ds_read2_b32 v[42:43], v9 offset0:32 offset1:48
ds_read2_b32 v[44:45], v9 offset0:64 offset1:80
ds_read2_b32 v[46:47], v9 offset0:96 offset1:112
s_waitcnt lgkmcnt(7)
v_perm_b32 v2, v33, v32, s40
v_accvgpr_write_b32 a208, v2
s_waitcnt lgkmcnt(6)
v_perm_b32 v3, v35, v34, s40
v_accvgpr_write_b32 a209, v3
s_waitcnt lgkmcnt(5)
v_perm_b32 v2, v37, v36, s40
v_accvgpr_write_b32 a210, v2
s_waitcnt lgkmcnt(4)
v_perm_b32 v3, v39, v38, s40
v_accvgpr_write_b32 a211, v3
v_perm_b32 v2, v33, v32, s41
v_accvgpr_write_b32 a212, v2
v_perm_b32 v3, v35, v34, s41
v_accvgpr_write_b32 a213, v3
v_perm_b32 v2, v37, v36, s41
v_accvgpr_write_b32 a214, v2
v_perm_b32 v3, v39, v38, s41
v_accvgpr_write_b32 a215, v3
s_waitcnt vmcnt(34)
v_add_u32 v9, 16384, v29
ds_read2_b32 v[32:33], v9 offset0:0 offset1:16
ds_read2_b32 v[34:35], v9 offset0:32 offset1:48
ds_read2_b32 v[36:37], v9 offset0:64 offset1:80
ds_read2_b32 v[38:39], v9 offset0:96 offset1:112
s_waitcnt lgkmcnt(7)
v_perm_b32 v2, v41, v40, s40
v_accvgpr_write_b32 a216, v2
s_waitcnt lgkmcnt(6)
v_perm_b32 v3, v43, v42, s40
v_accvgpr_write_b32 a217, v3
s_waitcnt lgkmcnt(5)
v_perm_b32 v2, v45, v44, s40
v_accvgpr_write_b32 a218, v2
s_waitcnt lgkmcnt(4)
v_perm_b32 v3, v47, v46, s40
v_accvgpr_write_b32 a219, v3
v_perm_b32 v2, v41, v40, s41
v_accvgpr_write_b32 a220, v2
v_perm_b32 v3, v43, v42, s41
v_accvgpr_write_b32 a221, v3
v_perm_b32 v2, v45, v44, s41
v_accvgpr_write_b32 a222, v2
v_perm_b32 v3, v47, v46, s41
v_accvgpr_write_b32 a223, v3
s_waitcnt vmcnt(32)
v_add_u32 v9, 18432, v29
ds_read2_b32 v[40:41], v9 offset0:0 offset1:16
ds_read2_b32 v[42:43], v9 offset0:32 offset1:48
ds_read2_b32 v[44:45], v9 offset0:64 offset1:80
ds_read2_b32 v[46:47], v9 offset0:96 offset1:112
s_waitcnt lgkmcnt(7)
v_perm_b32 v2, v33, v32, s40
v_accvgpr_write_b32 a224, v2
s_waitcnt lgkmcnt(6)
v_perm_b32 v3, v35, v34, s40
v_accvgpr_write_b32 a225, v3
s_waitcnt lgkmcnt(5)
v_perm_b32 v2, v37, v36, s40
v_accvgpr_write_b32 a226, v2
s_waitcnt lgkmcnt(4)
v_perm_b32 v3, v39, v38, s40
v_accvgpr_write_b32 a227, v3
v_perm_b32 v2, v33, v32, s41
v_accvgpr_write_b32 a228, v2
v_perm_b32 v3, v35, v34, s41
v_accvgpr_write_b32 a229, v3
v_perm_b32 v2, v37, v36, s41
v_accvgpr_write_b32 a230, v2
v_perm_b32 v3, v39, v38, s41
v_accvgpr_write_b32 a231, v3
s_waitcnt vmcnt(30)
v_add_u32 v9, 20480, v29
ds_read2_b32 v[32:33], v9 offset0:0 offset1:16
ds_read2_b32 v[34:35], v9 offset0:32 offset1:48
ds_read2_b32 v[36:37], v9 offset0:64 offset1:80
ds_read2_b32 v[38:39], v9 offset0:96 offset1:112
s_waitcnt lgkmcnt(7)
v_perm_b32 v2, v41, v40, s40
v_accvgpr_write_b32 a232, v2
s_waitcnt lgkmcnt(6)
v_perm_b32 v3, v43, v42, s40
v_accvgpr_write_b32 a233, v3
s_waitcnt lgkmcnt(5)
v_perm_b32 v2, v45, v44, s40
v_accvgpr_write_b32 a234, v2
s_waitcnt lgkmcnt(4)
v_perm_b32 v3, v47, v46, s40
v_accvgpr_write_b32 a235, v3
v_perm_b32 v2, v41, v40, s41
v_accvgpr_write_b32 a236, v2
v_perm_b32 v3, v43, v42, s41
v_accvgpr_write_b32 a237, v3
v_perm_b32 v2, v45, v44, s41
v_accvgpr_write_b32 a238, v2
v_perm_b32 v3, v47, v46, s41
v_accvgpr_write_b32 a239, v3
s_waitcnt vmcnt(28)
v_add_u32 v9, 22528, v29
ds_read2_b32 v[40:41], v9 offset0:0 offset1:16
ds_read2_b32 v[42:43], v9 offset0:32 offset1:48
ds_read2_b32 v[44:45], v9 offset0:64 offset1:80
ds_read2_b32 v[46:47], v9 offset0:96 offset1:112
s_waitcnt lgkmcnt(7)
v_perm_b32 v2, v33, v32, s40
v_accvgpr_write_b32 a240, v2
s_waitcnt lgkmcnt(6)
v_perm_b32 v3, v35, v34, s40
v_accvgpr_write_b32 a241, v3
s_waitcnt lgkmcnt(5)
v_perm_b32 v2, v37, v36, s40
v_accvgpr_write_b32 a242, v2
s_waitcnt lgkmcnt(4)
v_perm_b32 v3, v39, v38, s40
v_accvgpr_write_b32 a243, v3
v_perm_b32 v2, v33, v32, s41
v_accvgpr_write_b32 a244, v2
v_perm_b32 v3, v35, v34, s41
v_accvgpr_write_b32 a245, v3
v_perm_b32 v2, v37, v36, s41
v_accvgpr_write_b32 a246, v2
v_perm_b32 v3, v39, v38, s41
v_accvgpr_write_b32 a247, v3
s_waitcnt vmcnt(26)
v_add_u32 v9, 24576, v29
ds_read2_b32 v[32:33], v9 offset0:0 offset1:16
ds_read2_b32 v[34:35], v9 offset0:32 offset1:48
ds_read2_b32 v[36:37], v9 offset0:64 offset1:80
ds_read2_b32 v[38:39], v9 offset0:96 offset1:112
s_waitcnt lgkmcnt(7)
v_perm_b32 v2, v41, v40, s40
v_accvgpr_write_b32 a248, v2
s_waitcnt lgkmcnt(6)
v_perm_b32 v3, v43, v42, s40
v_accvgpr_write_b32 a249, v3
s_waitcnt lgkmcnt(5)
v_perm_b32 v2, v45, v44, s40
v_accvgpr_write_b32 a250, v2
s_waitcnt lgkmcnt(4)
v_perm_b32 v3, v47, v46, s40
v_accvgpr_write_b32 a251, v3
v_perm_b32 v2, v41, v40, s41
v_accvgpr_write_b32 a252, v2
v_perm_b32 v3, v43, v42, s41
v_accvgpr_write_b32 a253, v3
v_perm_b32 v2, v45, v44, s41
v_accvgpr_write_b32 a254, v2
v_perm_b32 v3, v47, v46, s41
v_accvgpr_write_b32 a255, v3
s_waitcnt vmcnt(24)
v_add_u32 v9, 26624, v29
ds_read2_b32 v[40:41], v9 offset0:0 offset1:16
ds_read2_b32 v[42:43], v9 offset0:32 offset1:48
ds_read2_b32 v[44:45], v9 offset0:64 offset1:80
ds_read2_b32 v[46:47], v9 offset0:96 offset1:112
s_waitcnt lgkmcnt(7)
v_perm_b32 v144, v33, v32, s40
s_waitcnt lgkmcnt(6)
v_perm_b32 v145, v35, v34, s40
s_waitcnt lgkmcnt(5)
v_perm_b32 v146, v37, v36, s40
s_waitcnt lgkmcnt(4)
v_perm_b32 v147, v39, v38, s40
v_perm_b32 v148, v33, v32, s41
v_perm_b32 v149, v35, v34, s41
v_perm_b32 v150, v37, v36, s41
v_perm_b32 v151, v39, v38, s41
s_waitcnt vmcnt(22)
v_add_u32 v9, 28672, v29
ds_read2_b32 v[32:33], v9 offset0:0 offset1:16
ds_read2_b32 v[34:35], v9 offset0:32 offset1:48
ds_read2_b32 v[36:37], v9 offset0:64 offset1:80
ds_read2_b32 v[38:39], v9 offset0:96 offset1:112
s_waitcnt lgkmcnt(7)
v_perm_b32 v152, v41, v40, s40
s_waitcnt lgkmcnt(6)
v_perm_b32 v153, v43, v42, s40
s_waitcnt lgkmcnt(5)
v_perm_b32 v154, v45, v44, s40
s_waitcnt lgkmcnt(4)
v_perm_b32 v155, v47, v46, s40
v_perm_b32 v156, v41, v40, s41
v_perm_b32 v157, v43, v42, s41
v_perm_b32 v158, v45, v44, s41
v_perm_b32 v159, v47, v46, s41
s_waitcnt vmcnt(20)
v_add_u32 v9, 30720, v29
ds_read2_b32 v[40:41], v9 offset0:0 offset1:16
ds_read2_b32 v[42:43], v9 offset0:32 offset1:48
ds_read2_b32 v[44:45], v9 offset0:64 offset1:80
ds_read2_b32 v[46:47], v9 offset0:96 offset1:112
s_waitcnt lgkmcnt(7)
v_perm_b32 v160, v33, v32, s40
s_waitcnt lgkmcnt(6)
v_perm_b32 v161, v35, v34, s40
s_waitcnt lgkmcnt(5)
v_perm_b32 v162, v37, v36, s40
s_waitcnt lgkmcnt(4)
v_perm_b32 v163, v39, v38, s40
v_perm_b32 v164, v33, v32, s41
v_perm_b32 v165, v35, v34, s41
v_perm_b32 v166, v37, v36, s41
v_perm_b32 v167, v39, v38, s41
s_waitcnt vmcnt(18)
v_add_u32 v9, 32768, v29
ds_read2_b32 v[32:33], v9 offset0:0 offset1:16
ds_read2_b32 v[34:35], v9 offset0:32 offset1:48
ds_read2_b32 v[36:37], v9 offset0:64 offset1:80
ds_read2_b32 v[38:39], v9 offset0:96 offset1:112
s_waitcnt lgkmcnt(7)
v_perm_b32 v168, v41, v40, s40
s_waitcnt lgkmcnt(6)
v_perm_b32 v169, v43, v42, s40
s_waitcnt lgkmcnt(5)
v_perm_b32 v170, v45, v44, s40
s_waitcnt lgkmcnt(4)
v_perm_b32 v171, v47, v46, s40
v_perm_b32 v172, v41, v40, s41
v_perm_b32 v173, v43, v42, s41
v_perm_b32 v174, v45, v44, s41
v_perm_b32 v175, v47, v46, s41
s_waitcnt vmcnt(16)
v_add_u32 v9, 34816, v29
ds_read2_b32 v[40:41], v9 offset0:0 offset1:16
ds_read2_b32 v[42:43], v9 offset0:32 offset1:48
ds_read2_b32 v[44:45], v9 offset0:64 offset1:80
ds_read2_b32 v[46:47], v9 offset0:96 offset1:112
s_waitcnt lgkmcnt(7)
v_perm_b32 v176, v33, v32, s40
s_waitcnt lgkmcnt(6)
v_perm_b32 v177, v35, v34, s40
s_waitcnt lgkmcnt(5)
v_perm_b32 v178, v37, v36, s40
s_waitcnt lgkmcnt(4)
v_perm_b32 v179, v39, v38, s40
v_perm_b32 v180, v33, v32, s41
v_perm_b32 v181, v35, v34, s41
v_perm_b32 v182, v37, v36, s41
v_perm_b32 v183, v39, v38, s41
s_waitcnt vmcnt(14)
v_add_u32 v9, 36864, v29
ds_read2_b32 v[32:33], v9 offset0:0 offset1:16
ds_read2_b32 v[34:35], v9 offset0:32 offset1:48
ds_read2_b32 v[36:37], v9 offset0:64 offset1:80
ds_read2_b32 v[38:39], v9 offset0:96 offset1:112
s_waitcnt lgkmcnt(7)
v_perm_b32 v184, v41, v40, s40
s_waitcnt lgkmcnt(6)
v_perm_b32 v185, v43, v42, s40
s_waitcnt lgkmcnt(5)
v_perm_b32 v186, v45, v44, s40
s_waitcnt lgkmcnt(4)
v_perm_b32 v187, v47, v46, s40
v_perm_b32 v188, v41, v40, s41
v_perm_b32 v189, v43, v42, s41
v_perm_b32 v190, v45, v44, s41
v_perm_b32 v191, v47, v46, s41
s_waitcnt vmcnt(12)
v_add_u32 v9, 38912, v29
ds_read2_b32 v[40:41], v9 offset0:0 offset1:16
ds_read2_b32 v[42:43], v9 offset0:32 offset1:48
ds_read2_b32 v[44:45], v9 offset0:64 offset1:80
ds_read2_b32 v[46:47], v9 offset0:96 offset1:112
s_waitcnt lgkmcnt(7)
v_perm_b32 v192, v33, v32, s40
s_waitcnt lgkmcnt(6)
v_perm_b32 v193, v35, v34, s40
s_waitcnt lgkmcnt(5)
v_perm_b32 v194, v37, v36, s40
s_waitcnt lgkmcnt(4)
v_perm_b32 v195, v39, v38, s40
v_perm_b32 v196, v33, v32, s41
v_perm_b32 v197, v35, v34, s41
v_perm_b32 v198, v37, v36, s41
v_perm_b32 v199, v39, v38, s41
s_waitcnt vmcnt(10)
v_add_u32 v9, 0, v29
ds_read2_b32 v[32:33], v9 offset0:0 offset1:16
ds_read2_b32 v[34:35], v9 offset0:32 offset1:48
ds_read2_b32 v[36:37], v9 offset0:64 offset1:80
ds_read2_b32 v[38:39], v9 offset0:96 offset1:112
s_waitcnt lgkmcnt(7)
v_perm_b32 v200, v41, v40, s40
s_waitcnt lgkmcnt(6)
v_perm_b32 v201, v43, v42, s40
s_waitcnt lgkmcnt(5)
v_perm_b32 v202, v45, v44, s40
s_waitcnt lgkmcnt(4)
v_perm_b32 v203, v47, v46, s40
v_perm_b32 v204, v41, v40, s41
v_perm_b32 v205, v43, v42, s41
v_perm_b32 v206, v45, v44, s41
v_perm_b32 v207, v47, v46, s41
s_waitcnt vmcnt(8)
v_add_u32 v9, 2048, v29
ds_read2_b32 v[40:41], v9 offset0:0 offset1:16
ds_read2_b32 v[42:43], v9 offset0:32 offset1:48
ds_read2_b32 v[44:45], v9 offset0:64 offset1:80
ds_read2_b32 v[46:47], v9 offset0:96 offset1:112
s_waitcnt lgkmcnt(7)
v_perm_b32 v208, v33, v32, s40
s_waitcnt lgkmcnt(6)
v_perm_b32 v209, v35, v34, s40
s_waitcnt lgkmcnt(5)
v_perm_b32 v210, v37, v36, s40
s_waitcnt lgkmcnt(4)
v_perm_b32 v211, v39, v38, s40
v_perm_b32 v212, v33, v32, s41
v_perm_b32 v213, v35, v34, s41
v_perm_b32 v214, v37, v36, s41
v_perm_b32 v215, v39, v38, s41
s_waitcnt vmcnt(6)
v_add_u32 v9, 4096, v29
ds_read2_b32 v[32:33], v9 offset0:0 offset1:16
ds_read2_b32 v[34:35], v9 offset0:32 offset1:48
ds_read2_b32 v[36:37], v9 offset0:64 offset1:80
ds_read2_b32 v[38:39], v9 offset0:96 offset1:112
s_waitcnt lgkmcnt(7)
v_perm_b32 v216, v41, v40, s40
s_waitcnt lgkmcnt(6)
v_perm_b32 v217, v43, v42, s40
s_waitcnt lgkmcnt(5)
v_perm_b32 v218, v45, v44, s40
s_waitcnt lgkmcnt(4)
v_perm_b32 v219, v47, v46, s40
v_perm_b32 v220, v41, v40, s41
v_perm_b32 v221, v43, v42, s41
v_perm_b32 v222, v45, v44, s41
v_perm_b32 v223, v47, v46, s41
s_waitcnt vmcnt(4)
v_add_u32 v9, 6144, v29
ds_read2_b32 v[40:41], v9 offset0:0 offset1:16
ds_read2_b32 v[42:43], v9 offset0:32 offset1:48
ds_read2_b32 v[44:45], v9 offset0:64 offset1:80
ds_read2_b32 v[46:47], v9 offset0:96 offset1:112
s_waitcnt lgkmcnt(7)
v_perm_b32 v224, v33, v32, s40
s_waitcnt lgkmcnt(6)
v_perm_b32 v225, v35, v34, s40
s_waitcnt lgkmcnt(5)
v_perm_b32 v226, v37, v36, s40
s_waitcnt lgkmcnt(4)
v_perm_b32 v227, v39, v38, s40
v_perm_b32 v228, v33, v32, s41
v_perm_b32 v229, v35, v34, s41
v_perm_b32 v230, v37, v36, s41
v_perm_b32 v231, v39, v38, s41
s_waitcnt vmcnt(2)
v_add_u32 v9, 8192, v29
ds_read2_b32 v[32:33], v9 offset0:0 offset1:16
ds_read2_b32 v[34:35], v9 offset0:32 offset1:48
ds_read2_b32 v[36:37], v9 offset0:64 offset1:80
ds_read2_b32 v[38:39], v9 offset0:96 offset1:112
s_waitcnt lgkmcnt(7)
v_perm_b32 v232, v41, v40, s40
s_waitcnt lgkmcnt(6)
v_perm_b32 v233, v43, v42, s40
s_waitcnt lgkmcnt(5)
v_perm_b32 v234, v45, v44, s40
s_waitcnt lgkmcnt(4)
v_perm_b32 v235, v47, v46, s40
v_perm_b32 v236, v41, v40, s41
v_perm_b32 v237, v43, v42, s41
v_perm_b32 v238, v45, v44, s41
v_perm_b32 v239, v47, v46, s41
s_waitcnt vmcnt(0)
v_add_u32 v9, 10240, v29
ds_read2_b32 v[40:41], v9 offset0:0 offset1:16
ds_read2_b32 v[42:43], v9 offset0:32 offset1:48
ds_read2_b32 v[44:45], v9 offset0:64 offset1:80
ds_read2_b32 v[46:47], v9 offset0:96 offset1:112
s_waitcnt lgkmcnt(7)
v_perm_b32 v240, v33, v32, s40
s_waitcnt lgkmcnt(6)
v_perm_b32 v241, v35, v34, s40
s_waitcnt lgkmcnt(5)
v_perm_b32 v242, v37, v36, s40
s_waitcnt lgkmcnt(4)
v_perm_b32 v243, v39, v38, s40
v_perm_b32 v244, v33, v32, s41
v_perm_b32 v245, v35, v34, s41
v_perm_b32 v246, v37, v36, s41
v_perm_b32 v247, v39, v38, s41
s_waitcnt lgkmcnt(3)
v_perm_b32 v248, v41, v40, s40
s_waitcnt lgkmcnt(2)
v_perm_b32 v249, v43, v42, s40
s_waitcnt lgkmcnt(1)
v_perm_b32 v250, v45, v44, s40
s_waitcnt lgkmcnt(0)
v_perm_b32 v251, v47, v46, s40
v_perm_b32 v252, v41, v40, s41
v_perm_b32 v253, v43, v42, s41
v_perm_b32 v254, v45, v44, s41
v_perm_b32 v255, v47, v46, s41
v_lshlrev_b32 v7, 4, v7
buffer_load_dwordx4 v[16:19], v7, s[48:51], s19 offen
s_mov_b32 s56, 0xffff0000
s_waitcnt vmcnt(0)
v_lshlrev_b32 v8, 16, v16
v_and_b32 v12, s56, v16
v_lshlrev_b32 v9, 16, v17
v_and_b32 v13, s56, v17
v_lshlrev_b32 v10, 16, v18
v_and_b32 v14, s56, v18
v_lshlrev_b32 v11, 16, v19
v_and_b32 v15, s56, v19
s_cmp_ge_u32 s18, 3
s_cselect_b32 s20, 72, 0
s_add_u32 s20, s20, s18
s_mov_b32 s25, 0
s_barrier
s_lshl_b32 s32, s17, 28
v_add_u32 v31, s32, v6
v_mov_b32 v2, 0x102580
OP_e:
buffer_load_dword v3, v2, s[8:11], 0 offen sc1
s_waitcnt vmcnt(0)
v_and_b32 v3, 0xffff, v3
v_cmp_gt_u32 vcc, 22, v3
s_cbranch_vccz OP_eok
s_add_u32 s57, s57, 1
s_cmp_gt_u32 s57, 0x40000
s_cbranch_scc1 L_fail
s_sleep 16
s_branch OP_e
OP_eok:
s_mul_i32 s21, s20, 57344
s_lshl_b32 s32, s23, 10
s_add_u32 s21, s21, s32
s_add_u32 s21, s21, 8388608
s_lshr_b32 s34, s20, 1
s_lshl_b32 s26, s34, 12
s_lshl_b32 s33, s17, 10
s_add_u32 s26, s26, s33
s_add_u32 s26, s26, 1310720
s_cmp_lt_u32 s34, s25
s_cbranch_scc1 OP_h0_ok
OP_h0:
s_mov_b32 s32, 1048768
buffer_load_dword v2, v5, s[8:11], s32 offen sc1
s_waitcnt vmcnt(0)
v_min_u32_dpp v2, v2, v2 row_shl:4 row_mask:0xf bank_mask:0xf
s_nop 1
v_min_u32_dpp v2, v2, v2 row_shl:2 row_mask:0xf bank_mask:0xf
s_nop 1
v_min_u32_dpp v2, v2, v2 row_shl:1 row_mask:0xf bank_mask:0xf
s_nop 0
v_readlane_b32 s32, v2, 0
v_readlane_b32 s33, v2, 8
s_lshl_b32 s32, s32, 1
s_lshl_b32 s33, s33, 1
s_add_u32 s33, s33, 1
s_min_u32 s25, s32, s33
s_cmp_lt_u32 s34, s25
s_cbranch_scc1 OP_h0_ok
s_add_u32 s57, s57, 1
s_cmp_gt_u32 s57, 0x40000
s_cbranch_scc1 L_fail
s_sleep 16
s_branch OP_h0
OP_h0_ok:
s_add_u32 s35, s21, 0
buffer_load_dwordx4 v[32:35], v1, s[8:11], s35 offen offset:0 sc1
buffer_load_dwordx4 v[36:39], v1, s[8:11], s35 offen offset:1024 sc1
buffer_load_dwordx4 v[40:43], v1, s[8:11], s35 offen offset:2048 sc1
buffer_load_dwordx4 v[44:47], v1, s[8:11], s35 offen offset:3072 sc1
s_add_u32 s35, s21, 4096
buffer_load_dwordx4 v[48:51], v1, s[8:11], s35 offen offset:0 sc1
buffer_load_dwordx4 v[52:55], v1, s[8:11], s35 offen offset:1024 sc1
buffer_load_dwordx4 v[56:59], v1, s[8:11], s35 offen offset:2048 sc1
buffer_load_dwordx4 v[60:63], v1, s[8:11], s35 offen offset:3072 sc1
s_add_u32 s35, s21, 8192
buffer_load_dwordx4 v[64:67], v1, s[8:11], s35 offen offset:0 sc1
buffer_load_dwordx4 v[68:71], v1, s[8:11], s35 offen offset:1024 sc1
buffer_load_dwordx4 v[72:75], v1, s[8:11], s35 offen offset:2048 sc1
buffer_load_dwordx4 v[76:79], v1, s[8:11], s35 offen offset:3072 sc1
s_add_u32 s35, s21, 12288
buffer_load_dwordx4 v[80:83], v1, s[8:11], s35 offen offset:0 sc1
buffer_load_dwordx4 v[84:87], v1, s[8:11], s35 offen offset:1024 sc1
buffer_load_dword v30, v28, s[8:11], s26 offen sc1
v_mov_b32 v2, 0x7ffffff0
buffer_store_dword v2, v2, s[64:67], 0 offen
OP_job:
s_lshl_b32 s22, s20, 17
s_lshl_b32 s32, s17, 15
s_add_u32 s22, s22, s32
s_add_u32 s22, s22, 83886080
s_mul_i32 s24, s20, 20480
s_add_u32 s24, s24, s19
s_waitcnt vmcnt(15)
v_mfma_f32_16x16x32_bf16 v[20:23], v[144:147], v[32:35], 0
v_mfma_f32_16x16x32_bf16 v[24:27], v[148:151], v[32:35], 0
s_waitcnt vmcnt(14)
v_mfma_f32_16x16x32_bf16 v[20:23], v[152:155], v[36:39], v[20:23]
v_mfma_f32_16x16x32_bf16 v[24:27], v[156:159], v[36:39], v[24:27]
s_waitcnt vmcnt(13)
v_mfma_f32_16x16x32_bf16 v[20:23], v[160:163], v[40:43], v[20:23]
v_mfma_f32_16x16x32_bf16 v[24:27], v[164:167], v[40:43], v[24:27]
s_waitcnt vmcnt(12)
v_mfma_f32_16x16x32_bf16 v[20:23], v[168:171], v[44:47], v[20:23]
v_mfma_f32_16x16x32_bf16 v[24:27], v[172:175], v[44:47], v[24:27]
s_waitcnt vmcnt(11)
v_mfma_f32_16x16x32_bf16 v[20:23], v[176:179], v[48:51], v[20:23]
v_mfma_f32_16x16x32_bf16 v[24:27], v[180:183], v[48:51], v[24:27]
s_waitcnt vmcnt(10)
v_mfma_f32_16x16x32_bf16 v[20:23], v[184:187], v[52:55], v[20:23]
v_mfma_f32_16x16x32_bf16 v[24:27], v[188:191], v[52:55], v[24:27]
s_waitcnt vmcnt(9)
v_mfma_f32_16x16x32_bf16 v[20:23], v[192:195], v[56:59], v[20:23]
v_mfma_f32_16x16x32_bf16 v[24:27], v[196:199], v[56:59], v[24:27]
s_waitcnt vmcnt(8)
v_mfma_f32_16x16x32_bf16 v[20:23], v[200:203], v[60:63], v[20:23]
v_mfma_f32_16x16x32_bf16 v[24:27], v[204:207], v[60:63], v[24:27]
s_waitcnt vmcnt(7)
v_mfma_f32_16x16x32_bf16 v[20:23], v[208:211], v[64:67], v[20:23]
v_mfma_f32_16x16x32_bf16 v[24:27], v[212:215], v[64:67], v[24:27]
s_waitcnt vmcnt(6)
v_mfma_f32_16x16x32_bf16 v[20:23], v[216:219], v[68:71], v[20:23]
v_mfma_f32_16x16x32_bf16 v[24:27], v[220:223], v[68:71], v[24:27]
s_waitcnt vmcnt(5)
v_mfma_f32_16x16x32_bf16 v[20:23], v[224:227], v[72:75], v[20:23]
v_mfma_f32_16x16x32_bf16 v[24:27], v[228:231], v[72:75], v[24:27]
s_waitcnt vmcnt(4)
v_mfma_f32_16x16x32_bf16 v[20:23], v[232:235], v[76:79], v[20:23]
v_mfma_f32_16x16x32_bf16 v[24:27], v[236:239], v[76:79], v[24:27]
s_waitcnt vmcnt(3)
v_mfma_f32_16x16x32_bf16 v[20:23], v[240:243], v[80:83], v[20:23]
v_mfma_f32_16x16x32_bf16 v[24:27], v[244:247], v[80:83], v[24:27]
s_waitcnt vmcnt(0)
s_cmp_ge_u32 s17, 2
s_cbranch_scc1 OP_h13
v_mfma_f32_16x16x32_bf16 v[20:23], v[248:251], v[84:87], v[20:23]
v_mfma_f32_16x16x32_bf16 v[24:27], v[252:255], v[84:87], v[24:27]
OP_h13:
v_cmp_ne_u32 vcc, 1, v30
s_cbranch_vccz OP_w2ok
OP_w2:
buffer_load_dword v30, v28, s[8:11], s26 offen sc1
s_waitcnt vmcnt(0)
v_cmp_ne_u32 vcc, 1, v30
s_cbranch_vccz OP_w2ok
s_add_u32 s57, s57, 1
s_cmp_gt_u32 s57, 0x40000
s_cbranch_scc1 L_fail
s_sleep 4
s_branch OP_w2
OP_w2ok:
s_nop 7
s_add_u32 s35, s22, 0
buffer_load_dwordx4 v[88:91], v1, s[8:11], s35 offen offset:0 sc1
buffer_load_dwordx4 v[92:95], v1, s[8:11], s35 offen offset:1024 sc1
buffer_load_dwordx4 v[96:99], v1, s[8:11], s35 offen offset:2048 sc1
buffer_load_dwordx4 v[100:103], v1, s[8:11], s35 offen offset:3072 sc1
s_add_u32 s35, s22, 4096
buffer_load_dwordx4 v[104:107], v1, s[8:11], s35 offen offset:0 sc1
buffer_load_dwordx4 v[108:111], v1, s[8:11], s35 offen offset:1024 sc1
buffer_load_dwordx4 v[112:115], v1, s[8:11], s35 offen offset:2048 sc1
buffer_load_dwordx4 v[116:119], v1, s[8:11], s35 offen offset:3072 sc1
s_add_u32 s35, s22, 8192
buffer_load_dwordx4 v[120:123], v1, s[8:11], s35 offen offset:0 sc1
buffer_load_dwordx4 v[124:127], v1, s[8:11], s35 offen offset:1024 sc1
buffer_load_dwordx4 v[128:131], v1, s[8:11], s35 offen offset:2048 sc1
buffer_load_dwordx4 v[132:135], v1, s[8:11], s35 offen offset:3072 sc1
s_add_u32 s35, s22, 12288
buffer_load_dwordx4 v[136:139], v1, s[8:11], s35 offen offset:0 sc1
buffer_load_dwordx4 v[140:143], v1, s[8:11], s35 offen offset:1024 sc1
buffer_load_dwordx4 v[32:35], v1, s[8:11], s35 offen offset:2048 sc1
buffer_load_dwordx4 v[36:39], v1, s[8:11], s35 offen offset:3072 sc1
s_add_u32 s35, s22, 16384
buffer_load_dwordx4 v[40:43], v1, s[8:11], s35 offen offset:0 sc1
buffer_load_dwordx4 v[44:47], v1, s[8:11], s35 offen offset:1024 sc1
buffer_load_dwordx4 v[48:51], v1, s[8:11], s35 offen offset:2048 sc1
buffer_load_dwordx4 v[52:55], v1, s[8:11], s35 offen offset:3072 sc1
s_add_u32 s35, s22, 20480
buffer_load_dwordx4 v[56:59], v1, s[8:11], s35 offen offset:0 sc1
buffer_load_dwordx4 v[60:63], v1, s[8:11], s35 offen offset:1024 sc1
buffer_load_dwordx4 v[64:67], v1, s[8:11], s35 offen offset:2048 sc1
buffer_load_dwordx4 v[68:71], v1, s[8:11], s35 offen offset:3072 sc1
s_add_u32 s35, s22, 24576
buffer_load_dwordx4 v[72:75], v1, s[8:11], s35 offen offset:0 sc1
buffer_load_dwordx4 v[76:79], v1, s[8:11], s35 offen offset:1024 sc1
buffer_load_dwordx4 v[80:83], v1, s[8:11], s35 offen offset:2048 sc1
buffer_load_dwordx4 v[84:87], v1, s[8:11], s35 offen offset:3072 sc1
buffer_load_dwordx4 v[16:19], v6, s[52:55], s24 offen
s_waitcnt vmcnt(28)
v_mfma_f32_16x16x32_bf16 v[20:23], a[0:3], v[88:91], v[20:23]
v_mfma_f32_16x16x32_bf16 v[24:27], a[4:7], v[88:91], v[24:27]
s_add_u32 s35, s22, 28672
buffer_load_dwordx4 v[88:91], v1, s[8:11], s35 offen offset:0 sc1
s_waitcnt vmcnt(28)
v_mfma_f32_16x16x32_bf16 v[20:23], a[8:11], v[92:95], v[20:23]
v_mfma_f32_16x16x32_bf16 v[24:27], a[12:15], v[92:95], v[24:27]
buffer_load_dwordx4 v[92:95], v1, s[8:11], s35 offen offset:1024 sc1
s_waitcnt vmcnt(28)
v_mfma_f32_16x16x32_bf16 v[20:23], a[16:19], v[96:99], v[20:23]
v_mfma_f32_16x16x32_bf16 v[24:27], a[20:23], v[96:99], v[24:27]
buffer_load_dwordx4 v[96:99], v1, s[8:11], s35 offen offset:2048 sc1
s_waitcnt vmcnt(28)
v_mfma_f32_16x16x32_bf16 v[20:23], a[24:27], v[100:103], v[20:23]
v_mfma_f32_16x16x32_bf16 v[24:27], a[28:31], v[100:103], v[24:27]
buffer_load_dwordx4 v[100:103], v1, s[8:11], s35 offen offset:3072 sc1
s_waitcnt vmcnt(28)
v_mfma_f32_16x16x32_bf16 v[20:23], a[32:35], v[104:107], v[20:23]
v_mfma_f32_16x16x32_bf16 v[24:27], a[36:39], v[104:107], v[24:27]
s_waitcnt vmcnt(27)
v_mfma_f32_16x16x32_bf16 v[20:23], a[40:43], v[108:111], v[20:23]
v_mfma_f32_16x16x32_bf16 v[24:27], a[44:47], v[108:111], v[24:27]
s_waitcnt vmcnt(26)
v_mfma_f32_16x16x32_bf16 v[20:23], a[48:51], v[112:115], v[20:23]
v_mfma_f32_16x16x32_bf16 v[24:27], a[52:55], v[112:115], v[24:27]
s_waitcnt vmcnt(25)
v_mfma_f32_16x16x32_bf16 v[20:23], a[56:59], v[116:119], v[20:23]
v_mfma_f32_16x16x32_bf16 v[24:27], a[60:63], v[116:119], v[24:27]
s_waitcnt vmcnt(24)
v_mfma_f32_16x16x32_bf16 v[20:23], a[64:67], v[120:123], v[20:23]
v_mfma_f32_16x16x32_bf16 v[24:27], a[68:71], v[120:123], v[24:27]
s_waitcnt vmcnt(23)
v_mfma_f32_16x16x32_bf16 v[20:23], a[72:75], v[124:127], v[20:23]
v_mfma_f32_16x16x32_bf16 v[24:27], a[76:79], v[124:127], v[24:27]
s_waitcnt vmcnt(22)
v_mfma_f32_16x16x32_bf16 v[20:23], a[80:83], v[128:131], v[20:23]
v_mfma_f32_16x16x32_bf16 v[24:27], a[84:87], v[128:131], v[24:27]
s_waitcnt vmcnt(21)
v_mfma_f32_16x16x32_bf16 v[20:23], a[88:91], v[132:135], v[20:23]
v_mfma_f32_16x16x32_bf16 v[24:27], a[92:95], v[132:135], v[24:27]
s_waitcnt vmcnt(20)
v_mfma_f32_16x16x32_bf16 v[20:23], a[96:99], v[136:139], v[20:23]
v_mfma_f32_16x16x32_bf16 v[24:27], a[100:103], v[136:139], v[24:27]
s_waitcnt vmcnt(19)
v_mfma_f32_16x16x32_bf16 v[20:23], a[104:107], v[140:143], v[20:23]
v_mfma_f32_16x16x32_bf16 v[24:27], a[108:111], v[140:143], v[24:27]
s_waitcnt vmcnt(18)
v_mfma_f32_16x16x32_bf16 v[20:23], a[112:115], v[32:35], v[20:23]
v_mfma_f32_16x16x32_bf16 v[24:27], a[116:119], v[32:35], v[24:27]
s_waitcnt vmcnt(17)
v_mfma_f32_16x16x32_bf16 v[20:23], a[120:123], v[36:39], v[20:23]
v_mfma_f32_16x16x32_bf16 v[24:27], a[124:127], v[36:39], v[24:27]
s_waitcnt vmcnt(16)
v_mfma_f32_16x16x32_bf16 v[20:23], a[128:131], v[40:43], v[20:23]
v_mfma_f32_16x16x32_bf16 v[24:27], a[132:135], v[40:43], v[24:27]
s_waitcnt vmcnt(15)
v_mfma_f32_16x16x32_bf16 v[20:23], a[136:139], v[44:47], v[20:23]
v_mfma_f32_16x16x32_bf16 v[24:27], a[140:143], v[44:47], v[24:27]
s_waitcnt vmcnt(14)
v_mfma_f32_16x16x32_bf16 v[20:23], a[144:147], v[48:51], v[20:23]
v_mfma_f32_16x16x32_bf16 v[24:27], a[148:151], v[48:51], v[24:27]
s_waitcnt vmcnt(13)
v_mfma_f32_16x16x32_bf16 v[20:23], a[152:155], v[52:55], v[20:23]
v_mfma_f32_16x16x32_bf16 v[24:27], a[156:159], v[52:55], v[24:27]
s_waitcnt vmcnt(12)
v_mfma_f32_16x16x32_bf16 v[20:23], a[160:163], v[56:59], v[20:23]
v_mfma_f32_16x16x32_bf16 v[24:27], a[164:167], v[56:59], v[24:27]
s_waitcnt vmcnt(11)
v_mfma_f32_16x16x32_bf16 v[20:23], a[168:171], v[60:63], v[20:23]
v_mfma_f32_16x16x32_bf16 v[24:27], a[172:175], v[60:63], v[24:27]
s_waitcnt vmcnt(10)
v_mfma_f32_16x16x32_bf16 v[20:23], a[176:179], v[64:67], v[20:23]
v_mfma_f32_16x16x32_bf16 v[24:27], a[180:183], v[64:67], v[24:27]
s_waitcnt vmcnt(9)
v_mfma_f32_16x16x32_bf16 v[20:23], a[184:187], v[68:71], v[20:23]
v_mfma_f32_16x16x32_bf16 v[24:27], a[188:191], v[68:71], v[24:27]
s_waitcnt vmcnt(8)
v_mfma_f32_16x16x32_bf16 v[20:23], a[192:195], v[72:75], v[20:23]
v_mfma_f32_16x16x32_bf16 v[24:27], a[196:199], v[72:75], v[24:27]
s_waitcnt vmcnt(7)
v_mfma_f32_16x16x32_bf16 v[20:23], a[200:203], v[76:79], v[20:23]
v_mfma_f32_16x16x32_bf16 v[24:27], a[204:207], v[76:79], v[24:27]
s_waitcnt vmcnt(6)
v_mfma_f32_16x16x32_bf16 v[20:23], a[208:211], v[80:83], v[20:23]
v_mfma_f32_16x16x32_bf16 v[24:27], a[212:215], v[80:83], v[24:27]
s_waitcnt vmcnt(5)
v_mfma_f32_16x16x32_bf16 v[20:23], a[216:219], v[84:87], v[20:23]
v_mfma_f32_16x16x32_bf16 v[24:27], a[220:223], v[84:87], v[24:27]
s_cmp_lt_u32 s20, 72
s_cselect_b32 s37, 3, 6
s_add_u32 s37, s37, s20
s_min_u32 s20, s37, 127
s_mul_i32 s21, s20, 57344
s_lshl_b32 s32, s23, 10
s_add_u32 s21, s21, s32
s_add_u32 s21, s21, 8388608
s_lshr_b32 s34, s20, 1
s_lshl_b32 s26, s34, 12
s_lshl_b32 s33, s17, 10
s_add_u32 s26, s26, s33
s_add_u32 s26, s26, 1310720
s_cmp_lt_u32 s34, s25
s_cbranch_scc1 OP_h_ok
OP_h:
s_mov_b32 s32, 1048768
buffer_load_dword v2, v5, s[8:11], s32 offen sc1
s_waitcnt vmcnt(0)
v_min_u32_dpp v2, v2, v2 row_shl:4 row_mask:0xf bank_mask:0xf
s_nop 1
v_min_u32_dpp v2, v2, v2 row_shl:2 row_mask:0xf bank_mask:0xf
s_nop 1
v_min_u32_dpp v2, v2, v2 row_shl:1 row_mask:0xf bank_mask:0xf
s_nop 0
v_readlane_b32 s32, v2, 0
v_readlane_b32 s33, v2, 8
s_lshl_b32 s32, s32, 1
s_lshl_b32 s33, s33, 1
s_add_u32 s33, s33, 1
s_min_u32 s25, s32, s33
s_cmp_lt_u32 s34, s25
s_cbranch_scc1 OP_h_ok
s_add_u32 s57, s57, 1
s_cmp_gt_u32 s57, 0x40000
s_cbranch_scc1 L_fail
s_sleep 16
s_branch OP_h
OP_h_ok:
s_add_u32 s35, s21, 0
buffer_load_dwordx4 v[32:35], v1, s[8:11], s35 offen offset:0 sc1
buffer_load_dwordx4 v[36:39], v1, s[8:11], s35 offen offset:1024 sc1
buffer_load_dwordx4 v[40:43], v1, s[8:11], s35 offen offset:2048 sc1
buffer_load_dwordx4 v[44:47], v1, s[8:11], s35 offen offset:3072 sc1
s_add_u32 s35, s21, 4096
buffer_load_dwordx4 v[48:51], v1, s[8:11], s35 offen offset:0 sc1
buffer_load_dwordx4 v[52:55], v1, s[8:11], s35 offen offset:1024 sc1
buffer_load_dwordx4 v[56:59], v1, s[8:11], s35 offen offset:2048 sc1
buffer_load_dwordx4 v[60:63], v1, s[8:11], s35 offen offset:3072 sc1
s_add_u32 s35, s21, 8192
buffer_load_dwordx4 v[64:67], v1, s[8:11], s35 offen offset:0 sc1
buffer_load_dwordx4 v[68:71], v1, s[8:11], s35 offen offset:1024 sc1
buffer_load_dwordx4 v[72:75], v1, s[8:11], s35 offen offset:2048 sc1
buffer_load_dwordx4 v[76:79], v1, s[8:11], s35 offen offset:3072 sc1
s_add_u32 s35, s21, 12288
buffer_load_dwordx4 v[80:83], v1, s[8:11], s35 offen offset:0 sc1
buffer_load_dwordx4 v[84:87], v1, s[8:11], s35 offen offset:1024 sc1
buffer_load_dword v30, v28, s[8:11], s26 offen sc1
s_waitcnt vmcnt(18)
v_mfma_f32_16x16x32_bf16 v[20:23], a[224:227], v[88:91], v[20:23]
v_mfma_f32_16x16x32_bf16 v[24:27], a[228:231], v[88:91], v[24:27]
s_waitcnt vmcnt(17)
v_mfma_f32_16x16x32_bf16 v[20:23], a[232:235], v[92:95], v[20:23]
v_mfma_f32_16x16x32_bf16 v[24:27], a[236:239], v[92:95], v[24:27]
s_waitcnt vmcnt(16)
v_mfma_f32_16x16x32_bf16 v[20:23], a[240:243], v[96:99], v[20:23]
v_mfma_f32_16x16x32_bf16 v[24:27], a[244:247], v[96:99], v[24:27]
s_waitcnt vmcnt(15)
v_mfma_f32_16x16x32_bf16 v[20:23], a[248:251], v[100:103], v[20:23]
v_mfma_f32_16x16x32_bf16 v[24:27], a[252:255], v[100:103], v[24:27]
s_lshl_b32 s32, s17, 11
v_add_u32 v2, s32, v1
s_nop 1
ds_write_b128 v2, v[20:23] offset:0
s_nop 2
ds_write_b128 v2, v[24:27] offset:1024
s_waitcnt lgkmcnt(0)
s_barrier
s_cmp_lg_u32 s17, 0
s_cbranch_scc1 OP_skip
ds_read_b128 v[104:107], v1 offset:2048
ds_read_b128 v[108:111], v1 offset:3072
ds_read_b128 v[112:115], v1 offset:4096
ds_read_b128 v[116:119], v1 offset:5120
ds_read_b128 v[120:123], v1 offset:6144
ds_read_b128 v[124:127], v1 offset:7168
v_lshlrev_b32 v2, 16, v16
v_and_b32 v3, s56, v16
v_add_f32 v2, v2, v8
v_add_f32 v3, v3, v12
v_add_f32 v20, v20, v2
v_add_f32 v24, v24, v3
v_lshlrev_b32 v2, 16, v17
v_and_b32 v3, s56, v17
v_add_f32 v2, v2, v9
v_add_f32 v3, v3, v13
v_add_f32 v21, v21, v2
v_add_f32 v25, v25, v3
v_lshlrev_b32 v2, 16, v18
v_and_b32 v3, s56, v18
v_add_f32 v2, v2, v10
v_add_f32 v3, v3, v14
v_add_f32 v22, v22, v2
v_add_f32 v26, v26, v3
v_lshlrev_b32 v2, 16, v19
v_and_b32 v3, s56, v19
v_add_f32 v2, v2, v11
v_add_f32 v3, v3, v15
v_add_f32 v23, v23, v2
v_add_f32 v27, v27, v3
s_waitcnt lgkmcnt(5)
v_add_f32 v20, v20, v104
v_add_f32 v21, v21, v105
v_add_f32 v22, v22, v106
v_add_f32 v23, v23, v107
s_waitcnt lgkmcnt(4)
v_add_f32 v24, v24, v108
v_add_f32 v25, v25, v109
v_add_f32 v26, v26, v110
v_add_f32 v27, v27, v111
s_waitcnt lgkmcnt(3)
v_add_f32 v20, v20, v112
v_add_f32 v21, v21, v113
v_add_f32 v22, v22, v114
v_add_f32 v23, v23, v115
s_waitcnt lgkmcnt(2)
v_add_f32 v24, v24, v116
v_add_f32 v25, v25, v117
v_add_f32 v26, v26, v118
v_add_f32 v27, v27, v119
s_waitcnt lgkmcnt(1)
v_add_f32 v20, v20, v120
v_add_f32 v21, v21, v121
v_add_f32 v22, v22, v122
v_add_f32 v23, v23, v123
s_waitcnt lgkmcnt(0)
v_add_f32 v24, v24, v124
v_add_f32 v25, v25, v125
v_add_f32 v26, v26, v126
v_add_f32 v27, v27, v127
v_cvt_pk_bf16_f32 v104, v20, v24
v_cvt_pk_bf16_f32 v105, v21, v25
v_cvt_pk_bf16_f32 v106, v22, v26
v_cvt_pk_bf16_f32 v107, v23, v27
OP_skip:
buffer_store_dwordx4 v[104:107], v31, s[64:67], s24 offen
s_barrier
s_cmp_lt_u32 s37, 128
s_cbranch_scc1 OP_job
s_waitcnt vmcnt(0)
s_branch L_wend
L_g1:
s_and_b32 s19, s16, 1
s_lshr_b32 s18, s16, 1
s_lshl_b32 s33, s17, 6
s_cmp_lt_u32 s18, 32
s_cbranch_scc1 G1_kv
s_cmp_lt_u32 s18, 48
s_cbranch_scc1 G1_qq
s_cmp_lg_u32 s17, 0
s_cbranch_scc1 G1_d_all
v_mov_b32 v2, 0x40
G1_d_0:
buffer_load_dword v3, v2, s[60:63], 0 offen sc1
s_waitcnt vmcnt(0)
v_cmp_gt_u32 vcc, 0x1, v3
s_cbranch_vccz G1_d_0_ok
s_add_u32 s57, s57, 1
s_cmp_gt_u32 s57, 0x40000
s_cbranch_scc1 L_fail
s_sleep 8
s_branch G1_d_0
G1_d_0_ok:
v_mov_b32 v2, 0x102400
G1_d_1:
buffer_load_dword v3, v2, s[8:11], 0 offen sc1
s_waitcnt vmcnt(0)
v_cmp_gt_u32 vcc, 0x3c, v3
s_cbranch_vccz G1_d_1_ok
s_add_u32 s57, s57, 1
s_cmp_gt_u32 s57, 0x40000
s_cbranch_scc1 L_fail
s_sleep 8
s_branch G1_d_1
G1_d_1_ok:
G1_d_all:
s_barrier
s_load_dwordx2 s[12:13], s[0:1], 64
s_mov_b32 s14, 2211840
s_mov_b32 s15, 0x20000
s_load_dwordx2 s[44:45], s[0:1], 64
s_mov_b32 s46, 2211840
s_mov_b32 s47, 0x20000
s_sub_u32 s32, s18, 48
s_lshl_b32 s22, s32, 9
s_add_u32 s22, s22, s33
s_add_u32 s23, s22, 256
s_mov_b32 s24, 3456
s_lshl_b32 s25, s32, 13
s_lshl_b32 s34, s17, 10
s_add_u32 s25, s25, s34
s_mul_i32 s34, s19, 114688
s_add_u32 s25, s25, s34
s_add_u32 s25, s25, 8388608
s_add_u32 s26, s25, 4096
s_mov_b32 s27, 229376
s_branch G1_go
G1_qq:
s_waitcnt lgkmcnt(0)
s_load_dwordx2 s[12:13], s[0:1], 16
s_mov_b32 s14, 5242880
s_mov_b32 s15, 0x20000
s_load_dwordx2 s[44:45], s[0:1], 16
s_mov_b32 s46, 5242880
s_mov_b32 s47, 0x20000
s_sub_u32 s32, s18, 32
s_lshl_b32 s22, s32, 9
s_add_u32 s22, s22, s33
s_add_u32 s23, s22, 256
s_lshl_b32 s25, s32, 14
s_add_u32 s25, s25, 33554432
s_add_u32 s26, s25, 8192
s_branch G1_att
G1_kv:
s_waitcnt lgkmcnt(0)
s_load_dwordx2 s[12:13], s[0:1], 24
s_mov_b32 s14, 5242880
s_mov_b32 s15, 0x20000
s_load_dwordx2 s[44:45], s[0:1], 32
s_mov_b32 s46, 5242880
s_mov_b32 s47, 0x20000
s_lshl_b32 s22, s18, 8
s_add_u32 s22, s22, s33
s_mov_b32 s23, s22
s_lshl_b32 s25, s18, 13
s_add_u32 s26, s25, 67108864
s_add_u32 s25, s25, 50331648
G1_att:
s_mov_b32 s24, 8192
s_lshl_b32 s34, s17, 11
s_lshl_b32 s35, s19, 18
s_add_u32 s34, s34, s35
s_add_u32 s25, s25, s34
s_add_u32 s26, s26, s34
s_mov_b32 s27, 524288
G1_go:
s_waitcnt lgkmcnt(0)
s_mov_b32 s40, 0x05040100
s_mov_b32 s41, 0x07060302
v_lshlrev_b32 v1, 4, v0
v_lshrrev_b32 v5, 4, v0
v_and_b32 v6, 15, v0
s_lshl_b32 s32, s17, 3
v_add_u32 v7, s32, v5
v_mul_lo_u32 v4, v7, s24
v_lshl_add_u32 v4, v6, 4, v4
s_lshl_b32 s32, s17, 6
v_lshlrev_b32 v7, 11, v5
v_lshl_add_u32 v7, v6, 2, v7
v_add_u32 v8, s32, v7
v_add_u32 v9, 0x10000, v8
v_add_u32 v10, 0x20000, v8
s_lshl_b32 s42, s24, 5
s_lshl_b32 s64, s24, 2
s_lshl_b32 s65, s17, 11
s_sub_u32 s66, s22, s32
s_sub_u32 s67, s23, s32
s_add_u32 m0, s65, 0
s_nop 0
buffer_load_dwordx4 v4, s[12:15], s66 offen lds
s_add_u32 s39, s66, s64
s_add_u32 m0, s65, 1024
s_nop 0
buffer_load_dwordx4 v4, s[12:15], s39 offen lds
s_add_u32 s66, s66, s42
s_add_u32 m0, s65, 8192
s_nop 0
buffer_load_dwordx4 v4, s[44:47], s67 offen lds
s_add_u32 s39, s67, s64
s_add_u32 m0, s65, 9216
s_nop 0
buffer_load_dwordx4 v4, s[44:47], s39 offen lds
s_add_u32 s67, s67, s42
s_add_u32 m0, s65, 16384
s_nop 0
buffer_load_dwordx4 v4, s[12:15], s66 offen lds
s_add_u32 s39, s66, s64
s_add_u32 m0, s65, 17408
s_nop 0
buffer_load_dwordx4 v4, s[12:15], s39 offen lds
s_add_u32 s66, s66, s42
s_add_u32 m0, s65, 24576
s_nop 0
buffer_load_dwordx4 v4, s[44:47], s67 offen lds
s_add_u32 s39, s67, s64
s_add_u32 m0, s65, 25600
s_nop 0
buffer_load_dwordx4 v4, s[44:47], s39 offen lds
s_add_u32 s67, s67, s42
s_add_u32 m0, s65, 32768
s_nop 0
buffer_load_dwordx4 v4, s[12:15], s66 offen lds
s_add_u32 s39, s66, s64
s_add_u32 m0, s65, 33792
s_nop 0
buffer_load_dwordx4 v4, s[12:15], s39 offen lds
s_add_u32 s66, s66, s42
s_add_u32 m0, s65, 40960
s_nop 0
buffer_load_dwordx4 v4, s[44:47], s67 offen lds
s_add_u32 s39, s67, s64
s_add_u32 m0, s65, 41984
s_nop 0
buffer_load_dwordx4 v4, s[44:47], s39 offen lds
s_add_u32 s67, s67, s42
s_add_u32 m0, s65, 49152
s_nop 0
buffer_load_dwordx4 v4, s[12:15], s66 offen lds
s_add_u32 s39, s66, s64
s_add_u32 m0, s65, 50176
s_nop 0
buffer_load_dwordx4 v4, s[12:15], s39 offen lds
s_add_u32 s66, s66, s42
s_add_u32 m0, s65, 57344
s_nop 0
buffer_load_dwordx4 v4, s[44:47], s67 offen lds
s_add_u32 s39, s67, s64
s_add_u32 m0, s65, 58368
s_nop 0
buffer_load_dwordx4 v4, s[44:47], s39 offen lds
s_add_u32 s67, s67, s42
s_add_u32 m0, s65, 65536
s_nop 0
buffer_load_dwordx4 v4, s[12:15], s66 offen lds
s_add_u32 s39, s66, s64
s_add_u32 m0, s65, 66560
s_nop 0
buffer_load_dwordx4 v4, s[12:15], s39 offen lds
s_add_u32 s66, s66, s42
s_add_u32 m0, s65, 73728
s_nop 0
buffer_load_dwordx4 v4, s[44:47], s67 offen lds
s_add_u32 s39, s67, s64
s_add_u32 m0, s65, 74752
s_nop 0
buffer_load_dwordx4 v4, s[44:47], s39 offen lds
s_add_u32 s67, s67, s42
s_add_u32 m0, s65, 81920
s_nop 0
buffer_load_dwordx4 v4, s[12:15], s66 offen lds
s_add_u32 s39, s66, s64
s_add_u32 m0, s65, 82944
s_nop 0
buffer_load_dwordx4 v4, s[12:15], s39 offen lds
s_add_u32 s66, s66, s42
s_add_u32 m0, s65, 90112
s_nop 0
buffer_load_dwordx4 v4, s[44:47], s67 offen lds
s_add_u32 s39, s67, s64
s_add_u32 m0, s65, 91136
s_nop 0
buffer_load_dwordx4 v4, s[44:47], s39 offen lds
s_add_u32 s67, s67, s42
s_add_u32 m0, s65, 98304
s_nop 0
buffer_load_dwordx4 v4, s[12:15], s66 offen lds
s_add_u32 s39, s66, s64
s_add_u32 m0, s65, 99328
s_nop 0
buffer_load_dwordx4 v4, s[12:15], s39 offen lds
s_add_u32 s66, s66, s42
s_add_u32 m0, s65, 106496
s_nop 0
buffer_load_dwordx4 v4, s[44:47], s67 offen lds
s_add_u32 s39, s67, s64
s_add_u32 m0, s65, 107520
s_nop 0
buffer_load_dwordx4 v4, s[44:47], s39 offen lds
s_add_u32 s67, s67, s42
s_add_u32 m0, s65, 114688
s_nop 0
buffer_load_dwordx4 v4, s[12:15], s66 offen lds
s_add_u32 s39, s66, s64
s_add_u32 m0, s65, 115712
s_nop 0
buffer_load_dwordx4 v4, s[12:15], s39 offen lds
s_add_u32 s66, s66, s42
s_add_u32 m0, s65, 122880
s_nop 0
buffer_load_dwordx4 v4, s[44:47], s67 offen lds
s_add_u32 s39, s67, s64
s_add_u32 m0, s65, 123904
s_nop 0
buffer_load_dwordx4 v4, s[44:47], s39 offen lds
s_add_u32 s67, s67, s42
s_add_u32 m0, s65, 131072
s_nop 0
buffer_load_dwordx4 v4, s[12:15], s66 offen lds
s_add_u32 s39, s66, s64
s_add_u32 m0, s65, 132096
s_nop 0
buffer_load_dwordx4 v4, s[12:15], s39 offen lds
s_add_u32 s66, s66, s42
s_add_u32 m0, s65, 139264
s_nop 0
buffer_load_dwordx4 v4, s[44:47], s67 offen lds
s_add_u32 s39, s67, s64
s_add_u32 m0, s65, 140288
s_nop 0
buffer_load_dwordx4 v4, s[44:47], s39 offen lds
s_add_u32 s67, s67, s42
s_add_u32 m0, s65, 147456
s_nop 0
buffer_load_dwordx4 v4, s[12:15], s66 offen lds
s_add_u32 s39, s66, s64
s_add_u32 m0, s65, 148480
s_nop 0
buffer_load_dwordx4 v4, s[12:15], s39 offen lds
s_add_u32 s66, s66, s42
s_add_u32 m0, s65, 155648
s_nop 0
buffer_load_dwordx4 v4, s[44:47], s67 offen lds
s_add_u32 s39, s67, s64
s_add_u32 m0, s65, 156672
s_nop 0
buffer_load_dwordx4 v4, s[44:47], s39 offen lds
s_add_u32 s67, s67, s42
s_waitcnt vmcnt(36)
s_barrier
ds_read2st64_b32 v[16:17], v8 offset0:0 offset1:1
ds_read2st64_b32 v[18:19], v8 offset0:2 offset1:3
ds_read2st64_b32 v[20:21], v8 offset0:4 offset1:5
ds_read2st64_b32 v[22:23], v8 offset0:6 offset1:7
ds_read2st64_b32 v[24:25], v8 offset0:32 offset1:33
ds_read2st64_b32 v[26:27], v8 offset0:34 offset1:35
ds_read2st64_b32 v[28:29], v8 offset0:36 offset1:37
ds_read2st64_b32 v[30:31], v8 offset0:38 offset1:39
s_waitcnt vmcnt(32)
s_waitcnt lgkmcnt(0)
s_barrier
ds_read2st64_b32 v[32:33], v8 offset0:64 offset1:65
ds_read2st64_b32 v[34:35], v8 offset0:66 offset1:67
ds_read2st64_b32 v[36:37], v8 offset0:68 offset1:69
ds_read2st64_b32 v[38:39], v8 offset0:70 offset1:71
ds_read2st64_b32 v[40:41], v8 offset0:96 offset1:97
ds_read2st64_b32 v[42:43], v8 offset0:98 offset1:99
ds_read2st64_b32 v[44:45], v8 offset0:100 offset1:101
ds_read2st64_b32 v[46:47], v8 offset0:102 offset1:103
s_add_u32 m0, s65, 0
s_nop 0
buffer_load_dwordx4 v4, s[12:15], s66 offen lds
s_add_u32 s39, s66, s64
s_add_u32 m0, s65, 1024
s_nop 0
buffer_load_dwordx4 v4, s[12:15], s39 offen lds
s_add_u32 s66, s66, s42
v_perm_b32 v2, v17, v16, s40
v_accvgpr_write_b32 a0, v2
v_perm_b32 v3, v19, v18, s40
v_accvgpr_write_b32 a1, v3
v_perm_b32 v2, v21, v20, s40
v_accvgpr_write_b32 a2, v2
v_perm_b32 v3, v23, v22, s40
v_accvgpr_write_b32 a3, v3
v_perm_b32 v2, v17, v16, s41
v_accvgpr_write_b32 a4, v2
v_perm_b32 v3, v19, v18, s41
v_accvgpr_write_b32 a5, v3
v_perm_b32 v2, v21, v20, s41
v_accvgpr_write_b32 a6, v2
v_perm_b32 v3, v23, v22, s41
v_accvgpr_write_b32 a7, v3
s_add_u32 m0, s65, 8192
s_nop 0
buffer_load_dwordx4 v4, s[44:47], s67 offen lds
s_add_u32 s39, s67, s64
s_add_u32 m0, s65, 9216
s_nop 0
buffer_load_dwordx4 v4, s[44:47], s39 offen lds
s_add_u32 s67, s67, s42
v_perm_b32 v2, v25, v24, s40
v_accvgpr_write_b32 a160, v2
v_perm_b32 v3, v27, v26, s40
v_accvgpr_write_b32 a161, v3
v_perm_b32 v2, v29, v28, s40
v_accvgpr_write_b32 a162, v2
v_perm_b32 v3, v31, v30, s40
v_accvgpr_write_b32 a163, v3
v_perm_b32 v2, v25, v24, s41
v_accvgpr_write_b32 a164, v2
v_perm_b32 v3, v27, v26, s41
v_accvgpr_write_b32 a165, v3
v_perm_b32 v2, v29, v28, s41
v_accvgpr_write_b32 a166, v2
v_perm_b32 v3, v31, v30, s41
v_accvgpr_write_b32 a167, v3
s_waitcnt vmcnt(32)
s_waitcnt lgkmcnt(0)
s_barrier
ds_read2st64_b32 v[16:17], v8 offset0:128 offset1:129
ds_read2st64_b32 v[18:19], v8 offset0:130 offset1:131
ds_read2st64_b32 v[20:21], v8 offset0:132 offset1:133
ds_read2st64_b32 v[22:23], v8 offset0:134 offset1:135
ds_read2st64_b32 v[24:25], v8 offset0:160 offset1:161
ds_read2st64_b32 v[26:27], v8 offset0:162 offset1:163
ds_read2st64_b32 v[28:29], v8 offset0:164 offset1:165
ds_read2st64_b32 v[30:31], v8 offset0:166 offset1:167
s_add_u32 m0, s65, 16384
s_nop 0
buffer_load_dwordx4 v4, s[12:15], s66 offen lds
s_add_u32 s39, s66, s64
s_add_u32 m0, s65, 17408
s_nop 0
buffer_load_dwordx4 v4, s[12:15], s39 offen lds
s_add_u32 s66, s66, s42
v_perm_b32 v2, v33, v32, s40
v_accvgpr_write_b32 a8, v2
v_perm_b32 v3, v35, v34, s40
v_accvgpr_write_b32 a9, v3
v_perm_b32 v2, v37, v36, s40
v_accvgpr_write_b32 a10, v2
v_perm_b32 v3, v39, v38, s40
v_accvgpr_write_b32 a11, v3
v_perm_b32 v2, v33, v32, s41
v_accvgpr_write_b32 a12, v2
v_perm_b32 v3, v35, v34, s41
v_accvgpr_write_b32 a13, v3
v_perm_b32 v2, v37, v36, s41
v_accvgpr_write_b32 a14, v2
v_perm_b32 v3, v39, v38, s41
v_accvgpr_write_b32 a15, v3
s_add_u32 m0, s65, 24576
s_nop 0
buffer_load_dwordx4 v4, s[44:47], s67 offen lds
s_add_u32 s39, s67, s64
s_add_u32 m0, s65, 25600
s_nop 0
buffer_load_dwordx4 v4, s[44:47], s39 offen lds
s_add_u32 s67, s67, s42
v_perm_b32 v2, v41, v40, s40
v_accvgpr_write_b32 a168, v2
v_perm_b32 v3, v43, v42, s40
v_accvgpr_write_b32 a169, v3
v_perm_b32 v2, v45, v44, s40
v_accvgpr_write_b32 a170, v2
v_perm_b32 v3, v47, v46, s40
v_accvgpr_write_b32 a171, v3
v_perm_b32 v2, v41, v40, s41
v_accvgpr_write_b32 a172, v2
v_perm_b32 v3, v43, v42, s41
v_accvgpr_write_b32 a173, v3
v_perm_b32 v2, v45, v44, s41
v_accvgpr_write_b32 a174, v2
v_perm_b32 v3, v47, v46, s41
v_accvgpr_write_b32 a175, v3
s_waitcnt vmcnt(32)
s_waitcnt lgkmcnt(0)
s_barrier
ds_read2st64_b32 v[32:33], v8 offset0:192 offset1:193
ds_read2st64_b32 v[34:35], v8 offset0:194 offset1:195
ds_read2st64_b32 v[36:37], v8 offset0:196 offset1:197
ds_read2st64_b32 v[38:39], v8 offset0:198 offset1:199
ds_read2st64_b32 v[40:41], v8 offset0:224 offset1:225
ds_read2st64_b32 v[42:43], v8 offset0:226 offset1:227
ds_read2st64_b32 v[44:45], v8 offset0:228 offset1:229
ds_read2st64_b32 v[46:47], v8 offset0:230 offset1:231
s_add_u32 m0, s65, 32768
s_nop 0
buffer_load_dwordx4 v4, s[12:15], s66 offen lds
s_add_u32 s39, s66, s64
s_add_u32 m0, s65, 33792
s_nop 0
buffer_load_dwordx4 v4, s[12:15], s39 offen lds
s_add_u32 s66, s66, s42
v_perm_b32 v2, v17, v16, s40
v_accvgpr_write_b32 a16, v2
v_perm_b32 v3, v19, v18, s40
v_accvgpr_write_b32 a17, v3
v_perm_b32 v2, v21, v20, s40
v_accvgpr_write_b32 a18, v2
v_perm_b32 v3, v23, v22, s40
v_accvgpr_write_b32 a19, v3
v_perm_b32 v2, v17, v16, s41
v_accvgpr_write_b32 a20, v2
v_perm_b32 v3, v19, v18, s41
v_accvgpr_write_b32 a21, v3
v_perm_b32 v2, v21, v20, s41
v_accvgpr_write_b32 a22, v2
v_perm_b32 v3, v23, v22, s41
v_accvgpr_write_b32 a23, v3
s_add_u32 m0, s65, 40960
s_nop 0
buffer_load_dwordx4 v4, s[44:47], s67 offen lds
s_add_u32 s39, s67, s64
s_add_u32 m0, s65, 41984
s_nop 0
buffer_load_dwordx4 v4, s[44:47], s39 offen lds
s_add_u32 s67, s67, s42
v_perm_b32 v2, v25, v24, s40
v_accvgpr_write_b32 a176, v2
v_perm_b32 v3, v27, v26, s40
v_accvgpr_write_b32 a177, v3
v_perm_b32 v2, v29, v28, s40
v_accvgpr_write_b32 a178, v2
v_perm_b32 v3, v31, v30, s40
v_accvgpr_write_b32 a179, v3
v_perm_b32 v2, v25, v24, s41
v_accvgpr_write_b32 a180, v2
v_perm_b32 v3, v27, v26, s41
v_accvgpr_write_b32 a181, v3
v_perm_b32 v2, v29, v28, s41
v_accvgpr_write_b32 a182, v2
v_perm_b32 v3, v31, v30, s41
v_accvgpr_write_b32 a183, v3
s_waitcnt vmcnt(32)
s_waitcnt lgkmcnt(0)
s_barrier
ds_read2st64_b32 v[16:17], v9 offset0:0 offset1:1
ds_read2st64_b32 v[18:19], v9 offset0:2 offset1:3
ds_read2st64_b32 v[20:21], v9 offset0:4 offset1:5
ds_read2st64_b32 v[22:23], v9 offset0:6 offset1:7
ds_read2st64_b32 v[24:25], v9 offset0:32 offset1:33
ds_read2st64_b32 v[26:27], v9 offset0:34 offset1:35
ds_read2st64_b32 v[28:29], v9 offset0:36 offset1:37
ds_read2st64_b32 v[30:31], v9 offset0:38 offset1:39
s_add_u32 m0, s65, 49152
s_nop 0
buffer_load_dwordx4 v4, s[12:15], s66 offen lds
s_add_u32 s39, s66, s64
s_add_u32 m0, s65, 50176
s_nop 0
buffer_load_dwordx4 v4, s[12:15], s39 offen lds
s_add_u32 s66, s66, s42
v_perm_b32 v2, v33, v32, s40
v_accvgpr_write_b32 a24, v2
v_perm_b32 v3, v35, v34, s40
v_accvgpr_write_b32 a25, v3
v_perm_b32 v2, v37, v36, s40
v_accvgpr_write_b32 a26, v2
v_perm_b32 v3, v39, v38, s40
v_accvgpr_write_b32 a27, v3
v_perm_b32 v2, v33, v32, s41
v_accvgpr_write_b32 a28, v2
v_perm_b32 v3, v35, v34, s41
v_accvgpr_write_b32 a29, v3
v_perm_b32 v2, v37, v36, s41
v_accvgpr_write_b32 a30, v2
v_perm_b32 v3, v39, v38, s41
v_accvgpr_write_b32 a31, v3
s_add_u32 m0, s65, 57344
s_nop 0
buffer_load_dwordx4 v4, s[44:47], s67 offen lds
s_add_u32 s39, s67, s64
s_add_u32 m0, s65, 58368
s_nop 0
buffer_load_dwordx4 v4, s[44:47], s39 offen lds
s_add_u32 s67, s67, s42
v_perm_b32 v2, v41, v40, s40
v_accvgpr_write_b32 a184, v2
v_perm_b32 v3, v43, v42, s40
v_accvgpr_write_b32 a185, v3
v_perm_b32 v2, v45, v44, s40
v_accvgpr_write_b32 a186, v2
v_perm_b32 v3, v47, v46, s40
v_accvgpr_write_b32 a187, v3
v_perm_b32 v2, v41, v40, s41
v_accvgpr_write_b32 a188, v2
v_perm_b32 v3, v43, v42, s41
v_accvgpr_write_b32 a189, v3
v_perm_b32 v2, v45, v44, s41
v_accvgpr_write_b32 a190, v2
v_perm_b32 v3, v47, v46, s41
v_accvgpr_write_b32 a191, v3
s_waitcnt vmcnt(32)
s_waitcnt lgkmcnt(0)
s_barrier
ds_read2st64_b32 v[32:33], v9 offset0:64 offset1:65
ds_read2st64_b32 v[34:35], v9 offset0:66 offset1:67
ds_read2st64_b32 v[36:37], v9 offset0:68 offset1:69
ds_read2st64_b32 v[38:39], v9 offset0:70 offset1:71
ds_read2st64_b32 v[40:41], v9 offset0:96 offset1:97
ds_read2st64_b32 v[42:43], v9 offset0:98 offset1:99
ds_read2st64_b32 v[44:45], v9 offset0:100 offset1:101
ds_read2st64_b32 v[46:47], v9 offset0:102 offset1:103
s_add_u32 m0, s65, 65536
s_nop 0
buffer_load_dwordx4 v4, s[12:15], s66 offen lds
s_add_u32 s39, s66, s64
s_add_u32 m0, s65, 66560
s_nop 0
buffer_load_dwordx4 v4, s[12:15], s39 offen lds
s_add_u32 s66, s66, s42
v_perm_b32 v2, v17, v16, s40
v_accvgpr_write_b32 a32, v2
v_perm_b32 v3, v19, v18, s40
v_accvgpr_write_b32 a33, v3
v_perm_b32 v2, v21, v20, s40
v_accvgpr_write_b32 a34, v2
v_perm_b32 v3, v23, v22, s40
v_accvgpr_write_b32 a35, v3
v_perm_b32 v2, v17, v16, s41
v_accvgpr_write_b32 a36, v2
v_perm_b32 v3, v19, v18, s41
v_accvgpr_write_b32 a37, v3
v_perm_b32 v2, v21, v20, s41
v_accvgpr_write_b32 a38, v2
v_perm_b32 v3, v23, v22, s41
v_accvgpr_write_b32 a39, v3
s_add_u32 m0, s65, 73728
s_nop 0
buffer_load_dwordx4 v4, s[44:47], s67 offen lds
s_add_u32 s39, s67, s64
s_add_u32 m0, s65, 74752
s_nop 0
buffer_load_dwordx4 v4, s[44:47], s39 offen lds
s_add_u32 s67, s67, s42
v_perm_b32 v2, v25, v24, s40
v_accvgpr_write_b32 a192, v2
v_perm_b32 v3, v27, v26, s40
v_accvgpr_write_b32 a193, v3
v_perm_b32 v2, v29, v28, s40
v_accvgpr_write_b32 a194, v2
v_perm_b32 v3, v31, v30, s40
v_accvgpr_write_b32 a195, v3
v_perm_b32 v2, v25, v24, s41
v_accvgpr_write_b32 a196, v2
v_perm_b32 v3, v27, v26, s41
v_accvgpr_write_b32 a197, v3
v_perm_b32 v2, v29, v28, s41
v_accvgpr_write_b32 a198, v2
v_perm_b32 v3, v31, v30, s41
v_accvgpr_write_b32 a199, v3
s_waitcnt vmcnt(32)
s_waitcnt lgkmcnt(0)
s_barrier
ds_read2st64_b32 v[16:17], v9 offset0:128 offset1:129
ds_read2st64_b32 v[18:19], v9 offset0:130 offset1:131
ds_read2st64_b32 v[20:21], v9 offset0:132 offset1:133
ds_read2st64_b32 v[22:23], v9 offset0:134 offset1:135
ds_read2st64_b32 v[24:25], v9 offset0:160 offset1:161
ds_read2st64_b32 v[26:27], v9 offset0:162 offset1:163
ds_read2st64_b32 v[28:29], v9 offset0:164 offset1:165
ds_read2st64_b32 v[30:31], v9 offset0:166 offset1:167
s_add_u32 m0, s65, 81920
s_nop 0
buffer_load_dwordx4 v4, s[12:15], s66 offen lds
s_add_u32 s39, s66, s64
s_add_u32 m0, s65, 82944
s_nop 0
buffer_load_dwordx4 v4, s[12:15], s39 offen lds
s_add_u32 s66, s66, s42
v_perm_b32 v2, v33, v32, s40
v_accvgpr_write_b32 a40, v2
v_perm_b32 v3, v35, v34, s40
v_accvgpr_write_b32 a41, v3
v_perm_b32 v2, v37, v36, s40
v_accvgpr_write_b32 a42, v2
v_perm_b32 v3, v39, v38, s40
v_accvgpr_write_b32 a43, v3
v_perm_b32 v2, v33, v32, s41
v_accvgpr_write_b32 a44, v2
v_perm_b32 v3, v35, v34, s41
v_accvgpr_write_b32 a45, v3
v_perm_b32 v2, v37, v36, s41
v_accvgpr_write_b32 a46, v2
v_perm_b32 v3, v39, v38, s41
v_accvgpr_write_b32 a47, v3
s_add_u32 m0, s65, 90112
s_nop 0
buffer_load_dwordx4 v4, s[44:47], s67 offen lds
s_add_u32 s39, s67, s64
s_add_u32 m0, s65, 91136
s_nop 0
buffer_load_dwordx4 v4, s[44:47], s39 offen lds
s_add_u32 s67, s67, s42
v_perm_b32 v2, v41, v40, s40
v_accvgpr_write_b32 a200, v2
v_perm_b32 v3, v43, v42, s40
v_accvgpr_write_b32 a201, v3
v_perm_b32 v2, v45, v44, s40
v_accvgpr_write_b32 a202, v2
v_perm_b32 v3, v47, v46, s40
v_accvgpr_write_b32 a203, v3
v_perm_b32 v2, v41, v40, s41
v_accvgpr_write_b32 a204, v2
v_perm_b32 v3, v43, v42, s41
v_accvgpr_write_b32 a205, v3
v_perm_b32 v2, v45, v44, s41
v_accvgpr_write_b32 a206, v2
v_perm_b32 v3, v47, v46, s41
v_accvgpr_write_b32 a207, v3
s_waitcnt vmcnt(32)
s_waitcnt lgkmcnt(0)
s_barrier
ds_read2st64_b32 v[32:33], v9 offset0:192 offset1:193
ds_read2st64_b32 v[34:35], v9 offset0:194 offset1:195
ds_read2st64_b32 v[36:37], v9 offset0:196 offset1:197
ds_read2st64_b32 v[38:39], v9 offset0:198 offset1:199
ds_read2st64_b32 v[40:41], v9 offset0:224 offset1:225
ds_read2st64_b32 v[42:43], v9 offset0:226 offset1:227
ds_read2st64_b32 v[44:45], v9 offset0:228 offset1:229
ds_read2st64_b32 v[46:47], v9 offset0:230 offset1:231
s_add_u32 m0, s65, 98304
s_nop 0
buffer_load_dwordx4 v4, s[12:15], s66 offen lds
s_add_u32 s39, s66, s64
s_add_u32 m0, s65, 99328
s_nop 0
buffer_load_dwordx4 v4, s[12:15], s39 offen lds
s_add_u32 s66, s66, s42
v_perm_b32 v2, v17, v16, s40
v_accvgpr_write_b32 a48, v2
v_perm_b32 v3, v19, v18, s40
v_accvgpr_write_b32 a49, v3
v_perm_b32 v2, v21, v20, s40
v_accvgpr_write_b32 a50, v2
v_perm_b32 v3, v23, v22, s40
v_accvgpr_write_b32 a51, v3
v_perm_b32 v2, v17, v16, s41
v_accvgpr_write_b32 a52, v2
v_perm_b32 v3, v19, v18, s41
v_accvgpr_write_b32 a53, v3
v_perm_b32 v2, v21, v20, s41
v_accvgpr_write_b32 a54, v2
v_perm_b32 v3, v23, v22, s41
v_accvgpr_write_b32 a55, v3
s_add_u32 m0, s65, 106496
s_nop 0
buffer_load_dwordx4 v4, s[44:47], s67 offen lds
s_add_u32 s39, s67, s64
s_add_u32 m0, s65, 107520
s_nop 0
buffer_load_dwordx4 v4, s[44:47], s39 offen lds
s_add_u32 s67, s67, s42
v_perm_b32 v2, v25, v24, s40
v_accvgpr_write_b32 a208, v2
v_perm_b32 v3, v27, v26, s40
v_accvgpr_write_b32 a209, v3
v_perm_b32 v2, v29, v28, s40
v_accvgpr_write_b32 a210, v2
v_perm_b32 v3, v31, v30, s40
v_accvgpr_write_b32 a211, v3
v_perm_b32 v2, v25, v24, s41
v_accvgpr_write_b32 a212, v2
v_perm_b32 v3, v27, v26, s41
v_accvgpr_write_b32 a213, v3
v_perm_b32 v2, v29, v28, s41
v_accvgpr_write_b32 a214, v2
v_perm_b32 v3, v31, v30, s41
v_accvgpr_write_b32 a215, v3
s_waitcnt vmcnt(32)
s_waitcnt lgkmcnt(0)
s_barrier
ds_read2st64_b32 v[16:17], v10 offset0:0 offset1:1
ds_read2st64_b32 v[18:19], v10 offset0:2 offset1:3
ds_read2st64_b32 v[20:21], v10 offset0:4 offset1:5
ds_read2st64_b32 v[22:23], v10 offset0:6 offset1:7
ds_read2st64_b32 v[24:25], v10 offset0:32 offset1:33
ds_read2st64_b32 v[26:27], v10 offset0:34 offset1:35
ds_read2st64_b32 v[28:29], v10 offset0:36 offset1:37
ds_read2st64_b32 v[30:31], v10 offset0:38 offset1:39
s_add_u32 m0, s65, 114688
s_nop 0
buffer_load_dwordx4 v4, s[12:15], s66 offen lds
s_add_u32 s39, s66, s64
s_add_u32 m0, s65, 115712
s_nop 0
buffer_load_dwordx4 v4, s[12:15], s39 offen lds
s_add_u32 s66, s66, s42
v_perm_b32 v2, v33, v32, s40
v_accvgpr_write_b32 a56, v2
v_perm_b32 v3, v35, v34, s40
v_accvgpr_write_b32 a57, v3
v_perm_b32 v2, v37, v36, s40
v_accvgpr_write_b32 a58, v2
v_perm_b32 v3, v39, v38, s40
v_accvgpr_write_b32 a59, v3
v_perm_b32 v2, v33, v32, s41
v_accvgpr_write_b32 a60, v2
v_perm_b32 v3, v35, v34, s41
v_accvgpr_write_b32 a61, v3
v_perm_b32 v2, v37, v36, s41
v_accvgpr_write_b32 a62, v2
v_perm_b32 v3, v39, v38, s41
v_accvgpr_write_b32 a63, v3
s_add_u32 m0, s65, 122880
s_nop 0
buffer_load_dwordx4 v4, s[44:47], s67 offen lds
s_add_u32 s39, s67, s64
s_add_u32 m0, s65, 123904
s_nop 0
buffer_load_dwordx4 v4, s[44:47], s39 offen lds
s_add_u32 s67, s67, s42
v_perm_b32 v2, v41, v40, s40
v_accvgpr_write_b32 a216, v2
v_perm_b32 v3, v43, v42, s40
v_accvgpr_write_b32 a217, v3
v_perm_b32 v2, v45, v44, s40
v_accvgpr_write_b32 a218, v2
v_perm_b32 v3, v47, v46, s40
v_accvgpr_write_b32 a219, v3
v_perm_b32 v2, v41, v40, s41
v_accvgpr_write_b32 a220, v2
v_perm_b32 v3, v43, v42, s41
v_accvgpr_write_b32 a221, v3
v_perm_b32 v2, v45, v44, s41
v_accvgpr_write_b32 a222, v2
v_perm_b32 v3, v47, v46, s41
v_accvgpr_write_b32 a223, v3
s_waitcnt vmcnt(32)
s_waitcnt lgkmcnt(0)
s_barrier
ds_read2st64_b32 v[32:33], v10 offset0:64 offset1:65
ds_read2st64_b32 v[34:35], v10 offset0:66 offset1:67
ds_read2st64_b32 v[36:37], v10 offset0:68 offset1:69
ds_read2st64_b32 v[38:39], v10 offset0:70 offset1:71
ds_read2st64_b32 v[40:41], v10 offset0:96 offset1:97
ds_read2st64_b32 v[42:43], v10 offset0:98 offset1:99
ds_read2st64_b32 v[44:45], v10 offset0:100 offset1:101
ds_read2st64_b32 v[46:47], v10 offset0:102 offset1:103
s_add_u32 m0, s65, 131072
s_nop 0
buffer_load_dwordx4 v4, s[12:15], s66 offen lds
s_add_u32 s39, s66, s64
s_add_u32 m0, s65, 132096
s_nop 0
buffer_load_dwordx4 v4, s[12:15], s39 offen lds
s_add_u32 s66, s66, s42
v_perm_b32 v2, v17, v16, s40
v_accvgpr_write_b32 a64, v2
v_perm_b32 v3, v19, v18, s40
v_accvgpr_write_b32 a65, v3
v_perm_b32 v2, v21, v20, s40
v_accvgpr_write_b32 a66, v2
v_perm_b32 v3, v23, v22, s40
v_accvgpr_write_b32 a67, v3
v_perm_b32 v2, v17, v16, s41
v_accvgpr_write_b32 a68, v2
v_perm_b32 v3, v19, v18, s41
v_accvgpr_write_b32 a69, v3
v_perm_b32 v2, v21, v20, s41
v_accvgpr_write_b32 a70, v2
v_perm_b32 v3, v23, v22, s41
v_accvgpr_write_b32 a71, v3
s_add_u32 m0, s65, 139264
s_nop 0
buffer_load_dwordx4 v4, s[44:47], s67 offen lds
s_add_u32 s39, s67, s64
s_add_u32 m0, s65, 140288
s_nop 0
buffer_load_dwordx4 v4, s[44:47], s39 offen lds
s_add_u32 s67, s67, s42
v_perm_b32 v2, v25, v24, s40
v_accvgpr_write_b32 a224, v2
v_perm_b32 v3, v27, v26, s40
v_accvgpr_write_b32 a225, v3
v_perm_b32 v2, v29, v28, s40
v_accvgpr_write_b32 a226, v2
v_perm_b32 v3, v31, v30, s40
v_accvgpr_write_b32 a227, v3
v_perm_b32 v2, v25, v24, s41
v_accvgpr_write_b32 a228, v2
v_perm_b32 v3, v27, v26, s41
v_accvgpr_write_b32 a229, v3
v_perm_b32 v2, v29, v28, s41
v_accvgpr_write_b32 a230, v2
v_perm_b32 v3, v31, v30, s41
v_accvgpr_write_b32 a231, v3
s_waitcnt vmcnt(32)
s_waitcnt lgkmcnt(0)
s_barrier
ds_read2st64_b32 v[16:17], v8 offset0:0 offset1:1
ds_read2st64_b32 v[18:19], v8 offset0:2 offset1:3
ds_read2st64_b32 v[20:21], v8 offset0:4 offset1:5
ds_read2st64_b32 v[22:23], v8 offset0:6 offset1:7
ds_read2st64_b32 v[24:25], v8 offset0:32 offset1:33
ds_read2st64_b32 v[26:27], v8 offset0:34 offset1:35
ds_read2st64_b32 v[28:29], v8 offset0:36 offset1:37
ds_read2st64_b32 v[30:31], v8 offset0:38 offset1:39
s_add_u32 m0, s65, 147456
s_nop 0
buffer_load_dwordx4 v4, s[12:15], s66 offen lds
s_add_u32 s39, s66, s64
s_add_u32 m0, s65, 148480
s_nop 0
buffer_load_dwordx4 v4, s[12:15], s39 offen lds
s_add_u32 s66, s66, s42
v_perm_b32 v2, v33, v32, s40
v_accvgpr_write_b32 a72, v2
v_perm_b32 v3, v35, v34, s40
v_accvgpr_write_b32 a73, v3
v_perm_b32 v2, v37, v36, s40
v_accvgpr_write_b32 a74, v2
v_perm_b32 v3, v39, v38, s40
v_accvgpr_write_b32 a75, v3
v_perm_b32 v2, v33, v32, s41
v_accvgpr_write_b32 a76, v2
v_perm_b32 v3, v35, v34, s41
v_accvgpr_write_b32 a77, v3
v_perm_b32 v2, v37, v36, s41
v_accvgpr_write_b32 a78, v2
v_perm_b32 v3, v39, v38, s41
v_accvgpr_write_b32 a79, v3
s_add_u32 m0, s65, 155648
s_nop 0
buffer_load_dwordx4 v4, s[44:47], s67 offen lds
s_add_u32 s39, s67, s64
s_add_u32 m0, s65, 156672
s_nop 0
buffer_load_dwordx4 v4, s[44:47], s39 offen lds
s_add_u32 s67, s67, s42
v_perm_b32 v2, v41, v40, s40
v_accvgpr_write_b32 a232, v2
v_perm_b32 v3, v43, v42, s40
v_accvgpr_write_b32 a233, v3
v_perm_b32 v2, v45, v44, s40
v_accvgpr_write_b32 a234, v2
v_perm_b32 v3, v47, v46, s40
v_accvgpr_write_b32 a235, v3
v_perm_b32 v2, v41, v40, s41
v_accvgpr_write_b32 a236, v2
v_perm_b32 v3, v43, v42, s41
v_accvgpr_write_b32 a237, v3
v_perm_b32 v2, v45, v44, s41
v_accvgpr_write_b32 a238, v2
v_perm_b32 v3, v47, v46, s41
v_accvgpr_write_b32 a239, v3
s_waitcnt vmcnt(32)
s_waitcnt lgkmcnt(0)
s_barrier
ds_read2st64_b32 v[32:33], v8 offset0:64 offset1:65
ds_read2st64_b32 v[34:35], v8 offset0:66 offset1:67
ds_read2st64_b32 v[36:37], v8 offset0:68 offset1:69
ds_read2st64_b32 v[38:39], v8 offset0:70 offset1:71
ds_read2st64_b32 v[40:41], v8 offset0:96 offset1:97
ds_read2st64_b32 v[42:43], v8 offset0:98 offset1:99
ds_read2st64_b32 v[44:45], v8 offset0:100 offset1:101
ds_read2st64_b32 v[46:47], v8 offset0:102 offset1:103
v_perm_b32 v2, v17, v16, s40
v_accvgpr_write_b32 a80, v2
v_perm_b32 v3, v19, v18, s40
v_accvgpr_write_b32 a81, v3
v_perm_b32 v2, v21, v20, s40
v_accvgpr_write_b32 a82, v2
v_perm_b32 v3, v23, v22, s40
v_accvgpr_write_b32 a83, v3
v_perm_b32 v2, v17, v16, s41
v_accvgpr_write_b32 a84, v2
v_perm_b32 v3, v19, v18, s41
v_accvgpr_write_b32 a85, v3
v_perm_b32 v2, v21, v20, s41
v_accvgpr_write_b32 a86, v2
v_perm_b32 v3, v23, v22, s41
v_accvgpr_write_b32 a87, v3
v_perm_b32 v2, v25, v24, s40
v_accvgpr_write_b32 a240, v2
v_perm_b32 v3, v27, v26, s40
v_accvgpr_write_b32 a241, v3
v_perm_b32 v2, v29, v28, s40
v_accvgpr_write_b32 a242, v2
v_perm_b32 v3, v31, v30, s40
v_accvgpr_write_b32 a243, v3
v_perm_b32 v2, v25, v24, s41
v_accvgpr_write_b32 a244, v2
v_perm_b32 v3, v27, v26, s41
v_accvgpr_write_b32 a245, v3
v_perm_b32 v2, v29, v28, s41
v_accvgpr_write_b32 a246, v2
v_perm_b32 v3, v31, v30, s41
v_accvgpr_write_b32 a247, v3
s_waitcnt vmcnt(28)
s_waitcnt lgkmcnt(0)
s_barrier
ds_read2st64_b32 v[16:17], v8 offset0:128 offset1:129
ds_read2st64_b32 v[18:19], v8 offset0:130 offset1:131
ds_read2st64_b32 v[20:21], v8 offset0:132 offset1:133
ds_read2st64_b32 v[22:23], v8 offset0:134 offset1:135
ds_read2st64_b32 v[24:25], v8 offset0:160 offset1:161
ds_read2st64_b32 v[26:27], v8 offset0:162 offset1:163
ds_read2st64_b32 v[28:29], v8 offset0:164 offset1:165
ds_read2st64_b32 v[30:31], v8 offset0:166 offset1:167
v_perm_b32 v2, v33, v32, s40
v_accvgpr_write_b32 a88, v2
v_perm_b32 v3, v35, v34, s40
v_accvgpr_write_b32 a89, v3
v_perm_b32 v2, v37, v36, s40
v_accvgpr_write_b32 a90, v2
v_perm_b32 v3, v39, v38, s40
v_accvgpr_write_b32 a91, v3
v_perm_b32 v2, v33, v32, s41
v_accvgpr_write_b32 a92, v2
v_perm_b32 v3, v35, v34, s41
v_accvgpr_write_b32 a93, v3
v_perm_b32 v2, v37, v36, s41
v_accvgpr_write_b32 a94, v2
v_perm_b32 v3, v39, v38, s41
v_accvgpr_write_b32 a95, v3
v_perm_b32 v2, v41, v40, s40
v_accvgpr_write_b32 a248, v2
v_perm_b32 v3, v43, v42, s40
v_accvgpr_write_b32 a249, v3
v_perm_b32 v2, v45, v44, s40
v_accvgpr_write_b32 a250, v2
v_perm_b32 v3, v47, v46, s40
v_accvgpr_write_b32 a251, v3
v_perm_b32 v2, v41, v40, s41
v_accvgpr_write_b32 a252, v2
v_perm_b32 v3, v43, v42, s41
v_accvgpr_write_b32 a253, v3
v_perm_b32 v2, v45, v44, s41
v_accvgpr_write_b32 a254, v2
v_perm_b32 v3, v47, v46, s41
v_accvgpr_write_b32 a255, v3
s_waitcnt vmcnt(24)
s_waitcnt lgkmcnt(0)
s_barrier
ds_read2st64_b32 v[32:33], v8 offset0:192 offset1:193
ds_read2st64_b32 v[34:35], v8 offset0:194 offset1:195
ds_read2st64_b32 v[36:37], v8 offset0:196 offset1:197
ds_read2st64_b32 v[38:39], v8 offset0:198 offset1:199
ds_read2st64_b32 v[40:41], v8 offset0:224 offset1:225
ds_read2st64_b32 v[42:43], v8 offset0:226 offset1:227
ds_read2st64_b32 v[44:45], v8 offset0:228 offset1:229
ds_read2st64_b32 v[46:47], v8 offset0:230 offset1:231
v_perm_b32 v2, v17, v16, s40
v_accvgpr_write_b32 a96, v2
v_perm_b32 v3, v19, v18, s40
v_accvgpr_write_b32 a97, v3
v_perm_b32 v2, v21, v20, s40
v_accvgpr_write_b32 a98, v2
v_perm_b32 v3, v23, v22, s40
v_accvgpr_write_b32 a99, v3
v_perm_b32 v2, v17, v16, s41
v_accvgpr_write_b32 a100, v2
v_perm_b32 v3, v19, v18, s41
v_accvgpr_write_b32 a101, v3
v_perm_b32 v2, v21, v20, s41
v_accvgpr_write_b32 a102, v2
v_perm_b32 v3, v23, v22, s41
v_accvgpr_write_b32 a103, v3
v_perm_b32 v192, v25, v24, s40
v_perm_b32 v193, v27, v26, s40
v_perm_b32 v194, v29, v28, s40
v_perm_b32 v195, v31, v30, s40
v_perm_b32 v196, v25, v24, s41
v_perm_b32 v197, v27, v26, s41
v_perm_b32 v198, v29, v28, s41
v_perm_b32 v199, v31, v30, s41
s_waitcnt vmcnt(20)
s_waitcnt lgkmcnt(0)
s_barrier
ds_read2st64_b32 v[16:17], v9 offset0:0 offset1:1
ds_read2st64_b32 v[18:19], v9 offset0:2 offset1:3
ds_read2st64_b32 v[20:21], v9 offset0:4 offset1:5
ds_read2st64_b32 v[22:23], v9 offset0:6 offset1:7
ds_read2st64_b32 v[24:25], v9 offset0:32 offset1:33
ds_read2st64_b32 v[26:27], v9 offset0:34 offset1:35
ds_read2st64_b32 v[28:29], v9 offset0:36 offset1:37
ds_read2st64_b32 v[30:31], v9 offset0:38 offset1:39
v_perm_b32 v2, v33, v32, s40
v_accvgpr_write_b32 a104, v2
v_perm_b32 v3, v35, v34, s40
v_accvgpr_write_b32 a105, v3
v_perm_b32 v2, v37, v36, s40
v_accvgpr_write_b32 a106, v2
v_perm_b32 v3, v39, v38, s40
v_accvgpr_write_b32 a107, v3
v_perm_b32 v2, v33, v32, s41
v_accvgpr_write_b32 a108, v2
v_perm_b32 v3, v35, v34, s41
v_accvgpr_write_b32 a109, v3
v_perm_b32 v2, v37, v36, s41
v_accvgpr_write_b32 a110, v2
v_perm_b32 v3, v39, v38, s41
v_accvgpr_write_b32 a111, v3
v_perm_b32 v200, v41, v40, s40
v_perm_b32 v201, v43, v42, s40
v_perm_b32 v202, v45, v44, s40
v_perm_b32 v203, v47, v46, s40
v_perm_b32 v204, v41, v40, s41
v_perm_b32 v205, v43, v42, s41
v_perm_b32 v206, v45, v44, s41
v_perm_b32 v207, v47, v46, s41
s_waitcnt vmcnt(16)
s_waitcnt lgkmcnt(0)
s_barrier
ds_read2st64_b32 v[32:33], v9 offset0:64 offset1:65
ds_read2st64_b32 v[34:35], v9 offset0:66 offset1:67
ds_read2st64_b32 v[36:37], v9 offset0:68 offset1:69
ds_read2st64_b32 v[38:39], v9 offset0:70 offset1:71
ds_read2st64_b32 v[40:41], v9 offset0:96 offset1:97
ds_read2st64_b32 v[42:43], v9 offset0:98 offset1:99
ds_read2st64_b32 v[44:45], v9 offset0:100 offset1:101
ds_read2st64_b32 v[46:47], v9 offset0:102 offset1:103
v_perm_b32 v2, v17, v16, s40
v_accvgpr_write_b32 a112, v2
v_perm_b32 v3, v19, v18, s40
v_accvgpr_write_b32 a113, v3
v_perm_b32 v2, v21, v20, s40
v_accvgpr_write_b32 a114, v2
v_perm_b32 v3, v23, v22, s40
v_accvgpr_write_b32 a115, v3
v_perm_b32 v2, v17, v16, s41
v_accvgpr_write_b32 a116, v2
v_perm_b32 v3, v19, v18, s41
v_accvgpr_write_b32 a117, v3
v_perm_b32 v2, v21, v20, s41
v_accvgpr_write_b32 a118, v2
v_perm_b32 v3, v23, v22, s41
v_accvgpr_write_b32 a119, v3
v_perm_b32 v208, v25, v24, s40
v_perm_b32 v209, v27, v26, s40
v_perm_b32 v210, v29, v28, s40
v_perm_b32 v211, v31, v30, s40
v_perm_b32 v212, v25, v24, s41
v_perm_b32 v213, v27, v26, s41
v_perm_b32 v214, v29, v28, s41
v_perm_b32 v215, v31, v30, s41
s_waitcnt vmcnt(12)
s_waitcnt lgkmcnt(0)
s_barrier
ds_read2st64_b32 v[16:17], v9 offset0:128 offset1:129
ds_read2st64_b32 v[18:19], v9 offset0:130 offset1:131
ds_read2st64_b32 v[20:21], v9 offset0:132 offset1:133
ds_read2st64_b32 v[22:23], v9 offset0:134 offset1:135
ds_read2st64_b32 v[24:25], v9 offset0:160 offset1:161
ds_read2st64_b32 v[26:27], v9 offset0:162 offset1:163
ds_read2st64_b32 v[28:29], v9 offset0:164 offset1:165
ds_read2st64_b32 v[30:31], v9 offset0:166 offset1:167
v_perm_b32 v2, v33, v32, s40
v_accvgpr_write_b32 a120, v2
v_perm_b32 v3, v35, v34, s40
v_accvgpr_write_b32 a121, v3
v_perm_b32 v2, v37, v36, s40
v_accvgpr_write_b32 a122, v2
v_perm_b32 v3, v39, v38, s40
v_accvgpr_write_b32 a123, v3
v_perm_b32 v2, v33, v32, s41
v_accvgpr_write_b32 a124, v2
v_perm_b32 v3, v35, v34, s41
v_accvgpr_write_b32 a125, v3
v_perm_b32 v2, v37, v36, s41
v_accvgpr_write_b32 a126, v2
v_perm_b32 v3, v39, v38, s41
v_accvgpr_write_b32 a127, v3
v_perm_b32 v216, v41, v40, s40
v_perm_b32 v217, v43, v42, s40
v_perm_b32 v218, v45, v44, s40
v_perm_b32 v219, v47, v46, s40
v_perm_b32 v220, v41, v40, s41
v_perm_b32 v221, v43, v42, s41
v_perm_b32 v222, v45, v44, s41
v_perm_b32 v223, v47, v46, s41
s_waitcnt vmcnt(8)
s_waitcnt lgkmcnt(0)
s_barrier
ds_read2st64_b32 v[32:33], v9 offset0:192 offset1:193
ds_read2st64_b32 v[34:35], v9 offset0:194 offset1:195
ds_read2st64_b32 v[36:37], v9 offset0:196 offset1:197
ds_read2st64_b32 v[38:39], v9 offset0:198 offset1:199
ds_read2st64_b32 v[40:41], v9 offset0:224 offset1:225
ds_read2st64_b32 v[42:43], v9 offset0:226 offset1:227
ds_read2st64_b32 v[44:45], v9 offset0:228 offset1:229
ds_read2st64_b32 v[46:47], v9 offset0:230 offset1:231
v_perm_b32 v2, v17, v16, s40
v_accvgpr_write_b32 a128, v2
v_perm_b32 v3, v19, v18, s40
v_accvgpr_write_b32 a129, v3
v_perm_b32 v2, v21, v20, s40
v_accvgpr_write_b32 a130, v2
v_perm_b32 v3, v23, v22, s40
v_accvgpr_write_b32 a131, v3
v_perm_b32 v2, v17, v16, s41
v_accvgpr_write_b32 a132, v2
v_perm_b32 v3, v19, v18, s41
v_accvgpr_write_b32 a133, v3
v_perm_b32 v2, v21, v20, s41
v_accvgpr_write_b32 a134, v2
v_perm_b32 v3, v23, v22, s41
v_accvgpr_write_b32 a135, v3
v_perm_b32 v224, v25, v24, s40
v_perm_b32 v225, v27, v26, s40
v_perm_b32 v226, v29, v28, s40
v_perm_b32 v227, v31, v30, s40
v_perm_b32 v228, v25, v24, s41
v_perm_b32 v229, v27, v26, s41
v_perm_b32 v230, v29, v28, s41
v_perm_b32 v231, v31, v30, s41
s_waitcnt vmcnt(4)
s_waitcnt lgkmcnt(0)
s_barrier
ds_read2st64_b32 v[16:17], v10 offset0:0 offset1:1
ds_read2st64_b32 v[18:19], v10 offset0:2 offset1:3
ds_read2st64_b32 v[20:21], v10 offset0:4 offset1:5
ds_read2st64_b32 v[22:23], v10 offset0:6 offset1:7
ds_read2st64_b32 v[24:25], v10 offset0:32 offset1:33
ds_read2st64_b32 v[26:27], v10 offset0:34 offset1:35
ds_read2st64_b32 v[28:29], v10 offset0:36 offset1:37
ds_read2st64_b32 v[30:31], v10 offset0:38 offset1:39
v_perm_b32 v2, v33, v32, s40
v_accvgpr_write_b32 a136, v2
v_perm_b32 v3, v35, v34, s40
v_accvgpr_write_b32 a137, v3
v_perm_b32 v2, v37, v36, s40
v_accvgpr_write_b32 a138, v2
v_perm_b32 v3, v39, v38, s40
v_accvgpr_write_b32 a139, v3
v_perm_b32 v2, v33, v32, s41
v_accvgpr_write_b32 a140, v2
v_perm_b32 v3, v35, v34, s41
v_accvgpr_write_b32 a141, v3
v_perm_b32 v2, v37, v36, s41
v_accvgpr_write_b32 a142, v2
v_perm_b32 v3, v39, v38, s41
v_accvgpr_write_b32 a143, v3
v_perm_b32 v232, v41, v40, s40
v_perm_b32 v233, v43, v42, s40
v_perm_b32 v234, v45, v44, s40
v_perm_b32 v235, v47, v46, s40
v_perm_b32 v236, v41, v40, s41
v_perm_b32 v237, v43, v42, s41
v_perm_b32 v238, v45, v44, s41
v_perm_b32 v239, v47, v46, s41
s_waitcnt vmcnt(0)
s_waitcnt lgkmcnt(0)
s_barrier
ds_read2st64_b32 v[32:33], v10 offset0:64 offset1:65
ds_read2st64_b32 v[34:35], v10 offset0:66 offset1:67
ds_read2st64_b32 v[36:37], v10 offset0:68 offset1:69
ds_read2st64_b32 v[38:39], v10 offset0:70 offset1:71
ds_read2st64_b32 v[40:41], v10 offset0:96 offset1:97
ds_read2st64_b32 v[42:43], v10 offset0:98 offset1:99
ds_read2st64_b32 v[44:45], v10 offset0:100 offset1:101
ds_read2st64_b32 v[46:47], v10 offset0:102 offset1:103
v_perm_b32 v2, v17, v16, s40
v_accvgpr_write_b32 a144, v2
v_perm_b32 v3, v19, v18, s40
v_accvgpr_write_b32 a145, v3
v_perm_b32 v2, v21, v20, s40
v_accvgpr_write_b32 a146, v2
v_perm_b32 v3, v23, v22, s40
v_accvgpr_write_b32 a147, v3
v_perm_b32 v2, v17, v16, s41
v_accvgpr_write_b32 a148, v2
v_perm_b32 v3, v19, v18, s41
v_accvgpr_write_b32 a149, v3
v_perm_b32 v2, v21, v20, s41
v_accvgpr_write_b32 a150, v2
v_perm_b32 v3, v23, v22, s41
v_accvgpr_write_b32 a151, v3
v_perm_b32 v240, v25, v24, s40
v_perm_b32 v241, v27, v26, s40
v_perm_b32 v242, v29, v28, s40
v_perm_b32 v243, v31, v30, s40
v_perm_b32 v244, v25, v24, s41
v_perm_b32 v245, v27, v26, s41
v_perm_b32 v246, v29, v28, s41
v_perm_b32 v247, v31, v30, s41
s_waitcnt lgkmcnt(0)
s_barrier
v_perm_b32 v2, v33, v32, s40
v_accvgpr_write_b32 a152, v2
v_perm_b32 v3, v35, v34, s40
v_accvgpr_write_b32 a153, v3
v_perm_b32 v2, v37, v36, s40
v_accvgpr_write_b32 a154, v2
v_perm_b32 v3, v39, v38, s40
v_accvgpr_write_b32 a155, v3
v_perm_b32 v2, v33, v32, s41
v_accvgpr_write_b32 a156, v2
v_perm_b32 v3, v35, v34, s41
v_accvgpr_write_b32 a157, v3
v_perm_b32 v2, v37, v36, s41
v_accvgpr_write_b32 a158, v2
v_perm_b32 v3, v39, v38, s41
v_accvgpr_write_b32 a159, v3
v_perm_b32 v248, v41, v40, s40
v_perm_b32 v249, v43, v42, s40
v_perm_b32 v250, v45, v44, s40
v_perm_b32 v251, v47, v46, s40
v_perm_b32 v252, v41, v40, s41
v_perm_b32 v253, v43, v42, s41
v_perm_b32 v254, v45, v44, s41
v_perm_b32 v255, v47, v46, s41
s_cmp_lg_u32 s17, 0
s_cbranch_scc1 G1_ln_all
v_mov_b32 v2, 0x40
G1_ln_0:
buffer_load_dword v3, v2, s[60:63], 0 offen sc1
s_waitcnt vmcnt(0)
v_cmp_gt_u32 vcc, 0x1, v3
s_cbranch_vccz G1_ln_0_ok
s_add_u32 s57, s57, 1
s_cmp_gt_u32 s57, 0x40000
s_cbranch_scc1 L_fail
s_sleep 8
s_branch G1_ln_0
G1_ln_0_ok:
v_mov_b32 v2, 0x102500
G1_ln_1:
buffer_load_dword v3, v2, s[8:11], 0 offen sc1
s_waitcnt vmcnt(0)
v_cmp_gt_u32 vcc, 0x40, v3
s_cbranch_vccz G1_ln_1_ok
s_add_u32 s57, s57, 1
s_cmp_gt_u32 s57, 0x40000
s_cbranch_scc1 L_fail
s_sleep 8
s_branch G1_ln_1
G1_ln_1_ok:
G1_ln_all:
s_barrier
s_mul_i32 s29, s19, 40960
s_mul_i32 s32, s17, 10240
s_add_u32 s29, s29, s32
s_add_u32 s29, s29, 4194304
s_mul_i32 s28, s17, 10240
s_mov_b32 s21, 0
s_lshl_b32 s30, s19, 8
s_lshl_b32 s32, s18, 2
s_add_u32 s30, s30, s32
s_add_u32 s30, s30, 1048576
s_lshl_b32 s31, s18, 7
s_lshl_b32 s32, s19, 3
s_add_u32 s31, s31, s32
s_add_u32 s31, s31, 1062912
s_add_u32 m0, s28, 0
s_add_u32 s32, s29, 0
buffer_load_dwordx4 v1, s[8:11], s32 offen offset:0 sc1 lds
buffer_load_dwordx4 v1, s[8:11], s32 offen offset:1024 sc1 lds
buffer_load_dwordx4 v1, s[8:11], s32 offen offset:2048 sc1 lds
buffer_load_dwordx4 v1, s[8:11], s32 offen offset:3072 sc1 lds
s_add_u32 m0, s28, 4096
s_add_u32 s32, s29, 4096
buffer_load_dwordx4 v1, s[8:11], s32 offen offset:0 sc1 lds
buffer_load_dwordx4 v1, s[8:11], s32 offen offset:1024 sc1 lds
buffer_load_dwordx4 v1, s[8:11], s32 offen offset:2048 sc1 lds
buffer_load_dwordx4 v1, s[8:11], s32 offen offset:3072 sc1 lds
s_add_u32 m0, s28, 8192
s_add_u32 s32, s29, 8192
buffer_load_dwordx4 v1, s[8:11], s32 offen offset:0 sc1 lds
buffer_load_dwordx4 v1, s[8:11], s32 offen offset:1024 sc1 lds
s_add_u32 s29, s29, 81920
s_waitcnt vmcnt(0)
v_mov_b32 v5, v1
s_cmp_lt_u32 s18, 32
s_cbranch_scc1 G1L_kv
s_cmp_lt_u32 s18, 48
s_cbranch_scc1 G1L_qq
s_load_dwordx2 s[48:49], s[0:1], 72
s_mov_b32 s50, 3456
s_mov_b32 s51, 0x20000
v_lshrrev_b32 v6, 4, v0
v_lshlrev_b32 v6, 4, v6
s_waitcnt lgkmcnt(0)
buffer_load_dwordx4 v[72:75], v6, s[48:51], s22 offen
buffer_load_dwordx4 v[76:79], v6, s[48:51], s23 offen
s_mov_b32 s32, 0xffff0000
s_waitcnt vmcnt(1)
v_lshlrev_b32 v96, 16, v72
v_and_b32 v100, s32, v72
v_lshlrev_b32 v97, 16, v73
v_and_b32 v101, s32, v73
v_lshlrev_b32 v98, 16, v74
v_and_b32 v102, s32, v74
v_lshlrev_b32 v99, 16, v75
v_and_b32 v103, s32, v75
s_waitcnt vmcnt(0)
v_lshlrev_b32 v104, 16, v76
v_and_b32 v108, s32, v76
v_lshlrev_b32 v105, 16, v77
v_and_b32 v109, s32, v77
v_lshlrev_b32 v106, 16, v78
v_and_b32 v110, s32, v78
v_lshlrev_b32 v107, 16, v79
v_and_b32 v111, s32, v79
s_mov_b32 s52, 0xc0135761
s_mov_b32 s53, 0xbdd2d3e8
v_mov_b32 v7, s52
G1L_hh:
s_waitcnt vmcnt(4)
s_cmp_lg_u32 s21, 1
s_cbranch_scc1 G1L_hh_nw
s_waitcnt vmcnt(0)
G1L_hh_nw:
s_barrier
s_cmp_lt_u32 s21, 1
s_cbranch_scc1 G1L_hh_nf
s_cmp_lg_u32 s17, 0
s_cbranch_scc1 G1L_hh_nf
s_sub_u32 s32, s21, 1
s_max_u32 s32, s32, 1
v_mov_b32 v2, s32
v_mov_b32 v3, 0
s_mov_b64 exec, 1
buffer_store_dword v2, v3, s[8:11], s30 offen sc1
s_mov_b64 exec, -1
G1L_hh_nf:
s_xor_b32 s28, s28, 0x10000
s_cmp_eq_u32 s21, 31
s_cbranch_scc1 G1L_hh_nd
s_add_u32 m0, s28, 0
s_add_u32 s32, s29, 0
buffer_load_dwordx4 v1, s[8:11], s32 offen offset:0 sc1 lds
buffer_load_dwordx4 v1, s[8:11], s32 offen offset:1024 sc1 lds
buffer_load_dwordx4 v1, s[8:11], s32 offen offset:2048 sc1 lds
buffer_load_dwordx4 v1, s[8:11], s32 offen offset:3072 sc1 lds
s_add_u32 m0, s28, 4096
s_add_u32 s32, s29, 4096
buffer_load_dwordx4 v1, s[8:11], s32 offen offset:0 sc1 lds
buffer_load_dwordx4 v1, s[8:11], s32 offen offset:1024 sc1 lds
buffer_load_dwordx4 v1, s[8:11], s32 offen offset:2048 sc1 lds
buffer_load_dwordx4 v1, s[8:11], s32 offen offset:3072 sc1 lds
s_add_u32 m0, s28, 8192
s_add_u32 s32, s29, 8192
buffer_load_dwordx4 v1, s[8:11], s32 offen offset:0 sc1 lds
buffer_load_dwordx4 v1, s[8:11], s32 offen offset:1024 sc1 lds
s_add_u32 s29, s29, 81920
G1L_hh_nd:
ds_read_b128 v[40:43], v5 offset:0
ds_read_b128 v[44:47], v5 offset:20480
ds_read_b128 v[48:51], v5 offset:1024
ds_read_b128 v[52:55], v5 offset:21504
ds_read_b128 v[56:59], v5 offset:2048
ds_read_b128 v[60:63], v5 offset:22528
s_waitcnt lgkmcnt(5)
v_mfma_f32_16x16x32_bf16 v[8:11], a[0:3], v[40:43], v[96:99]
ds_read_b128 v[64:67], v5 offset:3072
s_waitcnt lgkmcnt(5)
v_mfma_f32_16x16x32_bf16 v[12:15], a[0:3], v[44:47], v[96:99]
v_mfma_f32_16x16x32_bf16 v[16:19], a[4:7], v[40:43], v[100:103]
ds_read_b128 v[68:71], v5 offset:23552
v_mfma_f32_16x16x32_bf16 v[20:23], a[4:7], v[44:47], v[100:103]
v_mfma_f32_16x16x32_bf16 v[24:27], a[160:163], v[40:43], v[104:107]
v_mfma_f32_16x16x32_bf16 v[28:31], a[160:163], v[44:47], v[104:107]
v_mfma_f32_16x16x32_bf16 v[32:35], a[164:167], v[40:43], v[108:111]
v_mfma_f32_16x16x32_bf16 v[36:39], a[164:167], v[44:47], v[108:111]
s_waitcnt lgkmcnt(5)
v_mfma_f32_16x16x32_bf16 v[8:11], a[8:11], v[48:51], v[8:11]
ds_read_b128 v[40:43], v5 offset:4096
s_waitcnt lgkmcnt(5)
v_mfma_f32_16x16x32_bf16 v[12:15], a[8:11], v[52:55], v[12:15]
v_mfma_f32_16x16x32_bf16 v[16:19], a[12:15], v[48:51], v[16:19]
ds_read_b128 v[44:47], v5 offset:24576
v_mfma_f32_16x16x32_bf16 v[20:23], a[12:15], v[52:55], v[20:23]
v_mfma_f32_16x16x32_bf16 v[24:27], a[168:171], v[48:51], v[24:27]
v_mfma_f32_16x16x32_bf16 v[28:31], a[168:171], v[52:55], v[28:31]
v_mfma_f32_16x16x32_bf16 v[32:35], a[172:175], v[48:51], v[32:35]
v_mfma_f32_16x16x32_bf16 v[36:39], a[172:175], v[52:55], v[36:39]
s_waitcnt lgkmcnt(5)
v_mfma_f32_16x16x32_bf16 v[8:11], a[16:19], v[56:59], v[8:11]
ds_read_b128 v[48:51], v5 offset:5120
s_waitcnt lgkmcnt(5)
v_mfma_f32_16x16x32_bf16 v[12:15], a[16:19], v[60:63], v[12:15]
v_mfma_f32_16x16x32_bf16 v[16:19], a[20:23], v[56:59], v[16:19]
ds_read_b128 v[52:55], v5 offset:25600
v_mfma_f32_16x16x32_bf16 v[20:23], a[20:23], v[60:63], v[20:23]
v_mfma_f32_16x16x32_bf16 v[24:27], a[176:179], v[56:59], v[24:27]
v_mfma_f32_16x16x32_bf16 v[28:31], a[176:179], v[60:63], v[28:31]
v_mfma_f32_16x16x32_bf16 v[32:35], a[180:183], v[56:59], v[32:35]
v_mfma_f32_16x16x32_bf16 v[36:39], a[180:183], v[60:63], v[36:39]
s_waitcnt lgkmcnt(5)
v_mfma_f32_16x16x32_bf16 v[8:11], a[24:27], v[64:67], v[8:11]
ds_read_b128 v[56:59], v5 offset:6144
s_waitcnt lgkmcnt(5)
v_mfma_f32_16x16x32_bf16 v[12:15], a[24:27], v[68:71], v[12:15]
v_mfma_f32_16x16x32_bf16 v[16:19], a[28:31], v[64:67], v[16:19]
ds_read_b128 v[60:63], v5 offset:26624
v_mfma_f32_16x16x32_bf16 v[20:23], a[28:31], v[68:71], v[20:23]
v_mfma_f32_16x16x32_bf16 v[24:27], a[184:187], v[64:67], v[24:27]
v_mfma_f32_16x16x32_bf16 v[28:31], a[184:187], v[68:71], v[28:31]
v_mfma_f32_16x16x32_bf16 v[32:35], a[188:191], v[64:67], v[32:35]
v_mfma_f32_16x16x32_bf16 v[36:39], a[188:191], v[68:71], v[36:39]
s_waitcnt lgkmcnt(5)
v_mfma_f32_16x16x32_bf16 v[8:11], a[32:35], v[40:43], v[8:11]
ds_read_b128 v[64:67], v5 offset:7168
s_waitcnt lgkmcnt(5)
v_mfma_f32_16x16x32_bf16 v[12:15], a[32:35], v[44:47], v[12:15]
v_mfma_f32_16x16x32_bf16 v[16:19], a[36:39], v[40:43], v[16:19]
ds_read_b128 v[68:71], v5 offset:27648
v_mfma_f32_16x16x32_bf16 v[20:23], a[36:39], v[44:47], v[20:23]
v_mfma_f32_16x16x32_bf16 v[24:27], a[192:195], v[40:43], v[24:27]
v_mfma_f32_16x16x32_bf16 v[28:31], a[192:195], v[44:47], v[28:31]
v_mfma_f32_16x16x32_bf16 v[32:35], a[196:199], v[40:43], v[32:35]
v_mfma_f32_16x16x32_bf16 v[36:39], a[196:199], v[44:47], v[36:39]
s_waitcnt lgkmcnt(5)
v_mfma_f32_16x16x32_bf16 v[8:11], a[40:43], v[48:51], v[8:11]
ds_read_b128 v[40:43], v5 offset:8192
s_waitcnt lgkmcnt(5)
v_mfma_f32_16x16x32_bf16 v[12:15], a[40:43], v[52:55], v[12:15]
v_mfma_f32_16x16x32_bf16 v[16:19], a[44:47], v[48:51], v[16:19]
ds_read_b128 v[44:47], v5 offset:28672
v_mfma_f32_16x16x32_bf16 v[20:23], a[44:47], v[52:55], v[20:23]
v_mfma_f32_16x16x32_bf16 v[24:27], a[200:203], v[48:51], v[24:27]
v_mfma_f32_16x16x32_bf16 v[28:31], a[200:203], v[52:55], v[28:31]
v_mfma_f32_16x16x32_bf16 v[32:35], a[204:207], v[48:51], v[32:35]
v_mfma_f32_16x16x32_bf16 v[36:39], a[204:207], v[52:55], v[36:39]
s_waitcnt lgkmcnt(5)
v_mfma_f32_16x16x32_bf16 v[8:11], a[48:51], v[56:59], v[8:11]
ds_read_b128 v[48:51], v5 offset:9216
s_waitcnt lgkmcnt(5)
v_mfma_f32_16x16x32_bf16 v[12:15], a[48:51], v[60:63], v[12:15]
v_mfma_f32_16x16x32_bf16 v[16:19], a[52:55], v[56:59], v[16:19]
ds_read_b128 v[52:55], v5 offset:29696
v_mfma_f32_16x16x32_bf16 v[20:23], a[52:55], v[60:63], v[20:23]
v_mfma_f32_16x16x32_bf16 v[24:27], a[208:211], v[56:59], v[24:27]
v_mfma_f32_16x16x32_bf16 v[28:31], a[208:211], v[60:63], v[28:31]
v_mfma_f32_16x16x32_bf16 v[32:35], a[212:215], v[56:59], v[32:35]
v_mfma_f32_16x16x32_bf16 v[36:39], a[212:215], v[60:63], v[36:39]
s_waitcnt lgkmcnt(5)
v_mfma_f32_16x16x32_bf16 v[8:11], a[56:59], v[64:67], v[8:11]
ds_read_b128 v[56:59], v5 offset:10240
s_waitcnt lgkmcnt(5)
v_mfma_f32_16x16x32_bf16 v[12:15], a[56:59], v[68:71], v[12:15]
v_mfma_f32_16x16x32_bf16 v[16:19], a[60:63], v[64:67], v[16:19]
ds_read_b128 v[60:63], v5 offset:30720
v_mfma_f32_16x16x32_bf16 v[20:23], a[60:63], v[68:71], v[20:23]
v_mfma_f32_16x16x32_bf16 v[24:27], a[216:219], v[64:67], v[24:27]
v_mfma_f32_16x16x32_bf16 v[28:31], a[216:219], v[68:71], v[28:31]
v_mfma_f32_16x16x32_bf16 v[32:35], a[220:223], v[64:67], v[32:35]
v_mfma_f32_16x16x32_bf16 v[36:39], a[220:223], v[68:71], v[36:39]
s_waitcnt lgkmcnt(5)
v_mfma_f32_16x16x32_bf16 v[8:11], a[64:67], v[40:43], v[8:11]
ds_read_b128 v[64:67], v5 offset:11264
s_waitcnt lgkmcnt(5)
v_mfma_f32_16x16x32_bf16 v[12:15], a[64:67], v[44:47], v[12:15]
v_mfma_f32_16x16x32_bf16 v[16:19], a[68:71], v[40:43], v[16:19]
ds_read_b128 v[68:71], v5 offset:31744
v_mfma_f32_16x16x32_bf16 v[20:23], a[68:71], v[44:47], v[20:23]
v_mfma_f32_16x16x32_bf16 v[24:27], a[224:227], v[40:43], v[24:27]
v_mfma_f32_16x16x32_bf16 v[28:31], a[224:227], v[44:47], v[28:31]
v_mfma_f32_16x16x32_bf16 v[32:35], a[228:231], v[40:43], v[32:35]
v_mfma_f32_16x16x32_bf16 v[36:39], a[228:231], v[44:47], v[36:39]
s_waitcnt lgkmcnt(5)
v_mfma_f32_16x16x32_bf16 v[8:11], a[72:75], v[48:51], v[8:11]
ds_read_b128 v[40:43], v5 offset:12288
s_waitcnt lgkmcnt(5)
v_mfma_f32_16x16x32_bf16 v[12:15], a[72:75], v[52:55], v[12:15]
v_mfma_f32_16x16x32_bf16 v[16:19], a[76:79], v[48:51], v[16:19]
ds_read_b128 v[44:47], v5 offset:32768
v_mfma_f32_16x16x32_bf16 v[20:23], a[76:79], v[52:55], v[20:23]
v_mfma_f32_16x16x32_bf16 v[24:27], a[232:235], v[48:51], v[24:27]
v_mfma_f32_16x16x32_bf16 v[28:31], a[232:235], v[52:55], v[28:31]
v_mfma_f32_16x16x32_bf16 v[32:35], a[236:239], v[48:51], v[32:35]
v_mfma_f32_16x16x32_bf16 v[36:39], a[236:239], v[52:55], v[36:39]
s_waitcnt lgkmcnt(5)
v_mfma_f32_16x16x32_bf16 v[8:11], a[80:83], v[56:59], v[8:11]
ds_read_b128 v[48:51], v5 offset:13312
s_waitcnt lgkmcnt(5)
v_mfma_f32_16x16x32_bf16 v[12:15], a[80:83], v[60:63], v[12:15]
v_mfma_f32_16x16x32_bf16 v[16:19], a[84:87], v[56:59], v[16:19]
ds_read_b128 v[52:55], v5 offset:33792
v_mfma_f32_16x16x32_bf16 v[20:23], a[84:87], v[60:63], v[20:23]
v_mfma_f32_16x16x32_bf16 v[24:27], a[240:243], v[56:59], v[24:27]
v_mfma_f32_16x16x32_bf16 v[28:31], a[240:243], v[60:63], v[28:31]
v_mfma_f32_16x16x32_bf16 v[32:35], a[244:247], v[56:59], v[32:35]
v_mfma_f32_16x16x32_bf16 v[36:39], a[244:247], v[60:63], v[36:39]
s_waitcnt lgkmcnt(5)
v_mfma_f32_16x16x32_bf16 v[8:11], a[88:91], v[64:67], v[8:11]
ds_read_b128 v[56:59], v5 offset:14336
s_waitcnt lgkmcnt(5)
v_mfma_f32_16x16x32_bf16 v[12:15], a[88:91], v[68:71], v[12:15]
v_mfma_f32_16x16x32_bf16 v[16:19], a[92:95], v[64:67], v[16:19]
ds_read_b128 v[60:63], v5 offset:34816
v_mfma_f32_16x16x32_bf16 v[20:23], a[92:95], v[68:71], v[20:23]
v_mfma_f32_16x16x32_bf16 v[24:27], a[248:251], v[64:67], v[24:27]
v_mfma_f32_16x16x32_bf16 v[28:31], a[248:251], v[68:71], v[28:31]
v_mfma_f32_16x16x32_bf16 v[32:35], a[252:255], v[64:67], v[32:35]
v_mfma_f32_16x16x32_bf16 v[36:39], a[252:255], v[68:71], v[36:39]
s_waitcnt lgkmcnt(5)
v_mfma_f32_16x16x32_bf16 v[8:11], a[96:99], v[40:43], v[8:11]
ds_read_b128 v[64:67], v5 offset:15360
s_waitcnt lgkmcnt(5)
v_mfma_f32_16x16x32_bf16 v[12:15], a[96:99], v[44:47], v[12:15]
v_mfma_f32_16x16x32_bf16 v[16:19], a[100:103], v[40:43], v[16:19]
ds_read_b128 v[68:71], v5 offset:35840
v_mfma_f32_16x16x32_bf16 v[20:23], a[100:103], v[44:47], v[20:23]
v_mfma_f32_16x16x32_bf16 v[24:27], v[192:195], v[40:43], v[24:27]
v_mfma_f32_16x16x32_bf16 v[28:31], v[192:195], v[44:47], v[28:31]
v_mfma_f32_16x16x32_bf16 v[32:35], v[196:199], v[40:43], v[32:35]
v_mfma_f32_16x16x32_bf16 v[36:39], v[196:199], v[44:47], v[36:39]
s_waitcnt lgkmcnt(5)
v_mfma_f32_16x16x32_bf16 v[8:11], a[104:107], v[48:51], v[8:11]
ds_read_b128 v[40:43], v5 offset:16384
s_waitcnt lgkmcnt(5)
v_mfma_f32_16x16x32_bf16 v[12:15], a[104:107], v[52:55], v[12:15]
v_mfma_f32_16x16x32_bf16 v[16:19], a[108:111], v[48:51], v[16:19]
ds_read_b128 v[44:47], v5 offset:36864
v_mfma_f32_16x16x32_bf16 v[20:23], a[108:111], v[52:55], v[20:23]
v_mfma_f32_16x16x32_bf16 v[24:27], v[200:203], v[48:51], v[24:27]
v_mfma_f32_16x16x32_bf16 v[28:31], v[200:203], v[52:55], v[28:31]
v_mfma_f32_16x16x32_bf16 v[32:35], v[204:207], v[48:51], v[32:35]
v_mfma_f32_16x16x32_bf16 v[36:39], v[204:207], v[52:55], v[36:39]
s_waitcnt lgkmcnt(5)
v_mfma_f32_16x16x32_bf16 v[8:11], a[112:115], v[56:59], v[8:11]
ds_read_b128 v[48:51], v5 offset:17408
s_waitcnt lgkmcnt(5)
v_mfma_f32_16x16x32_bf16 v[12:15], a[112:115], v[60:63], v[12:15]
v_mfma_f32_16x16x32_bf16 v[16:19], a[116:119], v[56:59], v[16:19]
ds_read_b128 v[52:55], v5 offset:37888
v_mfma_f32_16x16x32_bf16 v[20:23], a[116:119], v[60:63], v[20:23]
v_mfma_f32_16x16x32_bf16 v[24:27], v[208:211], v[56:59], v[24:27]
v_mfma_f32_16x16x32_bf16 v[28:31], v[208:211], v[60:63], v[28:31]
v_mfma_f32_16x16x32_bf16 v[32:35], v[212:215], v[56:59], v[32:35]
v_mfma_f32_16x16x32_bf16 v[36:39], v[212:215], v[60:63], v[36:39]
s_waitcnt lgkmcnt(5)
v_mfma_f32_16x16x32_bf16 v[8:11], a[120:123], v[64:67], v[8:11]
ds_read_b128 v[56:59], v5 offset:18432
s_waitcnt lgkmcnt(5)
v_mfma_f32_16x16x32_bf16 v[12:15], a[120:123], v[68:71], v[12:15]
v_mfma_f32_16x16x32_bf16 v[16:19], a[124:127], v[64:67], v[16:19]
ds_read_b128 v[60:63], v5 offset:38912
v_mfma_f32_16x16x32_bf16 v[20:23], a[124:127], v[68:71], v[20:23]
v_mfma_f32_16x16x32_bf16 v[24:27], v[216:219], v[64:67], v[24:27]
v_mfma_f32_16x16x32_bf16 v[28:31], v[216:219], v[68:71], v[28:31]
v_mfma_f32_16x16x32_bf16 v[32:35], v[220:223], v[64:67], v[32:35]
v_mfma_f32_16x16x32_bf16 v[36:39], v[220:223], v[68:71], v[36:39]
s_waitcnt lgkmcnt(5)
v_mfma_f32_16x16x32_bf16 v[8:11], a[128:131], v[40:43], v[8:11]
ds_read_b128 v[64:67], v5 offset:19456
s_waitcnt lgkmcnt(5)
v_mfma_f32_16x16x32_bf16 v[12:15], a[128:131], v[44:47], v[12:15]
v_mfma_f32_16x16x32_bf16 v[16:19], a[132:135], v[40:43], v[16:19]
ds_read_b128 v[68:71], v5 offset:39936
v_mfma_f32_16x16x32_bf16 v[20:23], a[132:135], v[44:47], v[20:23]
v_mfma_f32_16x16x32_bf16 v[24:27], v[224:227], v[40:43], v[24:27]
v_mfma_f32_16x16x32_bf16 v[28:31], v[224:227], v[44:47], v[28:31]
v_mfma_f32_16x16x32_bf16 v[32:35], v[228:231], v[40:43], v[32:35]
v_mfma_f32_16x16x32_bf16 v[36:39], v[228:231], v[44:47], v[36:39]
s_waitcnt lgkmcnt(5)
v_mfma_f32_16x16x32_bf16 v[8:11], a[136:139], v[48:51], v[8:11]
s_waitcnt lgkmcnt(4)
v_mfma_f32_16x16x32_bf16 v[12:15], a[136:139], v[52:55], v[12:15]
v_mfma_f32_16x16x32_bf16 v[16:19], a[140:143], v[48:51], v[16:19]
v_mfma_f32_16x16x32_bf16 v[20:23], a[140:143], v[52:55], v[20:23]
v_mfma_f32_16x16x32_bf16 v[24:27], v[232:235], v[48:51], v[24:27]
v_mfma_f32_16x16x32_bf16 v[28:31], v[232:235], v[52:55], v[28:31]
v_mfma_f32_16x16x32_bf16 v[32:35], v[236:239], v[48:51], v[32:35]
v_mfma_f32_16x16x32_bf16 v[36:39], v[236:239], v[52:55], v[36:39]
s_waitcnt lgkmcnt(3)
v_mfma_f32_16x16x32_bf16 v[8:11], a[144:147], v[56:59], v[8:11]
s_waitcnt lgkmcnt(2)
v_mfma_f32_16x16x32_bf16 v[12:15], a[144:147], v[60:63], v[12:15]
v_mfma_f32_16x16x32_bf16 v[16:19], a[148:151], v[56:59], v[16:19]
v_mfma_f32_16x16x32_bf16 v[20:23], a[148:151], v[60:63], v[20:23]
v_mfma_f32_16x16x32_bf16 v[24:27], v[240:243], v[56:59], v[24:27]
v_mfma_f32_16x16x32_bf16 v[28:31], v[240:243], v[60:63], v[28:31]
v_mfma_f32_16x16x32_bf16 v[32:35], v[244:247], v[56:59], v[32:35]
v_mfma_f32_16x16x32_bf16 v[36:39], v[244:247], v[60:63], v[36:39]
s_waitcnt lgkmcnt(1)
v_mfma_f32_16x16x32_bf16 v[8:11], a[152:155], v[64:67], v[8:11]
s_waitcnt lgkmcnt(0)
v_mfma_f32_16x16x32_bf16 v[12:15], a[152:155], v[68:71], v[12:15]
v_mfma_f32_16x16x32_bf16 v[16:19], a[156:159], v[64:67], v[16:19]
v_mfma_f32_16x16x32_bf16 v[20:23], a[156:159], v[68:71], v[20:23]
v_mfma_f32_16x16x32_bf16 v[24:27], v[248:251], v[64:67], v[24:27]
v_mfma_f32_16x16x32_bf16 v[28:31], v[248:251], v[68:71], v[28:31]
v_mfma_f32_16x16x32_bf16 v[32:35], v[252:255], v[64:67], v[32:35]
v_mfma_f32_16x16x32_bf16 v[36:39], v[252:255], v[68:71], v[36:39]
v_xor_b32 v5, 0x10000, v5
v_mul_f32 v2, v8, v8
v_fma_f32 v2, v2, s53, v7
v_mul_f32 v2, v8, v2
v_exp_f32 v2, v2
s_nop 0
v_add_f32 v2, 1.0, v2
v_rcp_f32 v2, v2
s_nop 0
v_mul_f32 v8, v8, v2
v_mul_f32 v2, v9, v9
v_fma_f32 v2, v2, s53, v7
v_mul_f32 v2, v9, v2
v_exp_f32 v2, v2
s_nop 0
v_add_f32 v2, 1.0, v2
v_rcp_f32 v2, v2
s_nop 0
v_mul_f32 v9, v9, v2
v_mul_f32 v2, v10, v10
v_fma_f32 v2, v2, s53, v7
v_mul_f32 v2, v10, v2
v_exp_f32 v2, v2
s_nop 0
v_add_f32 v2, 1.0, v2
v_rcp_f32 v2, v2
s_nop 0
v_mul_f32 v10, v10, v2
v_mul_f32 v2, v11, v11
v_fma_f32 v2, v2, s53, v7
v_mul_f32 v2, v11, v2
v_exp_f32 v2, v2
s_nop 0
v_add_f32 v2, 1.0, v2
v_rcp_f32 v2, v2
s_nop 0
v_mul_f32 v11, v11, v2
v_mul_f32 v2, v16, v16
v_fma_f32 v2, v2, s53, v7
v_mul_f32 v2, v16, v2
v_exp_f32 v2, v2
s_nop 0
v_add_f32 v2, 1.0, v2
v_rcp_f32 v2, v2
s_nop 0
v_mul_f32 v16, v16, v2
v_mul_f32 v2, v17, v17
v_fma_f32 v2, v2, s53, v7
v_mul_f32 v2, v17, v2
v_exp_f32 v2, v2
s_nop 0
v_add_f32 v2, 1.0, v2
v_rcp_f32 v2, v2
s_nop 0
v_mul_f32 v17, v17, v2
v_mul_f32 v2, v18, v18
v_fma_f32 v2, v2, s53, v7
v_mul_f32 v2, v18, v2
v_exp_f32 v2, v2
s_nop 0
v_add_f32 v2, 1.0, v2
v_rcp_f32 v2, v2
s_nop 0
v_mul_f32 v18, v18, v2
v_mul_f32 v2, v19, v19
v_fma_f32 v2, v2, s53, v7
v_mul_f32 v2, v19, v2
v_exp_f32 v2, v2
s_nop 0
v_add_f32 v2, 1.0, v2
v_rcp_f32 v2, v2
s_nop 0
v_mul_f32 v19, v19, v2
v_cvt_pk_bf16_f32 v72, v8, v16
v_cvt_pk_bf16_f32 v73, v9, v17
v_cvt_pk_bf16_f32 v74, v10, v18
v_cvt_pk_bf16_f32 v75, v11, v19
buffer_store_dwordx4 v[72:75], v1, s[8:11], s25 offen sc1
v_mul_f32 v2, v12, v12
v_fma_f32 v2, v2, s53, v7
v_mul_f32 v2, v12, v2
v_exp_f32 v2, v2
s_nop 0
v_add_f32 v2, 1.0, v2
v_rcp_f32 v2, v2
s_nop 0
v_mul_f32 v12, v12, v2
v_mul_f32 v2, v13, v13
v_fma_f32 v2, v2, s53, v7
v_mul_f32 v2, v13, v2
v_exp_f32 v2, v2
s_nop 0
v_add_f32 v2, 1.0, v2
v_rcp_f32 v2, v2
s_nop 0
v_mul_f32 v13, v13, v2
v_mul_f32 v2, v14, v14
v_fma_f32 v2, v2, s53, v7
v_mul_f32 v2, v14, v2
v_exp_f32 v2, v2
s_nop 0
v_add_f32 v2, 1.0, v2
v_rcp_f32 v2, v2
s_nop 0
v_mul_f32 v14, v14, v2
v_mul_f32 v2, v15, v15
v_fma_f32 v2, v2, s53, v7
v_mul_f32 v2, v15, v2
v_exp_f32 v2, v2
s_nop 0
v_add_f32 v2, 1.0, v2
v_rcp_f32 v2, v2
s_nop 0
v_mul_f32 v15, v15, v2
v_mul_f32 v2, v20, v20
v_fma_f32 v2, v2, s53, v7
v_mul_f32 v2, v20, v2
v_exp_f32 v2, v2
s_nop 0
v_add_f32 v2, 1.0, v2
v_rcp_f32 v2, v2
s_nop 0
v_mul_f32 v20, v20, v2
v_mul_f32 v2, v21, v21
v_fma_f32 v2, v2, s53, v7
v_mul_f32 v2, v21, v2
v_exp_f32 v2, v2
s_nop 0
v_add_f32 v2, 1.0, v2
v_rcp_f32 v2, v2
s_nop 0
v_mul_f32 v21, v21, v2
v_mul_f32 v2, v22, v22
v_fma_f32 v2, v2, s53, v7
v_mul_f32 v2, v22, v2
v_exp_f32 v2, v2
s_nop 0
v_add_f32 v2, 1.0, v2
v_rcp_f32 v2, v2
s_nop 0
v_mul_f32 v22, v22, v2
v_mul_f32 v2, v23, v23
v_fma_f32 v2, v2, s53, v7
v_mul_f32 v2, v23, v2
v_exp_f32 v2, v2
s_nop 0
v_add_f32 v2, 1.0, v2
v_rcp_f32 v2, v2
s_nop 0
v_mul_f32 v23, v23, v2
v_cvt_pk_bf16_f32 v76, v12, v20
v_cvt_pk_bf16_f32 v77, v13, v21
v_cvt_pk_bf16_f32 v78, v14, v22
v_cvt_pk_bf16_f32 v79, v15, v23
s_add_u32 s32, s25, 57344
buffer_store_dwordx4 v[76:79], v1, s[8:11], s32 offen sc1
v_mul_f32 v2, v24, v24
v_fma_f32 v2, v2, s53, v7
v_mul_f32 v2, v24, v2
v_exp_f32 v2, v2
s_nop 0
v_add_f32 v2, 1.0, v2
v_rcp_f32 v2, v2
s_nop 0
v_mul_f32 v24, v24, v2
v_mul_f32 v2, v25, v25
v_fma_f32 v2, v2, s53, v7
v_mul_f32 v2, v25, v2
v_exp_f32 v2, v2
s_nop 0
v_add_f32 v2, 1.0, v2
v_rcp_f32 v2, v2
s_nop 0
v_mul_f32 v25, v25, v2
v_mul_f32 v2, v26, v26
v_fma_f32 v2, v2, s53, v7
v_mul_f32 v2, v26, v2
v_exp_f32 v2, v2
s_nop 0
v_add_f32 v2, 1.0, v2
v_rcp_f32 v2, v2
s_nop 0
v_mul_f32 v26, v26, v2
v_mul_f32 v2, v27, v27
v_fma_f32 v2, v2, s53, v7
v_mul_f32 v2, v27, v2
v_exp_f32 v2, v2
s_nop 0
v_add_f32 v2, 1.0, v2
v_rcp_f32 v2, v2
s_nop 0
v_mul_f32 v27, v27, v2
v_mul_f32 v2, v32, v32
v_fma_f32 v2, v2, s53, v7
v_mul_f32 v2, v32, v2
v_exp_f32 v2, v2
s_nop 0
v_add_f32 v2, 1.0, v2
v_rcp_f32 v2, v2
s_nop 0
v_mul_f32 v32, v32, v2
v_mul_f32 v2, v33, v33
v_fma_f32 v2, v2, s53, v7
v_mul_f32 v2, v33, v2
v_exp_f32 v2, v2
s_nop 0
v_add_f32 v2, 1.0, v2
v_rcp_f32 v2, v2
s_nop 0
v_mul_f32 v33, v33, v2
v_mul_f32 v2, v34, v34
v_fma_f32 v2, v2, s53, v7
v_mul_f32 v2, v34, v2
v_exp_f32 v2, v2
s_nop 0
v_add_f32 v2, 1.0, v2
v_rcp_f32 v2, v2
s_nop 0
v_mul_f32 v34, v34, v2
v_mul_f32 v2, v35, v35
v_fma_f32 v2, v2, s53, v7
v_mul_f32 v2, v35, v2
v_exp_f32 v2, v2
s_nop 0
v_add_f32 v2, 1.0, v2
v_rcp_f32 v2, v2
s_nop 0
v_mul_f32 v35, v35, v2
v_cvt_pk_bf16_f32 v80, v24, v32
v_cvt_pk_bf16_f32 v81, v25, v33
v_cvt_pk_bf16_f32 v82, v26, v34
v_cvt_pk_bf16_f32 v83, v27, v35
buffer_store_dwordx4 v[80:83], v1, s[8:11], s26 offen sc1
v_mul_f32 v2, v28, v28
v_fma_f32 v2, v2, s53, v7
v_mul_f32 v2, v28, v2
v_exp_f32 v2, v2
s_nop 0
v_add_f32 v2, 1.0, v2
v_rcp_f32 v2, v2
s_nop 0
v_mul_f32 v28, v28, v2
v_mul_f32 v2, v29, v29
v_fma_f32 v2, v2, s53, v7
v_mul_f32 v2, v29, v2
v_exp_f32 v2, v2
s_nop 0
v_add_f32 v2, 1.0, v2
v_rcp_f32 v2, v2
s_nop 0
v_mul_f32 v29, v29, v2
v_mul_f32 v2, v30, v30
v_fma_f32 v2, v2, s53, v7
v_mul_f32 v2, v30, v2
v_exp_f32 v2, v2
s_nop 0
v_add_f32 v2, 1.0, v2
v_rcp_f32 v2, v2
s_nop 0
v_mul_f32 v30, v30, v2
v_mul_f32 v2, v31, v31
v_fma_f32 v2, v2, s53, v7
v_mul_f32 v2, v31, v2
v_exp_f32 v2, v2
s_nop 0
v_add_f32 v2, 1.0, v2
v_rcp_f32 v2, v2
s_nop 0
v_mul_f32 v31, v31, v2
v_mul_f32 v2, v36, v36
v_fma_f32 v2, v2, s53, v7
v_mul_f32 v2, v36, v2
v_exp_f32 v2, v2
s_nop 0
v_add_f32 v2, 1.0, v2
v_rcp_f32 v2, v2
s_nop 0
v_mul_f32 v36, v36, v2
v_mul_f32 v2, v37, v37
v_fma_f32 v2, v2, s53, v7
v_mul_f32 v2, v37, v2
v_exp_f32 v2, v2
s_nop 0
v_add_f32 v2, 1.0, v2
v_rcp_f32 v2, v2
s_nop 0
v_mul_f32 v37, v37, v2
v_mul_f32 v2, v38, v38
v_fma_f32 v2, v2, s53, v7
v_mul_f32 v2, v38, v2
v_exp_f32 v2, v2
s_nop 0
v_add_f32 v2, 1.0, v2
v_rcp_f32 v2, v2
s_nop 0
v_mul_f32 v38, v38, v2
v_mul_f32 v2, v39, v39
v_fma_f32 v2, v2, s53, v7
v_mul_f32 v2, v39, v2
v_exp_f32 v2, v2
s_nop 0
v_add_f32 v2, 1.0, v2
v_rcp_f32 v2, v2
s_nop 0
v_mul_f32 v39, v39, v2
v_cvt_pk_bf16_f32 v84, v28, v36
v_cvt_pk_bf16_f32 v85, v29, v37
v_cvt_pk_bf16_f32 v86, v30, v38
v_cvt_pk_bf16_f32 v87, v31, v39
s_add_u32 s32, s26, 57344
buffer_store_dwordx4 v[84:87], v1, s[8:11], s32 offen sc1
s_add_u32 s25, s25, s27
s_add_u32 s26, s26, s27
s_add_u32 s21, s21, 1
s_cmp_lt_u32 s21, 32
s_cbranch_scc1 G1L_hh
s_branch G1_done
G1L_qq:
s_waitcnt vmcnt(4)
s_cmp_lg_u32 s21, 1
s_cbranch_scc1 G1L_qq_nw
s_waitcnt vmcnt(0)
G1L_qq_nw:
s_barrier
s_cmp_lt_u32 s21, 1
s_cbranch_scc1 G1L_qq_nf
s_cmp_lg_u32 s17, 0
s_cbranch_scc1 G1L_qq_nf
s_sub_u32 s32, s21, 1
s_max_u32 s32, s32, 1
v_mov_b32 v2, s32
v_mov_b32 v3, 0
s_mov_b64 exec, 1
buffer_store_dword v2, v3, s[8:11], s30 offen sc1
s_mov_b64 exec, -1
G1L_qq_nf:
s_xor_b32 s28, s28, 0x10000
s_cmp_eq_u32 s21, 31
s_cbranch_scc1 G1L_qq_nd
s_add_u32 m0, s28, 0
s_add_u32 s32, s29, 0
buffer_load_dwordx4 v1, s[8:11], s32 offen offset:0 sc1 lds
buffer_load_dwordx4 v1, s[8:11], s32 offen offset:1024 sc1 lds
buffer_load_dwordx4 v1, s[8:11], s32 offen offset:2048 sc1 lds
buffer_load_dwordx4 v1, s[8:11], s32 offen offset:3072 sc1 lds
s_add_u32 m0, s28, 4096
s_add_u32 s32, s29, 4096
buffer_load_dwordx4 v1, s[8:11], s32 offen offset:0 sc1 lds
buffer_load_dwordx4 v1, s[8:11], s32 offen offset:1024 sc1 lds
buffer_load_dwordx4 v1, s[8:11], s32 offen offset:2048 sc1 lds
buffer_load_dwordx4 v1, s[8:11], s32 offen offset:3072 sc1 lds
s_add_u32 m0, s28, 8192
s_add_u32 s32, s29, 8192
buffer_load_dwordx4 v1, s[8:11], s32 offen offset:0 sc1 lds
buffer_load_dwordx4 v1, s[8:11], s32 offen offset:1024 sc1 lds
s_add_u32 s29, s29, 81920
G1L_qq_nd:
ds_read_b128 v[40:43], v5 offset:0
ds_read_b128 v[44:47], v5 offset:20480
ds_read_b128 v[48:51], v5 offset:1024
ds_read_b128 v[52:55], v5 offset:21504
ds_read_b128 v[56:59], v5 offset:2048
ds_read_b128 v[60:63], v5 offset:22528
s_waitcnt lgkmcnt(5)
v_mfma_f32_16x16x32_bf16 v[8:11], a[0:3], v[40:43], 0
ds_read_b128 v[64:67], v5 offset:3072
s_waitcnt lgkmcnt(5)
v_mfma_f32_16x16x32_bf16 v[12:15], a[0:3], v[44:47], 0
v_mfma_f32_16x16x32_bf16 v[16:19], a[4:7], v[40:43], 0
ds_read_b128 v[68:71], v5 offset:23552
v_mfma_f32_16x16x32_bf16 v[20:23], a[4:7], v[44:47], 0
v_mfma_f32_16x16x32_bf16 v[24:27], a[160:163], v[40:43], 0
v_mfma_f32_16x16x32_bf16 v[28:31], a[160:163], v[44:47], 0
v_mfma_f32_16x16x32_bf16 v[32:35], a[164:167], v[40:43], 0
v_mfma_f32_16x16x32_bf16 v[36:39], a[164:167], v[44:47], 0
s_waitcnt lgkmcnt(5)
v_mfma_f32_16x16x32_bf16 v[8:11], a[8:11], v[48:51], v[8:11]
ds_read_b128 v[40:43], v5 offset:4096
s_waitcnt lgkmcnt(5)
v_mfma_f32_16x16x32_bf16 v[12:15], a[8:11], v[52:55], v[12:15]
v_mfma_f32_16x16x32_bf16 v[16:19], a[12:15], v[48:51], v[16:19]
ds_read_b128 v[44:47], v5 offset:24576
v_mfma_f32_16x16x32_bf16 v[20:23], a[12:15], v[52:55], v[20:23]
v_mfma_f32_16x16x32_bf16 v[24:27], a[168:171], v[48:51], v[24:27]
v_mfma_f32_16x16x32_bf16 v[28:31], a[168:171], v[52:55], v[28:31]
v_mfma_f32_16x16x32_bf16 v[32:35], a[172:175], v[48:51], v[32:35]
v_mfma_f32_16x16x32_bf16 v[36:39], a[172:175], v[52:55], v[36:39]
s_waitcnt lgkmcnt(5)
v_mfma_f32_16x16x32_bf16 v[8:11], a[16:19], v[56:59], v[8:11]
ds_read_b128 v[48:51], v5 offset:5120
s_waitcnt lgkmcnt(5)
v_mfma_f32_16x16x32_bf16 v[12:15], a[16:19], v[60:63], v[12:15]
v_mfma_f32_16x16x32_bf16 v[16:19], a[20:23], v[56:59], v[16:19]
ds_read_b128 v[52:55], v5 offset:25600
v_mfma_f32_16x16x32_bf16 v[20:23], a[20:23], v[60:63], v[20:23]
v_mfma_f32_16x16x32_bf16 v[24:27], a[176:179], v[56:59], v[24:27]
v_mfma_f32_16x16x32_bf16 v[28:31], a[176:179], v[60:63], v[28:31]
v_mfma_f32_16x16x32_bf16 v[32:35], a[180:183], v[56:59], v[32:35]
v_mfma_f32_16x16x32_bf16 v[36:39], a[180:183], v[60:63], v[36:39]
s_waitcnt lgkmcnt(5)
v_mfma_f32_16x16x32_bf16 v[8:11], a[24:27], v[64:67], v[8:11]
ds_read_b128 v[56:59], v5 offset:6144
s_waitcnt lgkmcnt(5)
v_mfma_f32_16x16x32_bf16 v[12:15], a[24:27], v[68:71], v[12:15]
v_mfma_f32_16x16x32_bf16 v[16:19], a[28:31], v[64:67], v[16:19]
ds_read_b128 v[60:63], v5 offset:26624
v_mfma_f32_16x16x32_bf16 v[20:23], a[28:31], v[68:71], v[20:23]
v_mfma_f32_16x16x32_bf16 v[24:27], a[184:187], v[64:67], v[24:27]
v_mfma_f32_16x16x32_bf16 v[28:31], a[184:187], v[68:71], v[28:31]
v_mfma_f32_16x16x32_bf16 v[32:35], a[188:191], v[64:67], v[32:35]
v_mfma_f32_16x16x32_bf16 v[36:39], a[188:191], v[68:71], v[36:39]
s_waitcnt lgkmcnt(5)
v_mfma_f32_16x16x32_bf16 v[8:11], a[32:35], v[40:43], v[8:11]
ds_read_b128 v[64:67], v5 offset:7168
s_waitcnt lgkmcnt(5)
v_mfma_f32_16x16x32_bf16 v[12:15], a[32:35], v[44:47], v[12:15]
v_mfma_f32_16x16x32_bf16 v[16:19], a[36:39], v[40:43], v[16:19]
ds_read_b128 v[68:71], v5 offset:27648
v_mfma_f32_16x16x32_bf16 v[20:23], a[36:39], v[44:47], v[20:23]
v_mfma_f32_16x16x32_bf16 v[24:27], a[192:195], v[40:43], v[24:27]
v_mfma_f32_16x16x32_bf16 v[28:31], a[192:195], v[44:47], v[28:31]
v_mfma_f32_16x16x32_bf16 v[32:35], a[196:199], v[40:43], v[32:35]
v_mfma_f32_16x16x32_bf16 v[36:39], a[196:199], v[44:47], v[36:39]
s_waitcnt lgkmcnt(5)
v_mfma_f32_16x16x32_bf16 v[8:11], a[40:43], v[48:51], v[8:11]
ds_read_b128 v[40:43], v5 offset:8192
s_waitcnt lgkmcnt(5)
v_mfma_f32_16x16x32_bf16 v[12:15], a[40:43], v[52:55], v[12:15]
v_mfma_f32_16x16x32_bf16 v[16:19], a[44:47], v[48:51], v[16:19]
ds_read_b128 v[44:47], v5 offset:28672
v_mfma_f32_16x16x32_bf16 v[20:23], a[44:47], v[52:55], v[20:23]
v_mfma_f32_16x16x32_bf16 v[24:27], a[200:203], v[48:51], v[24:27]
v_mfma_f32_16x16x32_bf16 v[28:31], a[200:203], v[52:55], v[28:31]
v_mfma_f32_16x16x32_bf16 v[32:35], a[204:207], v[48:51], v[32:35]
v_mfma_f32_16x16x32_bf16 v[36:39], a[204:207], v[52:55], v[36:39]
s_waitcnt lgkmcnt(5)
v_mfma_f32_16x16x32_bf16 v[8:11], a[48:51], v[56:59], v[8:11]
ds_read_b128 v[48:51], v5 offset:9216
s_waitcnt lgkmcnt(5)
v_mfma_f32_16x16x32_bf16 v[12:15], a[48:51], v[60:63], v[12:15]
v_mfma_f32_16x16x32_bf16 v[16:19], a[52:55], v[56:59], v[16:19]
ds_read_b128 v[52:55], v5 offset:29696
v_mfma_f32_16x16x32_bf16 v[20:23], a[52:55], v[60:63], v[20:23]
v_mfma_f32_16x16x32_bf16 v[24:27], a[208:211], v[56:59], v[24:27]
v_mfma_f32_16x16x32_bf16 v[28:31], a[208:211], v[60:63], v[28:31]
v_mfma_f32_16x16x32_bf16 v[32:35], a[212:215], v[56:59], v[32:35]
v_mfma_f32_16x16x32_bf16 v[36:39], a[212:215], v[60:63], v[36:39]
s_waitcnt lgkmcnt(5)
v_mfma_f32_16x16x32_bf16 v[8:11], a[56:59], v[64:67], v[8:11]
ds_read_b128 v[56:59], v5 offset:10240
s_waitcnt lgkmcnt(5)
v_mfma_f32_16x16x32_bf16 v[12:15], a[56:59], v[68:71], v[12:15]
v_mfma_f32_16x16x32_bf16 v[16:19], a[60:63], v[64:67], v[16:19]
ds_read_b128 v[60:63], v5 offset:30720
v_mfma_f32_16x16x32_bf16 v[20:23], a[60:63], v[68:71], v[20:23]
v_mfma_f32_16x16x32_bf16 v[24:27], a[216:219], v[64:67], v[24:27]
v_mfma_f32_16x16x32_bf16 v[28:31], a[216:219], v[68:71], v[28:31]
v_mfma_f32_16x16x32_bf16 v[32:35], a[220:223], v[64:67], v[32:35]
v_mfma_f32_16x16x32_bf16 v[36:39], a[220:223], v[68:71], v[36:39]
s_waitcnt lgkmcnt(5)
v_mfma_f32_16x16x32_bf16 v[8:11], a[64:67], v[40:43], v[8:11]
ds_read_b128 v[64:67], v5 offset:11264
s_waitcnt lgkmcnt(5)
v_mfma_f32_16x16x32_bf16 v[12:15], a[64:67], v[44:47], v[12:15]
v_mfma_f32_16x16x32_bf16 v[16:19], a[68:71], v[40:43], v[16:19]
ds_read_b128 v[68:71], v5 offset:31744
v_mfma_f32_16x16x32_bf16 v[20:23], a[68:71], v[44:47], v[20:23]
v_mfma_f32_16x16x32_bf16 v[24:27], a[224:227], v[40:43], v[24:27]
v_mfma_f32_16x16x32_bf16 v[28:31], a[224:227], v[44:47], v[28:31]
v_mfma_f32_16x16x32_bf16 v[32:35], a[228:231], v[40:43], v[32:35]
v_mfma_f32_16x16x32_bf16 v[36:39], a[228:231], v[44:47], v[36:39]
s_waitcnt lgkmcnt(5)
v_mfma_f32_16x16x32_bf16 v[8:11], a[72:75], v[48:51], v[8:11]
ds_read_b128 v[40:43], v5 offset:12288
s_waitcnt lgkmcnt(5)
v_mfma_f32_16x16x32_bf16 v[12:15], a[72:75], v[52:55], v[12:15]
v_mfma_f32_16x16x32_bf16 v[16:19], a[76:79], v[48:51], v[16:19]
ds_read_b128 v[44:47], v5 offset:32768
v_mfma_f32_16x16x32_bf16 v[20:23], a[76:79], v[52:55], v[20:23]
v_mfma_f32_16x16x32_bf16 v[24:27], a[232:235], v[48:51], v[24:27]
v_mfma_f32_16x16x32_bf16 v[28:31], a[232:235], v[52:55], v[28:31]
v_mfma_f32_16x16x32_bf16 v[32:35], a[236:239], v[48:51], v[32:35]
v_mfma_f32_16x16x32_bf16 v[36:39], a[236:239], v[52:55], v[36:39]
s_waitcnt lgkmcnt(5)
v_mfma_f32_16x16x32_bf16 v[8:11], a[80:83], v[56:59], v[8:11]
ds_read_b128 v[48:51], v5 offset:13312
s_waitcnt lgkmcnt(5)
v_mfma_f32_16x16x32_bf16 v[12:15], a[80:83], v[60:63], v[12:15]
v_mfma_f32_16x16x32_bf16 v[16:19], a[84:87], v[56:59], v[16:19]
ds_read_b128 v[52:55], v5 offset:33792
v_mfma_f32_16x16x32_bf16 v[20:23], a[84:87], v[60:63], v[20:23]
v_mfma_f32_16x16x32_bf16 v[24:27], a[240:243], v[56:59], v[24:27]
v_mfma_f32_16x16x32_bf16 v[28:31], a[240:243], v[60:63], v[28:31]
v_mfma_f32_16x16x32_bf16 v[32:35], a[244:247], v[56:59], v[32:35]
v_mfma_f32_16x16x32_bf16 v[36:39], a[244:247], v[60:63], v[36:39]
s_waitcnt lgkmcnt(5)
v_mfma_f32_16x16x32_bf16 v[8:11], a[88:91], v[64:67], v[8:11]
ds_read_b128 v[56:59], v5 offset:14336
s_waitcnt lgkmcnt(5)
v_mfma_f32_16x16x32_bf16 v[12:15], a[88:91], v[68:71], v[12:15]
v_mfma_f32_16x16x32_bf16 v[16:19], a[92:95], v[64:67], v[16:19]
ds_read_b128 v[60:63], v5 offset:34816
v_mfma_f32_16x16x32_bf16 v[20:23], a[92:95], v[68:71], v[20:23]
v_mfma_f32_16x16x32_bf16 v[24:27], a[248:251], v[64:67], v[24:27]
v_mfma_f32_16x16x32_bf16 v[28:31], a[248:251], v[68:71], v[28:31]
v_mfma_f32_16x16x32_bf16 v[32:35], a[252:255], v[64:67], v[32:35]
v_mfma_f32_16x16x32_bf16 v[36:39], a[252:255], v[68:71], v[36:39]
s_waitcnt lgkmcnt(5)
v_mfma_f32_16x16x32_bf16 v[8:11], a[96:99], v[40:43], v[8:11]
ds_read_b128 v[64:67], v5 offset:15360
s_waitcnt lgkmcnt(5)
v_mfma_f32_16x16x32_bf16 v[12:15], a[96:99], v[44:47], v[12:15]
v_mfma_f32_16x16x32_bf16 v[16:19], a[100:103], v[40:43], v[16:19]
ds_read_b128 v[68:71], v5 offset:35840
v_mfma_f32_16x16x32_bf16 v[20:23], a[100:103], v[44:47], v[20:23]
v_mfma_f32_16x16x32_bf16 v[24:27], v[192:195], v[40:43], v[24:27]
v_mfma_f32_16x16x32_bf16 v[28:31], v[192:195], v[44:47], v[28:31]
v_mfma_f32_16x16x32_bf16 v[32:35], v[196:199], v[40:43], v[32:35]
v_mfma_f32_16x16x32_bf16 v[36:39], v[196:199], v[44:47], v[36:39]
s_waitcnt lgkmcnt(5)
v_mfma_f32_16x16x32_bf16 v[8:11], a[104:107], v[48:51], v[8:11]
ds_read_b128 v[40:43], v5 offset:16384
s_waitcnt lgkmcnt(5)
v_mfma_f32_16x16x32_bf16 v[12:15], a[104:107], v[52:55], v[12:15]
v_mfma_f32_16x16x32_bf16 v[16:19], a[108:111], v[48:51], v[16:19]
ds_read_b128 v[44:47], v5 offset:36864
v_mfma_f32_16x16x32_bf16 v[20:23], a[108:111], v[52:55], v[20:23]
v_mfma_f32_16x16x32_bf16 v[24:27], v[200:203], v[48:51], v[24:27]
v_mfma_f32_16x16x32_bf16 v[28:31], v[200:203], v[52:55], v[28:31]
v_mfma_f32_16x16x32_bf16 v[32:35], v[204:207], v[48:51], v[32:35]
v_mfma_f32_16x16x32_bf16 v[36:39], v[204:207], v[52:55], v[36:39]
s_waitcnt lgkmcnt(5)
v_mfma_f32_16x16x32_bf16 v[8:11], a[112:115], v[56:59], v[8:11]
ds_read_b128 v[48:51], v5 offset:17408
s_waitcnt lgkmcnt(5)
v_mfma_f32_16x16x32_bf16 v[12:15], a[112:115], v[60:63], v[12:15]
v_mfma_f32_16x16x32_bf16 v[16:19], a[116:119], v[56:59], v[16:19]
ds_read_b128 v[52:55], v5 offset:37888
v_mfma_f32_16x16x32_bf16 v[20:23], a[116:119], v[60:63], v[20:23]
v_mfma_f32_16x16x32_bf16 v[24:27], v[208:211], v[56:59], v[24:27]
v_mfma_f32_16x16x32_bf16 v[28:31], v[208:211], v[60:63], v[28:31]
v_mfma_f32_16x16x32_bf16 v[32:35], v[212:215], v[56:59], v[32:35]
v_mfma_f32_16x16x32_bf16 v[36:39], v[212:215], v[60:63], v[36:39]
s_waitcnt lgkmcnt(5)
v_mfma_f32_16x16x32_bf16 v[8:11], a[120:123], v[64:67], v[8:11]
ds_read_b128 v[56:59], v5 offset:18432
s_waitcnt lgkmcnt(5)
v_mfma_f32_16x16x32_bf16 v[12:15], a[120:123], v[68:71], v[12:15]
v_mfma_f32_16x16x32_bf16 v[16:19], a[124:127], v[64:67], v[16:19]
ds_read_b128 v[60:63], v5 offset:38912
v_mfma_f32_16x16x32_bf16 v[20:23], a[124:127], v[68:71], v[20:23]
v_mfma_f32_16x16x32_bf16 v[24:27], v[216:219], v[64:67], v[24:27]
v_mfma_f32_16x16x32_bf16 v[28:31], v[216:219], v[68:71], v[28:31]
v_mfma_f32_16x16x32_bf16 v[32:35], v[220:223], v[64:67], v[32:35]
v_mfma_f32_16x16x32_bf16 v[36:39], v[220:223], v[68:71], v[36:39]
s_waitcnt lgkmcnt(5)
v_mfma_f32_16x16x32_bf16 v[8:11], a[128:131], v[40:43], v[8:11]
ds_read_b128 v[64:67], v5 offset:19456
s_waitcnt lgkmcnt(5)
v_mfma_f32_16x16x32_bf16 v[12:15], a[128:131], v[44:47], v[12:15]
v_mfma_f32_16x16x32_bf16 v[16:19], a[132:135], v[40:43], v[16:19]
ds_read_b128 v[68:71], v5 offset:39936
v_mfma_f32_16x16x32_bf16 v[20:23], a[132:135], v[44:47], v[20:23]
v_mfma_f32_16x16x32_bf16 v[24:27], v[224:227], v[40:43], v[24:27]
v_mfma_f32_16x16x32_bf16 v[28:31], v[224:227], v[44:47], v[28:31]
v_mfma_f32_16x16x32_bf16 v[32:35], v[228:231], v[40:43], v[32:35]
v_mfma_f32_16x16x32_bf16 v[36:39], v[228:231], v[44:47], v[36:39]
s_waitcnt lgkmcnt(5)
v_mfma_f32_16x16x32_bf16 v[8:11], a[136:139], v[48:51], v[8:11]
s_waitcnt lgkmcnt(4)
v_mfma_f32_16x16x32_bf16 v[12:15], a[136:139], v[52:55], v[12:15]
v_mfma_f32_16x16x32_bf16 v[16:19], a[140:143], v[48:51], v[16:19]
v_mfma_f32_16x16x32_bf16 v[20:23], a[140:143], v[52:55], v[20:23]
v_mfma_f32_16x16x32_bf16 v[24:27], v[232:235], v[48:51], v[24:27]
v_mfma_f32_16x16x32_bf16 v[28:31], v[232:235], v[52:55], v[28:31]
v_mfma_f32_16x16x32_bf16 v[32:35], v[236:239], v[48:51], v[32:35]
v_mfma_f32_16x16x32_bf16 v[36:39], v[236:239], v[52:55], v[36:39]
s_waitcnt lgkmcnt(3)
v_mfma_f32_16x16x32_bf16 v[8:11], a[144:147], v[56:59], v[8:11]
s_waitcnt lgkmcnt(2)
v_mfma_f32_16x16x32_bf16 v[12:15], a[144:147], v[60:63], v[12:15]
v_mfma_f32_16x16x32_bf16 v[16:19], a[148:151], v[56:59], v[16:19]
v_mfma_f32_16x16x32_bf16 v[20:23], a[148:151], v[60:63], v[20:23]
v_mfma_f32_16x16x32_bf16 v[24:27], v[240:243], v[56:59], v[24:27]
v_mfma_f32_16x16x32_bf16 v[28:31], v[240:243], v[60:63], v[28:31]
v_mfma_f32_16x16x32_bf16 v[32:35], v[244:247], v[56:59], v[32:35]
v_mfma_f32_16x16x32_bf16 v[36:39], v[244:247], v[60:63], v[36:39]
s_waitcnt lgkmcnt(1)
v_mfma_f32_16x16x32_bf16 v[8:11], a[152:155], v[64:67], v[8:11]
s_waitcnt lgkmcnt(0)
v_mfma_f32_16x16x32_bf16 v[12:15], a[152:155], v[68:71], v[12:15]
v_mfma_f32_16x16x32_bf16 v[16:19], a[156:159], v[64:67], v[16:19]
v_mfma_f32_16x16x32_bf16 v[20:23], a[156:159], v[68:71], v[20:23]
v_mfma_f32_16x16x32_bf16 v[24:27], v[248:251], v[64:67], v[24:27]
v_mfma_f32_16x16x32_bf16 v[28:31], v[248:251], v[68:71], v[28:31]
v_mfma_f32_16x16x32_bf16 v[32:35], v[252:255], v[64:67], v[32:35]
v_mfma_f32_16x16x32_bf16 v[36:39], v[252:255], v[68:71], v[36:39]
v_xor_b32 v5, 0x10000, v5
v_cvt_pk_bf16_f32 v72, v8, v9
v_cvt_pk_bf16_f32 v73, v10, v11
v_cvt_pk_bf16_f32 v74, v16, v17
v_cvt_pk_bf16_f32 v75, v18, v19
buffer_store_dwordx4 v[72:75], v1, s[8:11], s25 offen offset:0 sc1
v_cvt_pk_bf16_f32 v76, v12, v13
v_cvt_pk_bf16_f32 v77, v14, v15
v_cvt_pk_bf16_f32 v78, v20, v21
v_cvt_pk_bf16_f32 v79, v22, v23
buffer_store_dwordx4 v[76:79], v1, s[8:11], s25 offen offset:1024 sc1
v_cvt_pk_bf16_f32 v80, v24, v25
v_cvt_pk_bf16_f32 v81, v26, v27
v_cvt_pk_bf16_f32 v82, v32, v33
v_cvt_pk_bf16_f32 v83, v34, v35
buffer_store_dwordx4 v[80:83], v1, s[8:11], s26 offen offset:0 sc1
v_cvt_pk_bf16_f32 v84, v28, v29
v_cvt_pk_bf16_f32 v85, v30, v31
v_cvt_pk_bf16_f32 v86, v36, v37
v_cvt_pk_bf16_f32 v87, v38, v39
buffer_store_dwordx4 v[84:87], v1, s[8:11], s26 offen offset:1024 sc1
s_add_u32 s25, s25, s27
s_add_u32 s26, s26, s27
s_add_u32 s21, s21, 1
s_cmp_lt_u32 s21, 32
s_cbranch_scc1 G1L_qq
s_branch G1_done
G1L_kv:
s_waitcnt vmcnt(4)
s_cmp_lg_u32 s21, 1
s_cbranch_scc1 G1L_kv_nw
s_waitcnt vmcnt(0)
G1L_kv_nw:
s_barrier
s_cmp_lt_u32 s21, 1
s_cbranch_scc1 G1L_kv_nf
s_cmp_lg_u32 s17, 0
s_cbranch_scc1 G1L_kv_nf
s_sub_u32 s32, s21, 1
s_max_u32 s32, s32, 1
v_mov_b32 v2, s32
v_mov_b32 v3, 0
s_mov_b64 exec, 1
buffer_store_dword v2, v3, s[8:11], s30 offen sc1
buffer_store_dword v2, v3, s[8:11], s31 offen sc1
s_mov_b64 exec, -1
G1L_kv_nf:
s_xor_b32 s28, s28, 0x10000
s_cmp_eq_u32 s21, 31
s_cbranch_scc1 G1L_kv_nd
s_add_u32 m0, s28, 0
s_add_u32 s32, s29, 0
buffer_load_dwordx4 v1, s[8:11], s32 offen offset:0 sc1 lds
buffer_load_dwordx4 v1, s[8:11], s32 offen offset:1024 sc1 lds
buffer_load_dwordx4 v1, s[8:11], s32 offen offset:2048 sc1 lds
buffer_load_dwordx4 v1, s[8:11], s32 offen offset:3072 sc1 lds
s_add_u32 m0, s28, 4096
s_add_u32 s32, s29, 4096
buffer_load_dwordx4 v1, s[8:11], s32 offen offset:0 sc1 lds
buffer_load_dwordx4 v1, s[8:11], s32 offen offset:1024 sc1 lds
buffer_load_dwordx4 v1, s[8:11], s32 offen offset:2048 sc1 lds
buffer_load_dwordx4 v1, s[8:11], s32 offen offset:3072 sc1 lds
s_add_u32 m0, s28, 8192
s_add_u32 s32, s29, 8192
buffer_load_dwordx4 v1, s[8:11], s32 offen offset:0 sc1 lds
buffer_load_dwordx4 v1, s[8:11], s32 offen offset:1024 sc1 lds
s_add_u32 s29, s29, 81920
G1L_kv_nd:
ds_read_b128 v[40:43], v5 offset:0
ds_read_b128 v[44:47], v5 offset:20480
ds_read_b128 v[48:51], v5 offset:1024
ds_read_b128 v[52:55], v5 offset:21504
ds_read_b128 v[56:59], v5 offset:2048
ds_read_b128 v[60:63], v5 offset:22528
s_waitcnt lgkmcnt(5)
v_mfma_f32_16x16x32_bf16 v[8:11], a[0:3], v[40:43], 0
ds_read_b128 v[64:67], v5 offset:3072
s_waitcnt lgkmcnt(5)
v_mfma_f32_16x16x32_bf16 v[12:15], a[0:3], v[44:47], 0
v_mfma_f32_16x16x32_bf16 v[16:19], a[4:7], v[40:43], 0
ds_read_b128 v[68:71], v5 offset:23552
v_mfma_f32_16x16x32_bf16 v[20:23], a[4:7], v[44:47], 0
v_mfma_f32_16x16x32_bf16 v[24:27], v[40:43], a[160:163], 0
v_mfma_f32_16x16x32_bf16 v[28:31], v[44:47], a[160:163], 0
v_mfma_f32_16x16x32_bf16 v[32:35], v[40:43], a[164:167], 0
v_mfma_f32_16x16x32_bf16 v[36:39], v[44:47], a[164:167], 0
s_waitcnt lgkmcnt(5)
v_mfma_f32_16x16x32_bf16 v[8:11], a[8:11], v[48:51], v[8:11]
ds_read_b128 v[40:43], v5 offset:4096
s_waitcnt lgkmcnt(5)
v_mfma_f32_16x16x32_bf16 v[12:15], a[8:11], v[52:55], v[12:15]
v_mfma_f32_16x16x32_bf16 v[16:19], a[12:15], v[48:51], v[16:19]
ds_read_b128 v[44:47], v5 offset:24576
v_mfma_f32_16x16x32_bf16 v[20:23], a[12:15], v[52:55], v[20:23]
v_mfma_f32_16x16x32_bf16 v[24:27], v[48:51], a[168:171], v[24:27]
v_mfma_f32_16x16x32_bf16 v[28:31], v[52:55], a[168:171], v[28:31]
v_mfma_f32_16x16x32_bf16 v[32:35], v[48:51], a[172:175], v[32:35]
v_mfma_f32_16x16x32_bf16 v[36:39], v[52:55], a[172:175], v[36:39]
s_waitcnt lgkmcnt(5)
v_mfma_f32_16x16x32_bf16 v[8:11], a[16:19], v[56:59], v[8:11]
ds_read_b128 v[48:51], v5 offset:5120
s_waitcnt lgkmcnt(5)
v_mfma_f32_16x16x32_bf16 v[12:15], a[16:19], v[60:63], v[12:15]
v_mfma_f32_16x16x32_bf16 v[16:19], a[20:23], v[56:59], v[16:19]
ds_read_b128 v[52:55], v5 offset:25600
v_mfma_f32_16x16x32_bf16 v[20:23], a[20:23], v[60:63], v[20:23]
v_mfma_f32_16x16x32_bf16 v[24:27], v[56:59], a[176:179], v[24:27]
v_mfma_f32_16x16x32_bf16 v[28:31], v[60:63], a[176:179], v[28:31]
v_mfma_f32_16x16x32_bf16 v[32:35], v[56:59], a[180:183], v[32:35]
v_mfma_f32_16x16x32_bf16 v[36:39], v[60:63], a[180:183], v[36:39]
s_waitcnt lgkmcnt(5)
v_mfma_f32_16x16x32_bf16 v[8:11], a[24:27], v[64:67], v[8:11]
ds_read_b128 v[56:59], v5 offset:6144
s_waitcnt lgkmcnt(5)
v_mfma_f32_16x16x32_bf16 v[12:15], a[24:27], v[68:71], v[12:15]
v_mfma_f32_16x16x32_bf16 v[16:19], a[28:31], v[64:67], v[16:19]
ds_read_b128 v[60:63], v5 offset:26624
v_mfma_f32_16x16x32_bf16 v[20:23], a[28:31], v[68:71], v[20:23]
v_mfma_f32_16x16x32_bf16 v[24:27], v[64:67], a[184:187], v[24:27]
v_mfma_f32_16x16x32_bf16 v[28:31], v[68:71], a[184:187], v[28:31]
v_mfma_f32_16x16x32_bf16 v[32:35], v[64:67], a[188:191], v[32:35]
v_mfma_f32_16x16x32_bf16 v[36:39], v[68:71], a[188:191], v[36:39]
s_waitcnt lgkmcnt(5)
v_mfma_f32_16x16x32_bf16 v[8:11], a[32:35], v[40:43], v[8:11]
ds_read_b128 v[64:67], v5 offset:7168
s_waitcnt lgkmcnt(5)
v_mfma_f32_16x16x32_bf16 v[12:15], a[32:35], v[44:47], v[12:15]
v_mfma_f32_16x16x32_bf16 v[16:19], a[36:39], v[40:43], v[16:19]
ds_read_b128 v[68:71], v5 offset:27648
v_mfma_f32_16x16x32_bf16 v[20:23], a[36:39], v[44:47], v[20:23]
v_mfma_f32_16x16x32_bf16 v[24:27], v[40:43], a[192:195], v[24:27]
v_mfma_f32_16x16x32_bf16 v[28:31], v[44:47], a[192:195], v[28:31]
v_mfma_f32_16x16x32_bf16 v[32:35], v[40:43], a[196:199], v[32:35]
v_mfma_f32_16x16x32_bf16 v[36:39], v[44:47], a[196:199], v[36:39]
s_waitcnt lgkmcnt(5)
v_mfma_f32_16x16x32_bf16 v[8:11], a[40:43], v[48:51], v[8:11]
ds_read_b128 v[40:43], v5 offset:8192
s_waitcnt lgkmcnt(5)
v_mfma_f32_16x16x32_bf16 v[12:15], a[40:43], v[52:55], v[12:15]
v_mfma_f32_16x16x32_bf16 v[16:19], a[44:47], v[48:51], v[16:19]
ds_read_b128 v[44:47], v5 offset:28672
v_mfma_f32_16x16x32_bf16 v[20:23], a[44:47], v[52:55], v[20:23]
v_mfma_f32_16x16x32_bf16 v[24:27], v[48:51], a[200:203], v[24:27]
v_mfma_f32_16x16x32_bf16 v[28:31], v[52:55], a[200:203], v[28:31]
v_mfma_f32_16x16x32_bf16 v[32:35], v[48:51], a[204:207], v[32:35]
v_mfma_f32_16x16x32_bf16 v[36:39], v[52:55], a[204:207], v[36:39]
s_waitcnt lgkmcnt(5)
v_mfma_f32_16x16x32_bf16 v[8:11], a[48:51], v[56:59], v[8:11]
ds_read_b128 v[48:51], v5 offset:9216
s_waitcnt lgkmcnt(5)
v_mfma_f32_16x16x32_bf16 v[12:15], a[48:51], v[60:63], v[12:15]
v_mfma_f32_16x16x32_bf16 v[16:19], a[52:55], v[56:59], v[16:19]
ds_read_b128 v[52:55], v5 offset:29696
v_mfma_f32_16x16x32_bf16 v[20:23], a[52:55], v[60:63], v[20:23]
v_mfma_f32_16x16x32_bf16 v[24:27], v[56:59], a[208:211], v[24:27]
v_mfma_f32_16x16x32_bf16 v[28:31], v[60:63], a[208:211], v[28:31]
v_mfma_f32_16x16x32_bf16 v[32:35], v[56:59], a[212:215], v[32:35]
v_mfma_f32_16x16x32_bf16 v[36:39], v[60:63], a[212:215], v[36:39]
s_waitcnt lgkmcnt(5)
v_mfma_f32_16x16x32_bf16 v[8:11], a[56:59], v[64:67], v[8:11]
ds_read_b128 v[56:59], v5 offset:10240
s_waitcnt lgkmcnt(5)
v_mfma_f32_16x16x32_bf16 v[12:15], a[56:59], v[68:71], v[12:15]
v_mfma_f32_16x16x32_bf16 v[16:19], a[60:63], v[64:67], v[16:19]
ds_read_b128 v[60:63], v5 offset:30720
v_mfma_f32_16x16x32_bf16 v[20:23], a[60:63], v[68:71], v[20:23]
v_mfma_f32_16x16x32_bf16 v[24:27], v[64:67], a[216:219], v[24:27]
v_mfma_f32_16x16x32_bf16 v[28:31], v[68:71], a[216:219], v[28:31]
v_mfma_f32_16x16x32_bf16 v[32:35], v[64:67], a[220:223], v[32:35]
v_mfma_f32_16x16x32_bf16 v[36:39], v[68:71], a[220:223], v[36:39]
s_waitcnt lgkmcnt(5)
v_mfma_f32_16x16x32_bf16 v[8:11], a[64:67], v[40:43], v[8:11]
ds_read_b128 v[64:67], v5 offset:11264
s_waitcnt lgkmcnt(5)
v_mfma_f32_16x16x32_bf16 v[12:15], a[64:67], v[44:47], v[12:15]
v_mfma_f32_16x16x32_bf16 v[16:19], a[68:71], v[40:43], v[16:19]
ds_read_b128 v[68:71], v5 offset:31744
v_mfma_f32_16x16x32_bf16 v[20:23], a[68:71], v[44:47], v[20:23]
v_mfma_f32_16x16x32_bf16 v[24:27], v[40:43], a[224:227], v[24:27]
v_mfma_f32_16x16x32_bf16 v[28:31], v[44:47], a[224:227], v[28:31]
v_mfma_f32_16x16x32_bf16 v[32:35], v[40:43], a[228:231], v[32:35]
v_mfma_f32_16x16x32_bf16 v[36:39], v[44:47], a[228:231], v[36:39]
s_waitcnt lgkmcnt(5)
v_mfma_f32_16x16x32_bf16 v[8:11], a[72:75], v[48:51], v[8:11]
ds_read_b128 v[40:43], v5 offset:12288
s_waitcnt lgkmcnt(5)
v_mfma_f32_16x16x32_bf16 v[12:15], a[72:75], v[52:55], v[12:15]
v_mfma_f32_16x16x32_bf16 v[16:19], a[76:79], v[48:51], v[16:19]
ds_read_b128 v[44:47], v5 offset:32768
v_mfma_f32_16x16x32_bf16 v[20:23], a[76:79], v[52:55], v[20:23]
v_mfma_f32_16x16x32_bf16 v[24:27], v[48:51], a[232:235], v[24:27]
v_mfma_f32_16x16x32_bf16 v[28:31], v[52:55], a[232:235], v[28:31]
v_mfma_f32_16x16x32_bf16 v[32:35], v[48:51], a[236:239], v[32:35]
v_mfma_f32_16x16x32_bf16 v[36:39], v[52:55], a[236:239], v[36:39]
s_waitcnt lgkmcnt(5)
v_mfma_f32_16x16x32_bf16 v[8:11], a[80:83], v[56:59], v[8:11]
ds_read_b128 v[48:51], v5 offset:13312
s_waitcnt lgkmcnt(5)
v_mfma_f32_16x16x32_bf16 v[12:15], a[80:83], v[60:63], v[12:15]
v_mfma_f32_16x16x32_bf16 v[16:19], a[84:87], v[56:59], v[16:19]
ds_read_b128 v[52:55], v5 offset:33792
v_mfma_f32_16x16x32_bf16 v[20:23], a[84:87], v[60:63], v[20:23]
v_mfma_f32_16x16x32_bf16 v[24:27], v[56:59], a[240:243], v[24:27]
v_mfma_f32_16x16x32_bf16 v[28:31], v[60:63], a[240:243], v[28:31]
v_mfma_f32_16x16x32_bf16 v[32:35], v[56:59], a[244:247], v[32:35]
v_mfma_f32_16x16x32_bf16 v[36:39], v[60:63], a[244:247], v[36:39]
s_waitcnt lgkmcnt(5)
v_mfma_f32_16x16x32_bf16 v[8:11], a[88:91], v[64:67], v[8:11]
ds_read_b128 v[56:59], v5 offset:14336
s_waitcnt lgkmcnt(5)
v_mfma_f32_16x16x32_bf16 v[12:15], a[88:91], v[68:71], v[12:15]
v_mfma_f32_16x16x32_bf16 v[16:19], a[92:95], v[64:67], v[16:19]
ds_read_b128 v[60:63], v5 offset:34816
v_mfma_f32_16x16x32_bf16 v[20:23], a[92:95], v[68:71], v[20:23]
v_mfma_f32_16x16x32_bf16 v[24:27], v[64:67], a[248:251], v[24:27]
v_mfma_f32_16x16x32_bf16 v[28:31], v[68:71], a[248:251], v[28:31]
v_mfma_f32_16x16x32_bf16 v[32:35], v[64:67], a[252:255], v[32:35]
v_mfma_f32_16x16x32_bf16 v[36:39], v[68:71], a[252:255], v[36:39]
s_waitcnt lgkmcnt(5)
v_mfma_f32_16x16x32_bf16 v[8:11], a[96:99], v[40:43], v[8:11]
ds_read_b128 v[64:67], v5 offset:15360
s_waitcnt lgkmcnt(5)
v_mfma_f32_16x16x32_bf16 v[12:15], a[96:99], v[44:47], v[12:15]
v_mfma_f32_16x16x32_bf16 v[16:19], a[100:103], v[40:43], v[16:19]
ds_read_b128 v[68:71], v5 offset:35840
v_mfma_f32_16x16x32_bf16 v[20:23], a[100:103], v[44:47], v[20:23]
v_mfma_f32_16x16x32_bf16 v[24:27], v[40:43], v[192:195], v[24:27]
v_mfma_f32_16x16x32_bf16 v[28:31], v[44:47], v[192:195], v[28:31]
v_mfma_f32_16x16x32_bf16 v[32:35], v[40:43], v[196:199], v[32:35]
v_mfma_f32_16x16x32_bf16 v[36:39], v[44:47], v[196:199], v[36:39]
s_waitcnt lgkmcnt(5)
v_mfma_f32_16x16x32_bf16 v[8:11], a[104:107], v[48:51], v[8:11]
ds_read_b128 v[40:43], v5 offset:16384
s_waitcnt lgkmcnt(5)
v_mfma_f32_16x16x32_bf16 v[12:15], a[104:107], v[52:55], v[12:15]
v_mfma_f32_16x16x32_bf16 v[16:19], a[108:111], v[48:51], v[16:19]
ds_read_b128 v[44:47], v5 offset:36864
v_mfma_f32_16x16x32_bf16 v[20:23], a[108:111], v[52:55], v[20:23]
v_mfma_f32_16x16x32_bf16 v[24:27], v[48:51], v[200:203], v[24:27]
v_mfma_f32_16x16x32_bf16 v[28:31], v[52:55], v[200:203], v[28:31]
v_mfma_f32_16x16x32_bf16 v[32:35], v[48:51], v[204:207], v[32:35]
v_mfma_f32_16x16x32_bf16 v[36:39], v[52:55], v[204:207], v[36:39]
s_waitcnt lgkmcnt(5)
v_mfma_f32_16x16x32_bf16 v[8:11], a[112:115], v[56:59], v[8:11]
ds_read_b128 v[48:51], v5 offset:17408
s_waitcnt lgkmcnt(5)
v_mfma_f32_16x16x32_bf16 v[12:15], a[112:115], v[60:63], v[12:15]
v_mfma_f32_16x16x32_bf16 v[16:19], a[116:119], v[56:59], v[16:19]
ds_read_b128 v[52:55], v5 offset:37888
v_mfma_f32_16x16x32_bf16 v[20:23], a[116:119], v[60:63], v[20:23]
v_mfma_f32_16x16x32_bf16 v[24:27], v[56:59], v[208:211], v[24:27]
v_mfma_f32_16x16x32_bf16 v[28:31], v[60:63], v[208:211], v[28:31]
v_mfma_f32_16x16x32_bf16 v[32:35], v[56:59], v[212:215], v[32:35]
v_mfma_f32_16x16x32_bf16 v[36:39], v[60:63], v[212:215], v[36:39]
s_waitcnt lgkmcnt(5)
v_mfma_f32_16x16x32_bf16 v[8:11], a[120:123], v[64:67], v[8:11]
ds_read_b128 v[56:59], v5 offset:18432
s_waitcnt lgkmcnt(5)
v_mfma_f32_16x16x32_bf16 v[12:15], a[120:123], v[68:71], v[12:15]
v_mfma_f32_16x16x32_bf16 v[16:19], a[124:127], v[64:67], v[16:19]
ds_read_b128 v[60:63], v5 offset:38912
v_mfma_f32_16x16x32_bf16 v[20:23], a[124:127], v[68:71], v[20:23]
v_mfma_f32_16x16x32_bf16 v[24:27], v[64:67], v[216:219], v[24:27]
v_mfma_f32_16x16x32_bf16 v[28:31], v[68:71], v[216:219], v[28:31]
v_mfma_f32_16x16x32_bf16 v[32:35], v[64:67], v[220:223], v[32:35]
v_mfma_f32_16x16x32_bf16 v[36:39], v[68:71], v[220:223], v[36:39]
s_waitcnt lgkmcnt(5)
v_mfma_f32_16x16x32_bf16 v[8:11], a[128:131], v[40:43], v[8:11]
ds_read_b128 v[64:67], v5 offset:19456
s_waitcnt lgkmcnt(5)
v_mfma_f32_16x16x32_bf16 v[12:15], a[128:131], v[44:47], v[12:15]
v_mfma_f32_16x16x32_bf16 v[16:19], a[132:135], v[40:43], v[16:19]
ds_read_b128 v[68:71], v5 offset:39936
v_mfma_f32_16x16x32_bf16 v[20:23], a[132:135], v[44:47], v[20:23]
v_mfma_f32_16x16x32_bf16 v[24:27], v[40:43], v[224:227], v[24:27]
v_mfma_f32_16x16x32_bf16 v[28:31], v[44:47], v[224:227], v[28:31]
v_mfma_f32_16x16x32_bf16 v[32:35], v[40:43], v[228:231], v[32:35]
v_mfma_f32_16x16x32_bf16 v[36:39], v[44:47], v[228:231], v[36:39]
s_waitcnt lgkmcnt(5)
v_mfma_f32_16x16x32_bf16 v[8:11], a[136:139], v[48:51], v[8:11]
s_waitcnt lgkmcnt(4)
v_mfma_f32_16x16x32_bf16 v[12:15], a[136:139], v[52:55], v[12:15]
v_mfma_f32_16x16x32_bf16 v[16:19], a[140:143], v[48:51], v[16:19]
v_mfma_f32_16x16x32_bf16 v[20:23], a[140:143], v[52:55], v[20:23]
v_mfma_f32_16x16x32_bf16 v[24:27], v[48:51], v[232:235], v[24:27]
v_mfma_f32_16x16x32_bf16 v[28:31], v[52:55], v[232:235], v[28:31]
v_mfma_f32_16x16x32_bf16 v[32:35], v[48:51], v[236:239], v[32:35]
v_mfma_f32_16x16x32_bf16 v[36:39], v[52:55], v[236:239], v[36:39]
s_waitcnt lgkmcnt(3)
v_mfma_f32_16x16x32_bf16 v[8:11], a[144:147], v[56:59], v[8:11]
s_waitcnt lgkmcnt(2)
v_mfma_f32_16x16x32_bf16 v[12:15], a[144:147], v[60:63], v[12:15]
v_mfma_f32_16x16x32_bf16 v[16:19], a[148:151], v[56:59], v[16:19]
v_mfma_f32_16x16x32_bf16 v[20:23], a[148:151], v[60:63], v[20:23]
v_mfma_f32_16x16x32_bf16 v[24:27], v[56:59], v[240:243], v[24:27]
v_mfma_f32_16x16x32_bf16 v[28:31], v[60:63], v[240:243], v[28:31]
v_mfma_f32_16x16x32_bf16 v[32:35], v[56:59], v[244:247], v[32:35]
v_mfma_f32_16x16x32_bf16 v[36:39], v[60:63], v[244:247], v[36:39]
s_waitcnt lgkmcnt(1)
v_mfma_f32_16x16x32_bf16 v[8:11], a[152:155], v[64:67], v[8:11]
s_waitcnt lgkmcnt(0)
v_mfma_f32_16x16x32_bf16 v[12:15], a[152:155], v[68:71], v[12:15]
v_mfma_f32_16x16x32_bf16 v[16:19], a[156:159], v[64:67], v[16:19]
v_mfma_f32_16x16x32_bf16 v[20:23], a[156:159], v[68:71], v[20:23]
v_mfma_f32_16x16x32_bf16 v[24:27], v[64:67], v[248:251], v[24:27]
v_mfma_f32_16x16x32_bf16 v[28:31], v[68:71], v[248:251], v[28:31]
v_mfma_f32_16x16x32_bf16 v[32:35], v[64:67], v[252:255], v[32:35]
v_mfma_f32_16x16x32_bf16 v[36:39], v[68:71], v[252:255], v[36:39]
v_xor_b32 v5, 0x10000, v5
v_cvt_pk_bf16_f32 v72, v8, v9
v_cvt_pk_bf16_f32 v73, v10, v11
v_cvt_pk_bf16_f32 v74, v16, v17
v_cvt_pk_bf16_f32 v75, v18, v19
buffer_store_dwordx4 v[72:75], v1, s[8:11], s25 offen offset:0 sc1
v_cvt_pk_bf16_f32 v76, v12, v13
v_cvt_pk_bf16_f32 v77, v14, v15
v_cvt_pk_bf16_f32 v78, v20, v21
v_cvt_pk_bf16_f32 v79, v22, v23
buffer_store_dwordx4 v[76:79], v1, s[8:11], s25 offen offset:1024 sc1
v_cvt_pk_bf16_f32 v80, v24, v25
v_cvt_pk_bf16_f32 v81, v26, v27
v_cvt_pk_bf16_f32 v82, v28, v29
v_cvt_pk_bf16_f32 v83, v30, v31
buffer_store_dwordx4 v[80:83], v1, s[8:11], s26 offen offset:0 sc1
v_cvt_pk_bf16_f32 v84, v32, v33
v_cvt_pk_bf16_f32 v85, v34, v35
v_cvt_pk_bf16_f32 v86, v36, v37
v_cvt_pk_bf16_f32 v87, v38, v39
buffer_store_dwordx4 v[84:87], v1, s[8:11], s26 offen offset:1024 sc1
s_add_u32 s25, s25, s27
s_add_u32 s26, s26, s27
s_add_u32 s21, s21, 1
s_cmp_lt_u32 s21, 32
s_cbranch_scc1 G1L_kv
s_branch G1_done
G1_done:
s_waitcnt vmcnt(0)
s_barrier
s_cmp_lg_u32 s17, 0
s_cbranch_scc1 G1_fin
v_mov_b32 v2, 32
v_mov_b32 v3, 0
s_mov_b64 exec, 1
buffer_store_dword v2, v3, s[8:11], s30 offen sc1
s_cmp_ge_u32 s18, 32
s_cbranch_scc1 G1_fin
buffer_store_dword v2, v3, s[8:11], s31 offen sc1
G1_fin:
s_mov_b64 exec, -1
s_waitcnt vmcnt(0)
s_cmp_lt_u32 s16, 64
s_cbranch_scc1 G1_noatt
s_cmp_ge_u32 s16, 96
s_cbranch_scc1 L_wend
s_sub_u32 s27, s16, 64
s_lshl_b32 s27, s27, 2
s_add_u32 s27, s27, s17
s_add_u32 s27, s27, 88
s_add_u32 s18, s27, 1152
s_barrier
s_branch AT_setup
G1_noatt:
s_cmp_ge_u32 s16, 60
s_cbranch_scc1 L_wend
s_add_u32 s16, s16, 60
s_branch L_out
s_branch L_wend
L_fail:
L_wend:
L_end:
s_endpgm
L_chain:
s_lshr_b32 s23, s35, 5
s_and_b32 s16, s35, 31
s_load_dwordx2 s[86:87], s[0:1], 8
s_load_dwordx4 s[88:91], s[0:1], 16
s_load_dwordx4 s[92:95], s[0:1], 32
s_waitcnt lgkmcnt(0)
s_cmp_eq_u32 s17, 1
s_cbranch_scc1 C_set1
s_cmp_eq_u32 s17, 2
s_cbranch_scc1 C_set2
s_cmp_eq_u32 s17, 3
s_cbranch_scc1 C_set3
C_set0:
v_and_b32 v10, 63, v0
v_lshlrev_b32 v1, 4, v10
v_add_u32 v3, 0x10000, v1
v_add_u32 v4, 0x20000, v1
v_lshlrev_b32 v6, 3, v10
v_lshrrev_b32 v11, 4, v10
v_and_b32 v12, 15, v10
v_and_b32 v13, 7, v10
v_lshlrev_b32 v14, 7, v11
v_lshl_add_u32 v2, v13, 4, v14
v_and_b32 v14, 1, v12
v_lshlrev_b32 v14, 7, v14
v_lshrrev_b32 v15, 2, v12
v_lshl_add_u32 v15, v11, 2, v15
v_lshl_add_u32 v5, v15, 3, v14
v_lshrrev_b32 v14, 1, v11
v_lshlrev_b32 v14, 4, v14
v_and_b32 v15, 1, v11
v_lshl_add_u32 v14, v15, 3, v14
v_lshrrev_b32 v15, 2, v12
v_lshlrev_b32 v15, 12, v15
v_and_b32 v16, 3, v12
v_lshl_add_u32 v15, v16, 5, v15
v_add_u32 v15, v15, v14
s_lshl_b32 s32, s16, 7
v_add_u32 v8, s32, v15
v_mov_b32 v17, 0x7ffffff0
v_and_b32 v15, 1, v11
v_lshlrev_b32 v15, 3, v15
v_lshrrev_b32 v16, 1, v11
v_lshl_add_u32 v15, v16, 2, v15
v_lshl_add_u32 v15, v13, 4, v15
v_add_u32 v15, s32, v15
v_cmp_gt_u32 vcc, 8, v12
s_nop 1
v_cndmask_b32 v9, v17, v15, vcc
v_mov_b32 v7, v1
v_mov_b32 v15, 0x8888
v_mov_b32 v16, 0xdddd
v_cmp_gt_u32 vcc, 8, v12
s_nop 1
v_cndmask_b32 v0, v16, v15, vcc
s_mov_b32 s28, 0x3e0293ee
s_mov_b32 s29, 0xbe0293ee
s_mov_b32 s30, -1
s_mov_b32 s31, 0
s_mov_b32 s40, 0x3f803f80
s_mov_b32 s41, 0x3f803f80
s_mov_b32 s42, 0x3f003f00
s_mov_b32 s43, 0x3f003f00
s_mov_b32 s57, 0
s_mov_b32 s18, 0
s_mul_i32 s19, s23, 524288
s_add_u32 s19, s19, 0
s_add_u32 s20, s19, 393216
s_mov_b32 s46, s20
s_add_u32 s21, s20, 16384
s_lshl_b32 s32, s16, 13
s_add_u32 s24, s32, 50331648
s_add_u32 s25, s32, 67108864
s_lshl_b32 s3, s16, 15
s_add_u32 s3, s3, 134217728
s_lshl_b32 s22, s16, 7
s_add_u32 s22, s22, 1058816
s_lshl_b32 s32, s16, 12
s_add_u32 s26, s32, 16777216
s_mov_b32 s48, s8
s_mov_b32 s49, s9
s_cmp_eq_u32 s23, 0
s_cselect_b32 s50, s10, 0
s_mov_b32 s51, 0x20000
s_add_u32 s33, s19, 163840
s_lshl_b32 s45, s16, 12
s_add_u32 s45, s45, s33
s_lshl_b32 s56, s16, 12
s_add_u32 s56, s56, s19
s_xor_b32 s56, s56, s45
s_lshr_b32 s55, s16, 2
s_add_u32 s55, s55, 32
s_lshl_b32 s55, s55, 12
s_and_b32 s39, s16, 3
s_lshl_b32 s39, s39, 5
s_add_u32 s55, s55, s39
s_add_u32 s55, s55, s33
s_lshr_b32 s58, s16, 2
s_add_u32 s58, s58, 32
s_lshl_b32 s58, s58, 12
s_and_b32 s39, s16, 3
s_lshl_b32 s39, s39, 5
s_add_u32 s58, s58, s39
s_add_u32 s58, s58, s19
s_xor_b32 s58, s58, s55
s_branch C_pro
C_set1:
v_and_b32 v10, 63, v0
v_lshlrev_b32 v1, 4, v10
v_add_u32 v3, 0x10000, v1
v_add_u32 v4, 0x20000, v1
v_lshlrev_b32 v6, 3, v10
v_lshrrev_b32 v11, 4, v10
v_and_b32 v12, 15, v10
v_and_b32 v13, 7, v10
v_lshlrev_b32 v14, 7, v11
v_lshl_add_u32 v2, v13, 4, v14
v_and_b32 v14, 1, v12
v_lshlrev_b32 v14, 7, v14
v_lshrrev_b32 v15, 2, v12
v_lshl_add_u32 v15, v11, 2, v15
v_lshl_add_u32 v5, v15, 3, v14
v_lshrrev_b32 v14, 1, v11
v_lshlrev_b32 v14, 4, v14
v_and_b32 v15, 1, v11
v_lshl_add_u32 v14, v15, 3, v14
v_lshrrev_b32 v15, 2, v12
v_lshlrev_b32 v15, 12, v15
v_and_b32 v16, 3, v12
v_lshl_add_u32 v15, v16, 5, v15
v_add_u32 v15, v15, v14
s_lshl_b32 s32, s16, 7
v_add_u32 v8, s32, v15
v_mov_b32 v17, 0x7ffffff0
v_lshrrev_b32 v15, 1, v10
v_lshlrev_b32 v15, 7, v15
v_and_b32 v16, 1, v10
v_lshl_add_u32 v7, v16, 4, v15
s_lshr_b32 s32, s16, 2
s_lshl_b32 s32, s32, 7
s_and_b32 s33, s16, 3
s_lshl_b32 s33, s33, 2
s_add_u32 s32, s32, s33
s_add_u32 s32, s32, 4096
v_add_u32 v15, s32, v1
v_cmp_gt_u32 vcc, 8, v10
s_nop 1
v_cndmask_b32 v9, v17, v15, vcc
v_mov_b32 v15, 0x8888
v_mov_b32 v16, 0xdddd
v_cmp_gt_u32 vcc, 8, v12
s_nop 1
v_cndmask_b32 v0, v16, v15, vcc
s_mov_b32 s28, 0x3e0293ee
s_mov_b32 s29, 0xbe0293ee
s_mov_b32 s30, -1
s_mov_b32 s31, 0
s_mov_b32 s40, 0x3f803f80
s_mov_b32 s41, 0x3f803f80
s_mov_b32 s42, 0x3f003f00
s_mov_b32 s43, 0x3f003f00
s_mov_b32 s57, 0
s_mov_b32 s18, 0
s_mul_i32 s19, s23, 524288
s_add_u32 s19, s19, 0
s_add_u32 s20, s19, 393216
s_mov_b32 s46, s20
s_add_u32 s21, s20, 16384
s_lshl_b32 s32, s16, 13
s_add_u32 s24, s32, 50331648
s_add_u32 s25, s32, 67110912
s_lshl_b32 s3, s16, 15
s_add_u32 s3, s3, 134217728
s_lshl_b32 s22, s16, 7
s_add_u32 s22, s22, 1058816
s_lshl_b32 s32, s16, 12
s_add_u32 s26, s32, 16778240
s_mov_b32 s48, s8
s_mov_b32 s49, s9
s_cmp_eq_u32 s23, 0
s_cselect_b32 s50, s10, 0
s_mov_b32 s51, 0x20000
s_add_u32 s33, s19, 163840
s_lshl_b32 s45, s16, 12
s_add_u32 s45, s45, s33
s_lshl_b32 s56, s16, 12
s_add_u32 s56, s56, s19
s_xor_b32 s56, s56, s45
s_lshr_b32 s55, s16, 2
s_add_u32 s55, s55, 32
s_lshl_b32 s55, s55, 12
s_and_b32 s39, s16, 3
s_lshl_b32 s39, s39, 5
s_add_u32 s55, s55, s39
s_add_u32 s55, s55, s33
s_lshr_b32 s58, s16, 2
s_add_u32 s58, s58, 32
s_lshl_b32 s58, s58, 12
s_and_b32 s39, s16, 3
s_lshl_b32 s39, s39, 5
s_add_u32 s58, s58, s39
s_add_u32 s58, s58, s19
s_xor_b32 s58, s58, s55
s_branch C_pro
C_set2:
v_and_b32 v10, 63, v0
v_lshlrev_b32 v1, 4, v10
v_add_u32 v3, 0x10000, v1
v_add_u32 v4, 0x20000, v1
v_lshlrev_b32 v6, 3, v10
v_lshrrev_b32 v11, 4, v10
v_and_b32 v12, 15, v10
v_and_b32 v13, 7, v10
v_lshlrev_b32 v14, 7, v11
v_lshl_add_u32 v2, v13, 4, v14
v_and_b32 v14, 1, v12
v_lshlrev_b32 v14, 7, v14
v_lshrrev_b32 v15, 2, v12
v_lshl_add_u32 v15, v11, 2, v15
v_lshl_add_u32 v5, v15, 3, v14
v_lshrrev_b32 v14, 1, v11
v_lshlrev_b32 v14, 4, v14
v_and_b32 v15, 1, v11
v_lshl_add_u32 v14, v15, 3, v14
v_lshrrev_b32 v15, 2, v12
v_lshlrev_b32 v15, 12, v15
v_and_b32 v16, 3, v12
v_lshl_add_u32 v15, v16, 5, v15
v_add_u32 v15, v15, v14
s_lshl_b32 s32, s16, 7
v_add_u32 v8, s32, v15
v_mov_b32 v17, 0x7ffffff0
v_lshrrev_b32 v15, 1, v10
v_lshlrev_b32 v15, 7, v15
v_and_b32 v16, 1, v10
v_lshl_add_u32 v7, v16, 4, v15
v_lshrrev_b32 v15, 3, v10
v_lshlrev_b32 v15, 7, v15
v_and_b32 v16, 1, v10
v_lshl_add_u32 v15, v16, 6, v15
v_bfe_u32 v16, v10, 1, 2
v_lshl_add_u32 v9, v16, 2, v15
v_mov_b32 v15, 0x8888
v_mov_b32 v16, 0xdddd
v_cmp_gt_u32 vcc, 8, v12
s_nop 1
v_cndmask_b32 v0, v16, v15, vcc
s_mov_b32 s28, 0x3e0293ee
s_mov_b32 s29, 0xbe0293ee
s_mov_b32 s30, -1
s_mov_b32 s31, 0
s_mov_b32 s40, 0x3f803f80
s_mov_b32 s41, 0x3f803f80
s_mov_b32 s42, 0x3f003f00
s_mov_b32 s43, 0x3f003f00
s_mov_b32 s57, 0
s_mov_b32 s18, 0
s_mul_i32 s19, s23, 524288
s_add_u32 s19, s19, 0
s_add_u32 s20, s19, 393216
s_mov_b32 s46, s20
s_add_u32 s21, s20, 16384
s_lshl_b32 s32, s16, 13
s_add_u32 s24, s32, 50331648
s_add_u32 s25, s32, 67112960
s_lshl_b32 s3, s16, 15
s_add_u32 s3, s3, 134217728
s_lshl_b32 s22, s16, 7
s_add_u32 s22, s22, 1058816
s_lshl_b32 s32, s16, 12
s_add_u32 s26, s32, 16779264
s_mov_b32 s48, s8
s_mov_b32 s49, s9
s_cmp_eq_u32 s23, 0
s_cselect_b32 s50, s10, 0
s_mov_b32 s51, 0x20000
s_add_u32 s33, s19, 163840
s_lshl_b32 s45, s16, 12
s_add_u32 s45, s45, s33
s_lshl_b32 s56, s16, 12
s_add_u32 s56, s56, s19
s_xor_b32 s56, s56, s45
s_lshr_b32 s55, s16, 2
s_add_u32 s55, s55, 32
s_lshl_b32 s55, s55, 12
s_and_b32 s39, s16, 3
s_lshl_b32 s39, s39, 5
s_add_u32 s55, s55, s39
s_add_u32 s55, s55, s33
s_lshr_b32 s58, s16, 2
s_add_u32 s58, s58, 32
s_lshl_b32 s58, s58, 12
s_and_b32 s39, s16, 3
s_lshl_b32 s39, s39, 5
s_add_u32 s58, s58, s39
s_add_u32 s58, s58, s19
s_xor_b32 s58, s58, s55
s_branch C_pro
C_set3:
v_and_b32 v10, 63, v0
v_lshlrev_b32 v1, 4, v10
v_add_u32 v3, 0x10000, v1
v_add_u32 v4, 0x20000, v1
v_lshlrev_b32 v6, 3, v10
v_lshrrev_b32 v11, 4, v10
v_and_b32 v12, 15, v10
v_and_b32 v13, 7, v10
v_lshlrev_b32 v14, 7, v11
v_lshl_add_u32 v2, v13, 4, v14
v_and_b32 v14, 1, v12
v_lshlrev_b32 v14, 7, v14
v_lshrrev_b32 v15, 2, v12
v_lshl_add_u32 v15, v11, 2, v15
v_lshl_add_u32 v5, v15, 3, v14
v_lshrrev_b32 v14, 1, v11
v_lshlrev_b32 v14, 4, v14
v_and_b32 v15, 1, v11
v_lshl_add_u32 v14, v15, 3, v14
v_lshrrev_b32 v15, 2, v12
v_lshlrev_b32 v15, 12, v15
v_and_b32 v16, 3, v12
v_lshl_add_u32 v15, v16, 5, v15
v_add_u32 v15, v15, v14
s_lshl_b32 s32, s16, 7
v_add_u32 v8, s32, v15
v_mov_b32 v17, 0x7ffffff0
v_lshlrev_b32 v9, 7, v10
v_mov_b32 v7, 0
v_mov_b32 v15, 0x8888
v_mov_b32 v16, 0xdddd
v_cmp_gt_u32 vcc, 8, v12
s_nop 1
v_cndmask_b32 v0, v16, v15, vcc
s_mov_b32 s28, 0x3e0293ee
s_mov_b32 s29, 0xbe0293ee
s_mov_b32 s30, -1
s_mov_b32 s31, 0
s_mov_b32 s40, 0x3f803f80
s_mov_b32 s41, 0x3f803f80
s_mov_b32 s42, 0x3f003f00
s_mov_b32 s43, 0x3f003f00
s_mov_b32 s57, 0
s_mov_b32 s18, 0
s_mul_i32 s19, s23, 524288
s_add_u32 s19, s19, 0
s_add_u32 s20, s19, 393216
s_mov_b32 s46, s20
s_add_u32 s21, s20, 16384
s_lshl_b32 s32, s16, 13
s_add_u32 s24, s32, 50331648
s_add_u32 s25, s32, 67115008
s_lshl_b32 s3, s16, 15
s_add_u32 s3, s3, 134217728
s_lshl_b32 s22, s16, 7
s_add_u32 s22, s22, 1058816
s_lshl_b32 s32, s16, 12
s_add_u32 s26, s32, 16780288
s_mov_b32 s48, s8
s_mov_b32 s49, s9
s_cmp_eq_u32 s23, 0
s_cselect_b32 s50, s10, 0
s_mov_b32 s51, 0x20000
s_add_u32 s33, s19, 163840
s_lshl_b32 s45, s16, 12
s_add_u32 s45, s45, s33
s_lshl_b32 s56, s16, 12
s_add_u32 s56, s56, s19
s_xor_b32 s56, s56, s45
s_lshr_b32 s55, s16, 2
s_add_u32 s55, s55, 32
s_lshl_b32 s55, s55, 12
s_and_b32 s39, s16, 3
s_lshl_b32 s39, s39, 5
s_add_u32 s55, s55, s39
s_add_u32 s55, s55, s33
s_lshr_b32 s58, s16, 2
s_add_u32 s58, s58, 32
s_lshl_b32 s58, s58, 12
s_and_b32 s39, s16, 3
s_lshl_b32 s39, s39, 5
s_add_u32 s58, s58, s39
s_add_u32 s58, s58, s19
s_xor_b32 s58, s58, s55
C_pro:
s_nop 4
s_lshl_b32 s32, s17, 3
v_add_u32 v16, s32, v11
v_lshlrev_b32 v14, 4, v12
v_lshl_add_u32 v24, v16, 13, v14
v_mul_u32_u24 v15, 1280, v16
v_add_u32 v25, v15, v14
v_lshrrev_b32 v16, 3, v12
v_mul_u32_u24 v16, 81920, v16
v_add_u32 v15, v15, v16
v_lshl_add_u32 v26, v13, 4, v15
s_lshl_b32 s32, s17, 6
s_add_u32 s32, s32, 24576
v_lshlrev_b32 v14, 10, v11
v_lshl_add_u32 v14, v12, 2, v14
v_add_u32 v28, s32, v14
v_add_u32 v29, 0x10000, v28
v_add_u32 v30, 0x20000, v28
s_lshl_b32 s65, s17, 11
s_add_u32 s65, s65, 24576
v_add_u32 v40, s65, v1
v_add_u32 v41, 0x10000, v40
v_add_u32 v42, 0x20000, v40
s_mov_b32 s68, s88
s_mov_b32 s69, s89
s_mov_b32 s70, 5242880
s_mov_b32 s71, 0x20000
s_mov_b32 s72, s90
s_mov_b32 s73, s91
s_mov_b32 s74, 5242880
s_mov_b32 s75, 0x20000
s_mov_b32 s76, s92
s_mov_b32 s77, s93
s_mov_b32 s78, 5242880
s_mov_b32 s79, 0x20000
s_mov_b32 s80, s94
s_mov_b32 s81, s95
s_mov_b32 s82, 5242880
s_mov_b32 s83, 0x20000
s_lshl_b32 s84, s16, 8
s_mul_i32 s32, s23, 2621440
s_sub_u32 s85, s84, s32
s_add_u32 s85, s85, 2621440
s_add_u32 s84, s84, s32
s_mul_i32 s64, s16, 163840
s_mul_i32 s32, s23, 640
s_add_u32 s64, s64, s32
s_add_u32 s32, s84, 0
s_add_u32 m0, s65, 0
s_nop 0
buffer_load_dwordx4 v24, s[72:75], s32 offen lds
s_add_u32 s32, s84, 32768
s_add_u32 m0, s65, 1024
s_nop 0
buffer_load_dwordx4 v24, s[72:75], s32 offen lds
s_add_u32 s32, s84, 262144
s_add_u32 m0, s65, 8192
s_nop 0
buffer_load_dwordx4 v24, s[72:75], s32 offen lds
s_add_u32 s32, s84, 294912
s_add_u32 m0, s65, 9216
s_nop 0
buffer_load_dwordx4 v24, s[72:75], s32 offen lds
s_add_u32 s32, s84, 524288
s_add_u32 m0, s65, 16384
s_nop 0
buffer_load_dwordx4 v24, s[72:75], s32 offen lds
s_add_u32 s32, s84, 557056
s_add_u32 m0, s65, 17408
s_nop 0
buffer_load_dwordx4 v24, s[72:75], s32 offen lds
s_add_u32 s32, s84, 786432
s_add_u32 m0, s65, 24576
s_nop 0
buffer_load_dwordx4 v24, s[72:75], s32 offen lds
s_add_u32 s32, s84, 819200
s_add_u32 m0, s65, 25600
s_nop 0
buffer_load_dwordx4 v24, s[72:75], s32 offen lds
s_add_u32 s32, s84, 1048576
s_add_u32 m0, s65, 32768
s_nop 0
buffer_load_dwordx4 v24, s[72:75], s32 offen lds
s_add_u32 s32, s84, 1081344
s_add_u32 m0, s65, 33792
s_nop 0
buffer_load_dwordx4 v24, s[72:75], s32 offen lds
s_add_u32 s32, s84, 1572864
s_add_u32 m0, s65, 40960
s_nop 0
buffer_load_dwordx4 v24, s[72:75], s32 offen lds
s_add_u32 s32, s84, 1605632
s_add_u32 m0, s65, 41984
s_nop 0
buffer_load_dwordx4 v24, s[72:75], s32 offen lds
s_mov_b32 s12, s86
s_mov_b32 s13, s87
s_mov_b32 s14, 10240
s_mov_b32 s15, 0x20000
v_mul_u32_u24 v14, 1280, v13
v_lshrrev_b32 v15, 3, v10
v_lshl_add_u32 v14, v15, 4, v14
s_add_u32 s33, s17, 0
s_lshl_b32 s34, s33, 10
v_add_u32 v56, s34, v1
s_mul_i32 s34, s23, 5
s_add_u32 s33, s33, s34
s_cmp_ge_u32 s33, 10
s_cselect_b32 s34, 10, 0
s_sub_u32 s33, s33, s34
s_lshl_b32 s33, s33, 7
buffer_load_dwordx4 v[44:47], v14, s[12:15], s33 offen
s_add_u32 s33, s17, 4
s_lshl_b32 s34, s33, 10
v_add_u32 v57, s34, v1
s_mul_i32 s34, s23, 5
s_add_u32 s33, s33, s34
s_cmp_ge_u32 s33, 10
s_cselect_b32 s34, 10, 0
s_sub_u32 s33, s33, s34
s_lshl_b32 s33, s33, 7
buffer_load_dwordx4 v[48:51], v14, s[12:15], s33 offen
s_and_b32 s33, s17, 1
s_add_u32 s33, s33, 8
s_lshl_b32 s34, s33, 10
v_add_u32 v58, s34, v1
s_mul_i32 s34, s23, 5
s_add_u32 s33, s33, s34
s_cmp_ge_u32 s33, 10
s_cselect_b32 s34, 10, 0
s_sub_u32 s33, s33, s34
s_lshl_b32 s33, s33, 7
buffer_load_dwordx4 v[52:55], v14, s[12:15], s33 offen
s_waitcnt vmcnt(13)
s_barrier
ds_read2st64_b32 a[136:137], v28 offset0:0 offset1:1
ds_read2st64_b32 a[138:139], v28 offset0:2 offset1:3
ds_read2st64_b32 a[140:141], v28 offset0:16 offset1:17
ds_read2st64_b32 a[142:143], v28 offset0:18 offset1:19
s_waitcnt vmcnt(11)
s_waitcnt lgkmcnt(0)
s_barrier
s_add_u32 s32, s84, 1835008
s_add_u32 m0, s65, 49152
s_nop 0
buffer_load_dwordx4 v24, s[72:75], s32 offen lds
s_add_u32 s32, s84, 1867776
s_add_u32 m0, s65, 50176
s_nop 0
buffer_load_dwordx4 v24, s[72:75], s32 offen lds
ds_read2st64_b32 a[144:145], v28 offset0:32 offset1:33
ds_read2st64_b32 a[146:147], v28 offset0:34 offset1:35
ds_read2st64_b32 a[148:149], v28 offset0:48 offset1:49
ds_read2st64_b32 a[150:151], v28 offset0:50 offset1:51
s_waitcnt vmcnt(11)
s_waitcnt lgkmcnt(0)
s_barrier
s_add_u32 s32, s84, 2097152
s_add_u32 m0, s65, 57344
s_nop 0
buffer_load_dwordx4 v24, s[72:75], s32 offen lds
s_add_u32 s32, s84, 2129920
s_add_u32 m0, s65, 58368
s_nop 0
buffer_load_dwordx4 v24, s[72:75], s32 offen lds
ds_read2st64_b32 a[152:153], v28 offset0:64 offset1:65
ds_read2st64_b32 a[154:155], v28 offset0:66 offset1:67
ds_read2st64_b32 a[156:157], v28 offset0:80 offset1:81
ds_read2st64_b32 a[158:159], v28 offset0:82 offset1:83
s_waitcnt vmcnt(11)
s_waitcnt lgkmcnt(0)
s_barrier
s_add_u32 s32, s85, 0
s_add_u32 m0, s65, 65536
s_nop 0
buffer_load_dwordx4 v24, s[72:75], s32 offen lds
s_add_u32 s32, s85, 32768
s_add_u32 m0, s65, 66560
s_nop 0
buffer_load_dwordx4 v24, s[72:75], s32 offen lds
ds_read2st64_b32 a[160:161], v28 offset0:96 offset1:97
ds_read2st64_b32 a[162:163], v28 offset0:98 offset1:99
ds_read2st64_b32 a[164:165], v28 offset0:112 offset1:113
ds_read2st64_b32 a[166:167], v28 offset0:114 offset1:115
s_waitcnt vmcnt(11)
s_waitcnt lgkmcnt(0)
s_barrier
s_add_u32 s32, s85, 524288
s_add_u32 m0, s65, 73728
s_nop 0
buffer_load_dwordx4 v24, s[72:75], s32 offen lds
s_add_u32 s32, s85, 557056
s_add_u32 m0, s65, 74752
s_nop 0
buffer_load_dwordx4 v24, s[72:75], s32 offen lds
ds_read2st64_b32 a[168:169], v28 offset0:128 offset1:129
ds_read2st64_b32 a[170:171], v28 offset0:130 offset1:131
ds_read2st64_b32 a[172:173], v28 offset0:144 offset1:145
ds_read2st64_b32 a[174:175], v28 offset0:146 offset1:147
s_waitcnt vmcnt(11)
s_waitcnt lgkmcnt(0)
s_barrier
s_add_u32 s32, s85, 1048576
s_add_u32 m0, s65, 81920
s_nop 0
buffer_load_dwordx4 v24, s[72:75], s32 offen lds
s_add_u32 s32, s85, 1081344
s_add_u32 m0, s65, 82944
s_nop 0
buffer_load_dwordx4 v24, s[72:75], s32 offen lds
ds_read2st64_b32 a[176:177], v28 offset0:160 offset1:161
ds_read2st64_b32 a[178:179], v28 offset0:162 offset1:163
ds_read2st64_b32 a[180:181], v28 offset0:176 offset1:177
ds_read2st64_b32 a[182:183], v28 offset0:178 offset1:179
s_waitcnt vmcnt(8)
s_waitcnt lgkmcnt(0)
s_barrier
s_add_u32 s32, s85, 1310720
s_add_u32 m0, s65, 90112
s_nop 0
buffer_load_dwordx4 v24, s[72:75], s32 offen lds
s_add_u32 s32, s85, 1343488
s_add_u32 m0, s65, 91136
s_nop 0
buffer_load_dwordx4 v24, s[72:75], s32 offen lds
ds_read2st64_b32 a[184:185], v28 offset0:192 offset1:193
ds_read2st64_b32 a[186:187], v28 offset0:194 offset1:195
ds_read2st64_b32 a[188:189], v28 offset0:208 offset1:209
ds_read2st64_b32 a[190:191], v28 offset0:210 offset1:211
s_waitcnt vmcnt(8)
s_waitcnt lgkmcnt(0)
s_barrier
s_add_u32 s32, s85, 1572864
s_add_u32 m0, s65, 98304
s_nop 0
buffer_load_dwordx4 v24, s[72:75], s32 offen lds
s_add_u32 s32, s85, 1605632
s_add_u32 m0, s65, 99328
s_nop 0
buffer_load_dwordx4 v24, s[72:75], s32 offen lds
ds_read2st64_b32 a[192:193], v28 offset0:224 offset1:225
ds_read2st64_b32 a[194:195], v28 offset0:226 offset1:227
ds_read2st64_b32 a[196:197], v28 offset0:240 offset1:241
ds_read2st64_b32 a[198:199], v28 offset0:242 offset1:243
s_waitcnt vmcnt(8)
s_waitcnt lgkmcnt(0)
s_barrier
s_add_u32 s32, s85, 1835008
s_add_u32 m0, s65, 106496
s_nop 0
buffer_load_dwordx4 v24, s[72:75], s32 offen lds
s_add_u32 s32, s85, 1867776
s_add_u32 m0, s65, 107520
s_nop 0
buffer_load_dwordx4 v24, s[72:75], s32 offen lds
ds_read2st64_b32 a[200:201], v29 offset0:0 offset1:1
ds_read2st64_b32 a[202:203], v29 offset0:2 offset1:3
ds_read2st64_b32 a[204:205], v29 offset0:16 offset1:17
ds_read2st64_b32 a[206:207], v29 offset0:18 offset1:19
s_waitcnt vmcnt(8)
s_waitcnt lgkmcnt(0)
s_barrier
s_add_u32 s32, s85, 2097152
s_add_u32 m0, s65, 114688
s_nop 0
buffer_load_dwordx4 v24, s[72:75], s32 offen lds
s_add_u32 s32, s85, 2129920
s_add_u32 m0, s65, 115712
s_nop 0
buffer_load_dwordx4 v24, s[72:75], s32 offen lds
ds_read2st64_b32 a[208:209], v29 offset0:32 offset1:33
ds_read2st64_b32 a[210:211], v29 offset0:34 offset1:35
ds_read2st64_b32 a[212:213], v29 offset0:48 offset1:49
ds_read2st64_b32 a[214:215], v29 offset0:50 offset1:51
s_waitcnt vmcnt(8)
s_waitcnt lgkmcnt(0)
s_barrier
s_add_u32 s32, s85, 2359296
s_add_u32 m0, s65, 122880
s_nop 0
buffer_load_dwordx4 v24, s[72:75], s32 offen lds
s_add_u32 s32, s85, 2392064
s_add_u32 m0, s65, 123904
s_nop 0
buffer_load_dwordx4 v24, s[72:75], s32 offen lds
ds_read2st64_b32 a[216:217], v29 offset0:64 offset1:65
ds_read2st64_b32 a[218:219], v29 offset0:66 offset1:67
ds_read2st64_b32 a[220:221], v29 offset0:80 offset1:81
ds_read2st64_b32 a[222:223], v29 offset0:82 offset1:83
s_waitcnt vmcnt(8)
s_waitcnt lgkmcnt(0)
s_barrier
s_add_u32 s32, s84, 786432
s_add_u32 m0, s65, 131072
s_nop 0
buffer_load_dwordx4 v24, s[76:79], s32 offen lds
s_add_u32 s32, s84, 819200
s_add_u32 m0, s65, 132096
s_nop 0
buffer_load_dwordx4 v24, s[76:79], s32 offen lds
ds_read2st64_b32 a[224:225], v29 offset0:96 offset1:97
ds_read2st64_b32 a[226:227], v29 offset0:98 offset1:99
ds_read2st64_b32 a[228:229], v29 offset0:112 offset1:113
ds_read2st64_b32 a[230:231], v29 offset0:114 offset1:115
s_waitcnt vmcnt(8)
s_waitcnt lgkmcnt(0)
s_barrier
s_add_u32 s32, s84, 1048576
s_add_u32 m0, s65, 0
s_nop 0
buffer_load_dwordx4 v24, s[76:79], s32 offen lds
s_add_u32 s32, s84, 1081344
s_add_u32 m0, s65, 1024
s_nop 0
buffer_load_dwordx4 v24, s[76:79], s32 offen lds
ds_read2st64_b32 a[232:233], v29 offset0:128 offset1:129
ds_read2st64_b32 a[234:235], v29 offset0:130 offset1:131
ds_read2st64_b32 a[236:237], v29 offset0:144 offset1:145
ds_read2st64_b32 a[238:239], v29 offset0:146 offset1:147
s_waitcnt vmcnt(8)
s_waitcnt lgkmcnt(0)
s_barrier
s_add_u32 s32, s84, 1310720
s_add_u32 m0, s65, 8192
s_nop 0
buffer_load_dwordx4 v24, s[76:79], s32 offen lds
s_add_u32 s32, s84, 1343488
s_add_u32 m0, s65, 9216
s_nop 0
buffer_load_dwordx4 v24, s[76:79], s32 offen lds
ds_read2st64_b32 a[240:241], v29 offset0:160 offset1:161
ds_read2st64_b32 a[242:243], v29 offset0:162 offset1:163
ds_read2st64_b32 a[244:245], v29 offset0:176 offset1:177
ds_read2st64_b32 a[246:247], v29 offset0:178 offset1:179
s_waitcnt vmcnt(8)
s_waitcnt lgkmcnt(0)
s_barrier
s_add_u32 s32, s84, 1572864
s_add_u32 m0, s65, 16384
s_nop 0
buffer_load_dwordx4 v24, s[76:79], s32 offen lds
s_add_u32 s32, s84, 1605632
s_add_u32 m0, s65, 17408
s_nop 0
buffer_load_dwordx4 v24, s[76:79], s32 offen lds
ds_read2st64_b32 a[248:249], v29 offset0:192 offset1:193
ds_read2st64_b32 a[250:251], v29 offset0:194 offset1:195
ds_read2st64_b32 a[252:253], v29 offset0:208 offset1:209
ds_read2st64_b32 a[254:255], v29 offset0:210 offset1:211
s_waitcnt vmcnt(8)
s_waitcnt lgkmcnt(0)
s_barrier
s_add_u32 s32, s84, 1835008
s_add_u32 m0, s65, 24576
s_nop 0
buffer_load_dwordx4 v24, s[76:79], s32 offen lds
s_add_u32 s32, s84, 1867776
s_add_u32 m0, s65, 25600
s_nop 0
buffer_load_dwordx4 v24, s[76:79], s32 offen lds
ds_read2st64_b32 v[88:89], v29 offset0:224 offset1:225
ds_read2st64_b32 v[90:91], v29 offset0:226 offset1:227
ds_read2st64_b32 v[92:93], v29 offset0:240 offset1:241
ds_read2st64_b32 v[94:95], v29 offset0:242 offset1:243
s_waitcnt vmcnt(8)
s_waitcnt lgkmcnt(0)
s_barrier
s_add_u32 s32, s84, 2097152
s_add_u32 m0, s65, 32768
s_nop 0
buffer_load_dwordx4 v24, s[76:79], s32 offen lds
s_add_u32 s32, s84, 2129920
s_add_u32 m0, s65, 33792
s_nop 0
buffer_load_dwordx4 v24, s[76:79], s32 offen lds
ds_read2st64_b32 v[96:97], v30 offset0:0 offset1:1
ds_read2st64_b32 v[98:99], v30 offset0:2 offset1:3
ds_read2st64_b32 v[100:101], v30 offset0:16 offset1:17
ds_read2st64_b32 v[102:103], v30 offset0:18 offset1:19
s_waitcnt vmcnt(8)
s_waitcnt lgkmcnt(0)
s_barrier
s_add_u32 s32, s85, 0
s_add_u32 m0, s65, 40960
s_nop 0
buffer_load_dwordx4 v24, s[76:79], s32 offen lds
s_add_u32 s32, s85, 32768
s_add_u32 m0, s65, 41984
s_nop 0
buffer_load_dwordx4 v24, s[76:79], s32 offen lds
ds_read2st64_b32 v[104:105], v28 offset0:0 offset1:1
ds_read2st64_b32 v[106:107], v28 offset0:2 offset1:3
ds_read2st64_b32 v[108:109], v28 offset0:16 offset1:17
ds_read2st64_b32 v[110:111], v28 offset0:18 offset1:19
s_waitcnt vmcnt(8)
s_waitcnt lgkmcnt(0)
s_barrier
s_add_u32 s32, s85, 262144
s_add_u32 m0, s65, 49152
s_nop 0
buffer_load_dwordx4 v24, s[76:79], s32 offen lds
s_add_u32 s32, s85, 294912
s_add_u32 m0, s65, 50176
s_nop 0
buffer_load_dwordx4 v24, s[76:79], s32 offen lds
ds_read2st64_b32 v[112:113], v28 offset0:32 offset1:33
ds_read2st64_b32 v[114:115], v28 offset0:34 offset1:35
ds_read2st64_b32 v[116:117], v28 offset0:48 offset1:49
ds_read2st64_b32 v[118:119], v28 offset0:50 offset1:51
s_waitcnt vmcnt(8)
s_waitcnt lgkmcnt(0)
s_barrier
s_add_u32 s32, s85, 524288
s_add_u32 m0, s65, 57344
s_nop 0
buffer_load_dwordx4 v24, s[76:79], s32 offen lds
s_add_u32 s32, s85, 557056
s_add_u32 m0, s65, 58368
s_nop 0
buffer_load_dwordx4 v24, s[76:79], s32 offen lds
ds_read2st64_b32 v[120:121], v28 offset0:64 offset1:65
ds_read2st64_b32 v[122:123], v28 offset0:66 offset1:67
ds_read2st64_b32 v[124:125], v28 offset0:80 offset1:81
ds_read2st64_b32 v[126:127], v28 offset0:82 offset1:83
s_waitcnt vmcnt(8)
s_waitcnt lgkmcnt(0)
s_barrier
s_add_u32 s32, s85, 786432
s_add_u32 m0, s65, 65536
s_nop 0
buffer_load_dwordx4 v24, s[76:79], s32 offen lds
s_add_u32 s32, s85, 819200
s_add_u32 m0, s65, 66560
s_nop 0
buffer_load_dwordx4 v24, s[76:79], s32 offen lds
ds_read2st64_b32 v[128:129], v28 offset0:96 offset1:97
ds_read2st64_b32 v[130:131], v28 offset0:98 offset1:99
ds_read2st64_b32 v[132:133], v28 offset0:112 offset1:113
ds_read2st64_b32 v[134:135], v28 offset0:114 offset1:115
ds_write_b128 v56, v[44:47] offset:0
ds_write_b128 v57, v[48:51] offset:0
ds_write_b128 v58, v[52:55] offset:0
s_waitcnt vmcnt(8)
s_waitcnt lgkmcnt(0)
s_barrier
s_add_u32 s32, s85, 1048576
s_add_u32 m0, s65, 73728
s_nop 0
buffer_load_dwordx4 v24, s[76:79], s32 offen lds
s_add_u32 s32, s85, 1081344
s_add_u32 m0, s65, 74752
s_nop 0
buffer_load_dwordx4 v24, s[76:79], s32 offen lds
ds_read2st64_b32 v[136:137], v28 offset0:128 offset1:129
ds_read2st64_b32 v[138:139], v28 offset0:130 offset1:131
ds_read2st64_b32 v[140:141], v28 offset0:144 offset1:145
ds_read2st64_b32 v[142:143], v28 offset0:146 offset1:147
s_waitcnt vmcnt(8)
s_waitcnt lgkmcnt(0)
s_barrier
s_add_u32 s32, s85, 1310720
s_add_u32 m0, s65, 81920
s_nop 0
buffer_load_dwordx4 v24, s[76:79], s32 offen lds
s_add_u32 s32, s85, 1343488
s_add_u32 m0, s65, 82944
s_nop 0
buffer_load_dwordx4 v24, s[76:79], s32 offen lds
ds_read2st64_b32 v[144:145], v28 offset0:160 offset1:161
ds_read2st64_b32 v[146:147], v28 offset0:162 offset1:163
ds_read2st64_b32 v[148:149], v28 offset0:176 offset1:177
ds_read2st64_b32 v[150:151], v28 offset0:178 offset1:179
s_waitcnt vmcnt(8)
s_waitcnt lgkmcnt(0)
s_barrier
s_add_u32 s32, s85, 1572864
s_add_u32 m0, s65, 90112
s_nop 0
buffer_load_dwordx4 v24, s[76:79], s32 offen lds
s_add_u32 s32, s85, 1605632
s_add_u32 m0, s65, 91136
s_nop 0
buffer_load_dwordx4 v24, s[76:79], s32 offen lds
ds_read2st64_b32 v[152:153], v28 offset0:192 offset1:193
ds_read2st64_b32 v[154:155], v28 offset0:194 offset1:195
ds_read2st64_b32 v[156:157], v28 offset0:208 offset1:209
ds_read2st64_b32 v[158:159], v28 offset0:210 offset1:211
s_waitcnt vmcnt(8)
s_waitcnt lgkmcnt(0)
s_barrier
s_add_u32 s32, s85, 1835008
s_add_u32 m0, s65, 98304
s_nop 0
buffer_load_dwordx4 v24, s[76:79], s32 offen lds
s_add_u32 s32, s85, 1867776
s_add_u32 m0, s65, 99328
s_nop 0
buffer_load_dwordx4 v24, s[76:79], s32 offen lds
ds_read2st64_b32 v[160:161], v28 offset0:224 offset1:225
ds_read2st64_b32 v[162:163], v28 offset0:226 offset1:227
ds_read2st64_b32 v[164:165], v28 offset0:240 offset1:241
ds_read2st64_b32 v[166:167], v28 offset0:242 offset1:243
v_mov_b32 v17, 0
s_mov_b32 s32, 128
v_writelane_b32 v17, s32, 1
s_mov_b32 s32, 64
v_writelane_b32 v17, s32, 2
buffer_load_dword v18, v17, s[60:63], 0 offen sc1
s_waitcnt vmcnt(9)
s_waitcnt lgkmcnt(0)
s_barrier
s_add_u32 s32, s85, 2097152
s_add_u32 m0, s65, 106496
s_nop 0
buffer_load_dwordx4 v24, s[76:79], s32 offen lds
s_add_u32 s32, s85, 2129920
s_add_u32 m0, s65, 107520
s_nop 0
buffer_load_dwordx4 v24, s[76:79], s32 offen lds
ds_read2st64_b32 v[168:169], v29 offset0:0 offset1:1
ds_read2st64_b32 v[170:171], v29 offset0:2 offset1:3
ds_read2st64_b32 v[172:173], v29 offset0:16 offset1:17
ds_read2st64_b32 v[174:175], v29 offset0:18 offset1:19
s_waitcnt vmcnt(9)
s_waitcnt lgkmcnt(0)
s_barrier
s_add_u32 s32, s85, 2359296
s_add_u32 m0, s65, 114688
s_nop 0
buffer_load_dwordx4 v24, s[76:79], s32 offen lds
s_add_u32 s32, s85, 2392064
s_add_u32 m0, s65, 115712
s_nop 0
buffer_load_dwordx4 v24, s[76:79], s32 offen lds
ds_read2st64_b32 v[176:177], v29 offset0:32 offset1:33
ds_read2st64_b32 v[178:179], v29 offset0:34 offset1:35
ds_read2st64_b32 v[180:181], v29 offset0:48 offset1:49
ds_read2st64_b32 v[182:183], v29 offset0:50 offset1:51
s_waitcnt vmcnt(9)
s_waitcnt lgkmcnt(0)
s_barrier
s_add_u32 s32, s64, 256
s_add_u32 m0, s65, 122880
s_nop 0
buffer_load_dwordx4 v25, s[80:83], s32 offen lds
s_add_u32 s32, s64, 5376
s_add_u32 m0, s65, 123904
s_nop 0
buffer_load_dwordx4 v25, s[80:83], s32 offen lds
ds_read2st64_b32 v[184:185], v29 offset0:64 offset1:65
ds_read2st64_b32 v[186:187], v29 offset0:66 offset1:67
ds_read2st64_b32 v[188:189], v29 offset0:80 offset1:81
ds_read2st64_b32 v[190:191], v29 offset0:82 offset1:83
s_waitcnt vmcnt(9)
s_waitcnt lgkmcnt(0)
s_barrier
s_add_u32 s32, s64, 41216
s_add_u32 m0, s65, 131072
s_nop 0
buffer_load_dwordx4 v25, s[80:83], s32 offen lds
s_add_u32 s32, s64, 46336
s_add_u32 m0, s65, 132096
s_nop 0
buffer_load_dwordx4 v25, s[80:83], s32 offen lds
ds_read2st64_b32 v[192:193], v29 offset0:96 offset1:97
ds_read2st64_b32 v[194:195], v29 offset0:98 offset1:99
ds_read2st64_b32 v[196:197], v29 offset0:112 offset1:113
ds_read2st64_b32 v[198:199], v29 offset0:114 offset1:115
s_waitcnt vmcnt(9)
s_waitcnt lgkmcnt(0)
s_barrier
s_add_u32 s32, s64, 82176
s_add_u32 m0, s65, 0
s_nop 0
buffer_load_dwordx4 v25, s[80:83], s32 offen lds
s_add_u32 s32, s64, 87296
s_add_u32 m0, s65, 1024
s_nop 0
buffer_load_dwordx4 v25, s[80:83], s32 offen lds
ds_read2st64_b32 v[200:201], v29 offset0:128 offset1:129
ds_read2st64_b32 v[202:203], v29 offset0:130 offset1:131
ds_read2st64_b32 v[204:205], v29 offset0:144 offset1:145
ds_read2st64_b32 v[206:207], v29 offset0:146 offset1:147
s_waitcnt vmcnt(8)
s_waitcnt lgkmcnt(0)
s_barrier
s_add_u32 s32, s64, 123136
s_add_u32 m0, s65, 8192
s_nop 0
buffer_load_dwordx4 v25, s[80:83], s32 offen lds
s_add_u32 s32, s64, 128256
s_add_u32 m0, s65, 9216
s_nop 0
buffer_load_dwordx4 v25, s[80:83], s32 offen lds
ds_read2st64_b32 v[208:209], v29 offset0:160 offset1:161
ds_read2st64_b32 v[210:211], v29 offset0:162 offset1:163
ds_read2st64_b32 v[212:213], v29 offset0:176 offset1:177
ds_read2st64_b32 v[214:215], v29 offset0:178 offset1:179
s_waitcnt vmcnt(8)
s_waitcnt lgkmcnt(0)
s_barrier
s_add_u32 s32, s84, 0
s_add_u32 m0, s65, 16384
s_nop 0
buffer_load_dwordx4 v24, s[68:71], s32 offen lds
s_add_u32 s32, s84, 32768
s_add_u32 m0, s65, 17408
s_nop 0
buffer_load_dwordx4 v24, s[68:71], s32 offen lds
ds_read2st64_b32 v[216:217], v29 offset0:192 offset1:193
ds_read2st64_b32 v[218:219], v29 offset0:194 offset1:195
ds_read2st64_b32 v[220:221], v29 offset0:208 offset1:209
ds_read2st64_b32 v[222:223], v29 offset0:210 offset1:211
s_waitcnt vmcnt(8)
s_waitcnt lgkmcnt(0)
s_barrier
s_add_u32 s32, s84, 262144
s_add_u32 m0, s65, 24576
s_nop 0
buffer_load_dwordx4 v24, s[68:71], s32 offen lds
s_add_u32 s32, s84, 294912
s_add_u32 m0, s65, 25600
s_nop 0
buffer_load_dwordx4 v24, s[68:71], s32 offen lds
ds_read2st64_b32 v[224:225], v29 offset0:224 offset1:225
ds_read2st64_b32 v[226:227], v29 offset0:226 offset1:227
ds_read2st64_b32 v[228:229], v29 offset0:240 offset1:241
ds_read2st64_b32 v[230:231], v29 offset0:242 offset1:243
s_waitcnt vmcnt(8)
s_waitcnt lgkmcnt(0)
s_barrier
s_add_u32 s32, s84, 524288
s_add_u32 m0, s65, 32768
s_nop 0
buffer_load_dwordx4 v24, s[68:71], s32 offen lds
s_add_u32 s32, s84, 557056
s_add_u32 m0, s65, 33792
s_nop 0
buffer_load_dwordx4 v24, s[68:71], s32 offen lds
ds_read2st64_b32 v[232:233], v30 offset0:0 offset1:1
ds_read2st64_b32 v[234:235], v30 offset0:2 offset1:3
ds_read2st64_b32 v[236:237], v30 offset0:16 offset1:17
ds_read2st64_b32 v[238:239], v30 offset0:18 offset1:19
s_waitcnt vmcnt(8)
s_waitcnt lgkmcnt(0)
s_barrier
s_add_u32 s32, s84, 786432
s_add_u32 m0, s65, 40960
s_nop 0
buffer_load_dwordx4 v24, s[68:71], s32 offen lds
s_add_u32 s32, s84, 819200
s_add_u32 m0, s65, 41984
s_nop 0
buffer_load_dwordx4 v24, s[68:71], s32 offen lds
ds_read2st64_b32 v[240:241], v28 offset0:0 offset1:1
ds_read2st64_b32 v[242:243], v28 offset0:2 offset1:3
ds_read2st64_b32 v[244:245], v28 offset0:16 offset1:17
ds_read2st64_b32 v[246:247], v28 offset0:18 offset1:19
s_waitcnt vmcnt(8)
s_waitcnt lgkmcnt(0)
s_barrier
s_add_u32 s32, s84, 1310720
s_add_u32 m0, s65, 49152
s_nop 0
buffer_load_dwordx4 v24, s[68:71], s32 offen lds
s_add_u32 s32, s84, 1343488
s_add_u32 m0, s65, 50176
s_nop 0
buffer_load_dwordx4 v24, s[68:71], s32 offen lds
ds_read2st64_b32 v[248:249], v28 offset0:32 offset1:33
ds_read2st64_b32 v[250:251], v28 offset0:34 offset1:35
ds_read2st64_b32 v[252:253], v28 offset0:48 offset1:49
ds_read2st64_b32 v[254:255], v28 offset0:50 offset1:51
s_waitcnt vmcnt(8)
s_waitcnt lgkmcnt(0)
s_barrier
s_add_u32 s32, s84, 1572864
s_add_u32 m0, s65, 57344
s_nop 0
buffer_load_dwordx4 v24, s[68:71], s32 offen lds
s_add_u32 s32, s84, 1605632
s_add_u32 m0, s65, 58368
s_nop 0
buffer_load_dwordx4 v24, s[68:71], s32 offen lds
ds_read2st64_b32 a[0:1], v28 offset0:64 offset1:65
ds_read2st64_b32 a[2:3], v28 offset0:66 offset1:67
ds_read2st64_b32 a[4:5], v28 offset0:80 offset1:81
ds_read2st64_b32 a[6:7], v28 offset0:82 offset1:83
s_waitcnt vmcnt(8)
s_waitcnt lgkmcnt(0)
s_barrier
s_add_u32 s32, s84, 2097152
s_add_u32 m0, s65, 65536
s_nop 0
buffer_load_dwordx4 v24, s[68:71], s32 offen lds
s_add_u32 s32, s84, 2129920
s_add_u32 m0, s65, 66560
s_nop 0
buffer_load_dwordx4 v24, s[68:71], s32 offen lds
ds_read2st64_b32 a[8:9], v28 offset0:96 offset1:97
ds_read2st64_b32 a[10:11], v28 offset0:98 offset1:99
ds_read2st64_b32 a[12:13], v28 offset0:112 offset1:113
ds_read2st64_b32 a[14:15], v28 offset0:114 offset1:115
s_waitcnt vmcnt(8)
s_waitcnt lgkmcnt(0)
s_barrier
s_add_u32 s32, s84, 2359296
s_add_u32 m0, s65, 73728
s_nop 0
buffer_load_dwordx4 v24, s[68:71], s32 offen lds
s_add_u32 s32, s84, 2392064
s_add_u32 m0, s65, 74752
s_nop 0
buffer_load_dwordx4 v24, s[68:71], s32 offen lds
ds_read2st64_b32 a[16:17], v28 offset0:128 offset1:129
ds_read2st64_b32 a[18:19], v28 offset0:130 offset1:131
ds_read2st64_b32 a[20:21], v28 offset0:144 offset1:145
ds_read2st64_b32 a[22:23], v28 offset0:146 offset1:147
s_waitcnt vmcnt(8)
s_waitcnt lgkmcnt(0)
s_barrier
s_add_u32 s32, s85, 0
s_add_u32 m0, s65, 81920
s_nop 0
buffer_load_dwordx4 v24, s[68:71], s32 offen lds
s_add_u32 s32, s85, 32768
s_add_u32 m0, s65, 82944
s_nop 0
buffer_load_dwordx4 v24, s[68:71], s32 offen lds
ds_read2st64_b32 a[24:25], v28 offset0:160 offset1:161
ds_read2st64_b32 a[26:27], v28 offset0:162 offset1:163
ds_read2st64_b32 a[28:29], v28 offset0:176 offset1:177
ds_read2st64_b32 a[30:31], v28 offset0:178 offset1:179
s_waitcnt vmcnt(8)
s_waitcnt lgkmcnt(0)
s_barrier
s_add_u32 s32, s85, 262144
s_add_u32 m0, s65, 90112
s_nop 0
buffer_load_dwordx4 v24, s[68:71], s32 offen lds
s_add_u32 s32, s85, 294912
s_add_u32 m0, s65, 91136
s_nop 0
buffer_load_dwordx4 v24, s[68:71], s32 offen lds
ds_read2st64_b32 a[32:33], v28 offset0:192 offset1:193
ds_read2st64_b32 a[34:35], v28 offset0:194 offset1:195
ds_read2st64_b32 a[36:37], v28 offset0:208 offset1:209
ds_read2st64_b32 a[38:39], v28 offset0:210 offset1:211
s_waitcnt vmcnt(8)
s_waitcnt lgkmcnt(0)
s_barrier
s_add_u32 s32, s85, 524288
s_add_u32 m0, s65, 98304
s_nop 0
buffer_load_dwordx4 v24, s[68:71], s32 offen lds
s_add_u32 s32, s85, 557056
s_add_u32 m0, s65, 99328
s_nop 0
buffer_load_dwordx4 v24, s[68:71], s32 offen lds
ds_read2st64_b32 a[40:41], v28 offset0:224 offset1:225
ds_read2st64_b32 a[42:43], v28 offset0:226 offset1:227
ds_read2st64_b32 a[44:45], v28 offset0:240 offset1:241
ds_read2st64_b32 a[46:47], v28 offset0:242 offset1:243
s_waitcnt vmcnt(8)
s_waitcnt lgkmcnt(0)
s_barrier
s_add_u32 s32, s85, 786432
s_add_u32 m0, s65, 106496
s_nop 0
buffer_load_dwordx4 v24, s[68:71], s32 offen lds
s_add_u32 s32, s85, 819200
s_add_u32 m0, s65, 107520
s_nop 0
buffer_load_dwordx4 v24, s[68:71], s32 offen lds
ds_read2st64_b32 a[48:49], v29 offset0:0 offset1:1
ds_read2st64_b32 a[50:51], v29 offset0:2 offset1:3
ds_read2st64_b32 a[52:53], v29 offset0:16 offset1:17
ds_read2st64_b32 a[54:55], v29 offset0:18 offset1:19
s_waitcnt vmcnt(8)
s_waitcnt lgkmcnt(0)
s_barrier
s_add_u32 s32, s85, 1048576
s_add_u32 m0, s65, 114688
s_nop 0
buffer_load_dwordx4 v24, s[68:71], s32 offen lds
s_add_u32 s32, s85, 1081344
s_add_u32 m0, s65, 115712
s_nop 0
buffer_load_dwordx4 v24, s[68:71], s32 offen lds
ds_read2st64_b32 a[56:57], v29 offset0:32 offset1:33
ds_read2st64_b32 a[58:59], v29 offset0:34 offset1:35
ds_read2st64_b32 a[60:61], v29 offset0:48 offset1:49
ds_read2st64_b32 a[62:63], v29 offset0:50 offset1:51
s_waitcnt vmcnt(8)
s_waitcnt lgkmcnt(0)
s_barrier
s_add_u32 s32, s85, 1572864
s_add_u32 m0, s65, 122880
s_nop 0
buffer_load_dwordx4 v24, s[68:71], s32 offen lds
s_add_u32 s32, s85, 1605632
s_add_u32 m0, s65, 123904
s_nop 0
buffer_load_dwordx4 v24, s[68:71], s32 offen lds
ds_read2st64_b32 a[64:65], v29 offset0:64 offset1:65
ds_read2st64_b32 a[66:67], v29 offset0:66 offset1:67
ds_read2st64_b32 a[68:69], v29 offset0:80 offset1:81
ds_read2st64_b32 a[70:71], v29 offset0:82 offset1:83
s_waitcnt vmcnt(8)
s_waitcnt lgkmcnt(0)
s_barrier
s_add_u32 s32, s85, 1835008
s_add_u32 m0, s65, 131072
s_nop 0
buffer_load_dwordx4 v24, s[68:71], s32 offen lds
s_add_u32 s32, s85, 1867776
s_add_u32 m0, s65, 132096
s_nop 0
buffer_load_dwordx4 v24, s[68:71], s32 offen lds
ds_read2st64_b32 a[72:73], v29 offset0:96 offset1:97
ds_read2st64_b32 a[74:75], v29 offset0:98 offset1:99
ds_read2st64_b32 a[76:77], v29 offset0:112 offset1:113
ds_read2st64_b32 a[78:79], v29 offset0:114 offset1:115
s_waitcnt vmcnt(8)
s_waitcnt lgkmcnt(0)
s_barrier
s_add_u32 s32, s85, 2097152
s_add_u32 m0, s65, 0
s_nop 0
buffer_load_dwordx4 v24, s[68:71], s32 offen lds
s_add_u32 s32, s85, 2129920
s_add_u32 m0, s65, 1024
s_nop 0
buffer_load_dwordx4 v24, s[68:71], s32 offen lds
ds_read2st64_b32 a[80:81], v29 offset0:128 offset1:129
ds_read2st64_b32 a[82:83], v29 offset0:130 offset1:131
ds_read2st64_b32 a[84:85], v29 offset0:144 offset1:145
ds_read2st64_b32 a[86:87], v29 offset0:146 offset1:147
s_waitcnt vmcnt(8)
s_waitcnt lgkmcnt(0)
s_barrier
s_add_u32 s32, s85, 2359296
s_add_u32 m0, s65, 8192
s_nop 0
buffer_load_dwordx4 v24, s[68:71], s32 offen lds
s_add_u32 s32, s85, 2392064
s_add_u32 m0, s65, 9216
s_nop 0
buffer_load_dwordx4 v24, s[68:71], s32 offen lds
ds_read2st64_b32 a[88:89], v29 offset0:160 offset1:161
ds_read2st64_b32 a[90:91], v29 offset0:162 offset1:163
ds_read2st64_b32 a[92:93], v29 offset0:176 offset1:177
ds_read2st64_b32 a[94:95], v29 offset0:178 offset1:179
s_waitcnt vmcnt(8)
s_waitcnt lgkmcnt(0)
s_barrier
s_add_u32 s32, s64, 0
s_add_u32 m0, s65, 16384
s_nop 0
buffer_load_dwordx4 v25, s[80:83], s32 offen lds
s_add_u32 s32, s64, 5120
s_add_u32 m0, s65, 17408
s_nop 0
buffer_load_dwordx4 v25, s[80:83], s32 offen lds
ds_read2st64_b32 a[96:97], v29 offset0:192 offset1:193
ds_read2st64_b32 a[98:99], v29 offset0:194 offset1:195
ds_read2st64_b32 a[100:101], v29 offset0:208 offset1:209
ds_read2st64_b32 a[102:103], v29 offset0:210 offset1:211
s_waitcnt vmcnt(8)
s_waitcnt lgkmcnt(0)
s_barrier
s_add_u32 s32, s64, 40960
s_add_u32 m0, s65, 24576
s_nop 0
buffer_load_dwordx4 v25, s[80:83], s32 offen lds
s_add_u32 s32, s64, 46080
s_add_u32 m0, s65, 25600
s_nop 0
buffer_load_dwordx4 v25, s[80:83], s32 offen lds
ds_read2st64_b32 a[104:105], v29 offset0:224 offset1:225
ds_read2st64_b32 a[106:107], v29 offset0:226 offset1:227
ds_read2st64_b32 a[108:109], v29 offset0:240 offset1:241
ds_read2st64_b32 a[110:111], v29 offset0:242 offset1:243
s_waitcnt vmcnt(8)
s_waitcnt lgkmcnt(0)
s_barrier
s_add_u32 s32, s64, 81920
s_add_u32 m0, s65, 32768
s_nop 0
buffer_load_dwordx4 v25, s[80:83], s32 offen lds
s_add_u32 s32, s64, 87040
s_add_u32 m0, s65, 33792
s_nop 0
buffer_load_dwordx4 v25, s[80:83], s32 offen lds
ds_read2st64_b32 a[112:113], v30 offset0:0 offset1:1
ds_read2st64_b32 a[114:115], v30 offset0:2 offset1:3
ds_read2st64_b32 a[116:117], v30 offset0:16 offset1:17
ds_read2st64_b32 a[118:119], v30 offset0:18 offset1:19
s_waitcnt vmcnt(8)
s_waitcnt lgkmcnt(0)
s_barrier
s_add_u32 s32, s64, 122880
s_add_u32 m0, s65, 40960
s_nop 0
buffer_load_dwordx4 v25, s[80:83], s32 offen lds
s_add_u32 s32, s64, 128000
s_add_u32 m0, s65, 41984
s_nop 0
buffer_load_dwordx4 v25, s[80:83], s32 offen lds
ds_read2st64_b32 a[120:121], v28 offset0:0 offset1:1
ds_read2st64_b32 a[122:123], v28 offset0:2 offset1:3
ds_read2st64_b32 a[124:125], v28 offset0:16 offset1:17
ds_read2st64_b32 a[126:127], v28 offset0:18 offset1:19
s_waitcnt vmcnt(8)
s_waitcnt lgkmcnt(0)
s_barrier
s_add_u32 s32, s64, 512
s_add_u32 m0, s65, 49152
s_nop 0
buffer_load_dwordx4 v26, s[80:83], s32 offen lds
s_add_u32 s32, s64, 5632
s_add_u32 m0, s65, 50176
s_nop 0
buffer_load_dwordx4 v26, s[80:83], s32 offen lds
ds_read2st64_b32 a[128:129], v28 offset0:32 offset1:33
ds_read2st64_b32 a[130:131], v28 offset0:34 offset1:35
ds_read2st64_b32 a[132:133], v28 offset0:48 offset1:49
ds_read2st64_b32 a[134:135], v28 offset0:50 offset1:51
s_waitcnt vmcnt(8)
s_waitcnt lgkmcnt(0)
s_barrier
s_add_u32 s32, s64, 41472
s_add_u32 m0, s65, 57344
s_nop 0
buffer_load_dwordx4 v26, s[80:83], s32 offen lds
s_add_u32 s32, s64, 46592
s_add_u32 m0, s65, 58368
s_nop 0
buffer_load_dwordx4 v26, s[80:83], s32 offen lds
ds_read2st64_b32 v[32:33], v28 offset0:64 offset1:65
ds_read2st64_b32 v[34:35], v28 offset0:66 offset1:67
ds_read2st64_b32 v[36:37], v28 offset0:80 offset1:81
ds_read2st64_b32 v[38:39], v28 offset0:82 offset1:83
s_waitcnt vmcnt(8)
s_waitcnt lgkmcnt(0)
s_barrier
ds_write_b128 v40, v[32:35] offset:16384
ds_write_b128 v40, v[36:39] offset:17408
s_add_u32 s32, s84, 0
s_add_u32 m0, s65, 65536
s_nop 0
buffer_load_dwordx4 v24, s[76:79], s32 offen lds
s_add_u32 s32, s84, 32768
s_add_u32 m0, s65, 66560
s_nop 0
buffer_load_dwordx4 v24, s[76:79], s32 offen lds
ds_read2st64_b32 v[32:33], v28 offset0:96 offset1:97
ds_read2st64_b32 v[34:35], v28 offset0:98 offset1:99
ds_read2st64_b32 v[36:37], v28 offset0:112 offset1:113
ds_read2st64_b32 v[38:39], v28 offset0:114 offset1:115
s_waitcnt vmcnt(8)
s_waitcnt lgkmcnt(0)
s_barrier
ds_write_b128 v40, v[32:35] offset:24576
ds_write_b128 v40, v[36:39] offset:25600
s_add_u32 s32, s84, 262144
s_add_u32 m0, s65, 73728
s_nop 0
buffer_load_dwordx4 v24, s[76:79], s32 offen lds
s_add_u32 s32, s84, 294912
s_add_u32 m0, s65, 74752
s_nop 0
buffer_load_dwordx4 v24, s[76:79], s32 offen lds
ds_read2st64_b32 v[32:33], v28 offset0:128 offset1:129
ds_read2st64_b32 v[34:35], v28 offset0:130 offset1:131
ds_read2st64_b32 v[36:37], v28 offset0:144 offset1:145
ds_read2st64_b32 v[38:39], v28 offset0:146 offset1:147
s_waitcnt vmcnt(8)
s_waitcnt lgkmcnt(0)
s_barrier
ds_write_b128 v40, v[32:35] offset:32768
ds_write_b128 v40, v[36:39] offset:33792
s_add_u32 s32, s84, 524288
s_add_u32 m0, s65, 81920
s_nop 0
buffer_load_dwordx4 v24, s[76:79], s32 offen lds
s_add_u32 s32, s84, 557056
s_add_u32 m0, s65, 82944
s_nop 0
buffer_load_dwordx4 v24, s[76:79], s32 offen lds
ds_read2st64_b32 v[32:33], v28 offset0:160 offset1:161
ds_read2st64_b32 v[34:35], v28 offset0:162 offset1:163
ds_read2st64_b32 v[36:37], v28 offset0:176 offset1:177
ds_read2st64_b32 v[38:39], v28 offset0:178 offset1:179
s_waitcnt vmcnt(8)
s_waitcnt lgkmcnt(0)
s_barrier
ds_write_b128 v40, v[32:35] offset:40960
ds_write_b128 v40, v[36:39] offset:41984
s_add_u32 s32, s84, 1048576
s_add_u32 m0, s65, 90112
s_nop 0
buffer_load_dwordx4 v24, s[68:71], s32 offen lds
s_add_u32 s32, s84, 1081344
s_add_u32 m0, s65, 91136
s_nop 0
buffer_load_dwordx4 v24, s[68:71], s32 offen lds
ds_read2st64_b32 v[32:33], v28 offset0:192 offset1:193
ds_read2st64_b32 v[34:35], v28 offset0:194 offset1:195
ds_read2st64_b32 v[36:37], v28 offset0:208 offset1:209
ds_read2st64_b32 v[38:39], v28 offset0:210 offset1:211
s_waitcnt vmcnt(8)
s_waitcnt lgkmcnt(0)
s_barrier
ds_write_b128 v40, v[32:35] offset:49152
ds_write_b128 v40, v[36:39] offset:50176
s_add_u32 s32, s84, 1310720
s_add_u32 m0, s65, 98304
s_nop 0
buffer_load_dwordx4 v24, s[72:75], s32 offen lds
s_add_u32 s32, s84, 1343488
s_add_u32 m0, s65, 99328
s_nop 0
buffer_load_dwordx4 v24, s[72:75], s32 offen lds
ds_read2st64_b32 v[32:33], v28 offset0:224 offset1:225
ds_read2st64_b32 v[34:35], v28 offset0:226 offset1:227
ds_read2st64_b32 v[36:37], v28 offset0:240 offset1:241
ds_read2st64_b32 v[38:39], v28 offset0:242 offset1:243
s_waitcnt vmcnt(8)
s_waitcnt lgkmcnt(0)
s_barrier
ds_write_b128 v40, v[32:35] offset:57344
ds_write_b128 v40, v[36:39] offset:58368
s_add_u32 s32, s84, 1835008
s_add_u32 m0, s65, 106496
s_nop 0
buffer_load_dwordx4 v24, s[68:71], s32 offen lds
s_add_u32 s32, s84, 1867776
s_add_u32 m0, s65, 107520
s_nop 0
buffer_load_dwordx4 v24, s[68:71], s32 offen lds
ds_read2st64_b32 v[32:33], v29 offset0:0 offset1:1
ds_read2st64_b32 v[34:35], v29 offset0:2 offset1:3
ds_read2st64_b32 v[36:37], v29 offset0:16 offset1:17
ds_read2st64_b32 v[38:39], v29 offset0:18 offset1:19
s_waitcnt vmcnt(8)
s_waitcnt lgkmcnt(0)
s_barrier
ds_write_b128 v41, v[32:35] offset:0
ds_write_b128 v41, v[36:39] offset:1024
s_add_u32 s32, s84, 2359296
s_add_u32 m0, s65, 114688
s_nop 0
buffer_load_dwordx4 v24, s[72:75], s32 offen lds
s_add_u32 s32, s84, 2392064
s_add_u32 m0, s65, 115712
s_nop 0
buffer_load_dwordx4 v24, s[72:75], s32 offen lds
ds_read2st64_b32 v[32:33], v29 offset0:32 offset1:33
ds_read2st64_b32 v[34:35], v29 offset0:34 offset1:35
ds_read2st64_b32 v[36:37], v29 offset0:48 offset1:49
ds_read2st64_b32 v[38:39], v29 offset0:50 offset1:51
s_waitcnt vmcnt(8)
s_waitcnt lgkmcnt(0)
s_barrier
ds_write_b128 v41, v[32:35] offset:8192
ds_write_b128 v41, v[36:39] offset:9216
s_add_u32 s32, s84, 2359296
s_add_u32 m0, s65, 122880
s_nop 0
buffer_load_dwordx4 v24, s[76:79], s32 offen lds
s_add_u32 s32, s84, 2392064
s_add_u32 m0, s65, 123904
s_nop 0
buffer_load_dwordx4 v24, s[76:79], s32 offen lds
ds_read2st64_b32 v[32:33], v29 offset0:64 offset1:65
ds_read2st64_b32 v[34:35], v29 offset0:66 offset1:67
ds_read2st64_b32 v[36:37], v29 offset0:80 offset1:81
ds_read2st64_b32 v[38:39], v29 offset0:82 offset1:83
s_waitcnt vmcnt(8)
s_waitcnt lgkmcnt(0)
s_barrier
ds_write_b128 v41, v[32:35] offset:16384
ds_write_b128 v41, v[36:39] offset:17408
s_add_u32 s32, s85, 262144
s_add_u32 m0, s65, 131072
s_nop 0
buffer_load_dwordx4 v24, s[72:75], s32 offen lds
s_add_u32 s32, s85, 294912
s_add_u32 m0, s65, 132096
s_nop 0
buffer_load_dwordx4 v24, s[72:75], s32 offen lds
ds_read2st64_b32 v[32:33], v29 offset0:96 offset1:97
ds_read2st64_b32 v[34:35], v29 offset0:98 offset1:99
ds_read2st64_b32 v[36:37], v29 offset0:112 offset1:113
ds_read2st64_b32 v[38:39], v29 offset0:114 offset1:115
v_readlane_b32 s66, v18, 2
s_lshl_b32 s5, s16, 7
s_add_u32 s5, s5, 1062912
s_mov_b32 s32, 1058176
buffer_load_dword v19, off, s[8:11], s32 sc1
buffer_load_dword v20, v6, s[8:11], s5 offen sc1
s_waitcnt vmcnt(10)
s_waitcnt lgkmcnt(0)
s_barrier
ds_write_b128 v41, v[32:35] offset:24576
ds_write_b128 v41, v[36:39] offset:25600
s_add_u32 s32, s85, 786432
s_add_u32 m0, s65, 0
s_nop 0
buffer_load_dwordx4 v24, s[72:75], s32 offen lds
s_add_u32 s32, s85, 819200
s_add_u32 m0, s65, 1024
s_nop 0
buffer_load_dwordx4 v24, s[72:75], s32 offen lds
ds_read2st64_b32 v[32:33], v29 offset0:128 offset1:129
ds_read2st64_b32 v[34:35], v29 offset0:130 offset1:131
ds_read2st64_b32 v[36:37], v29 offset0:144 offset1:145
ds_read2st64_b32 v[38:39], v29 offset0:146 offset1:147
s_waitcnt vmcnt(10)
s_waitcnt lgkmcnt(0)
s_barrier
ds_write_b128 v41, v[32:35] offset:32768
ds_write_b128 v41, v[36:39] offset:33792
s_add_u32 s32, s85, 1310720
s_add_u32 m0, s65, 8192
s_nop 0
buffer_load_dwordx4 v24, s[68:71], s32 offen lds
s_add_u32 s32, s85, 1343488
s_add_u32 m0, s65, 9216
s_nop 0
buffer_load_dwordx4 v24, s[68:71], s32 offen lds
ds_read2st64_b32 v[32:33], v29 offset0:160 offset1:161
ds_read2st64_b32 v[34:35], v29 offset0:162 offset1:163
ds_read2st64_b32 v[36:37], v29 offset0:176 offset1:177
ds_read2st64_b32 v[38:39], v29 offset0:178 offset1:179
s_waitcnt vmcnt(10)
s_waitcnt lgkmcnt(0)
s_barrier
ds_write_b128 v41, v[32:35] offset:40960
ds_write_b128 v41, v[36:39] offset:41984
ds_read2st64_b32 v[32:33], v29 offset0:192 offset1:193
ds_read2st64_b32 v[34:35], v29 offset0:194 offset1:195
ds_read2st64_b32 v[36:37], v29 offset0:208 offset1:209
ds_read2st64_b32 v[38:39], v29 offset0:210 offset1:211
s_waitcnt vmcnt(8)
s_waitcnt lgkmcnt(0)
s_barrier
ds_write_b128 v41, v[32:35] offset:49152
ds_write_b128 v41, v[36:39] offset:50176
ds_read2st64_b32 v[32:33], v29 offset0:224 offset1:225
ds_read2st64_b32 v[34:35], v29 offset0:226 offset1:227
ds_read2st64_b32 v[36:37], v29 offset0:240 offset1:241
ds_read2st64_b32 v[38:39], v29 offset0:242 offset1:243
s_cmp_eq_u32 s17, 0
s_cselect_b32 s67, s66, 0
s_mov_b32 s32, 0x7ffffff0
s_cmp_eq_u32 s67, 1
s_cselect_b32 s32, 1057792, s32
v_mov_b32 v21, s32
v_mov_b32 v22, 1
s_mov_b64 exec, 1
buffer_atomic_add v22, v21, s[8:11], 0 offen
s_mov_b64 exec, -1
s_waitcnt vmcnt(7)
s_waitcnt lgkmcnt(0)
s_barrier
ds_write_b128 v41, v[32:35] offset:57344
ds_write_b128 v41, v[36:39] offset:58368
ds_read2st64_b32 v[32:33], v30 offset0:0 offset1:1
ds_read2st64_b32 v[34:35], v30 offset0:2 offset1:3
ds_read2st64_b32 v[36:37], v30 offset0:16 offset1:17
ds_read2st64_b32 v[38:39], v30 offset0:18 offset1:19
s_waitcnt vmcnt(3)
s_waitcnt lgkmcnt(0)
s_barrier
ds_write_b128 v42, v[32:35] offset:0
ds_write_b128 v42, v[36:39] offset:1024
ds_read2st64_b32 v[32:33], v28 offset0:0 offset1:1
ds_read2st64_b32 v[34:35], v28 offset0:2 offset1:3
ds_read2st64_b32 v[36:37], v28 offset0:16 offset1:17
ds_read2st64_b32 v[38:39], v28 offset0:18 offset1:19
v_readlane_b32 s33, v20, 0
v_readlane_b32 s38, v20, 1
v_readlane_b32 s39, v20, 2
s_lshl_b32 s33, s33, 1
s_lshl_b32 s38, s38, 1
s_add_u32 s38, s38, 1
s_min_u32 s33, s33, s38
s_cmp_ge_u32 s33, 64
s_cselect_b32 s33, 0x100, s33
s_sub_u32 s59, s33, 1
s_cmp_eq_u32 s39, 1
s_cselect_b32 s38, 0x100, 8
s_min_i32 s59, s59, s38
v_readfirstlane_b32 s47, v19
s_and_b32 s32, s47, 0xffff
s_cmp_ge_u32 s32, 22
s_cselect_b32 s59, s59, -1
s_cmp_eq_u32 s66, 1
s_cselect_b32 s59, s59, -1
s_cmp_ge_i32 s59, 0
s_cselect_b32 s14, s10, 0
s_mov_b32 s12, s8
s_mov_b32 s13, s9
s_mov_b32 s15, 0x20000
s_lshl_b32 s32, s17, 11
s_add_u32 m0, s32, 10240
s_add_u32 s32, s32, s24
buffer_load_dwordx4 v1, s[12:15], s32 offen offset:0 sc1 lds
buffer_load_dwordx4 v1, s[12:15], s32 offen offset:1024 sc1 lds
s_lshl_b32 s32, s16, 2
s_add_u32 s32, s32, s17
s_mul_i32 s32, s32, 3328
s_add_u32 s32, s32, s19
v_lshrrev_b32 v21, 4, v1
v_min_u32 v21, 25, v21
v_lshlrev_b32 v21, 7, v21
buffer_load_dword v22, v21, s[12:15], s32 offen sc1
s_waitcnt vmcnt(4)
s_waitcnt lgkmcnt(0)
s_barrier
ds_write_b128 v40, v[32:35] offset:0
ds_write_b128 v40, v[36:39] offset:1024
ds_read2st64_b32 v[32:33], v28 offset0:32 offset1:33
ds_read2st64_b32 v[34:35], v28 offset0:34 offset1:35
ds_read2st64_b32 v[36:37], v28 offset0:48 offset1:49
ds_read2st64_b32 v[38:39], v28 offset0:50 offset1:51
s_waitcnt lgkmcnt(0)
s_barrier
ds_write_b128 v40, v[32:35] offset:8192
ds_write_b128 v40, v[36:39] offset:9216
s_waitcnt vmcnt(0) lgkmcnt(0)
s_cmp_ge_i32 s59, 0
s_cbranch_scc1 C_go
v_mov_b32 v10, 0x40
C_z:
buffer_load_dword v11, v10, s[60:63], 0 offen sc1
s_waitcnt vmcnt(0)
v_cmp_gt_u32 vcc, 0x1, v11
s_cbranch_vccz C_z_ok
s_add_u32 s57, s57, 1
s_cmp_gt_u32 s57, 0x40000
s_cbranch_scc1 C_fail
s_sleep 8
s_branch C_z
C_z_ok:
s_cmp_lg_u32 s17, 0
s_cbranch_scc1 C_sent
s_cmp_eq_u32 s67, 1
s_cbranch_scc1 C_sent
v_mov_b32 v21, 0x102400
v_mov_b32 v22, 1
s_mov_b64 exec, 1
buffer_atomic_add v22, v21, s[8:11], 0 offen
s_mov_b64 exec, -1
C_sent:
C_kvm:
s_mov_b32 s32, 1058176
buffer_load_dword v19, off, s[8:11], s32 sc1
s_waitcnt vmcnt(0)
v_readfirstlane_b32 s47, v19
s_and_b32 s32, s47, 0xffff
s_cmp_ge_u32 s32, 22
s_cbranch_scc1 C_kvmok
s_add_u32 s57, s57, 1
s_cmp_gt_u32 s57, 0x40000
s_cbranch_scc1 C_fail
s_sleep 4
s_branch C_kvm
C_kvmok:
s_mov_b32 s18, -1
v_mov_b32 v20, 0
C_rdy:
s_nop 0
v_readlane_b32 s33, v20, 0
v_readlane_b32 s38, v20, 1
v_readlane_b32 s39, v20, 2
s_lshl_b32 s33, s33, 1
s_lshl_b32 s38, s38, 1
s_add_u32 s38, s38, 1
s_min_u32 s33, s33, s38
s_cmp_ge_u32 s33, 64
s_cselect_b32 s33, 0x100, s33
s_sub_u32 s59, s33, 1
s_cmp_eq_u32 s39, 1
s_cselect_b32 s38, 0x100, 8
s_min_i32 s59, s59, s38
s_cmp_gt_i32 s59, s18
s_cbranch_scc1 C_rdy_ok
s_add_u32 s57, s57, 1
s_cmp_gt_u32 s57, 0x40000
s_cbranch_scc1 C_fail
s_sleep 2
buffer_load_dword v20, v6, s[8:11], s5 offen sc1
s_waitcnt vmcnt(0)
s_branch C_rdy
C_rdy_ok:
s_mov_b32 s18, 0
s_lshl_b32 s32, s17, 11
s_add_u32 m0, s32, 10240
s_add_u32 s32, s32, s24
buffer_load_dwordx4 v1, s[8:11], s32 offen offset:0 sc1 lds
buffer_load_dwordx4 v1, s[8:11], s32 offen offset:1024 sc1 lds
s_lshl_b32 s32, s16, 2
s_add_u32 s32, s32, s17
s_mul_i32 s32, s32, 3328
s_add_u32 s32, s32, s19
v_lshrrev_b32 v21, 4, v1
v_min_u32 v21, 25, v21
v_lshlrev_b32 v21, 7, v21
buffer_load_dword v22, v21, s[8:11], s32 offen sc1
buffer_load_dword v18, v17, s[60:63], 0 offen sc1
s_waitcnt vmcnt(0)
C_go:
v_sad_u8 v18, v18, 0, 0
s_nop 0
v_readlane_b32 s32, v18, 0
v_readlane_b32 s33, v18, 1
s_cmp_lg_u32 s17, 3
s_cbranch_scc1 C_nv
v_mov_b32 v7, v20
C_nv:
s_min_u32 s32, s32, s33
s_cmp_ge_u32 s32, 32
s_cbranch_scc1 C_cnt
buffer_load_dword v18, v17, s[60:63], 0 offen sc1
s_waitcnt vmcnt(0)
v_sad_u8 v18, v18, 0, 0
s_nop 0
v_readlane_b32 s32, v18, 0
v_readlane_b32 s33, v18, 1
C_cnt:
s_lshr_b32 s47, s47, 3
s_and_b32 s47, s47, 0x6000
s_lshl_b32 s4, s23, 21
s_add_u32 s4, s4, 117440512
s_lshr_b32 s37, s4, 5
s_and_b32 s37, s37, 0x4000
s_lshr_b32 s27, s4, 8
s_and_b32 s27, s27, 0x2000
s_or_b32 s37, s37, s27
s_xor_b32 s37, s37, s47
s_add_u32 s27, s4, s37
s_min_u32 s32, s32, s33
s_cmp_lt_u32 s32, 32
s_cbranch_scc1 C_slow
s_cmp_eq_u32 s17, 1
s_cbranch_scc1 C_f1_in
s_cmp_eq_u32 s17, 2
s_cbranch_scc1 C_f2_in
s_cmp_eq_u32 s17, 3
s_cbranch_scc1 C_f3_in
C_f0_in:
s_add_u32 s25, s24, 16777216
s_add_u32 s24, s24, 262144
v_mov_b64 v[28:29], 0
v_mov_b64 v[30:31], 0
v_mov_b64 v[32:33], 0
v_mov_b64 v[34:35], 0
v_mov_b64 v[40:41], 0
v_mov_b64 v[42:43], 0
ds_read_b128 v[44:47], v3 offset:24576
ds_read_b128 v[48:51], v3 offset:25600
ds_read_b128 v[52:55], v3 offset:32768
ds_read_b128 v[56:59], v3 offset:33792
ds_read_b128 v[60:63], v3 offset:40960
ds_read_b128 v[64:67], v3 offset:41984
s_waitcnt lgkmcnt(0)
s_barrier
s_branch C_f0_first
C_f0:
s_nop 15
s_nop 3
buffer_load_dwordx4 v[68:71], v1, s[8:11], s37 offen offset:0 sc1
s_nop 15
s_nop 15
buffer_load_dwordx4 v[68:71], v1, s[8:11], s37 offen offset:0 sc1
s_waitcnt vmcnt(1)
C_f0_chk:
v_max3_u32 v10, v68, v69, v70
v_max_u32 v10, v10, v71
v_cmp_eq_u32 vcc, -1, v10
s_cbranch_vccnz C_f0_chkslow
ds_write_b128 v1, v[68:71] offset:0
buffer_store_dwordx4 v[36:39], v1, s[8:11], s45 offen offset:0
buffer_store_dword v36, v9, s[8:11], s21 offen
s_mov_b32 s21, s34
s_waitcnt lgkmcnt(0)
buffer_load_dwordx4 v[68:71], v1, s[8:11], s44 offen offset:0 sc1
s_barrier
ds_read_b128 v[12:15], v2 offset:0
ds_read_b128 v[16:19], v2 offset:512
ds_read_b128 v[20:23], v2 offset:1024
ds_read_b128 v[24:27], v2 offset:1536
s_waitcnt lgkmcnt(3)
v_smfmac_f32_16x16x64_bf16 v[28:31], v[12:15], a[0:7], v0
v_smfmac_f32_16x16x64_bf16 v[32:35], v[12:15], a[136:143], v0
v_smfmac_f32_16x16x64_bf16 v[40:43], v[12:15], v[44:51], v0
ds_read_b128 v[12:15], v2 offset:2048
ds_read_b128 v[44:47], v3 offset:49152
s_waitcnt lgkmcnt(4)
v_smfmac_f32_16x16x64_bf16 v[28:31], v[16:19], a[8:15], v0
ds_read_b128 v[48:51], v3 offset:50176
v_smfmac_f32_16x16x64_bf16 v[32:35], v[16:19], a[144:151], v0
v_smfmac_f32_16x16x64_bf16 v[40:43], v[16:19], v[52:59], v0
ds_read_b128 v[16:19], v2 offset:2560
ds_read_b128 v[52:55], v3 offset:57344
s_waitcnt lgkmcnt(6)
v_smfmac_f32_16x16x64_bf16 v[28:31], v[20:23], a[16:23], v0
ds_read_b128 v[56:59], v3 offset:58368
v_smfmac_f32_16x16x64_bf16 v[32:35], v[20:23], a[152:159], v0
v_smfmac_f32_16x16x64_bf16 v[40:43], v[20:23], v[60:67], v0
ds_read_b128 v[20:23], v2 offset:3072
ds_read_b128 v[60:63], v4 offset:0
s_waitcnt lgkmcnt(8)
v_smfmac_f32_16x16x64_bf16 v[28:31], v[24:27], a[24:31], v0
ds_read_b128 v[64:67], v4 offset:1024
v_smfmac_f32_16x16x64_bf16 v[32:35], v[24:27], a[160:167], v0
v_smfmac_f32_16x16x64_bf16 v[40:43], v[24:27], v[96:103], v0
ds_read_b128 v[24:27], v2 offset:3584
s_waitcnt lgkmcnt(7)
v_smfmac_f32_16x16x64_bf16 v[28:31], v[12:15], v[44:51], v0
ds_read_b128 v[44:47], v4 offset:8192
ds_read_b128 v[48:51], v4 offset:9216
v_smfmac_f32_16x16x64_bf16 v[32:35], v[12:15], a[168:175], v0
v_smfmac_f32_16x16x64_bf16 v[40:43], v[12:15], v[104:111], v0
ds_read_b128 v[12:15], v2 offset:4096
s_waitcnt lgkmcnt(9)
v_smfmac_f32_16x16x64_bf16 v[28:31], v[16:19], a[32:39], v0
s_waitcnt lgkmcnt(7)
v_smfmac_f32_16x16x64_bf16 v[32:35], v[16:19], v[52:59], v0
ds_read_b128 v[52:55], v4 offset:16384
ds_read_b128 v[56:59], v4 offset:17408
v_smfmac_f32_16x16x64_bf16 v[40:43], v[16:19], v[112:119], v0
ds_read_b128 v[16:19], v2 offset:4608
s_waitcnt lgkmcnt(9)
v_smfmac_f32_16x16x64_bf16 v[28:31], v[20:23], a[40:47], v0
v_smfmac_f32_16x16x64_bf16 v[32:35], v[20:23], a[176:183], v0
s_waitcnt vmcnt(0)
v_max3_u32 v10, v68, v69, v70
s_waitcnt lgkmcnt(6)
v_smfmac_f32_16x16x64_bf16 v[28:31], v[24:27], v[60:67], v0
v_max_u32 v10, v10, v71
ds_write_b128 v1, v[68:71] offset:5120
v_smfmac_f32_16x16x64_bf16 v[32:35], v[24:27], a[184:191], v0
v_cmp_eq_u32 vcc, -1, v10
ds_read_b128 v[60:63], v4 offset:24576
s_waitcnt lgkmcnt(5)
v_smfmac_f32_16x16x64_bf16 v[28:31], v[12:15], a[48:55], v0
ds_read_b128 v[64:67], v4 offset:25600
v_smfmac_f32_16x16x64_bf16 v[32:35], v[12:15], a[192:199], v0
s_waitcnt lgkmcnt(3)
v_smfmac_f32_16x16x64_bf16 v[28:31], v[16:19], a[56:63], v0
v_smfmac_f32_16x16x64_bf16 v[32:35], v[16:19], v[44:51], v0
ds_read_b128 v[44:47], v1 offset:24576
ds_read_b128 v[48:51], v1 offset:25600
s_cbranch_vccnz C_f0_rslow
C_f0_rok:
s_waitcnt lgkmcnt(4)
s_barrier
C_f0_mid:
v_smfmac_f32_16x16x64_bf16 v[40:43], v[20:23], v[120:127], v0
ds_read_b128 v[20:23], v2 offset:5120
v_smfmac_f32_16x16x64_bf16 v[40:43], v[24:27], v[128:135], v0
ds_read_b128 v[24:27], v2 offset:5632
v_smfmac_f32_16x16x64_bf16 v[40:43], v[12:15], v[136:143], v0
ds_read_b128 v[12:15], v2 offset:6144
v_smfmac_f32_16x16x64_bf16 v[40:43], v[16:19], v[52:59], v0
ds_read_b128 v[16:19], v2 offset:6656
ds_read_b128 v[52:55], v1 offset:32768
s_waitcnt lgkmcnt(4)
v_smfmac_f32_16x16x64_bf16 v[28:31], v[20:23], a[64:71], v0
ds_read_b128 v[56:59], v1 offset:33792
buffer_load_dwordx4 v[80:83], v1, s[8:11], s25 offen offset:0 sc1
v_smfmac_f32_16x16x64_bf16 v[32:35], v[20:23], a[200:207], v0
ds_read_b128 v[20:23], v2 offset:7168
s_waitcnt lgkmcnt(5)
v_smfmac_f32_16x16x64_bf16 v[28:31], v[24:27], a[72:79], v0
buffer_load_dwordx4 v[84:87], v1, s[8:11], s25 offen offset:1024 sc1
v_smfmac_f32_16x16x64_bf16 v[32:35], v[24:27], v[60:67], v0
ds_read_b128 v[24:27], v2 offset:7680
s_waitcnt lgkmcnt(5)
v_smfmac_f32_16x16x64_bf16 v[28:31], v[12:15], a[80:87], v0
v_smfmac_f32_16x16x64_bf16 v[32:35], v[12:15], a[208:215], v0
ds_read_b128 v[12:15], v2 offset:8192
s_waitcnt lgkmcnt(5)
v_smfmac_f32_16x16x64_bf16 v[28:31], v[16:19], a[88:95], v0
v_smfmac_f32_16x16x64_bf16 v[32:35], v[16:19], v[44:51], v0
ds_read_b128 v[16:19], v2 offset:8704
s_waitcnt lgkmcnt(3)
v_smfmac_f32_16x16x64_bf16 v[28:31], v[20:23], a[96:103], v0
v_smfmac_f32_16x16x64_bf16 v[32:35], v[20:23], a[216:223], v0
ds_read_b128 v[20:23], v2 offset:9216
s_waitcnt lgkmcnt(3)
v_smfmac_f32_16x16x64_bf16 v[28:31], v[24:27], v[52:59], v0
v_smfmac_f32_16x16x64_bf16 v[32:35], v[24:27], a[224:231], v0
ds_read_b128 v[24:27], v2 offset:9728
s_waitcnt lgkmcnt(3)
v_smfmac_f32_16x16x64_bf16 v[28:31], v[12:15], a[104:111], v0
ds_read_b128 v[52:55], v1 offset:10240
ds_read_b128 v[56:59], v1 offset:11264
v_smfmac_f32_16x16x64_bf16 v[32:35], v[12:15], a[232:239], v0
ds_read_b128 v[68:71], v1 offset:12288
ds_read_b128 v[72:75], v1 offset:13312
s_waitcnt lgkmcnt(6)
v_smfmac_f32_16x16x64_bf16 v[28:31], v[16:19], a[112:119], v0
s_add_u32 s52, s19, 0
s_add_u32 s53, s19, 65536
s_waitcnt lgkmcnt(5)
v_smfmac_f32_16x16x64_bf16 v[28:31], v[20:23], a[120:127], v0
s_add_u32 s54, s19, 131072
s_xor_b32 s45, s45, s56
s_waitcnt lgkmcnt(4)
v_smfmac_f32_16x16x64_bf16 v[28:31], v[24:27], a[128:135], v0
v_smfmac_f32_16x16x64_bf16 v[32:35], v[16:19], a[240:247], v0
v_smfmac_f32_16x16x64_bf16 v[32:35], v[20:23], a[248:255], v0
v_cvt_pk_bf16_f32 v36, v28, v29
v_smfmac_f32_16x16x64_bf16 v[32:35], v[24:27], v[88:95], v0
v_cvt_pk_bf16_f32 v37, v30, v31
ds_write_b64 v6, v[36:37] offset:18432
v_smfmac_f32_16x16x64_bf16 v[40:43], v[12:15], v[192:199], v0
s_cmp_eq_u32 s18, 63
v_smfmac_f32_16x16x64_bf16 v[40:43], v[16:19], v[200:207], v0
v_cvt_pk_bf16_f32 v76, v32, v33
v_cvt_pk_bf16_f32 v77, v34, v35
ds_write_b64 v6, v[76:77] offset:20480
v_smfmac_f32_16x16x64_bf16 v[40:43], v[20:23], v[208:215], v0
ds_read_b128 v[12:15], v2 offset:5120
ds_read_b128 v[16:19], v2 offset:5632
v_smfmac_f32_16x16x64_bf16 v[40:43], v[24:27], v[216:223], v0
ds_read_b128 v[20:23], v2 offset:6144
ds_read_b128 v[24:27], v2 offset:6656
s_cbranch_scc1 C_f0_last
s_waitcnt lgkmcnt(4)
s_barrier
ds_read_b64_tr_b16 v[44:45], v5 offset:18432
ds_read_b64_tr_b16 v[46:47], v5 offset:18688
ds_read_b64_tr_b16 v[48:49], v5 offset:20480
ds_read_b64_tr_b16 v[50:51], v5 offset:20736
s_waitcnt lgkmcnt(7)
v_smfmac_f32_16x16x64_bf16 v[40:43], v[12:15], v[144:151], v0
ds_read_b64_tr_b16 v[60:61], v5 offset:18944
ds_read_b64_tr_b16 v[62:63], v5 offset:19200
s_waitcnt lgkmcnt(8)
v_smfmac_f32_16x16x64_bf16 v[40:43], v[16:19], v[152:159], v0
ds_read_b64_tr_b16 v[64:65], v5 offset:20992
ds_read_b64_tr_b16 v[66:67], v5 offset:21248
s_waitcnt lgkmcnt(9)
v_smfmac_f32_16x16x64_bf16 v[40:43], v[20:23], v[160:167], v0
ds_read_b64_tr_b16 v[12:13], v5 offset:19456
ds_read_b64_tr_b16 v[14:15], v5 offset:19712
ds_read_b64_tr_b16 v[16:17], v5 offset:21504
s_waitcnt lgkmcnt(11)
v_smfmac_f32_16x16x64_bf16 v[40:43], v[24:27], v[168:175], v0
ds_read_b64_tr_b16 v[18:19], v5 offset:21760
ds_read_b128 v[20:23], v1 offset:14336
ds_read_b128 v[24:27], v1 offset:15360
s_waitcnt lgkmcnt(12)
v_mfma_f32_16x16x32_bf16 v[28:31], v[52:55], v[44:47], 0
ds_read_b128 v[52:55], v1 offset:16384
v_mfma_f32_16x16x32_bf16 v[32:35], v[56:59], v[44:47], 0
ds_read_b128 v[56:59], v1 offset:17408
s_waitcnt lgkmcnt(12)
v_mfma_f32_16x16x32_bf16 v[36:39], v[48:51], v[44:47], 0
ds_read_b64_tr_b16 v[44:45], v5 offset:19968
ds_read_b64_tr_b16 v[46:47], v5 offset:20224
s_waitcnt lgkmcnt(12)
v_mfma_f32_16x16x32_bf16 v[28:31], v[68:71], v[60:63], v[28:31]
ds_read_b64_tr_b16 v[48:49], v5 offset:22016
ds_read_b64_tr_b16 v[50:51], v5 offset:22272
v_mfma_f32_16x16x32_bf16 v[32:35], v[72:75], v[60:63], v[32:35]
s_waitcnt lgkmcnt(12)
v_mfma_f32_16x16x32_bf16 v[36:39], v[64:67], v[60:63], v[36:39]
s_waitcnt lgkmcnt(7)
v_mfma_f32_16x16x32_bf16 v[28:31], v[20:23], v[12:15], v[28:31]
ds_read_b128 v[20:23], v2 offset:7168
v_mov_b64 v[60:61], s[40:41]
s_waitcnt lgkmcnt(7)
v_mfma_f32_16x16x32_bf16 v[32:35], v[24:27], v[12:15], v[32:35]
ds_read_b128 v[24:27], v2 offset:7680
v_mov_b64 v[62:63], s[40:41]
v_mfma_f32_16x16x32_bf16 v[36:39], v[16:19], v[12:15], v[36:39]
v_mov_b64 v[64:65], s[42:43]
s_waitcnt lgkmcnt(4)
v_mfma_f32_16x16x32_bf16 v[28:31], v[52:55], v[44:47], v[28:31]
v_mfma_f32_16x16x32_bf16 v[32:35], v[56:59], v[44:47], v[32:35]
s_waitcnt lgkmcnt(2)
v_mfma_f32_16x16x32_bf16 v[36:39], v[48:51], v[44:47], v[36:39]
s_waitcnt lgkmcnt(1)
v_smfmac_f32_16x16x64_bf16 v[40:43], v[20:23], v[176:183], v0
v_max3_f32 v10, v28, v29, v30
s_waitcnt lgkmcnt(0)
v_smfmac_f32_16x16x64_bf16 v[40:43], v[24:27], v[184:191], v0
v_max3_f32 v11, v31, v32, v33
v_max3_f32 v10, v10, v34, v35
v_max3_f32 v11, v11, v36, v37
v_max3_f32 v10, v10, v38, v39
v_max_f32 v10, v10, v11
v_mov_b32 v11, v10
s_nop 1
v_cvt_pk_bf16_f32 v78, v40, v41
v_cvt_pk_bf16_f32 v79, v42, v43
v_permlane32_swap_b32 v10, v11
v_max_f32 v10, v10, v11
v_mov_b32 v11, v10
buffer_store_dwordx4 v[76:79], v1, s[48:51], s26 offen sc1
v_cndmask_b32 v58, 0, v78, s[30:31]
v_cndmask_b32 v59, 0, v79, s[30:31]
v_permlane16_swap_b32 v10, v11
v_max_f32 v10, v10, v11
v_mul_f32 v10, s29, v10
v_pk_fma_f32 v[28:29], v[28:29], s[28:29], v[10:11] op_sel_hi:[1,0,0]
v_pk_fma_f32 v[30:31], v[30:31], s[28:29], v[10:11] op_sel_hi:[1,0,0]
v_pk_fma_f32 v[32:33], v[32:33], s[28:29], v[10:11] op_sel_hi:[1,0,0]
v_pk_fma_f32 v[34:35], v[34:35], s[28:29], v[10:11] op_sel_hi:[1,0,0]
v_exp_f32 v28, v28
v_exp_f32 v29, v29
v_exp_f32 v30, v30
v_exp_f32 v31, v31
v_exp_f32 v32, v32
v_exp_f32 v33, v33
v_exp_f32 v34, v34
v_exp_f32 v35, v35
v_cvt_pk_bf16_f32 v52, v28, v29
v_cvt_pk_bf16_f32 v53, v30, v31
v_cvt_pk_bf16_f32 v54, v32, v33
v_cvt_pk_bf16_f32 v55, v34, v35
v_fma_f32 v36, v36, s28, v10
v_fma_f32 v37, v37, s28, v10
v_mfma_f32_16x16x32_bf16 v[16:19], v[60:63], v[52:55], 0
v_fma_f32 v38, v38, s28, v10
v_fma_f32 v39, v39, s28, v10
s_waitcnt vmcnt(2)
v_mfma_f32_16x16x32_bf16 v[28:31], v[80:83], v[52:55], 0
v_exp_f32 v36, v36
s_waitcnt vmcnt(1)
v_mfma_f32_16x16x32_bf16 v[32:35], v[84:87], v[52:55], 0
v_exp_f32 v37, v37
v_exp_f32 v38, v38
v_exp_f32 v39, v39
v_cvt_pk_bf16_f32 v56, v36, v37
v_cvt_pk_bf16_f32 v57, v38, v39
v_cndmask_b32 v74, v78, 0, s[30:31]
v_cndmask_b32 v75, v79, 0, s[30:31]
v_mfma_f32_16x16x16_bf16 v[16:19], v[64:65], v[56:57], v[16:19]
v_mov_b64 v[40:41], 0
v_mov_b64 v[42:43], 0
v_mfma_f32_16x16x16_bf16 v[28:31], v[58:59], v[56:57], v[28:31]
v_mov_b64 v[36:37], 0
v_mov_b64 v[38:39], 0
v_mfma_f32_16x16x16_bf16 v[32:35], v[74:75], v[56:57], v[32:35]
s_nop 1
v_rcp_f32 v10, v16
ds_read_b128 v[44:47], v1 offset:40960
ds_read_b128 v[48:51], v1 offset:41984
v_pk_mul_f32 v[28:29], v[28:29], v[10:11] op_sel_hi:[1,0]
v_pk_mul_f32 v[30:31], v[30:31], v[10:11] op_sel_hi:[1,0]
s_nop 0
v_pk_mul_f32 v[32:33], v[32:33], v[10:11] op_sel_hi:[1,0]
v_pk_mul_f32 v[34:35], v[34:35], v[10:11] op_sel_hi:[1,0]
v_cvt_pk_bf16_f32 v12, v28, v32
v_cvt_pk_bf16_f32 v13, v29, v33
v_cvt_pk_bf16_f32 v14, v30, v34
v_cvt_pk_bf16_f32 v15, v31, v35
ds_write_b128 v2, v[12:15] offset:22528
ds_read_b128 v[52:55], v3 offset:8192
ds_read_b128 v[56:59], v3 offset:9216
ds_read_b128 v[60:63], v3 offset:16384
ds_read_b128 v[64:67], v3 offset:17408
ds_read_b128 v[68:71], v3 offset:12288
ds_read_b128 v[72:75], v3 offset:13312
v_mov_b64 v[28:29], 0
v_mov_b64 v[30:31], 0
v_smfmac_f32_16x16x64_bf16 v[36:39], v[12:15], v[224:231], v0
s_waitcnt lgkmcnt(6)
s_barrier
ds_read_b128 v[16:19], v2 offset:23040
ds_read_b128 v[20:23], v2 offset:23552
ds_read_b128 v[24:27], v2 offset:24064
v_smfmac_f32_16x16x64_bf16 v[40:43], v[12:15], v[44:51], v0
ds_read_b128 v[44:47], v3 offset:20480
ds_read_b128 v[48:51], v3 offset:21504
s_waitcnt lgkmcnt(9)
v_smfmac_f32_16x16x64_bf16 v[28:31], v[12:15], v[52:59], v0
ds_read_b128 v[52:55], v1 offset:49152
ds_read_b128 v[56:59], v1 offset:50176
s_waitcnt lgkmcnt(6)
v_smfmac_f32_16x16x64_bf16 v[28:31], v[16:19], v[60:67], v0
ds_read_b128 v[60:63], v1 offset:57344
ds_read_b128 v[64:67], v1 offset:58368
s_waitcnt lgkmcnt(7)
v_smfmac_f32_16x16x64_bf16 v[28:31], v[20:23], v[68:75], v0
ds_read_b128 v[68:71], v3 offset:0
ds_read_b128 v[72:75], v3 offset:1024
s_waitcnt lgkmcnt(6)
v_smfmac_f32_16x16x64_bf16 v[28:31], v[24:27], v[44:51], v0
v_smfmac_f32_16x16x64_bf16 v[36:39], v[16:19], v[232:239], v0
v_smfmac_f32_16x16x64_bf16 v[36:39], v[20:23], v[240:247], v0
v_cvt_pk_bf16_f32 v10, v28, v29
v_smfmac_f32_16x16x64_bf16 v[36:39], v[24:27], v[248:255], v0
v_cvt_pk_bf16_f32 v11, v30, v31
buffer_store_dwordx2 v[10:11], v8, s[8:11], s54 offen
s_waitcnt lgkmcnt(4)
v_smfmac_f32_16x16x64_bf16 v[40:43], v[16:19], v[52:59], v0
s_waitcnt lgkmcnt(2)
v_smfmac_f32_16x16x64_bf16 v[40:43], v[20:23], v[60:67], v0
v_cvt_pk_bf16_f32 v10, v36, v37
s_waitcnt lgkmcnt(0)
v_smfmac_f32_16x16x64_bf16 v[40:43], v[24:27], v[68:75], v0
v_cvt_pk_bf16_f32 v11, v38, v39
buffer_store_dwordx2 v[10:11], v8, s[8:11], s53 offen
v_bfe_u32 v65, v2, 4, 3
v_and_b32 v66, 1, v65
v_lshlrev_b32 v66, 4, v66
v_lshrrev_b32 v65, 1, v65
v_mov_b32 v64, 0x3f80
v_lshlrev_b32 v66, v66, v64
v_cvt_pk_bf16_f32 v10, v40, v41
v_cvt_pk_bf16_f32 v11, v42, v43
buffer_store_dwordx2 v[10:11], v8, s[8:11], s52 offen
v_cmp_eq_u32 vcc, 0, v65
s_nop 1
v_cndmask_b32 v60, 0, v66, vcc
v_cmp_eq_u32 vcc, 1, v65
s_nop 1
v_cndmask_b32 v61, 0, v66, vcc
v_cmp_eq_u32 vcc, 2, v65
s_nop 1
v_cndmask_b32 v62, 0, v66, vcc
v_cmp_eq_u32 vcc, 3, v65
s_nop 1
v_cndmask_b32 v63, 0, v66, vcc
v_mov_b64 v[28:29], 0
v_mov_b64 v[30:31], 0
v_mov_b64 v[32:33], 0
v_mov_b64 v[34:35], 0
v_mov_b64 v[40:41], 0
v_mov_b64 v[42:43], 0
v_mov_b64 v[36:37], -1
v_mov_b64 v[38:39], -1
s_add_u32 s18, s18, 1
s_xor_b32 s19, s19, 163840
s_add_u32 s26, s26, 131072
s_xor_b32 s44, s27, 0x202000
s_add_u32 s25, s24, 16777216
s_add_u32 s24, s24, 262144
s_mov_b32 s35, s27
s_mov_b32 s36, 0
s_nop 15
s_nop 15
s_nop 4
buffer_load_dwordx4 v[44:47], v1, s[8:11], s45 offen offset:0 sc1
buffer_load_dwordx4 v[48:51], v1, s[8:11], s45 offen offset:1024 sc1
buffer_load_dwordx4 v[52:55], v1, s[8:11], s45 offen offset:2048 sc1
buffer_load_dwordx4 v[56:59], v1, s[8:11], s45 offen offset:3072 sc1
s_nop 15
s_nop 15
C_f0_red:
buffer_load_dwordx4 v[44:47], v1, s[8:11], s45 offen offset:0 sc1
buffer_load_dwordx4 v[48:51], v1, s[8:11], s45 offen offset:1024 sc1
buffer_load_dwordx4 v[52:55], v1, s[8:11], s45 offen offset:2048 sc1
buffer_load_dwordx4 v[56:59], v1, s[8:11], s45 offen offset:3072 sc1
s_waitcnt vmcnt(7)
v_mfma_f32_16x16x32_bf16 v[64:67], v[44:47], v[60:63], 0
s_waitcnt vmcnt(6)
v_mfma_f32_16x16x32_bf16 v[64:67], v[48:51], v[60:63], v[64:67]
s_waitcnt vmcnt(5)
v_mfma_f32_16x16x32_bf16 v[64:67], v[52:55], v[60:63], v[64:67]
s_waitcnt vmcnt(4)
v_mfma_f32_16x16x32_bf16 v[64:67], v[56:59], v[60:63], v[64:67]
s_nop 7
v_permlane32_swap_b32 v64, v66
v_permlane32_swap_b32 v65, v67
v_add_f32 v64, v64, v66
v_add_f32 v65, v65, v67
v_cmp_u_f32 vcc, v64, v65
v_cvt_pk_bf16_f32 v72, v64, v65
s_cbranch_vccnz C_f0_redslow
C_f0_redok:
buffer_store_dword v72, v9, s[8:11], s20 offen
s_barrier
buffer_store_dword v72, v9, s[8:11], s35 offen sc1
s_add_u32 s37, s20, 0
s_mov_b32 s34, s20
s_add_u32 s4, s4, 32768
s_lshr_b32 s32, s4, 5
s_and_b32 s32, s32, 0x4000
s_lshr_b32 s27, s4, 8
s_and_b32 s27, s27, 0x2000
s_or_b32 s32, s32, s27
s_xor_b32 s32, s32, s47
s_add_u32 s27, s4, s32
s_add_u32 s20, s20, 8192
s_sub_u32 s32, s20, s46
s_cmp_eq_u32 s32, 24576
s_cselect_b32 s20, s46, s20
s_waitcnt vmcnt(5)
ds_read_b128 v[44:47], v3 offset:24576
s_waitcnt vmcnt(4)
ds_read_b128 v[48:51], v3 offset:25600
s_waitcnt vmcnt(3)
ds_read_b128 v[52:55], v3 offset:32768
s_waitcnt vmcnt(2)
ds_read_b128 v[56:59], v3 offset:33792
ds_read_b128 v[60:63], v3 offset:40960
ds_read_b128 v[64:67], v3 offset:41984
s_branch C_f0
C_f0_first:
ds_read_b128 v[12:15], v2 offset:0
ds_read_b128 v[16:19], v2 offset:512
ds_read_b128 v[20:23], v2 offset:1024
ds_read_b128 v[24:27], v2 offset:1536
s_waitcnt lgkmcnt(3)
v_smfmac_f32_16x16x64_bf16 v[28:31], v[12:15], a[0:7], v0
v_smfmac_f32_16x16x64_bf16 v[32:35], v[12:15], a[136:143], v0
v_smfmac_f32_16x16x64_bf16 v[40:43], v[12:15], v[44:51], v0
ds_read_b128 v[12:15], v2 offset:2048
ds_read_b128 v[44:47], v3 offset:49152
s_waitcnt lgkmcnt(4)
v_smfmac_f32_16x16x64_bf16 v[28:31], v[16:19], a[8:15], v0
ds_read_b128 v[48:51], v3 offset:50176
v_smfmac_f32_16x16x64_bf16 v[32:35], v[16:19], a[144:151], v0
v_smfmac_f32_16x16x64_bf16 v[40:43], v[16:19], v[52:59], v0
ds_read_b128 v[16:19], v2 offset:2560
ds_read_b128 v[52:55], v3 offset:57344
s_waitcnt lgkmcnt(6)
v_smfmac_f32_16x16x64_bf16 v[28:31], v[20:23], a[16:23], v0
ds_read_b128 v[56:59], v3 offset:58368
v_smfmac_f32_16x16x64_bf16 v[32:35], v[20:23], a[152:159], v0
v_smfmac_f32_16x16x64_bf16 v[40:43], v[20:23], v[60:67], v0
ds_read_b128 v[20:23], v2 offset:3072
ds_read_b128 v[60:63], v4 offset:0
s_waitcnt lgkmcnt(8)
v_smfmac_f32_16x16x64_bf16 v[28:31], v[24:27], a[24:31], v0
ds_read_b128 v[64:67], v4 offset:1024
v_smfmac_f32_16x16x64_bf16 v[32:35], v[24:27], a[160:167], v0
v_smfmac_f32_16x16x64_bf16 v[40:43], v[24:27], v[96:103], v0
ds_read_b128 v[24:27], v2 offset:3584
s_waitcnt lgkmcnt(7)
v_smfmac_f32_16x16x64_bf16 v[28:31], v[12:15], v[44:51], v0
ds_read_b128 v[44:47], v4 offset:8192
ds_read_b128 v[48:51], v4 offset:9216
v_smfmac_f32_16x16x64_bf16 v[32:35], v[12:15], a[168:175], v0
v_smfmac_f32_16x16x64_bf16 v[40:43], v[12:15], v[104:111], v0
ds_read_b128 v[12:15], v2 offset:4096
s_waitcnt lgkmcnt(9)
v_smfmac_f32_16x16x64_bf16 v[28:31], v[16:19], a[32:39], v0
s_waitcnt lgkmcnt(7)
v_smfmac_f32_16x16x64_bf16 v[32:35], v[16:19], v[52:59], v0
ds_read_b128 v[52:55], v4 offset:16384
ds_read_b128 v[56:59], v4 offset:17408
v_smfmac_f32_16x16x64_bf16 v[40:43], v[16:19], v[112:119], v0
ds_read_b128 v[16:19], v2 offset:4608
s_waitcnt lgkmcnt(9)
v_smfmac_f32_16x16x64_bf16 v[28:31], v[20:23], a[40:47], v0
v_smfmac_f32_16x16x64_bf16 v[32:35], v[20:23], a[176:183], v0
s_waitcnt lgkmcnt(6)
v_smfmac_f32_16x16x64_bf16 v[28:31], v[24:27], v[60:67], v0
ds_read_b128 v[60:63], v4 offset:24576
ds_read_b128 v[64:67], v4 offset:25600
v_smfmac_f32_16x16x64_bf16 v[32:35], v[24:27], a[184:191], v0
s_waitcnt lgkmcnt(5)
v_smfmac_f32_16x16x64_bf16 v[28:31], v[12:15], a[48:55], v0
v_smfmac_f32_16x16x64_bf16 v[32:35], v[12:15], a[192:199], v0
s_waitcnt lgkmcnt(2)
v_smfmac_f32_16x16x64_bf16 v[28:31], v[16:19], a[56:63], v0
v_smfmac_f32_16x16x64_bf16 v[32:35], v[16:19], v[44:51], v0
ds_read_b128 v[44:47], v1 offset:24576
ds_read_b128 v[48:51], v1 offset:25600
s_waitcnt lgkmcnt(0)
s_branch C_f0_mid
C_f0_redslow:
s_add_u32 s36, s36, 1
s_and_b32 s32, s36, 7
s_cmp_lg_u32 s32, 0
s_cbranch_scc1 C_f0_red
s_add_u32 s57, s57, 1
s_cmp_gt_u32 s57, 0x40000
s_cbranch_scc1 C_fail
s_waitcnt vmcnt(0)
v_max3_u32 v10, v44, v45, v46
v_max_u32 v10, v10, v47
v_max3_u32 v10, v10, v48, v49
v_max3_u32 v10, v10, v50, v51
v_max3_u32 v10, v10, v52, v53
v_max3_u32 v10, v10, v54, v55
v_max3_u32 v10, v10, v56, v57
v_max3_u32 v10, v10, v58, v59
v_cmp_eq_u32 vcc, -1, v10
s_cbranch_vccz C_f0_redsum
buffer_load_dwordx4 v[44:47], v1, s[8:11], s45 offen offset:0 sc1
buffer_load_dwordx4 v[48:51], v1, s[8:11], s45 offen offset:1024 sc1
buffer_load_dwordx4 v[52:55], v1, s[8:11], s45 offen offset:2048 sc1
buffer_load_dwordx4 v[56:59], v1, s[8:11], s45 offen offset:3072 sc1
s_branch C_f0_red
C_f0_redsum:
v_mfma_f32_16x16x32_bf16 v[64:67], v[44:47], v[60:63], 0
v_mfma_f32_16x16x32_bf16 v[64:67], v[48:51], v[60:63], v[64:67]
v_mfma_f32_16x16x32_bf16 v[64:67], v[52:55], v[60:63], v[64:67]
v_mfma_f32_16x16x32_bf16 v[64:67], v[56:59], v[60:63], v[64:67]
s_nop 7
v_permlane32_swap_b32 v64, v66
v_permlane32_swap_b32 v65, v67
v_add_f32 v64, v64, v66
v_add_f32 v65, v65, v67
v_cvt_pk_bf16_f32 v72, v64, v65
v_min_u32 v72, -2, v72
s_branch C_f0_redok
C_f0_chkslow:
s_add_u32 s57, s57, 1
s_cmp_gt_u32 s57, 0x40000
s_cbranch_scc1 C_fail
buffer_load_dwordx4 v[68:71], v1, s[8:11], s37 offen offset:0 sc1
s_waitcnt vmcnt(1)
s_branch C_f0_chk
C_f0_rslow:
s_waitcnt vmcnt(0) lgkmcnt(0)
v_max3_u32 v10, v68, v69, v70
v_max_u32 v10, v10, v71
v_cmp_eq_u32 vcc, -1, v10
s_cbranch_vccz C_f0_rgot
s_add_u32 s57, s57, 1
s_cmp_gt_u32 s57, 0x40000
s_cbranch_scc1 C_fail
buffer_load_dwordx4 v[68:71], v1, s[8:11], s44 offen offset:0 sc1
s_branch C_f0_rslow
C_f0_rgot:
ds_write_b128 v1, v[68:71] offset:5120
s_waitcnt lgkmcnt(0)
s_branch C_f0_rok
C_f0_last:
s_waitcnt lgkmcnt(3)
v_smfmac_f32_16x16x64_bf16 v[40:43], v[12:15], v[144:151], v0
ds_read_b128 v[12:15], v2 offset:7168
s_waitcnt lgkmcnt(3)
v_smfmac_f32_16x16x64_bf16 v[40:43], v[16:19], v[152:159], v0
ds_read_b128 v[16:19], v2 offset:7680
s_waitcnt lgkmcnt(3)
v_smfmac_f32_16x16x64_bf16 v[40:43], v[20:23], v[160:167], v0
s_waitcnt lgkmcnt(2)
v_smfmac_f32_16x16x64_bf16 v[40:43], v[24:27], v[168:175], v0
s_waitcnt lgkmcnt(1)
v_smfmac_f32_16x16x64_bf16 v[40:43], v[12:15], v[176:183], v0
s_waitcnt lgkmcnt(0)
v_smfmac_f32_16x16x64_bf16 v[40:43], v[16:19], v[184:191], v0
s_nop 7
v_cvt_pk_bf16_f32 v78, v40, v41
v_cvt_pk_bf16_f32 v79, v42, v43
buffer_store_dwordx4 v[76:79], v1, s[48:51], s26 offen sc1
s_waitcnt vmcnt(0)
s_branch C_exit
C_f1_in:
s_add_u32 s25, s24, 16779264
s_add_u32 s24, s24, 262144
v_mov_b64 v[28:29], 0
v_mov_b64 v[30:31], 0
v_mov_b64 v[32:33], 0
v_mov_b64 v[34:35], 0
v_mov_b64 v[40:41], 0
v_mov_b64 v[42:43], 0
ds_read_b128 v[44:47], v3 offset:26624
ds_read_b128 v[48:51], v3 offset:27648
ds_read_b128 v[52:55], v3 offset:34816
ds_read_b128 v[56:59], v3 offset:35840
ds_read_b128 v[60:63], v3 offset:43008
ds_read_b128 v[64:67], v3 offset:44032
s_waitcnt lgkmcnt(0)
s_barrier
s_branch C_f1_first
C_f1:
s_nop 15
s_nop 3
buffer_load_dwordx4 v[68:71], v1, s[8:11], s37 offen offset:0 sc1
s_nop 15
s_nop 15
buffer_load_dwordx4 v[68:71], v1, s[8:11], s37 offen offset:0 sc1
s_waitcnt vmcnt(1)
C_f1_chk:
v_max3_u32 v10, v68, v69, v70
v_max_u32 v10, v10, v71
v_cmp_eq_u32 vcc, -1, v10
s_cbranch_vccnz C_f1_chkslow
ds_write_b128 v1, v[68:71] offset:1024
buffer_store_dwordx4 v[36:39], v1, s[8:11], s45 offen offset:1024
buffer_store_dwordx4 v[36:39], v7, s[8:11], s55 offen
buffer_store_dword v36, v9, s[8:11], s21 offen
s_mov_b32 s21, s34
s_waitcnt lgkmcnt(0)
buffer_load_dwordx4 v[68:71], v1, s[8:11], s44 offen offset:1024 sc1
s_barrier
ds_read_b128 v[12:15], v2 offset:0
ds_read_b128 v[16:19], v2 offset:512
ds_read_b128 v[20:23], v2 offset:1024
ds_read_b128 v[24:27], v2 offset:1536
s_waitcnt lgkmcnt(3)
v_smfmac_f32_16x16x64_bf16 v[28:31], v[12:15], a[0:7], v0
v_smfmac_f32_16x16x64_bf16 v[32:35], v[12:15], a[136:143], v0
v_smfmac_f32_16x16x64_bf16 v[40:43], v[12:15], v[44:51], v0
ds_read_b128 v[12:15], v2 offset:2048
ds_read_b128 v[44:47], v3 offset:51200
s_waitcnt lgkmcnt(4)
v_smfmac_f32_16x16x64_bf16 v[28:31], v[16:19], a[8:15], v0
ds_read_b128 v[48:51], v3 offset:52224
v_smfmac_f32_16x16x64_bf16 v[32:35], v[16:19], a[144:151], v0
v_smfmac_f32_16x16x64_bf16 v[40:43], v[16:19], v[52:59], v0
ds_read_b128 v[16:19], v2 offset:2560
ds_read_b128 v[52:55], v3 offset:59392
s_waitcnt lgkmcnt(6)
v_smfmac_f32_16x16x64_bf16 v[28:31], v[20:23], a[16:23], v0
ds_read_b128 v[56:59], v3 offset:60416
v_smfmac_f32_16x16x64_bf16 v[32:35], v[20:23], a[152:159], v0
v_smfmac_f32_16x16x64_bf16 v[40:43], v[20:23], v[60:67], v0
ds_read_b128 v[20:23], v2 offset:3072
ds_read_b128 v[60:63], v4 offset:2048
s_waitcnt lgkmcnt(8)
v_smfmac_f32_16x16x64_bf16 v[28:31], v[24:27], a[24:31], v0
ds_read_b128 v[64:67], v4 offset:3072
v_smfmac_f32_16x16x64_bf16 v[32:35], v[24:27], a[160:167], v0
v_smfmac_f32_16x16x64_bf16 v[40:43], v[24:27], v[96:103], v0
ds_read_b128 v[24:27], v2 offset:3584
s_waitcnt lgkmcnt(7)
v_smfmac_f32_16x16x64_bf16 v[28:31], v[12:15], v[44:51], v0
ds_read_b128 v[44:47], v4 offset:10240
ds_read_b128 v[48:51], v4 offset:11264
v_smfmac_f32_16x16x64_bf16 v[32:35], v[12:15], a[168:175], v0
v_smfmac_f32_16x16x64_bf16 v[40:43], v[12:15], v[104:111], v0
ds_read_b128 v[12:15], v2 offset:4096
s_waitcnt lgkmcnt(9)
v_smfmac_f32_16x16x64_bf16 v[28:31], v[16:19], a[32:39], v0
s_waitcnt lgkmcnt(7)
v_smfmac_f32_16x16x64_bf16 v[32:35], v[16:19], v[52:59], v0
ds_read_b128 v[52:55], v4 offset:18432
ds_read_b128 v[56:59], v4 offset:19456
v_smfmac_f32_16x16x64_bf16 v[40:43], v[16:19], v[112:119], v0
ds_read_b128 v[16:19], v2 offset:4608
s_waitcnt lgkmcnt(9)
v_smfmac_f32_16x16x64_bf16 v[28:31], v[20:23], a[40:47], v0
v_smfmac_f32_16x16x64_bf16 v[32:35], v[20:23], a[176:183], v0
s_waitcnt vmcnt(0)
v_max3_u32 v10, v68, v69, v70
s_waitcnt lgkmcnt(6)
v_smfmac_f32_16x16x64_bf16 v[28:31], v[24:27], v[60:67], v0
v_max_u32 v10, v10, v71
ds_write_b128 v1, v[68:71] offset:6144
v_smfmac_f32_16x16x64_bf16 v[32:35], v[24:27], a[184:191], v0
v_cmp_eq_u32 vcc, -1, v10
ds_read_b128 v[60:63], v4 offset:26624
s_waitcnt lgkmcnt(5)
v_smfmac_f32_16x16x64_bf16 v[28:31], v[12:15], a[48:55], v0
ds_read_b128 v[64:67], v4 offset:27648
v_smfmac_f32_16x16x64_bf16 v[32:35], v[12:15], a[192:199], v0
s_waitcnt lgkmcnt(3)
v_smfmac_f32_16x16x64_bf16 v[28:31], v[16:19], a[56:63], v0
v_smfmac_f32_16x16x64_bf16 v[32:35], v[16:19], v[44:51], v0
ds_read_b128 v[44:47], v1 offset:26624
ds_read_b128 v[48:51], v1 offset:27648
s_cbranch_vccnz C_f1_rslow
C_f1_rok:
s_waitcnt lgkmcnt(4)
s_barrier
C_f1_mid:
v_smfmac_f32_16x16x64_bf16 v[40:43], v[20:23], v[120:127], v0
ds_read_b128 v[20:23], v2 offset:5120
v_smfmac_f32_16x16x64_bf16 v[40:43], v[24:27], v[128:135], v0
ds_read_b128 v[24:27], v2 offset:5632
v_smfmac_f32_16x16x64_bf16 v[40:43], v[12:15], v[136:143], v0
ds_read_b128 v[12:15], v2 offset:6144
v_smfmac_f32_16x16x64_bf16 v[40:43], v[16:19], v[52:59], v0
ds_read_b128 v[16:19], v2 offset:6656
ds_read_b128 v[52:55], v1 offset:34816
s_waitcnt lgkmcnt(4)
v_smfmac_f32_16x16x64_bf16 v[28:31], v[20:23], a[64:71], v0
ds_read_b128 v[56:59], v1 offset:35840
buffer_load_dwordx4 v[80:83], v1, s[8:11], s25 offen offset:0 sc1
v_smfmac_f32_16x16x64_bf16 v[32:35], v[20:23], a[200:207], v0
ds_read_b128 v[20:23], v2 offset:7168
s_waitcnt lgkmcnt(5)
v_smfmac_f32_16x16x64_bf16 v[28:31], v[24:27], a[72:79], v0
buffer_load_dwordx4 v[84:87], v1, s[8:11], s25 offen offset:1024 sc1
v_smfmac_f32_16x16x64_bf16 v[32:35], v[24:27], v[60:67], v0
ds_read_b128 v[24:27], v2 offset:7680
s_waitcnt lgkmcnt(5)
v_smfmac_f32_16x16x64_bf16 v[28:31], v[12:15], a[80:87], v0
v_smfmac_f32_16x16x64_bf16 v[32:35], v[12:15], a[208:215], v0
ds_read_b128 v[12:15], v2 offset:8192
s_waitcnt lgkmcnt(5)
v_smfmac_f32_16x16x64_bf16 v[28:31], v[16:19], a[88:95], v0
v_smfmac_f32_16x16x64_bf16 v[32:35], v[16:19], v[44:51], v0
ds_read_b128 v[16:19], v2 offset:8704
s_waitcnt lgkmcnt(3)
v_smfmac_f32_16x16x64_bf16 v[28:31], v[20:23], a[96:103], v0
v_smfmac_f32_16x16x64_bf16 v[32:35], v[20:23], a[216:223], v0
ds_read_b128 v[20:23], v2 offset:9216
s_waitcnt lgkmcnt(3)
v_smfmac_f32_16x16x64_bf16 v[28:31], v[24:27], v[52:59], v0
v_smfmac_f32_16x16x64_bf16 v[32:35], v[24:27], a[224:231], v0
ds_read_b128 v[24:27], v2 offset:9728
s_waitcnt lgkmcnt(3)
v_smfmac_f32_16x16x64_bf16 v[28:31], v[12:15], a[104:111], v0
ds_read_b128 v[52:55], v1 offset:10240
ds_read_b128 v[56:59], v1 offset:11264
v_smfmac_f32_16x16x64_bf16 v[32:35], v[12:15], a[232:239], v0
ds_read_b128 v[68:71], v1 offset:12288
ds_read_b128 v[72:75], v1 offset:13312
s_waitcnt lgkmcnt(6)
v_smfmac_f32_16x16x64_bf16 v[28:31], v[16:19], a[112:119], v0
s_add_u32 s52, s19, 16384
s_add_u32 s53, s19, 81920
s_waitcnt lgkmcnt(5)
v_smfmac_f32_16x16x64_bf16 v[28:31], v[20:23], a[120:127], v0
s_add_u32 s54, s19, 147456
s_xor_b32 s45, s45, s56
s_waitcnt lgkmcnt(4)
v_smfmac_f32_16x16x64_bf16 v[28:31], v[24:27], a[128:135], v0
s_xor_b32 s55, s55, s58
v_smfmac_f32_16x16x64_bf16 v[32:35], v[16:19], a[240:247], v0
v_smfmac_f32_16x16x64_bf16 v[32:35], v[20:23], a[248:255], v0
v_cvt_pk_bf16_f32 v36, v28, v29
v_smfmac_f32_16x16x64_bf16 v[32:35], v[24:27], v[88:95], v0
v_cvt_pk_bf16_f32 v37, v30, v31
ds_write_b64 v6, v[36:37] offset:18944
v_smfmac_f32_16x16x64_bf16 v[40:43], v[12:15], v[192:199], v0
s_cmp_eq_u32 s18, 63
v_smfmac_f32_16x16x64_bf16 v[40:43], v[16:19], v[200:207], v0
v_cvt_pk_bf16_f32 v76, v32, v33
v_cvt_pk_bf16_f32 v77, v34, v35
ds_write_b64 v6, v[76:77] offset:20992
v_smfmac_f32_16x16x64_bf16 v[40:43], v[20:23], v[208:215], v0
ds_read_b128 v[12:15], v2 offset:5120
ds_read_b128 v[16:19], v2 offset:5632
v_smfmac_f32_16x16x64_bf16 v[40:43], v[24:27], v[216:223], v0
ds_read_b128 v[20:23], v2 offset:6144
ds_read_b128 v[24:27], v2 offset:6656
s_cbranch_scc1 C_f1_last
s_waitcnt lgkmcnt(4)
s_barrier
ds_read_b64_tr_b16 v[44:45], v5 offset:18432
ds_read_b64_tr_b16 v[46:47], v5 offset:18688
ds_read_b64_tr_b16 v[48:49], v5 offset:20480
ds_read_b64_tr_b16 v[50:51], v5 offset:20736
s_waitcnt lgkmcnt(7)
v_smfmac_f32_16x16x64_bf16 v[40:43], v[12:15], v[144:151], v0
ds_read_b64_tr_b16 v[60:61], v5 offset:18944
ds_read_b64_tr_b16 v[62:63], v5 offset:19200
s_waitcnt lgkmcnt(8)
v_smfmac_f32_16x16x64_bf16 v[40:43], v[16:19], v[152:159], v0
ds_read_b64_tr_b16 v[64:65], v5 offset:20992
ds_read_b64_tr_b16 v[66:67], v5 offset:21248
s_waitcnt lgkmcnt(9)
v_smfmac_f32_16x16x64_bf16 v[40:43], v[20:23], v[160:167], v0
ds_read_b64_tr_b16 v[12:13], v5 offset:19456
ds_read_b64_tr_b16 v[14:15], v5 offset:19712
ds_read_b64_tr_b16 v[16:17], v5 offset:21504
s_waitcnt lgkmcnt(11)
v_smfmac_f32_16x16x64_bf16 v[40:43], v[24:27], v[168:175], v0
ds_read_b64_tr_b16 v[18:19], v5 offset:21760
ds_read_b128 v[20:23], v1 offset:14336
ds_read_b128 v[24:27], v1 offset:15360
s_waitcnt lgkmcnt(12)
v_mfma_f32_16x16x32_bf16 v[28:31], v[52:55], v[44:47], 0
ds_read_b128 v[52:55], v1 offset:16384
v_mfma_f32_16x16x32_bf16 v[32:35], v[56:59], v[44:47], 0
ds_read_b128 v[56:59], v1 offset:17408
s_waitcnt lgkmcnt(12)
v_mfma_f32_16x16x32_bf16 v[36:39], v[48:51], v[44:47], 0
ds_read_b64_tr_b16 v[44:45], v5 offset:19968
ds_read_b64_tr_b16 v[46:47], v5 offset:20224
s_waitcnt lgkmcnt(12)
v_mfma_f32_16x16x32_bf16 v[28:31], v[68:71], v[60:63], v[28:31]
ds_read_b64_tr_b16 v[48:49], v5 offset:22016
ds_read_b64_tr_b16 v[50:51], v5 offset:22272
v_mfma_f32_16x16x32_bf16 v[32:35], v[72:75], v[60:63], v[32:35]
s_waitcnt lgkmcnt(12)
v_mfma_f32_16x16x32_bf16 v[36:39], v[64:67], v[60:63], v[36:39]
s_waitcnt lgkmcnt(7)
v_mfma_f32_16x16x32_bf16 v[28:31], v[20:23], v[12:15], v[28:31]
ds_read_b128 v[20:23], v2 offset:7168
v_mov_b64 v[60:61], s[40:41]
s_waitcnt lgkmcnt(7)
v_mfma_f32_16x16x32_bf16 v[32:35], v[24:27], v[12:15], v[32:35]
ds_read_b128 v[24:27], v2 offset:7680
v_mov_b64 v[62:63], s[40:41]
v_mfma_f32_16x16x32_bf16 v[36:39], v[16:19], v[12:15], v[36:39]
v_mov_b64 v[64:65], s[42:43]
s_waitcnt lgkmcnt(4)
v_mfma_f32_16x16x32_bf16 v[28:31], v[52:55], v[44:47], v[28:31]
v_mfma_f32_16x16x32_bf16 v[32:35], v[56:59], v[44:47], v[32:35]
s_waitcnt lgkmcnt(2)
v_mfma_f32_16x16x32_bf16 v[36:39], v[48:51], v[44:47], v[36:39]
s_waitcnt lgkmcnt(1)
v_smfmac_f32_16x16x64_bf16 v[40:43], v[20:23], v[176:183], v0
v_max3_f32 v10, v28, v29, v30
s_waitcnt lgkmcnt(0)
v_smfmac_f32_16x16x64_bf16 v[40:43], v[24:27], v[184:191], v0
v_max3_f32 v11, v31, v32, v33
v_max3_f32 v10, v10, v34, v35
v_max3_f32 v11, v11, v36, v37
v_max3_f32 v10, v10, v38, v39
v_max_f32 v10, v10, v11
v_mov_b32 v11, v10
s_nop 1
v_cvt_pk_bf16_f32 v78, v40, v41
v_cvt_pk_bf16_f32 v79, v42, v43
v_permlane32_swap_b32 v10, v11
v_max_f32 v10, v10, v11
v_mov_b32 v11, v10
buffer_store_dwordx4 v[76:79], v1, s[48:51], s26 offen sc1
v_cndmask_b32 v58, 0, v78, s[30:31]
v_cndmask_b32 v59, 0, v79, s[30:31]
v_permlane16_swap_b32 v10, v11
v_max_f32 v10, v10, v11
v_mul_f32 v10, s29, v10
v_pk_fma_f32 v[28:29], v[28:29], s[28:29], v[10:11] op_sel_hi:[1,0,0]
v_pk_fma_f32 v[30:31], v[30:31], s[28:29], v[10:11] op_sel_hi:[1,0,0]
v_pk_fma_f32 v[32:33], v[32:33], s[28:29], v[10:11] op_sel_hi:[1,0,0]
v_pk_fma_f32 v[34:35], v[34:35], s[28:29], v[10:11] op_sel_hi:[1,0,0]
v_exp_f32 v28, v28
v_exp_f32 v29, v29
v_exp_f32 v30, v30
v_exp_f32 v31, v31
v_exp_f32 v32, v32
v_exp_f32 v33, v33
v_exp_f32 v34, v34
v_exp_f32 v35, v35
v_cvt_pk_bf16_f32 v52, v28, v29
v_cvt_pk_bf16_f32 v53, v30, v31
v_cvt_pk_bf16_f32 v54, v32, v33
v_cvt_pk_bf16_f32 v55, v34, v35
v_fma_f32 v36, v36, s28, v10
v_fma_f32 v37, v37, s28, v10
v_mfma_f32_16x16x32_bf16 v[20:23], v[60:63], v[52:55], 0
v_fma_f32 v38, v38, s28, v10
v_fma_f32 v39, v39, s28, v10
s_waitcnt vmcnt(2)
v_mfma_f32_16x16x32_bf16 v[28:31], v[80:83], v[52:55], 0
v_exp_f32 v36, v36
s_waitcnt vmcnt(1)
v_mfma_f32_16x16x32_bf16 v[32:35], v[84:87], v[52:55], 0
v_exp_f32 v37, v37
v_exp_f32 v38, v38
v_exp_f32 v39, v39
v_cvt_pk_bf16_f32 v56, v36, v37
v_cvt_pk_bf16_f32 v57, v38, v39
v_cndmask_b32 v74, v78, 0, s[30:31]
v_cndmask_b32 v75, v79, 0, s[30:31]
v_mfma_f32_16x16x16_bf16 v[20:23], v[64:65], v[56:57], v[20:23]
v_mov_b64 v[40:41], 0
v_mov_b64 v[42:43], 0
v_mfma_f32_16x16x16_bf16 v[28:31], v[58:59], v[56:57], v[28:31]
v_mov_b64 v[36:37], 0
v_mov_b64 v[38:39], 0
v_mfma_f32_16x16x16_bf16 v[32:35], v[74:75], v[56:57], v[32:35]
s_nop 1
v_rcp_f32 v10, v20
ds_read_b128 v[44:47], v1 offset:51200
ds_read_b128 v[48:51], v1 offset:52224
v_pk_mul_f32 v[28:29], v[28:29], v[10:11] op_sel_hi:[1,0]
v_pk_mul_f32 v[30:31], v[30:31], v[10:11] op_sel_hi:[1,0]
s_nop 0
v_pk_mul_f32 v[32:33], v[32:33], v[10:11] op_sel_hi:[1,0]
v_pk_mul_f32 v[34:35], v[34:35], v[10:11] op_sel_hi:[1,0]
v_cvt_pk_bf16_f32 v16, v28, v32
v_cvt_pk_bf16_f32 v17, v29, v33
v_cvt_pk_bf16_f32 v18, v30, v34
v_cvt_pk_bf16_f32 v19, v31, v35
ds_write_b128 v2, v[16:19] offset:23040
ds_read_b128 v[52:55], v3 offset:18432
ds_read_b128 v[56:59], v3 offset:19456
ds_read_b128 v[60:63], v3 offset:10240
ds_read_b128 v[64:67], v3 offset:11264
ds_read_b128 v[68:71], v3 offset:14336
ds_read_b128 v[72:75], v3 offset:15360
v_mov_b64 v[28:29], 0
v_mov_b64 v[30:31], 0
v_smfmac_f32_16x16x64_bf16 v[36:39], v[16:19], v[232:239], v0
s_waitcnt lgkmcnt(6)
s_barrier
ds_read_b128 v[12:15], v2 offset:22528
ds_read_b128 v[20:23], v2 offset:23552
ds_read_b128 v[24:27], v2 offset:24064
v_smfmac_f32_16x16x64_bf16 v[40:43], v[16:19], v[44:51], v0
ds_read_b128 v[44:47], v3 offset:22528
ds_read_b128 v[48:51], v3 offset:23552
s_waitcnt lgkmcnt(9)
v_smfmac_f32_16x16x64_bf16 v[28:31], v[16:19], v[52:59], v0
ds_read_b128 v[52:55], v1 offset:43008
ds_read_b128 v[56:59], v1 offset:44032
s_waitcnt lgkmcnt(6)
v_smfmac_f32_16x16x64_bf16 v[28:31], v[12:15], v[60:67], v0
ds_read_b128 v[60:63], v1 offset:59392
ds_read_b128 v[64:67], v1 offset:60416
s_waitcnt lgkmcnt(7)
v_smfmac_f32_16x16x64_bf16 v[28:31], v[20:23], v[68:75], v0
ds_read_b128 v[68:71], v3 offset:2048
ds_read_b128 v[72:75], v3 offset:3072
s_waitcnt lgkmcnt(6)
v_smfmac_f32_16x16x64_bf16 v[28:31], v[24:27], v[44:51], v0
v_smfmac_f32_16x16x64_bf16 v[36:39], v[12:15], v[224:231], v0
v_smfmac_f32_16x16x64_bf16 v[36:39], v[20:23], v[240:247], v0
v_cvt_pk_bf16_f32 v10, v28, v29
v_smfmac_f32_16x16x64_bf16 v[36:39], v[24:27], v[248:255], v0
v_cvt_pk_bf16_f32 v11, v30, v31
buffer_store_dwordx2 v[10:11], v8, s[8:11], s54 offen
s_waitcnt lgkmcnt(4)
v_smfmac_f32_16x16x64_bf16 v[40:43], v[12:15], v[52:59], v0
s_waitcnt lgkmcnt(2)
v_smfmac_f32_16x16x64_bf16 v[40:43], v[20:23], v[60:67], v0
v_cvt_pk_bf16_f32 v10, v36, v37
s_waitcnt lgkmcnt(0)
v_smfmac_f32_16x16x64_bf16 v[40:43], v[24:27], v[68:75], v0
v_cvt_pk_bf16_f32 v11, v38, v39
buffer_store_dwordx2 v[10:11], v8, s[8:11], s53 offen
v_bfe_u32 v65, v2, 4, 3
v_and_b32 v66, 1, v65
v_lshlrev_b32 v66, 4, v66
v_lshrrev_b32 v65, 1, v65
v_mov_b32 v64, 0x3f80
v_lshlrev_b32 v66, v66, v64
v_cvt_pk_bf16_f32 v10, v40, v41
v_cvt_pk_bf16_f32 v11, v42, v43
buffer_store_dwordx2 v[10:11], v8, s[8:11], s52 offen
v_cmp_eq_u32 vcc, 0, v65
s_nop 1
v_cndmask_b32 v60, 0, v66, vcc
v_cmp_eq_u32 vcc, 1, v65
s_nop 1
v_cndmask_b32 v61, 0, v66, vcc
v_cmp_eq_u32 vcc, 2, v65
s_nop 1
v_cndmask_b32 v62, 0, v66, vcc
v_cmp_eq_u32 vcc, 3, v65
s_nop 1
v_cndmask_b32 v63, 0, v66, vcc
v_mov_b64 v[28:29], 0
v_mov_b64 v[30:31], 0
v_mov_b64 v[32:33], 0
v_mov_b64 v[34:35], 0
v_mov_b64 v[40:41], 0
v_mov_b64 v[42:43], 0
v_mov_b64 v[36:37], -1
v_mov_b64 v[38:39], -1
s_add_u32 s18, s18, 1
s_xor_b32 s19, s19, 163840
s_add_u32 s26, s26, 131072
s_xor_b32 s44, s27, 0x202000
s_add_u32 s25, s24, 16779264
s_add_u32 s24, s24, 262144
v_lshrrev_b32 v11, 1, v6
s_lshl_b32 s35, s16, 7
s_add_u32 s35, s35, 4096
s_add_u32 s35, s35, s27
s_mov_b32 s36, 0
s_nop 11
buffer_load_dwordx4 v[44:47], v7, s[8:11], s55 offen offset:0 sc1
s_nop 15
s_nop 15
C_f1_red:
buffer_load_dwordx4 v[44:47], v7, s[8:11], s55 offen offset:0 sc1
s_waitcnt vmcnt(1)
v_mfma_f32_16x16x32_bf16 v[64:67], v[44:47], v[60:63], 0
s_nop 7
v_add_f32 v64, v64, v66
v_add_f32 v65, v65, v67
v_mov_b64 v[66:67], v[64:65]
s_nop 1
v_permlane32_swap_b32 v64, v66
v_permlane32_swap_b32 v65, v67
v_add_f32 v64, v64, v66
v_add_f32 v65, v65, v67
v_mov_b64 v[66:67], v[64:65]
s_nop 1
v_permlane16_swap_b32 v64, v66
v_permlane16_swap_b32 v65, v67
v_add_f32 v64, v64, v66
v_add_f32 v65, v65, v67
v_cmp_u_f32 vcc, v64, v65
v_cvt_pk_bf16_f32 v72, v64, v65
s_cbranch_vccnz C_f1_redslow
C_f1_redok:
buffer_store_dword v72, v9, s[8:11], s20 offen
s_barrier
s_mov_b64 exec, 0xff
buffer_store_dword v72, v11, s[8:11], s35 offen sc1
s_mov_b64 exec, -1
s_add_u32 s37, s20, 1024
s_mov_b32 s34, s20
s_add_u32 s4, s4, 32768
s_lshr_b32 s32, s4, 5
s_and_b32 s32, s32, 0x4000
s_lshr_b32 s27, s4, 8
s_and_b32 s27, s27, 0x2000
s_or_b32 s32, s32, s27
s_xor_b32 s32, s32, s47
s_add_u32 s27, s4, s32
s_add_u32 s20, s20, 8192
s_sub_u32 s32, s20, s46
s_cmp_eq_u32 s32, 24576
s_cselect_b32 s20, s46, s20
s_waitcnt vmcnt(2)
ds_read_b128 v[44:47], v3 offset:26624
ds_read_b128 v[48:51], v3 offset:27648
ds_read_b128 v[52:55], v3 offset:34816
ds_read_b128 v[56:59], v3 offset:35840
ds_read_b128 v[60:63], v3 offset:43008
ds_read_b128 v[64:67], v3 offset:44032
s_branch C_f1
C_f1_first:
ds_read_b128 v[12:15], v2 offset:0
ds_read_b128 v[16:19], v2 offset:512
ds_read_b128 v[20:23], v2 offset:1024
ds_read_b128 v[24:27], v2 offset:1536
s_waitcnt lgkmcnt(3)
v_smfmac_f32_16x16x64_bf16 v[28:31], v[12:15], a[0:7], v0
v_smfmac_f32_16x16x64_bf16 v[32:35], v[12:15], a[136:143], v0
v_smfmac_f32_16x16x64_bf16 v[40:43], v[12:15], v[44:51], v0
ds_read_b128 v[12:15], v2 offset:2048
ds_read_b128 v[44:47], v3 offset:51200
s_waitcnt lgkmcnt(4)
v_smfmac_f32_16x16x64_bf16 v[28:31], v[16:19], a[8:15], v0
ds_read_b128 v[48:51], v3 offset:52224
v_smfmac_f32_16x16x64_bf16 v[32:35], v[16:19], a[144:151], v0
v_smfmac_f32_16x16x64_bf16 v[40:43], v[16:19], v[52:59], v0
ds_read_b128 v[16:19], v2 offset:2560
ds_read_b128 v[52:55], v3 offset:59392
s_waitcnt lgkmcnt(6)
v_smfmac_f32_16x16x64_bf16 v[28:31], v[20:23], a[16:23], v0
ds_read_b128 v[56:59], v3 offset:60416
v_smfmac_f32_16x16x64_bf16 v[32:35], v[20:23], a[152:159], v0
v_smfmac_f32_16x16x64_bf16 v[40:43], v[20:23], v[60:67], v0
ds_read_b128 v[20:23], v2 offset:3072
ds_read_b128 v[60:63], v4 offset:2048
s_waitcnt lgkmcnt(8)
v_smfmac_f32_16x16x64_bf16 v[28:31], v[24:27], a[24:31], v0
ds_read_b128 v[64:67], v4 offset:3072
v_smfmac_f32_16x16x64_bf16 v[32:35], v[24:27], a[160:167], v0
v_smfmac_f32_16x16x64_bf16 v[40:43], v[24:27], v[96:103], v0
ds_read_b128 v[24:27], v2 offset:3584
s_waitcnt lgkmcnt(7)
v_smfmac_f32_16x16x64_bf16 v[28:31], v[12:15], v[44:51], v0
ds_read_b128 v[44:47], v4 offset:10240
ds_read_b128 v[48:51], v4 offset:11264
v_smfmac_f32_16x16x64_bf16 v[32:35], v[12:15], a[168:175], v0
v_smfmac_f32_16x16x64_bf16 v[40:43], v[12:15], v[104:111], v0
ds_read_b128 v[12:15], v2 offset:4096
s_waitcnt lgkmcnt(9)
v_smfmac_f32_16x16x64_bf16 v[28:31], v[16:19], a[32:39], v0
s_waitcnt lgkmcnt(7)
v_smfmac_f32_16x16x64_bf16 v[32:35], v[16:19], v[52:59], v0
ds_read_b128 v[52:55], v4 offset:18432
ds_read_b128 v[56:59], v4 offset:19456
v_smfmac_f32_16x16x64_bf16 v[40:43], v[16:19], v[112:119], v0
ds_read_b128 v[16:19], v2 offset:4608
s_waitcnt lgkmcnt(9)
v_smfmac_f32_16x16x64_bf16 v[28:31], v[20:23], a[40:47], v0
v_smfmac_f32_16x16x64_bf16 v[32:35], v[20:23], a[176:183], v0
s_waitcnt lgkmcnt(6)
v_smfmac_f32_16x16x64_bf16 v[28:31], v[24:27], v[60:67], v0
ds_read_b128 v[60:63], v4 offset:26624
ds_read_b128 v[64:67], v4 offset:27648
v_smfmac_f32_16x16x64_bf16 v[32:35], v[24:27], a[184:191], v0
s_waitcnt lgkmcnt(5)
v_smfmac_f32_16x16x64_bf16 v[28:31], v[12:15], a[48:55], v0
v_smfmac_f32_16x16x64_bf16 v[32:35], v[12:15], a[192:199], v0
s_waitcnt lgkmcnt(2)
v_smfmac_f32_16x16x64_bf16 v[28:31], v[16:19], a[56:63], v0
v_smfmac_f32_16x16x64_bf16 v[32:35], v[16:19], v[44:51], v0
ds_read_b128 v[44:47], v1 offset:26624
ds_read_b128 v[48:51], v1 offset:27648
s_waitcnt lgkmcnt(0)
s_branch C_f1_mid
C_f1_redslow:
s_add_u32 s36, s36, 1
s_and_b32 s32, s36, 7
s_cmp_lg_u32 s32, 0
s_cbranch_scc1 C_f1_red
s_add_u32 s57, s57, 1
s_cmp_gt_u32 s57, 0x40000
s_cbranch_scc1 C_fail
s_waitcnt vmcnt(0)
v_max3_u32 v10, v44, v45, v46
v_max_u32 v10, v10, v47
v_cmp_eq_u32 vcc, -1, v10
s_cbranch_vccz C_f1_redsum
buffer_load_dwordx4 v[44:47], v7, s[8:11], s55 offen offset:0 sc1
s_branch C_f1_red
C_f1_redsum:
v_mfma_f32_16x16x32_bf16 v[64:67], v[44:47], v[60:63], 0
s_nop 7
v_add_f32 v64, v64, v66
v_add_f32 v65, v65, v67
v_mov_b64 v[66:67], v[64:65]
s_nop 1
v_permlane32_swap_b32 v64, v66
v_permlane32_swap_b32 v65, v67
v_add_f32 v64, v64, v66
v_add_f32 v65, v65, v67
v_mov_b64 v[66:67], v[64:65]
s_nop 1
v_permlane16_swap_b32 v64, v66
v_permlane16_swap_b32 v65, v67
v_add_f32 v64, v64, v66
v_add_f32 v65, v65, v67
v_cvt_pk_bf16_f32 v72, v64, v65
v_min_u32 v72, -2, v72
s_branch C_f1_redok
C_f1_chkslow:
s_add_u32 s57, s57, 1
s_cmp_gt_u32 s57, 0x40000
s_cbranch_scc1 C_fail
buffer_load_dwordx4 v[68:71], v1, s[8:11], s37 offen offset:0 sc1
s_waitcnt vmcnt(1)
s_branch C_f1_chk
C_f1_rslow:
s_waitcnt vmcnt(0) lgkmcnt(0)
v_max3_u32 v10, v68, v69, v70
v_max_u32 v10, v10, v71
v_cmp_eq_u32 vcc, -1, v10
s_cbranch_vccz C_f1_rgot
s_add_u32 s57, s57, 1
s_cmp_gt_u32 s57, 0x40000
s_cbranch_scc1 C_fail
buffer_load_dwordx4 v[68:71], v1, s[8:11], s44 offen offset:1024 sc1
s_branch C_f1_rslow
C_f1_rgot:
ds_write_b128 v1, v[68:71] offset:6144
s_waitcnt lgkmcnt(0)
s_branch C_f1_rok
C_f1_last:
s_waitcnt lgkmcnt(3)
v_smfmac_f32_16x16x64_bf16 v[40:43], v[12:15], v[144:151], v0
ds_read_b128 v[12:15], v2 offset:7168
s_waitcnt lgkmcnt(3)
v_smfmac_f32_16x16x64_bf16 v[40:43], v[16:19], v[152:159], v0
ds_read_b128 v[16:19], v2 offset:7680
s_waitcnt lgkmcnt(3)
v_smfmac_f32_16x16x64_bf16 v[40:43], v[20:23], v[160:167], v0
s_waitcnt lgkmcnt(2)
v_smfmac_f32_16x16x64_bf16 v[40:43], v[24:27], v[168:175], v0
s_waitcnt lgkmcnt(1)
v_smfmac_f32_16x16x64_bf16 v[40:43], v[12:15], v[176:183], v0
s_waitcnt lgkmcnt(0)
v_smfmac_f32_16x16x64_bf16 v[40:43], v[16:19], v[184:191], v0
s_nop 7
v_cvt_pk_bf16_f32 v78, v40, v41
v_cvt_pk_bf16_f32 v79, v42, v43
buffer_store_dwordx4 v[76:79], v1, s[48:51], s26 offen sc1
s_waitcnt vmcnt(0)
s_branch C_exit
C_f2_in:
s_add_u32 s25, s24, 16781312
s_add_u32 s24, s24, 262144
v_mov_b64 v[28:29], 0
v_mov_b64 v[30:31], 0
v_mov_b64 v[32:33], 0
v_mov_b64 v[34:35], 0
v_mov_b64 v[40:41], 0
v_mov_b64 v[42:43], 0
ds_read_b128 v[44:47], v3 offset:28672
ds_read_b128 v[48:51], v3 offset:29696
ds_read_b128 v[52:55], v3 offset:36864
ds_read_b128 v[56:59], v3 offset:37888
ds_read_b128 v[60:63], v3 offset:45056
ds_read_b128 v[64:67], v3 offset:46080
s_waitcnt lgkmcnt(0)
s_barrier
s_branch C_f2_first
C_f2:
s_nop 15
s_nop 13
buffer_load_dwordx4 v[68:71], v1, s[8:11], s37 offen offset:0 sc1
buffer_load_dwordx4 v[72:75], v1, s[8:11], s37 offen offset:1024 sc1
s_nop 15
s_nop 15
buffer_load_dwordx4 v[68:71], v1, s[8:11], s37 offen offset:0 sc1
buffer_load_dwordx4 v[72:75], v1, s[8:11], s37 offen offset:1024 sc1
s_waitcnt vmcnt(2)
C_f2_chk:
v_max3_u32 v10, v68, v69, v70
v_max_u32 v10, v10, v71
v_max3_u32 v10, v10, v72, v73
v_max3_u32 v10, v10, v74, v75
v_cmp_eq_u32 vcc, -1, v10
s_cbranch_vccnz C_f2_chkslow
ds_write_b128 v1, v[68:71] offset:2048
ds_write_b128 v1, v[72:75] offset:3072
buffer_store_dwordx4 v[36:39], v1, s[8:11], s45 offen offset:2048
s_mov_b32 s21, s34
s_waitcnt lgkmcnt(0)
s_add_u32 s33, s44, 4096
buffer_load_dwordx4 v[68:71], v7, s[8:11], s33 offen sc1
s_barrier
ds_read_b128 v[12:15], v2 offset:0
ds_read_b128 v[16:19], v2 offset:512
ds_read_b128 v[20:23], v2 offset:1024
ds_read_b128 v[24:27], v2 offset:1536
s_waitcnt lgkmcnt(3)
v_smfmac_f32_16x16x64_bf16 v[28:31], v[12:15], a[0:7], v0
v_smfmac_f32_16x16x64_bf16 v[32:35], v[12:15], a[136:143], v0
v_smfmac_f32_16x16x64_bf16 v[40:43], v[12:15], v[44:51], v0
ds_read_b128 v[12:15], v2 offset:2048
ds_read_b128 v[44:47], v3 offset:53248
s_waitcnt lgkmcnt(4)
v_smfmac_f32_16x16x64_bf16 v[28:31], v[16:19], a[8:15], v0
ds_read_b128 v[48:51], v3 offset:54272
v_smfmac_f32_16x16x64_bf16 v[32:35], v[16:19], a[144:151], v0
v_smfmac_f32_16x16x64_bf16 v[40:43], v[16:19], v[52:59], v0
ds_read_b128 v[16:19], v2 offset:2560
ds_read_b128 v[52:55], v3 offset:61440
s_waitcnt lgkmcnt(6)
v_smfmac_f32_16x16x64_bf16 v[28:31], v[20:23], a[16:23], v0
ds_read_b128 v[56:59], v3 offset:62464
v_smfmac_f32_16x16x64_bf16 v[32:35], v[20:23], a[152:159], v0
v_smfmac_f32_16x16x64_bf16 v[40:43], v[20:23], v[60:67], v0
ds_read_b128 v[20:23], v2 offset:3072
ds_read_b128 v[60:63], v4 offset:4096
s_waitcnt lgkmcnt(8)
v_smfmac_f32_16x16x64_bf16 v[28:31], v[24:27], a[24:31], v0
ds_read_b128 v[64:67], v4 offset:5120
v_smfmac_f32_16x16x64_bf16 v[32:35], v[24:27], a[160:167], v0
v_smfmac_f32_16x16x64_bf16 v[40:43], v[24:27], v[96:103], v0
ds_read_b128 v[24:27], v2 offset:3584
s_waitcnt lgkmcnt(7)
v_smfmac_f32_16x16x64_bf16 v[28:31], v[12:15], v[44:51], v0
ds_read_b128 v[44:47], v4 offset:12288
ds_read_b128 v[48:51], v4 offset:13312
v_smfmac_f32_16x16x64_bf16 v[32:35], v[12:15], a[168:175], v0
v_smfmac_f32_16x16x64_bf16 v[40:43], v[12:15], v[104:111], v0
ds_read_b128 v[12:15], v2 offset:4096
s_waitcnt lgkmcnt(9)
v_smfmac_f32_16x16x64_bf16 v[28:31], v[16:19], a[32:39], v0
s_waitcnt lgkmcnt(7)
v_smfmac_f32_16x16x64_bf16 v[32:35], v[16:19], v[52:59], v0
ds_read_b128 v[52:55], v4 offset:20480
ds_read_b128 v[56:59], v4 offset:21504
v_smfmac_f32_16x16x64_bf16 v[40:43], v[16:19], v[112:119], v0
ds_read_b128 v[16:19], v2 offset:4608
s_waitcnt lgkmcnt(9)
v_smfmac_f32_16x16x64_bf16 v[28:31], v[20:23], a[40:47], v0
v_smfmac_f32_16x16x64_bf16 v[32:35], v[20:23], a[176:183], v0
s_waitcnt vmcnt(0)
v_max3_u32 v10, v68, v69, v70
s_waitcnt lgkmcnt(6)
v_smfmac_f32_16x16x64_bf16 v[28:31], v[24:27], v[60:67], v0
v_max_u32 v10, v10, v71
ds_write_b32 v9, v68 offset:9216
v_smfmac_f32_16x16x64_bf16 v[32:35], v[24:27], a[184:191], v0
ds_write_b32 v9, v69 offset:9232
ds_write_b32 v9, v70 offset:9248
s_waitcnt lgkmcnt(6)
v_smfmac_f32_16x16x64_bf16 v[28:31], v[12:15], a[48:55], v0
ds_write_b32 v9, v71 offset:9264
v_cmp_eq_u32 vcc, -1, v10
v_smfmac_f32_16x16x64_bf16 v[32:35], v[12:15], a[192:199], v0
ds_read_b128 v[60:63], v4 offset:28672
ds_read_b128 v[64:67], v4 offset:29696
s_waitcnt lgkmcnt(6)
v_smfmac_f32_16x16x64_bf16 v[28:31], v[16:19], a[56:63], v0
v_smfmac_f32_16x16x64_bf16 v[32:35], v[16:19], v[44:51], v0
ds_read_b128 v[44:47], v1 offset:28672
ds_read_b128 v[48:51], v1 offset:29696
s_cbranch_vccnz C_f2_rslow
C_f2_rok:
s_waitcnt lgkmcnt(4)
s_barrier
C_f2_mid:
v_smfmac_f32_16x16x64_bf16 v[40:43], v[20:23], v[120:127], v0
ds_read_b128 v[20:23], v2 offset:5120
v_smfmac_f32_16x16x64_bf16 v[40:43], v[24:27], v[128:135], v0
ds_read_b128 v[24:27], v2 offset:5632
v_smfmac_f32_16x16x64_bf16 v[40:43], v[12:15], v[136:143], v0
ds_read_b128 v[12:15], v2 offset:6144
v_smfmac_f32_16x16x64_bf16 v[40:43], v[16:19], v[52:59], v0
ds_read_b128 v[16:19], v2 offset:6656
ds_read_b128 v[52:55], v1 offset:36864
s_waitcnt lgkmcnt(4)
v_smfmac_f32_16x16x64_bf16 v[28:31], v[20:23], a[64:71], v0
ds_read_b128 v[56:59], v1 offset:37888
v_mov_b32 v11, s18
v_smfmac_f32_16x16x64_bf16 v[32:35], v[20:23], a[200:207], v0
ds_read_b128 v[20:23], v2 offset:7168
buffer_load_dwordx4 v[80:83], v1, s[8:11], s25 offen offset:0 sc1
s_waitcnt lgkmcnt(5)
v_smfmac_f32_16x16x64_bf16 v[28:31], v[24:27], a[72:79], v0
buffer_load_dwordx4 v[84:87], v1, s[8:11], s25 offen offset:1024 sc1
v_smfmac_f32_16x16x64_bf16 v[32:35], v[24:27], v[60:67], v0
ds_read_b128 v[24:27], v2 offset:7680
s_waitcnt lgkmcnt(5)
v_smfmac_f32_16x16x64_bf16 v[28:31], v[12:15], a[80:87], v0
v_smfmac_f32_16x16x64_bf16 v[32:35], v[12:15], a[208:215], v0
ds_read_b128 v[12:15], v2 offset:8192
s_waitcnt lgkmcnt(5)
v_smfmac_f32_16x16x64_bf16 v[28:31], v[16:19], a[88:95], v0
v_smfmac_f32_16x16x64_bf16 v[32:35], v[16:19], v[44:51], v0
ds_read_b128 v[16:19], v2 offset:8704
s_waitcnt lgkmcnt(3)
v_smfmac_f32_16x16x64_bf16 v[28:31], v[20:23], a[96:103], v0
v_smfmac_f32_16x16x64_bf16 v[32:35], v[20:23], a[216:223], v0
ds_read_b128 v[20:23], v2 offset:9216
s_waitcnt lgkmcnt(3)
v_smfmac_f32_16x16x64_bf16 v[28:31], v[24:27], v[52:59], v0
v_smfmac_f32_16x16x64_bf16 v[32:35], v[24:27], a[224:231], v0
ds_read_b128 v[24:27], v2 offset:9728
s_waitcnt lgkmcnt(3)
v_smfmac_f32_16x16x64_bf16 v[28:31], v[12:15], a[104:111], v0
ds_read_b128 v[52:55], v1 offset:10240
ds_read_b128 v[56:59], v1 offset:11264
v_smfmac_f32_16x16x64_bf16 v[32:35], v[12:15], a[232:239], v0
ds_read_b128 v[68:71], v1 offset:12288
ds_read_b128 v[72:75], v1 offset:13312
s_waitcnt lgkmcnt(6)
v_smfmac_f32_16x16x64_bf16 v[28:31], v[16:19], a[112:119], v0
s_add_u32 s52, s19, 32768
s_add_u32 s53, s19, 98304
s_waitcnt lgkmcnt(5)
v_smfmac_f32_16x16x64_bf16 v[28:31], v[20:23], a[120:127], v0
s_xor_b32 s45, s45, s56
s_waitcnt lgkmcnt(4)
v_smfmac_f32_16x16x64_bf16 v[28:31], v[24:27], a[128:135], v0
v_smfmac_f32_16x16x64_bf16 v[32:35], v[16:19], a[240:247], v0
v_smfmac_f32_16x16x64_bf16 v[32:35], v[20:23], a[248:255], v0
v_cvt_pk_bf16_f32 v36, v28, v29
v_smfmac_f32_16x16x64_bf16 v[32:35], v[24:27], v[88:95], v0
v_cvt_pk_bf16_f32 v37, v30, v31
ds_write_b64 v6, v[36:37] offset:19456
v_smfmac_f32_16x16x64_bf16 v[40:43], v[12:15], v[192:199], v0
s_cmp_eq_u32 s18, 63
v_smfmac_f32_16x16x64_bf16 v[40:43], v[16:19], v[200:207], v0
v_cvt_pk_bf16_f32 v76, v32, v33
v_cvt_pk_bf16_f32 v77, v34, v35
ds_write_b64 v6, v[76:77] offset:21504
v_smfmac_f32_16x16x64_bf16 v[40:43], v[20:23], v[208:215], v0
ds_read_b128 v[12:15], v2 offset:5120
ds_read_b128 v[16:19], v2 offset:5632
v_smfmac_f32_16x16x64_bf16 v[40:43], v[24:27], v[216:223], v0
ds_read_b128 v[20:23], v2 offset:6144
ds_read_b128 v[24:27], v2 offset:6656
s_cbranch_scc1 C_f2_last
buffer_store_dword v11, off, s[48:51], s22 sc1
s_waitcnt lgkmcnt(4)
s_barrier
ds_read_b64_tr_b16 v[44:45], v5 offset:18432
ds_read_b64_tr_b16 v[46:47], v5 offset:18688
ds_read_b64_tr_b16 v[48:49], v5 offset:20480
ds_read_b64_tr_b16 v[50:51], v5 offset:20736
s_waitcnt lgkmcnt(7)
v_smfmac_f32_16x16x64_bf16 v[40:43], v[12:15], v[144:151], v0
ds_read_b64_tr_b16 v[60:61], v5 offset:18944
ds_read_b64_tr_b16 v[62:63], v5 offset:19200
s_waitcnt lgkmcnt(8)
v_smfmac_f32_16x16x64_bf16 v[40:43], v[16:19], v[152:159], v0
ds_read_b64_tr_b16 v[64:65], v5 offset:20992
ds_read_b64_tr_b16 v[66:67], v5 offset:21248
s_waitcnt lgkmcnt(9)
v_smfmac_f32_16x16x64_bf16 v[40:43], v[20:23], v[160:167], v0
ds_read_b64_tr_b16 v[12:13], v5 offset:19456
ds_read_b64_tr_b16 v[14:15], v5 offset:19712
ds_read_b64_tr_b16 v[16:17], v5 offset:21504
s_waitcnt lgkmcnt(11)
v_smfmac_f32_16x16x64_bf16 v[40:43], v[24:27], v[168:175], v0
ds_read_b64_tr_b16 v[18:19], v5 offset:21760
ds_read_b128 v[20:23], v1 offset:14336
ds_read_b128 v[24:27], v1 offset:15360
s_waitcnt lgkmcnt(12)
v_mfma_f32_16x16x32_bf16 v[28:31], v[52:55], v[44:47], 0
ds_read_b128 v[52:55], v1 offset:16384
v_mfma_f32_16x16x32_bf16 v[32:35], v[56:59], v[44:47], 0
ds_read_b128 v[56:59], v1 offset:17408
s_waitcnt lgkmcnt(12)
v_mfma_f32_16x16x32_bf16 v[36:39], v[48:51], v[44:47], 0
ds_read_b64_tr_b16 v[44:45], v5 offset:19968
ds_read_b64_tr_b16 v[46:47], v5 offset:20224
s_waitcnt lgkmcnt(12)
v_mfma_f32_16x16x32_bf16 v[28:31], v[68:71], v[60:63], v[28:31]
ds_read_b64_tr_b16 v[48:49], v5 offset:22016
ds_read_b64_tr_b16 v[50:51], v5 offset:22272
v_mfma_f32_16x16x32_bf16 v[32:35], v[72:75], v[60:63], v[32:35]
s_waitcnt lgkmcnt(12)
v_mfma_f32_16x16x32_bf16 v[36:39], v[64:67], v[60:63], v[36:39]
s_waitcnt lgkmcnt(7)
v_mfma_f32_16x16x32_bf16 v[28:31], v[20:23], v[12:15], v[28:31]
ds_read_b128 v[20:23], v2 offset:7168
v_mov_b64 v[60:61], s[40:41]
s_waitcnt lgkmcnt(7)
v_mfma_f32_16x16x32_bf16 v[32:35], v[24:27], v[12:15], v[32:35]
ds_read_b128 v[24:27], v2 offset:7680
v_mov_b64 v[62:63], s[40:41]
v_mfma_f32_16x16x32_bf16 v[36:39], v[16:19], v[12:15], v[36:39]
v_mov_b64 v[64:65], s[42:43]
s_waitcnt lgkmcnt(4)
v_mfma_f32_16x16x32_bf16 v[28:31], v[52:55], v[44:47], v[28:31]
v_mfma_f32_16x16x32_bf16 v[32:35], v[56:59], v[44:47], v[32:35]
s_waitcnt lgkmcnt(2)
v_mfma_f32_16x16x32_bf16 v[36:39], v[48:51], v[44:47], v[36:39]
s_waitcnt lgkmcnt(1)
v_smfmac_f32_16x16x64_bf16 v[40:43], v[20:23], v[176:183], v0
v_max3_f32 v10, v28, v29, v30
s_waitcnt lgkmcnt(0)
v_smfmac_f32_16x16x64_bf16 v[40:43], v[24:27], v[184:191], v0
v_max3_f32 v11, v31, v32, v33
v_max3_f32 v10, v10, v34, v35
v_max3_f32 v11, v11, v36, v37
v_max3_f32 v10, v10, v38, v39
v_max_f32 v10, v10, v11
v_mov_b32 v11, v10
s_nop 1
v_cvt_pk_bf16_f32 v78, v40, v41
v_cvt_pk_bf16_f32 v79, v42, v43
v_permlane32_swap_b32 v10, v11
v_max_f32 v10, v10, v11
v_mov_b32 v11, v10
buffer_store_dwordx4 v[76:79], v1, s[48:51], s26 offen sc1
v_cndmask_b32 v58, 0, v78, s[30:31]
v_cndmask_b32 v59, 0, v79, s[30:31]
v_permlane16_swap_b32 v10, v11
v_max_f32 v10, v10, v11
v_mul_f32 v10, s29, v10
v_pk_fma_f32 v[28:29], v[28:29], s[28:29], v[10:11] op_sel_hi:[1,0,0]
v_pk_fma_f32 v[30:31], v[30:31], s[28:29], v[10:11] op_sel_hi:[1,0,0]
v_pk_fma_f32 v[32:33], v[32:33], s[28:29], v[10:11] op_sel_hi:[1,0,0]
v_pk_fma_f32 v[34:35], v[34:35], s[28:29], v[10:11] op_sel_hi:[1,0,0]
v_exp_f32 v28, v28
v_exp_f32 v29, v29
v_exp_f32 v30, v30
v_exp_f32 v31, v31
v_exp_f32 v32, v32
v_exp_f32 v33, v33
v_exp_f32 v34, v34
v_exp_f32 v35, v35
v_cvt_pk_bf16_f32 v52, v28, v29
v_cvt_pk_bf16_f32 v53, v30, v31
v_cvt_pk_bf16_f32 v54, v32, v33
v_cvt_pk_bf16_f32 v55, v34, v35
v_fma_f32 v36, v36, s28, v10
v_fma_f32 v37, v37, s28, v10
v_mfma_f32_16x16x32_bf16 v[24:27], v[60:63], v[52:55], 0
v_fma_f32 v38, v38, s28, v10
v_fma_f32 v39, v39, s28, v10
s_waitcnt vmcnt(3)
v_mfma_f32_16x16x32_bf16 v[28:31], v[80:83], v[52:55], 0
v_exp_f32 v36, v36
s_waitcnt vmcnt(2)
v_mfma_f32_16x16x32_bf16 v[32:35], v[84:87], v[52:55], 0
v_exp_f32 v37, v37
v_exp_f32 v38, v38
v_exp_f32 v39, v39
v_cvt_pk_bf16_f32 v56, v36, v37
v_cvt_pk_bf16_f32 v57, v38, v39
v_cndmask_b32 v74, v78, 0, s[30:31]
v_cndmask_b32 v75, v79, 0, s[30:31]
v_mfma_f32_16x16x16_bf16 v[24:27], v[64:65], v[56:57], v[24:27]
v_mov_b64 v[40:41], 0
v_mov_b64 v[42:43], 0
v_mfma_f32_16x16x16_bf16 v[28:31], v[58:59], v[56:57], v[28:31]
v_mov_b64 v[36:37], 0
v_mov_b64 v[38:39], 0
v_mfma_f32_16x16x16_bf16 v[32:35], v[74:75], v[56:57], v[32:35]
s_nop 1
v_rcp_f32 v10, v24
ds_read_b128 v[44:47], v1 offset:61440
ds_read_b128 v[48:51], v1 offset:62464
v_pk_mul_f32 v[28:29], v[28:29], v[10:11] op_sel_hi:[1,0]
v_pk_mul_f32 v[30:31], v[30:31], v[10:11] op_sel_hi:[1,0]
s_nop 0
v_pk_mul_f32 v[32:33], v[32:33], v[10:11] op_sel_hi:[1,0]
v_pk_mul_f32 v[34:35], v[34:35], v[10:11] op_sel_hi:[1,0]
v_cvt_pk_bf16_f32 v20, v28, v32
v_cvt_pk_bf16_f32 v21, v29, v33
v_cvt_pk_bf16_f32 v22, v30, v34
v_cvt_pk_bf16_f32 v23, v31, v35
ds_write_b128 v2, v[20:23] offset:23552
ds_read_b128 v[52:55], v1 offset:45056
ds_read_b128 v[56:59], v1 offset:46080
ds_read_b128 v[60:63], v1 offset:53248
ds_read_b128 v[64:67], v1 offset:54272
ds_read_b128 v[68:71], v3 offset:4096
ds_read_b128 v[72:75], v3 offset:5120
v_mov_b64 v[28:29], 0
v_mov_b64 v[30:31], 0
v_smfmac_f32_16x16x64_bf16 v[36:39], v[20:23], v[240:247], v0
s_waitcnt lgkmcnt(6)
s_barrier
ds_read_b128 v[12:15], v2 offset:22528
ds_read_b128 v[16:19], v2 offset:23040
ds_read_b128 v[24:27], v2 offset:24064
v_smfmac_f32_16x16x64_bf16 v[40:43], v[20:23], v[44:51], v0
s_mov_b32 m0, 10240
s_nop 0
buffer_load_dwordx4 v1, s[8:11], s24 offen offset:0 sc1 lds
buffer_load_dwordx4 v1, s[8:11], s24 offen offset:1024 sc1 lds
buffer_load_dwordx4 v1, s[8:11], s24 offen offset:2048 sc1 lds
buffer_load_dwordx4 v1, s[8:11], s24 offen offset:3072 sc1 lds
s_waitcnt lgkmcnt(2)
v_smfmac_f32_16x16x64_bf16 v[40:43], v[12:15], v[52:59], v0
s_waitcnt lgkmcnt(1)
v_smfmac_f32_16x16x64_bf16 v[40:43], v[16:19], v[60:67], v0
s_waitcnt lgkmcnt(0)
v_smfmac_f32_16x16x64_bf16 v[40:43], v[24:27], v[68:75], v0
v_smfmac_f32_16x16x64_bf16 v[36:39], v[12:15], v[224:231], v0
v_smfmac_f32_16x16x64_bf16 v[36:39], v[16:19], v[232:239], v0
v_cvt_pk_bf16_f32 v10, v40, v41
v_smfmac_f32_16x16x64_bf16 v[36:39], v[24:27], v[248:255], v0
v_cvt_pk_bf16_f32 v11, v42, v43
buffer_store_dwordx2 v[10:11], v8, s[8:11], s52 offen
s_nop 5
v_cvt_pk_bf16_f32 v10, v36, v37
v_cvt_pk_bf16_f32 v11, v38, v39
buffer_store_dwordx2 v[10:11], v8, s[8:11], s53 offen
v_mov_b64 v[28:29], 0
v_mov_b64 v[30:31], 0
v_mov_b64 v[32:33], 0
v_mov_b64 v[34:35], 0
v_mov_b64 v[40:41], 0
v_mov_b64 v[42:43], 0
v_mov_b64 v[36:37], -1
v_mov_b64 v[38:39], -1
s_add_u32 s18, s18, 1
s_xor_b32 s19, s19, 163840
s_add_u32 s26, s26, 131072
s_xor_b32 s44, s27, 0x202000
s_add_u32 s25, s24, 16781312
s_add_u32 s24, s24, 262144
ds_read_b128 v[44:47], v3 offset:28672
ds_read_b128 v[48:51], v3 offset:29696
ds_read_b128 v[52:55], v3 offset:36864
ds_read_b128 v[56:59], v3 offset:37888
ds_read_b128 v[60:63], v3 offset:45056
ds_read_b128 v[64:67], v3 offset:46080
s_waitcnt vmcnt(2)
s_barrier
s_add_u32 s37, s20, 2048
s_mov_b32 s34, s20
s_add_u32 s4, s4, 32768
s_lshr_b32 s32, s4, 5
s_and_b32 s32, s32, 0x4000
s_lshr_b32 s27, s4, 8
s_and_b32 s27, s27, 0x2000
s_or_b32 s32, s32, s27
s_xor_b32 s32, s32, s47
s_add_u32 s27, s4, s32
s_add_u32 s20, s20, 8192
s_sub_u32 s32, s20, s46
s_cmp_eq_u32 s32, 24576
s_cselect_b32 s20, s46, s20
s_branch C_f2
C_f2_first:
ds_read_b128 v[12:15], v2 offset:0
ds_read_b128 v[16:19], v2 offset:512
ds_read_b128 v[20:23], v2 offset:1024
ds_read_b128 v[24:27], v2 offset:1536
s_waitcnt lgkmcnt(3)
v_smfmac_f32_16x16x64_bf16 v[28:31], v[12:15], a[0:7], v0
v_smfmac_f32_16x16x64_bf16 v[32:35], v[12:15], a[136:143], v0
v_smfmac_f32_16x16x64_bf16 v[40:43], v[12:15], v[44:51], v0
ds_read_b128 v[12:15], v2 offset:2048
ds_read_b128 v[44:47], v3 offset:53248
s_waitcnt lgkmcnt(4)
v_smfmac_f32_16x16x64_bf16 v[28:31], v[16:19], a[8:15], v0
ds_read_b128 v[48:51], v3 offset:54272
v_smfmac_f32_16x16x64_bf16 v[32:35], v[16:19], a[144:151], v0
v_smfmac_f32_16x16x64_bf16 v[40:43], v[16:19], v[52:59], v0
ds_read_b128 v[16:19], v2 offset:2560
ds_read_b128 v[52:55], v3 offset:61440
s_waitcnt lgkmcnt(6)
v_smfmac_f32_16x16x64_bf16 v[28:31], v[20:23], a[16:23], v0
ds_read_b128 v[56:59], v3 offset:62464
v_smfmac_f32_16x16x64_bf16 v[32:35], v[20:23], a[152:159], v0
v_smfmac_f32_16x16x64_bf16 v[40:43], v[20:23], v[60:67], v0
ds_read_b128 v[20:23], v2 offset:3072
ds_read_b128 v[60:63], v4 offset:4096
s_waitcnt lgkmcnt(8)
v_smfmac_f32_16x16x64_bf16 v[28:31], v[24:27], a[24:31], v0
ds_read_b128 v[64:67], v4 offset:5120
v_smfmac_f32_16x16x64_bf16 v[32:35], v[24:27], a[160:167], v0
v_smfmac_f32_16x16x64_bf16 v[40:43], v[24:27], v[96:103], v0
ds_read_b128 v[24:27], v2 offset:3584
s_waitcnt lgkmcnt(7)
v_smfmac_f32_16x16x64_bf16 v[28:31], v[12:15], v[44:51], v0
ds_read_b128 v[44:47], v4 offset:12288
ds_read_b128 v[48:51], v4 offset:13312
v_smfmac_f32_16x16x64_bf16 v[32:35], v[12:15], a[168:175], v0
v_smfmac_f32_16x16x64_bf16 v[40:43], v[12:15], v[104:111], v0
ds_read_b128 v[12:15], v2 offset:4096
s_waitcnt lgkmcnt(9)
v_smfmac_f32_16x16x64_bf16 v[28:31], v[16:19], a[32:39], v0
s_waitcnt lgkmcnt(7)
v_smfmac_f32_16x16x64_bf16 v[32:35], v[16:19], v[52:59], v0
ds_read_b128 v[52:55], v4 offset:20480
ds_read_b128 v[56:59], v4 offset:21504
v_smfmac_f32_16x16x64_bf16 v[40:43], v[16:19], v[112:119], v0
ds_read_b128 v[16:19], v2 offset:4608
s_waitcnt lgkmcnt(9)
v_smfmac_f32_16x16x64_bf16 v[28:31], v[20:23], a[40:47], v0
v_smfmac_f32_16x16x64_bf16 v[32:35], v[20:23], a[176:183], v0
s_waitcnt lgkmcnt(6)
v_smfmac_f32_16x16x64_bf16 v[28:31], v[24:27], v[60:67], v0
ds_read_b128 v[60:63], v4 offset:28672
ds_read_b128 v[64:67], v4 offset:29696
v_smfmac_f32_16x16x64_bf16 v[32:35], v[24:27], a[184:191], v0
s_waitcnt lgkmcnt(5)
v_smfmac_f32_16x16x64_bf16 v[28:31], v[12:15], a[48:55], v0
v_smfmac_f32_16x16x64_bf16 v[32:35], v[12:15], a[192:199], v0
s_waitcnt lgkmcnt(2)
v_smfmac_f32_16x16x64_bf16 v[28:31], v[16:19], a[56:63], v0
v_smfmac_f32_16x16x64_bf16 v[32:35], v[16:19], v[44:51], v0
ds_read_b128 v[44:47], v1 offset:28672
ds_read_b128 v[48:51], v1 offset:29696
s_waitcnt lgkmcnt(0)
s_branch C_f2_mid
C_f2_chkslow:
s_add_u32 s57, s57, 1
s_cmp_gt_u32 s57, 0x40000
s_cbranch_scc1 C_fail
buffer_load_dwordx4 v[68:71], v1, s[8:11], s37 offen offset:0 sc1
buffer_load_dwordx4 v[72:75], v1, s[8:11], s37 offen offset:1024 sc1
s_waitcnt vmcnt(2)
s_branch C_f2_chk
C_f2_rslow:
s_waitcnt vmcnt(0) lgkmcnt(0)
v_max3_u32 v10, v68, v69, v70
v_max_u32 v10, v10, v71
v_cmp_eq_u32 vcc, -1, v10
s_cbranch_vccz C_f2_rgot
s_add_u32 s57, s57, 1
s_cmp_gt_u32 s57, 0x40000
s_cbranch_scc1 C_fail
s_add_u32 s33, s44, 4096
buffer_load_dwordx4 v[68:71], v7, s[8:11], s33 offen sc1
s_branch C_f2_rslow
C_f2_rgot:
ds_write_b32 v9, v68 offset:9216
ds_write_b32 v9, v69 offset:9232
ds_write_b32 v9, v70 offset:9248
ds_write_b32 v9, v71 offset:9264
s_waitcnt lgkmcnt(0)
s_branch C_f2_rok
C_f2_last:
s_waitcnt lgkmcnt(3)
v_smfmac_f32_16x16x64_bf16 v[40:43], v[12:15], v[144:151], v0
ds_read_b128 v[12:15], v2 offset:7168
s_waitcnt lgkmcnt(3)
v_smfmac_f32_16x16x64_bf16 v[40:43], v[16:19], v[152:159], v0
ds_read_b128 v[16:19], v2 offset:7680
s_waitcnt lgkmcnt(3)
v_smfmac_f32_16x16x64_bf16 v[40:43], v[20:23], v[160:167], v0
s_waitcnt lgkmcnt(2)
v_smfmac_f32_16x16x64_bf16 v[40:43], v[24:27], v[168:175], v0
s_waitcnt lgkmcnt(1)
v_smfmac_f32_16x16x64_bf16 v[40:43], v[12:15], v[176:183], v0
s_waitcnt lgkmcnt(0)
v_smfmac_f32_16x16x64_bf16 v[40:43], v[16:19], v[184:191], v0
s_nop 7
v_cvt_pk_bf16_f32 v78, v40, v41
v_cvt_pk_bf16_f32 v79, v42, v43
buffer_store_dwordx4 v[76:79], v1, s[48:51], s26 offen sc1
s_waitcnt vmcnt(0)
s_branch C_exit
C_f3_in:
s_add_u32 s25, s24, 16783360
s_add_u32 s24, s24, 262144
v_mov_b64 v[28:29], 0
v_mov_b64 v[30:31], 0
v_mov_b64 v[32:33], 0
v_mov_b64 v[34:35], 0
v_mov_b64 v[40:41], 0
v_mov_b64 v[42:43], 0
ds_read_b128 v[44:47], v3 offset:30720
ds_read_b128 v[48:51], v3 offset:31744
ds_read_b128 v[52:55], v3 offset:38912
ds_read_b128 v[56:59], v3 offset:39936
ds_read_b128 v[60:63], v3 offset:47104
ds_read_b128 v[64:67], v3 offset:48128
s_waitcnt lgkmcnt(0)
s_barrier
s_branch C_f3_first
C_f3:
s_nop 15
s_nop 10
buffer_load_dwordx4 v[68:71], v1, s[8:11], s37 offen offset:0 sc1
s_nop 15
s_nop 15
buffer_load_dwordx4 v[68:71], v1, s[8:11], s37 offen offset:0 sc1
s_waitcnt vmcnt(1)
C_f3_chk:
v_max3_u32 v10, v68, v69, v70
v_max_u32 v10, v10, v71
v_cmp_eq_u32 vcc, -1, v10
s_cbranch_vccnz C_f3_chkslow
ds_write_b128 v1, v[68:71] offset:4096
buffer_store_dwordx4 v[36:39], v1, s[8:11], s45 offen offset:3072
s_mov_b32 s21, s34
s_waitcnt lgkmcnt(0)
buffer_load_dwordx4 v[68:71], v1, s[8:11], s44 offen offset:2048 sc1
buffer_load_dwordx4 v[72:75], v1, s[8:11], s44 offen offset:3072 sc1
s_barrier
ds_read_b128 v[12:15], v2 offset:0
ds_read_b128 v[16:19], v2 offset:512
ds_read_b128 v[20:23], v2 offset:1024
ds_read_b128 v[24:27], v2 offset:1536
s_waitcnt lgkmcnt(3)
v_smfmac_f32_16x16x64_bf16 v[28:31], v[12:15], a[0:7], v0
v_smfmac_f32_16x16x64_bf16 v[32:35], v[12:15], a[136:143], v0
v_smfmac_f32_16x16x64_bf16 v[40:43], v[12:15], v[44:51], v0
ds_read_b128 v[12:15], v2 offset:2048
ds_read_b128 v[44:47], v3 offset:55296
s_waitcnt lgkmcnt(4)
v_smfmac_f32_16x16x64_bf16 v[28:31], v[16:19], a[8:15], v0
ds_read_b128 v[48:51], v3 offset:56320
v_smfmac_f32_16x16x64_bf16 v[32:35], v[16:19], a[144:151], v0
v_smfmac_f32_16x16x64_bf16 v[40:43], v[16:19], v[52:59], v0
ds_read_b128 v[16:19], v2 offset:2560
ds_read_b128 v[52:55], v3 offset:63488
s_waitcnt lgkmcnt(6)
v_smfmac_f32_16x16x64_bf16 v[28:31], v[20:23], a[16:23], v0
ds_read_b128 v[56:59], v3 offset:64512
v_smfmac_f32_16x16x64_bf16 v[32:35], v[20:23], a[152:159], v0
v_smfmac_f32_16x16x64_bf16 v[40:43], v[20:23], v[60:67], v0
ds_read_b128 v[20:23], v2 offset:3072
ds_read_b128 v[60:63], v4 offset:6144
s_waitcnt lgkmcnt(8)
v_smfmac_f32_16x16x64_bf16 v[28:31], v[24:27], a[24:31], v0
ds_read_b128 v[64:67], v4 offset:7168
v_smfmac_f32_16x16x64_bf16 v[32:35], v[24:27], a[160:167], v0
v_smfmac_f32_16x16x64_bf16 v[40:43], v[24:27], v[96:103], v0
ds_read_b128 v[24:27], v2 offset:3584
s_waitcnt lgkmcnt(7)
v_smfmac_f32_16x16x64_bf16 v[28:31], v[12:15], v[44:51], v0
ds_read_b128 v[44:47], v4 offset:14336
ds_read_b128 v[48:51], v4 offset:15360
v_smfmac_f32_16x16x64_bf16 v[32:35], v[12:15], a[168:175], v0
v_smfmac_f32_16x16x64_bf16 v[40:43], v[12:15], v[104:111], v0
ds_read_b128 v[12:15], v2 offset:4096
s_waitcnt lgkmcnt(9)
v_smfmac_f32_16x16x64_bf16 v[28:31], v[16:19], a[32:39], v0
s_waitcnt lgkmcnt(7)
v_smfmac_f32_16x16x64_bf16 v[32:35], v[16:19], v[52:59], v0
ds_read_b128 v[52:55], v4 offset:22528
ds_read_b128 v[56:59], v4 offset:23552
v_smfmac_f32_16x16x64_bf16 v[40:43], v[16:19], v[112:119], v0
ds_read_b128 v[16:19], v2 offset:4608
s_waitcnt lgkmcnt(9)
v_smfmac_f32_16x16x64_bf16 v[28:31], v[20:23], a[40:47], v0
v_smfmac_f32_16x16x64_bf16 v[32:35], v[20:23], a[176:183], v0
s_waitcnt vmcnt(0)
v_max3_u32 v10, v68, v69, v70
s_waitcnt lgkmcnt(6)
v_smfmac_f32_16x16x64_bf16 v[28:31], v[24:27], v[60:67], v0
v_max_u32 v10, v10, v71
ds_write_b128 v1, v[68:71] offset:7168
v_smfmac_f32_16x16x64_bf16 v[32:35], v[24:27], a[184:191], v0
v_max3_u32 v10, v10, v72, v73
s_waitcnt lgkmcnt(4)
v_smfmac_f32_16x16x64_bf16 v[28:31], v[12:15], a[48:55], v0
v_max3_u32 v10, v10, v74, v75
ds_write_b128 v1, v[72:75] offset:8192
v_smfmac_f32_16x16x64_bf16 v[32:35], v[12:15], a[192:199], v0
v_cmp_eq_u32 vcc, -1, v10
ds_read_b128 v[60:63], v4 offset:30720
s_waitcnt lgkmcnt(3)
v_smfmac_f32_16x16x64_bf16 v[28:31], v[16:19], a[56:63], v0
ds_read_b128 v[64:67], v4 offset:31744
v_smfmac_f32_16x16x64_bf16 v[32:35], v[16:19], v[44:51], v0
ds_read_b128 v[44:47], v1 offset:30720
ds_read_b128 v[48:51], v1 offset:31744
s_cbranch_vccnz C_f3_rslow
C_f3_rok:
s_waitcnt lgkmcnt(4)
s_barrier
C_f3_mid:
v_smfmac_f32_16x16x64_bf16 v[40:43], v[20:23], v[120:127], v0
ds_read_b128 v[20:23], v2 offset:5120
v_smfmac_f32_16x16x64_bf16 v[40:43], v[24:27], v[128:135], v0
ds_read_b128 v[24:27], v2 offset:5632
v_smfmac_f32_16x16x64_bf16 v[40:43], v[12:15], v[136:143], v0
ds_read_b128 v[12:15], v2 offset:6144
v_smfmac_f32_16x16x64_bf16 v[40:43], v[16:19], v[52:59], v0
ds_read_b128 v[16:19], v2 offset:6656
ds_read_b128 v[52:55], v1 offset:38912
s_cmp_ge_u32 s18, s59
s_cbranch_scc1 C_f3_wait
C_f3_waited:
s_waitcnt lgkmcnt(4)
v_smfmac_f32_16x16x64_bf16 v[28:31], v[20:23], a[64:71], v0
ds_read_b128 v[56:59], v1 offset:39936
buffer_load_dwordx4 v[80:83], v1, s[8:11], s25 offen offset:0 sc1
v_smfmac_f32_16x16x64_bf16 v[32:35], v[20:23], a[200:207], v0
ds_read_b128 v[20:23], v2 offset:7168
s_waitcnt lgkmcnt(5)
v_smfmac_f32_16x16x64_bf16 v[28:31], v[24:27], a[72:79], v0
buffer_load_dwordx4 v[84:87], v1, s[8:11], s25 offen offset:1024 sc1
v_smfmac_f32_16x16x64_bf16 v[32:35], v[24:27], v[60:67], v0
ds_read_b128 v[24:27], v2 offset:7680
s_waitcnt lgkmcnt(5)
v_smfmac_f32_16x16x64_bf16 v[28:31], v[12:15], a[80:87], v0
v_smfmac_f32_16x16x64_bf16 v[32:35], v[12:15], a[208:215], v0
ds_read_b128 v[12:15], v2 offset:8192
s_waitcnt lgkmcnt(5)
v_smfmac_f32_16x16x64_bf16 v[28:31], v[16:19], a[88:95], v0
v_smfmac_f32_16x16x64_bf16 v[32:35], v[16:19], v[44:51], v0
ds_read_b128 v[16:19], v2 offset:8704
s_waitcnt lgkmcnt(3)
v_smfmac_f32_16x16x64_bf16 v[28:31], v[20:23], a[96:103], v0
v_smfmac_f32_16x16x64_bf16 v[32:35], v[20:23], a[216:223], v0
ds_read_b128 v[20:23], v2 offset:9216
s_waitcnt lgkmcnt(3)
v_smfmac_f32_16x16x64_bf16 v[28:31], v[24:27], v[52:59], v0
v_smfmac_f32_16x16x64_bf16 v[32:35], v[24:27], a[224:231], v0
ds_read_b128 v[24:27], v2 offset:9728
s_waitcnt lgkmcnt(3)
v_smfmac_f32_16x16x64_bf16 v[28:31], v[12:15], a[104:111], v0
ds_read_b128 v[52:55], v1 offset:10240
ds_read_b128 v[56:59], v1 offset:11264
v_smfmac_f32_16x16x64_bf16 v[32:35], v[12:15], a[232:239], v0
ds_read_b128 v[68:71], v1 offset:12288
ds_read_b128 v[72:75], v1 offset:13312
s_waitcnt lgkmcnt(6)
v_smfmac_f32_16x16x64_bf16 v[28:31], v[16:19], a[112:119], v0
s_add_u32 s52, s19, 49152
s_add_u32 s53, s19, 114688
s_waitcnt lgkmcnt(5)
v_smfmac_f32_16x16x64_bf16 v[28:31], v[20:23], a[120:127], v0
s_xor_b32 s45, s45, s56
s_waitcnt lgkmcnt(4)
v_smfmac_f32_16x16x64_bf16 v[28:31], v[24:27], a[128:135], v0
v_smfmac_f32_16x16x64_bf16 v[32:35], v[16:19], a[240:247], v0
v_smfmac_f32_16x16x64_bf16 v[32:35], v[20:23], a[248:255], v0
v_cvt_pk_bf16_f32 v36, v28, v29
v_smfmac_f32_16x16x64_bf16 v[32:35], v[24:27], v[88:95], v0
v_cvt_pk_bf16_f32 v37, v30, v31
ds_write_b64 v6, v[36:37] offset:19968
v_smfmac_f32_16x16x64_bf16 v[40:43], v[12:15], v[192:199], v0
s_cmp_eq_u32 s18, 63
v_smfmac_f32_16x16x64_bf16 v[40:43], v[16:19], v[200:207], v0
v_cvt_pk_bf16_f32 v76, v32, v33
v_cvt_pk_bf16_f32 v77, v34, v35
ds_write_b64 v6, v[76:77] offset:22016
v_smfmac_f32_16x16x64_bf16 v[40:43], v[20:23], v[208:215], v0
ds_read_b128 v[12:15], v2 offset:5120
ds_read_b128 v[16:19], v2 offset:5632
v_smfmac_f32_16x16x64_bf16 v[40:43], v[24:27], v[216:223], v0
ds_read_b128 v[20:23], v2 offset:6144
ds_read_b128 v[24:27], v2 offset:6656
s_cbranch_scc1 C_f3_last
buffer_load_dword v7, v9, s[8:11], s24 offen sc1
s_mov_b64 exec, 7
buffer_load_dword v7, v6, s[8:11], s5 offen sc1
s_mov_b64 exec, -1
s_waitcnt lgkmcnt(4)
s_barrier
ds_read_b64_tr_b16 v[44:45], v5 offset:18432
ds_read_b64_tr_b16 v[46:47], v5 offset:18688
ds_read_b64_tr_b16 v[48:49], v5 offset:20480
ds_read_b64_tr_b16 v[50:51], v5 offset:20736
s_waitcnt lgkmcnt(7)
v_smfmac_f32_16x16x64_bf16 v[40:43], v[12:15], v[144:151], v0
ds_read_b64_tr_b16 v[60:61], v5 offset:18944
ds_read_b64_tr_b16 v[62:63], v5 offset:19200
s_waitcnt lgkmcnt(8)
v_smfmac_f32_16x16x64_bf16 v[40:43], v[16:19], v[152:159], v0
ds_read_b64_tr_b16 v[64:65], v5 offset:20992
ds_read_b64_tr_b16 v[66:67], v5 offset:21248
s_waitcnt lgkmcnt(9)
v_smfmac_f32_16x16x64_bf16 v[40:43], v[20:23], v[160:167], v0
ds_read_b64_tr_b16 v[12:13], v5 offset:19456
ds_read_b64_tr_b16 v[14:15], v5 offset:19712
ds_read_b64_tr_b16 v[16:17], v5 offset:21504
s_waitcnt lgkmcnt(11)
v_smfmac_f32_16x16x64_bf16 v[40:43], v[24:27], v[168:175], v0
ds_read_b64_tr_b16 v[18:19], v5 offset:21760
ds_read_b128 v[20:23], v1 offset:14336
ds_read_b128 v[24:27], v1 offset:15360
s_waitcnt lgkmcnt(12)
v_mfma_f32_16x16x32_bf16 v[28:31], v[52:55], v[44:47], 0
ds_read_b128 v[52:55], v1 offset:16384
v_mfma_f32_16x16x32_bf16 v[32:35], v[56:59], v[44:47], 0
ds_read_b128 v[56:59], v1 offset:17408
s_waitcnt lgkmcnt(12)
v_mfma_f32_16x16x32_bf16 v[36:39], v[48:51], v[44:47], 0
ds_read_b64_tr_b16 v[44:45], v5 offset:19968
ds_read_b64_tr_b16 v[46:47], v5 offset:20224
s_waitcnt lgkmcnt(12)
v_mfma_f32_16x16x32_bf16 v[28:31], v[68:71], v[60:63], v[28:31]
ds_read_b64_tr_b16 v[48:49], v5 offset:22016
ds_read_b64_tr_b16 v[50:51], v5 offset:22272
v_mfma_f32_16x16x32_bf16 v[32:35], v[72:75], v[60:63], v[32:35]
s_waitcnt lgkmcnt(12)
v_mfma_f32_16x16x32_bf16 v[36:39], v[64:67], v[60:63], v[36:39]
s_waitcnt lgkmcnt(7)
v_mfma_f32_16x16x32_bf16 v[28:31], v[20:23], v[12:15], v[28:31]
ds_read_b128 v[20:23], v2 offset:7168
v_mov_b64 v[60:61], s[40:41]
s_waitcnt lgkmcnt(7)
v_mfma_f32_16x16x32_bf16 v[32:35], v[24:27], v[12:15], v[32:35]
ds_read_b128 v[24:27], v2 offset:7680
v_mov_b64 v[62:63], s[40:41]
v_mfma_f32_16x16x32_bf16 v[36:39], v[16:19], v[12:15], v[36:39]
v_mov_b64 v[64:65], s[42:43]
s_waitcnt lgkmcnt(4)
v_mfma_f32_16x16x32_bf16 v[28:31], v[52:55], v[44:47], v[28:31]
v_mfma_f32_16x16x32_bf16 v[32:35], v[56:59], v[44:47], v[32:35]
s_waitcnt lgkmcnt(2)
v_mfma_f32_16x16x32_bf16 v[36:39], v[48:51], v[44:47], v[36:39]
s_waitcnt lgkmcnt(1)
v_smfmac_f32_16x16x64_bf16 v[40:43], v[20:23], v[176:183], v0
v_max3_f32 v10, v28, v29, v30
s_waitcnt lgkmcnt(0)
v_smfmac_f32_16x16x64_bf16 v[40:43], v[24:27], v[184:191], v0
v_max3_f32 v11, v31, v32, v33
v_max3_f32 v10, v10, v34, v35
v_max3_f32 v11, v11, v36, v37
v_max3_f32 v10, v10, v38, v39
v_max_f32 v10, v10, v11
v_mov_b32 v11, v10
s_nop 1
v_cvt_pk_bf16_f32 v78, v40, v41
v_cvt_pk_bf16_f32 v79, v42, v43
v_permlane32_swap_b32 v10, v11
v_max_f32 v10, v10, v11
v_mov_b32 v11, v10
buffer_store_dwordx4 v[76:79], v1, s[48:51], s26 offen sc1
v_cndmask_b32 v58, 0, v78, s[30:31]
v_cndmask_b32 v59, 0, v79, s[30:31]
v_permlane16_swap_b32 v10, v11
v_max_f32 v10, v10, v11
v_mul_f32 v10, s29, v10
v_pk_fma_f32 v[28:29], v[28:29], s[28:29], v[10:11] op_sel_hi:[1,0,0]
v_pk_fma_f32 v[30:31], v[30:31], s[28:29], v[10:11] op_sel_hi:[1,0,0]
v_pk_fma_f32 v[32:33], v[32:33], s[28:29], v[10:11] op_sel_hi:[1,0,0]
v_pk_fma_f32 v[34:35], v[34:35], s[28:29], v[10:11] op_sel_hi:[1,0,0]
v_exp_f32 v28, v28
v_exp_f32 v29, v29
v_exp_f32 v30, v30
v_exp_f32 v31, v31
v_exp_f32 v32, v32
v_exp_f32 v33, v33
v_exp_f32 v34, v34
v_exp_f32 v35, v35
v_cvt_pk_bf16_f32 v52, v28, v29
v_cvt_pk_bf16_f32 v53, v30, v31
v_cvt_pk_bf16_f32 v54, v32, v33
v_cvt_pk_bf16_f32 v55, v34, v35
v_fma_f32 v36, v36, s28, v10
v_fma_f32 v37, v37, s28, v10
v_mfma_f32_16x16x32_bf16 v[12:15], v[60:63], v[52:55], 0
v_fma_f32 v38, v38, s28, v10
v_fma_f32 v39, v39, s28, v10
s_waitcnt vmcnt(4)
v_mfma_f32_16x16x32_bf16 v[28:31], v[80:83], v[52:55], 0
v_exp_f32 v36, v36
s_waitcnt vmcnt(3)
v_mfma_f32_16x16x32_bf16 v[32:35], v[84:87], v[52:55], 0
v_exp_f32 v37, v37
v_exp_f32 v38, v38
v_exp_f32 v39, v39
v_cvt_pk_bf16_f32 v56, v36, v37
v_cvt_pk_bf16_f32 v57, v38, v39
v_cndmask_b32 v74, v78, 0, s[30:31]
v_cndmask_b32 v75, v79, 0, s[30:31]
v_mfma_f32_16x16x16_bf16 v[12:15], v[64:65], v[56:57], v[12:15]
v_mov_b64 v[40:41], 0
v_mov_b64 v[42:43], 0
v_mfma_f32_16x16x16_bf16 v[28:31], v[58:59], v[56:57], v[28:31]
v_mov_b64 v[36:37], 0
v_mov_b64 v[38:39], 0
v_mfma_f32_16x16x16_bf16 v[32:35], v[74:75], v[56:57], v[32:35]
s_nop 1
v_rcp_f32 v10, v12
ds_read_b128 v[44:47], v3 offset:6144
ds_read_b128 v[48:51], v3 offset:7168
v_pk_mul_f32 v[28:29], v[28:29], v[10:11] op_sel_hi:[1,0]
v_pk_mul_f32 v[30:31], v[30:31], v[10:11] op_sel_hi:[1,0]
s_nop 0
v_pk_mul_f32 v[32:33], v[32:33], v[10:11] op_sel_hi:[1,0]
v_pk_mul_f32 v[34:35], v[34:35], v[10:11] op_sel_hi:[1,0]
v_cvt_pk_bf16_f32 v24, v28, v32
v_cvt_pk_bf16_f32 v25, v29, v33
v_cvt_pk_bf16_f32 v26, v30, v34
v_cvt_pk_bf16_f32 v27, v31, v35
ds_write_b128 v2, v[24:27] offset:24064
ds_read_b128 v[52:55], v1 offset:47104
ds_read_b128 v[56:59], v1 offset:48128
ds_read_b128 v[60:63], v1 offset:55296
ds_read_b128 v[64:67], v1 offset:56320
ds_read_b128 v[68:71], v1 offset:63488
ds_read_b128 v[72:75], v1 offset:64512
v_mov_b64 v[28:29], 0
v_mov_b64 v[30:31], 0
v_smfmac_f32_16x16x64_bf16 v[36:39], v[24:27], v[248:255], v0
s_waitcnt lgkmcnt(6)
s_barrier
ds_read_b128 v[12:15], v2 offset:22528
ds_read_b128 v[16:19], v2 offset:23040
ds_read_b128 v[20:23], v2 offset:23552
v_smfmac_f32_16x16x64_bf16 v[40:43], v[24:27], v[44:51], v0
s_mov_b32 m0, 14336
s_add_u32 s32, s24, 4096
buffer_load_dwordx4 v1, s[8:11], s32 offen offset:0 sc1 lds
buffer_load_dwordx4 v1, s[8:11], s32 offen offset:1024 sc1 lds
buffer_load_dwordx4 v1, s[8:11], s32 offen offset:2048 sc1 lds
buffer_load_dwordx4 v1, s[8:11], s32 offen offset:3072 sc1 lds
s_waitcnt lgkmcnt(2)
v_smfmac_f32_16x16x64_bf16 v[40:43], v[12:15], v[52:59], v0
s_waitcnt lgkmcnt(1)
v_smfmac_f32_16x16x64_bf16 v[40:43], v[16:19], v[60:67], v0
s_waitcnt lgkmcnt(0)
v_smfmac_f32_16x16x64_bf16 v[40:43], v[20:23], v[68:75], v0
v_smfmac_f32_16x16x64_bf16 v[36:39], v[12:15], v[224:231], v0
v_smfmac_f32_16x16x64_bf16 v[36:39], v[16:19], v[232:239], v0
v_cvt_pk_bf16_f32 v10, v40, v41
v_smfmac_f32_16x16x64_bf16 v[36:39], v[20:23], v[240:247], v0
v_cvt_pk_bf16_f32 v11, v42, v43
buffer_store_dwordx2 v[10:11], v8, s[8:11], s52 offen
s_nop 5
v_cvt_pk_bf16_f32 v10, v36, v37
v_cvt_pk_bf16_f32 v11, v38, v39
buffer_store_dwordx2 v[10:11], v8, s[8:11], s53 offen
v_mov_b64 v[28:29], 0
v_mov_b64 v[30:31], 0
v_mov_b64 v[32:33], 0
v_mov_b64 v[34:35], 0
v_mov_b64 v[40:41], 0
v_mov_b64 v[42:43], 0
v_mov_b64 v[36:37], -1
v_mov_b64 v[38:39], -1
s_add_u32 s18, s18, 1
s_xor_b32 s19, s19, 163840
s_add_u32 s26, s26, 131072
s_xor_b32 s44, s27, 0x202000
s_add_u32 s25, s24, 16783360
s_add_u32 s24, s24, 262144
ds_read_b128 v[44:47], v3 offset:30720
ds_read_b128 v[48:51], v3 offset:31744
ds_read_b128 v[52:55], v3 offset:38912
ds_read_b128 v[56:59], v3 offset:39936
ds_read_b128 v[60:63], v3 offset:47104
ds_read_b128 v[64:67], v3 offset:48128
s_waitcnt vmcnt(2)
s_barrier
s_add_u32 s37, s20, 4096
s_mov_b32 s34, s20
s_add_u32 s4, s4, 32768
s_lshr_b32 s32, s4, 5
s_and_b32 s32, s32, 0x4000
s_lshr_b32 s27, s4, 8
s_and_b32 s27, s27, 0x2000
s_or_b32 s32, s32, s27
s_xor_b32 s32, s32, s47
s_add_u32 s27, s4, s32
s_add_u32 s20, s20, 8192
s_sub_u32 s32, s20, s46
s_cmp_eq_u32 s32, 24576
s_cselect_b32 s20, s46, s20
s_branch C_f3
C_f3_first:
ds_read_b128 v[12:15], v2 offset:0
ds_read_b128 v[16:19], v2 offset:512
ds_read_b128 v[20:23], v2 offset:1024
ds_read_b128 v[24:27], v2 offset:1536
s_waitcnt lgkmcnt(3)
v_smfmac_f32_16x16x64_bf16 v[28:31], v[12:15], a[0:7], v0
v_smfmac_f32_16x16x64_bf16 v[32:35], v[12:15], a[136:143], v0
v_smfmac_f32_16x16x64_bf16 v[40:43], v[12:15], v[44:51], v0
ds_read_b128 v[12:15], v2 offset:2048
ds_read_b128 v[44:47], v3 offset:55296
s_waitcnt lgkmcnt(4)
v_smfmac_f32_16x16x64_bf16 v[28:31], v[16:19], a[8:15], v0
ds_read_b128 v[48:51], v3 offset:56320
v_smfmac_f32_16x16x64_bf16 v[32:35], v[16:19], a[144:151], v0
v_smfmac_f32_16x16x64_bf16 v[40:43], v[16:19], v[52:59], v0
ds_read_b128 v[16:19], v2 offset:2560
ds_read_b128 v[52:55], v3 offset:63488
s_waitcnt lgkmcnt(6)
v_smfmac_f32_16x16x64_bf16 v[28:31], v[20:23], a[16:23], v0
ds_read_b128 v[56:59], v3 offset:64512
v_smfmac_f32_16x16x64_bf16 v[32:35], v[20:23], a[152:159], v0
v_smfmac_f32_16x16x64_bf16 v[40:43], v[20:23], v[60:67], v0
ds_read_b128 v[20:23], v2 offset:3072
ds_read_b128 v[60:63], v4 offset:6144
s_waitcnt lgkmcnt(8)
v_smfmac_f32_16x16x64_bf16 v[28:31], v[24:27], a[24:31], v0
ds_read_b128 v[64:67], v4 offset:7168
v_smfmac_f32_16x16x64_bf16 v[32:35], v[24:27], a[160:167], v0
v_smfmac_f32_16x16x64_bf16 v[40:43], v[24:27], v[96:103], v0
ds_read_b128 v[24:27], v2 offset:3584
s_waitcnt lgkmcnt(7)
v_smfmac_f32_16x16x64_bf16 v[28:31], v[12:15], v[44:51], v0
ds_read_b128 v[44:47], v4 offset:14336
ds_read_b128 v[48:51], v4 offset:15360
v_smfmac_f32_16x16x64_bf16 v[32:35], v[12:15], a[168:175], v0
v_smfmac_f32_16x16x64_bf16 v[40:43], v[12:15], v[104:111], v0
ds_read_b128 v[12:15], v2 offset:4096
s_waitcnt lgkmcnt(9)
v_smfmac_f32_16x16x64_bf16 v[28:31], v[16:19], a[32:39], v0
s_waitcnt lgkmcnt(7)
v_smfmac_f32_16x16x64_bf16 v[32:35], v[16:19], v[52:59], v0
ds_read_b128 v[52:55], v4 offset:22528
ds_read_b128 v[56:59], v4 offset:23552
v_smfmac_f32_16x16x64_bf16 v[40:43], v[16:19], v[112:119], v0
ds_read_b128 v[16:19], v2 offset:4608
s_waitcnt lgkmcnt(9)
v_smfmac_f32_16x16x64_bf16 v[28:31], v[20:23], a[40:47], v0
v_smfmac_f32_16x16x64_bf16 v[32:35], v[20:23], a[176:183], v0
s_waitcnt lgkmcnt(6)
v_smfmac_f32_16x16x64_bf16 v[28:31], v[24:27], v[60:67], v0
ds_read_b128 v[60:63], v4 offset:30720
ds_read_b128 v[64:67], v4 offset:31744
v_smfmac_f32_16x16x64_bf16 v[32:35], v[24:27], a[184:191], v0
s_waitcnt lgkmcnt(5)
v_smfmac_f32_16x16x64_bf16 v[28:31], v[12:15], a[48:55], v0
v_smfmac_f32_16x16x64_bf16 v[32:35], v[12:15], a[192:199], v0
s_waitcnt lgkmcnt(2)
v_smfmac_f32_16x16x64_bf16 v[28:31], v[16:19], a[56:63], v0
v_smfmac_f32_16x16x64_bf16 v[32:35], v[16:19], v[44:51], v0
ds_read_b128 v[44:47], v1 offset:30720
ds_read_b128 v[48:51], v1 offset:31744
s_waitcnt lgkmcnt(0)
s_branch C_f3_mid
C_f3_wait:
C_f3_wl:
v_readlane_b32 s33, v7, 0
v_readlane_b32 s38, v7, 1
v_readlane_b32 s39, v7, 2
s_lshl_b32 s33, s33, 1
s_lshl_b32 s38, s38, 1
s_add_u32 s38, s38, 1
s_min_u32 s33, s33, s38
s_cmp_ge_u32 s33, 64
s_cselect_b32 s33, 0x100, s33
s_sub_u32 s59, s33, 1
s_cmp_eq_u32 s39, 1
s_cselect_b32 s38, 0x100, 8
s_min_i32 s59, s59, s38
s_cmp_gt_i32 s59, s18
s_cbranch_scc1 C_f3_wl_ok
s_add_u32 s57, s57, 1
s_cmp_gt_u32 s57, 0x40000
s_cbranch_scc1 C_fail
s_sleep 2
buffer_load_dword v7, v6, s[8:11], s5 offen sc1
s_waitcnt vmcnt(0)
s_branch C_f3_wl
C_f3_wl_ok:
s_branch C_f3_waited
C_f3_chkslow:
s_add_u32 s57, s57, 1
s_cmp_gt_u32 s57, 0x40000
s_cbranch_scc1 C_fail
buffer_load_dwordx4 v[68:71], v1, s[8:11], s37 offen offset:0 sc1
s_waitcnt vmcnt(1)
s_branch C_f3_chk
C_f3_rslow:
s_waitcnt vmcnt(0) lgkmcnt(0)
v_max3_u32 v10, v68, v69, v70
v_max_u32 v10, v10, v71
v_max3_u32 v10, v10, v72, v73
v_max3_u32 v10, v10, v74, v75
v_cmp_eq_u32 vcc, -1, v10
s_cbranch_vccz C_f3_rgot
s_add_u32 s57, s57, 1
s_cmp_gt_u32 s57, 0x40000
s_cbranch_scc1 C_fail
buffer_load_dwordx4 v[68:71], v1, s[8:11], s44 offen offset:2048 sc1
buffer_load_dwordx4 v[72:75], v1, s[8:11], s44 offen offset:3072 sc1
s_branch C_f3_rslow
C_f3_rgot:
ds_write_b128 v1, v[68:71] offset:7168
ds_write_b128 v1, v[72:75] offset:8192
s_waitcnt lgkmcnt(0)
s_branch C_f3_rok
C_f3_last:
s_waitcnt lgkmcnt(3)
v_smfmac_f32_16x16x64_bf16 v[40:43], v[12:15], v[144:151], v0
ds_read_b128 v[12:15], v2 offset:7168
s_waitcnt lgkmcnt(3)
v_smfmac_f32_16x16x64_bf16 v[40:43], v[16:19], v[152:159], v0
ds_read_b128 v[16:19], v2 offset:7680
s_waitcnt lgkmcnt(3)
v_smfmac_f32_16x16x64_bf16 v[40:43], v[20:23], v[160:167], v0
s_waitcnt lgkmcnt(2)
v_smfmac_f32_16x16x64_bf16 v[40:43], v[24:27], v[168:175], v0
s_waitcnt lgkmcnt(1)
v_smfmac_f32_16x16x64_bf16 v[40:43], v[12:15], v[176:183], v0
s_waitcnt lgkmcnt(0)
v_smfmac_f32_16x16x64_bf16 v[40:43], v[16:19], v[184:191], v0
s_nop 7
v_cvt_pk_bf16_f32 v78, v40, v41
v_cvt_pk_bf16_f32 v79, v42, v43
buffer_store_dwordx4 v[76:79], v1, s[48:51], s26 offen sc1
s_waitcnt vmcnt(0)
s_branch C_exit
C_slow:
s_cmp_eq_u32 s17, 1
s_cbranch_scc1 C_s1_in
s_cmp_eq_u32 s17, 2
s_cbranch_scc1 C_s2_in
s_cmp_eq_u32 s17, 3
s_cbranch_scc1 C_s3_in
C_s0_in:
s_add_u32 s25, s24, 16777216
s_add_u32 s24, s24, 262144
v_mov_b64 v[28:29], 0
v_mov_b64 v[30:31], 0
v_mov_b64 v[32:33], 0
v_mov_b64 v[34:35], 0
v_mov_b64 v[40:41], 0
v_mov_b64 v[42:43], 0
ds_read_b128 v[44:47], v3 offset:24576
ds_read_b128 v[48:51], v3 offset:25600
ds_read_b128 v[52:55], v3 offset:32768
ds_read_b128 v[56:59], v3 offset:33792
ds_read_b128 v[60:63], v3 offset:40960
ds_read_b128 v[64:67], v3 offset:41984
s_waitcnt lgkmcnt(0)
s_barrier
s_branch C_s0_first
C_s0:
s_nop 15
s_nop 3
buffer_load_dwordx4 v[68:71], v1, s[8:11], s37 offen offset:0 sc1
s_nop 15
s_nop 15
buffer_load_dwordx4 v[68:71], v1, s[8:11], s37 offen offset:0 sc1
s_waitcnt vmcnt(1)
C_s0_chk:
v_max3_u32 v10, v68, v69, v70
v_max_u32 v10, v10, v71
v_cmp_eq_u32 vcc, -1, v10
s_cbranch_vccnz C_s0_chkslow
ds_write_b128 v1, v[68:71] offset:0
buffer_store_dwordx4 v[36:39], v1, s[8:11], s45 offen offset:0 sc1
buffer_store_dword v36, v9, s[8:11], s21 offen sc1
s_mov_b32 s21, s34
s_waitcnt lgkmcnt(0)
buffer_load_dwordx4 v[68:71], v1, s[8:11], s44 offen offset:0 sc1
s_barrier
ds_read_b128 v[12:15], v2 offset:0
ds_read_b128 v[16:19], v2 offset:512
ds_read_b128 v[20:23], v2 offset:1024
ds_read_b128 v[24:27], v2 offset:1536
s_waitcnt lgkmcnt(3)
v_smfmac_f32_16x16x64_bf16 v[28:31], v[12:15], a[0:7], v0
v_smfmac_f32_16x16x64_bf16 v[32:35], v[12:15], a[136:143], v0
v_smfmac_f32_16x16x64_bf16 v[40:43], v[12:15], v[44:51], v0
ds_read_b128 v[12:15], v2 offset:2048
ds_read_b128 v[44:47], v3 offset:49152
s_waitcnt lgkmcnt(4)
v_smfmac_f32_16x16x64_bf16 v[28:31], v[16:19], a[8:15], v0
ds_read_b128 v[48:51], v3 offset:50176
v_smfmac_f32_16x16x64_bf16 v[32:35], v[16:19], a[144:151], v0
v_smfmac_f32_16x16x64_bf16 v[40:43], v[16:19], v[52:59], v0
ds_read_b128 v[16:19], v2 offset:2560
ds_read_b128 v[52:55], v3 offset:57344
s_waitcnt lgkmcnt(6)
v_smfmac_f32_16x16x64_bf16 v[28:31], v[20:23], a[16:23], v0
ds_read_b128 v[56:59], v3 offset:58368
v_smfmac_f32_16x16x64_bf16 v[32:35], v[20:23], a[152:159], v0
v_smfmac_f32_16x16x64_bf16 v[40:43], v[20:23], v[60:67], v0
ds_read_b128 v[20:23], v2 offset:3072
ds_read_b128 v[60:63], v4 offset:0
s_waitcnt lgkmcnt(8)
v_smfmac_f32_16x16x64_bf16 v[28:31], v[24:27], a[24:31], v0
ds_read_b128 v[64:67], v4 offset:1024
v_smfmac_f32_16x16x64_bf16 v[32:35], v[24:27], a[160:167], v0
v_smfmac_f32_16x16x64_bf16 v[40:43], v[24:27], v[96:103], v0
ds_read_b128 v[24:27], v2 offset:3584
s_waitcnt lgkmcnt(7)
v_smfmac_f32_16x16x64_bf16 v[28:31], v[12:15], v[44:51], v0
ds_read_b128 v[44:47], v4 offset:8192
ds_read_b128 v[48:51], v4 offset:9216
v_smfmac_f32_16x16x64_bf16 v[32:35], v[12:15], a[168:175], v0
v_smfmac_f32_16x16x64_bf16 v[40:43], v[12:15], v[104:111], v0
ds_read_b128 v[12:15], v2 offset:4096
s_waitcnt lgkmcnt(9)
v_smfmac_f32_16x16x64_bf16 v[28:31], v[16:19], a[32:39], v0
s_waitcnt lgkmcnt(7)
v_smfmac_f32_16x16x64_bf16 v[32:35], v[16:19], v[52:59], v0
ds_read_b128 v[52:55], v4 offset:16384
ds_read_b128 v[56:59], v4 offset:17408
v_smfmac_f32_16x16x64_bf16 v[40:43], v[16:19], v[112:119], v0
ds_read_b128 v[16:19], v2 offset:4608
s_waitcnt lgkmcnt(9)
v_smfmac_f32_16x16x64_bf16 v[28:31], v[20:23], a[40:47], v0
v_smfmac_f32_16x16x64_bf16 v[32:35], v[20:23], a[176:183], v0
s_waitcnt vmcnt(0)
v_max3_u32 v10, v68, v69, v70
s_waitcnt lgkmcnt(6)
v_smfmac_f32_16x16x64_bf16 v[28:31], v[24:27], v[60:67], v0
v_max_u32 v10, v10, v71
ds_write_b128 v1, v[68:71] offset:5120
v_smfmac_f32_16x16x64_bf16 v[32:35], v[24:27], a[184:191], v0
v_cmp_eq_u32 vcc, -1, v10
ds_read_b128 v[60:63], v4 offset:24576
s_waitcnt lgkmcnt(5)
v_smfmac_f32_16x16x64_bf16 v[28:31], v[12:15], a[48:55], v0
ds_read_b128 v[64:67], v4 offset:25600
v_smfmac_f32_16x16x64_bf16 v[32:35], v[12:15], a[192:199], v0
s_waitcnt lgkmcnt(3)
v_smfmac_f32_16x16x64_bf16 v[28:31], v[16:19], a[56:63], v0
v_smfmac_f32_16x16x64_bf16 v[32:35], v[16:19], v[44:51], v0
ds_read_b128 v[44:47], v1 offset:24576
ds_read_b128 v[48:51], v1 offset:25600
s_cbranch_vccnz C_s0_rslow
C_s0_rok:
s_waitcnt lgkmcnt(4)
s_barrier
C_s0_mid:
v_smfmac_f32_16x16x64_bf16 v[40:43], v[20:23], v[120:127], v0
ds_read_b128 v[20:23], v2 offset:5120
v_smfmac_f32_16x16x64_bf16 v[40:43], v[24:27], v[128:135], v0
ds_read_b128 v[24:27], v2 offset:5632
v_smfmac_f32_16x16x64_bf16 v[40:43], v[12:15], v[136:143], v0
ds_read_b128 v[12:15], v2 offset:6144
v_smfmac_f32_16x16x64_bf16 v[40:43], v[16:19], v[52:59], v0
ds_read_b128 v[16:19], v2 offset:6656
ds_read_b128 v[52:55], v1 offset:32768
s_waitcnt lgkmcnt(4)
v_smfmac_f32_16x16x64_bf16 v[28:31], v[20:23], a[64:71], v0
ds_read_b128 v[56:59], v1 offset:33792
buffer_load_dwordx4 v[80:83], v1, s[8:11], s25 offen offset:0 sc1
v_smfmac_f32_16x16x64_bf16 v[32:35], v[20:23], a[200:207], v0
ds_read_b128 v[20:23], v2 offset:7168
s_waitcnt lgkmcnt(5)
v_smfmac_f32_16x16x64_bf16 v[28:31], v[24:27], a[72:79], v0
buffer_load_dwordx4 v[84:87], v1, s[8:11], s25 offen offset:1024 sc1
v_smfmac_f32_16x16x64_bf16 v[32:35], v[24:27], v[60:67], v0
ds_read_b128 v[24:27], v2 offset:7680
s_waitcnt lgkmcnt(5)
v_smfmac_f32_16x16x64_bf16 v[28:31], v[12:15], a[80:87], v0
v_smfmac_f32_16x16x64_bf16 v[32:35], v[12:15], a[208:215], v0
ds_read_b128 v[12:15], v2 offset:8192
s_waitcnt lgkmcnt(5)
v_smfmac_f32_16x16x64_bf16 v[28:31], v[16:19], a[88:95], v0
v_smfmac_f32_16x16x64_bf16 v[32:35], v[16:19], v[44:51], v0
ds_read_b128 v[16:19], v2 offset:8704
s_waitcnt lgkmcnt(3)
v_smfmac_f32_16x16x64_bf16 v[28:31], v[20:23], a[96:103], v0
v_smfmac_f32_16x16x64_bf16 v[32:35], v[20:23], a[216:223], v0
ds_read_b128 v[20:23], v2 offset:9216
s_waitcnt lgkmcnt(3)
v_smfmac_f32_16x16x64_bf16 v[28:31], v[24:27], v[52:59], v0
v_smfmac_f32_16x16x64_bf16 v[32:35], v[24:27], a[224:231], v0
ds_read_b128 v[24:27], v2 offset:9728
s_waitcnt lgkmcnt(3)
v_smfmac_f32_16x16x64_bf16 v[28:31], v[12:15], a[104:111], v0
ds_read_b128 v[52:55], v1 offset:10240
ds_read_b128 v[56:59], v1 offset:11264
v_smfmac_f32_16x16x64_bf16 v[32:35], v[12:15], a[232:239], v0
ds_read_b128 v[68:71], v1 offset:12288
ds_read_b128 v[72:75], v1 offset:13312
s_waitcnt lgkmcnt(6)
v_smfmac_f32_16x16x64_bf16 v[28:31], v[16:19], a[112:119], v0
s_add_u32 s52, s19, 0
s_add_u32 s53, s19, 65536
s_waitcnt lgkmcnt(5)
v_smfmac_f32_16x16x64_bf16 v[28:31], v[20:23], a[120:127], v0
s_add_u32 s54, s19, 131072
s_xor_b32 s45, s45, s56
s_waitcnt lgkmcnt(4)
v_smfmac_f32_16x16x64_bf16 v[28:31], v[24:27], a[128:135], v0
v_smfmac_f32_16x16x64_bf16 v[32:35], v[16:19], a[240:247], v0
v_smfmac_f32_16x16x64_bf16 v[32:35], v[20:23], a[248:255], v0
v_cvt_pk_bf16_f32 v36, v28, v29
v_smfmac_f32_16x16x64_bf16 v[32:35], v[24:27], v[88:95], v0
v_cvt_pk_bf16_f32 v37, v30, v31
ds_write_b64 v6, v[36:37] offset:18432
v_smfmac_f32_16x16x64_bf16 v[40:43], v[12:15], v[192:199], v0
s_cmp_eq_u32 s18, 63
v_smfmac_f32_16x16x64_bf16 v[40:43], v[16:19], v[200:207], v0
v_cvt_pk_bf16_f32 v76, v32, v33
v_cvt_pk_bf16_f32 v77, v34, v35
ds_write_b64 v6, v[76:77] offset:20480
v_smfmac_f32_16x16x64_bf16 v[40:43], v[20:23], v[208:215], v0
ds_read_b128 v[12:15], v2 offset:5120
ds_read_b128 v[16:19], v2 offset:5632
v_smfmac_f32_16x16x64_bf16 v[40:43], v[24:27], v[216:223], v0
ds_read_b128 v[20:23], v2 offset:6144
ds_read_b128 v[24:27], v2 offset:6656
s_cbranch_scc1 C_s0_last
s_waitcnt lgkmcnt(4)
s_barrier
ds_read_b64_tr_b16 v[44:45], v5 offset:18432
ds_read_b64_tr_b16 v[46:47], v5 offset:18688
ds_read_b64_tr_b16 v[48:49], v5 offset:20480
ds_read_b64_tr_b16 v[50:51], v5 offset:20736
s_waitcnt lgkmcnt(7)
v_smfmac_f32_16x16x64_bf16 v[40:43], v[12:15], v[144:151], v0
ds_read_b64_tr_b16 v[60:61], v5 offset:18944
ds_read_b64_tr_b16 v[62:63], v5 offset:19200
s_waitcnt lgkmcnt(8)
v_smfmac_f32_16x16x64_bf16 v[40:43], v[16:19], v[152:159], v0
ds_read_b64_tr_b16 v[64:65], v5 offset:20992
ds_read_b64_tr_b16 v[66:67], v5 offset:21248
s_waitcnt lgkmcnt(9)
v_smfmac_f32_16x16x64_bf16 v[40:43], v[20:23], v[160:167], v0
ds_read_b64_tr_b16 v[12:13], v5 offset:19456
ds_read_b64_tr_b16 v[14:15], v5 offset:19712
ds_read_b64_tr_b16 v[16:17], v5 offset:21504
s_waitcnt lgkmcnt(11)
v_smfmac_f32_16x16x64_bf16 v[40:43], v[24:27], v[168:175], v0
ds_read_b64_tr_b16 v[18:19], v5 offset:21760
ds_read_b128 v[20:23], v1 offset:14336
ds_read_b128 v[24:27], v1 offset:15360
s_waitcnt lgkmcnt(12)
v_mfma_f32_16x16x32_bf16 v[28:31], v[52:55], v[44:47], 0
ds_read_b128 v[52:55], v1 offset:16384
v_mfma_f32_16x16x32_bf16 v[32:35], v[56:59], v[44:47], 0
ds_read_b128 v[56:59], v1 offset:17408
s_waitcnt lgkmcnt(12)
v_mfma_f32_16x16x32_bf16 v[36:39], v[48:51], v[44:47], 0
ds_read_b64_tr_b16 v[44:45], v5 offset:19968
ds_read_b64_tr_b16 v[46:47], v5 offset:20224
s_waitcnt lgkmcnt(12)
v_mfma_f32_16x16x32_bf16 v[28:31], v[68:71], v[60:63], v[28:31]
ds_read_b64_tr_b16 v[48:49], v5 offset:22016
ds_read_b64_tr_b16 v[50:51], v5 offset:22272
v_mfma_f32_16x16x32_bf16 v[32:35], v[72:75], v[60:63], v[32:35]
s_waitcnt lgkmcnt(12)
v_mfma_f32_16x16x32_bf16 v[36:39], v[64:67], v[60:63], v[36:39]
s_waitcnt lgkmcnt(7)
v_mfma_f32_16x16x32_bf16 v[28:31], v[20:23], v[12:15], v[28:31]
ds_read_b128 v[20:23], v2 offset:7168
v_mov_b64 v[60:61], s[40:41]
s_waitcnt lgkmcnt(7)
v_mfma_f32_16x16x32_bf16 v[32:35], v[24:27], v[12:15], v[32:35]
ds_read_b128 v[24:27], v2 offset:7680
v_mov_b64 v[62:63], s[40:41]
v_mfma_f32_16x16x32_bf16 v[36:39], v[16:19], v[12:15], v[36:39]
v_mov_b64 v[64:65], s[42:43]
s_waitcnt lgkmcnt(4)
v_mfma_f32_16x16x32_bf16 v[28:31], v[52:55], v[44:47], v[28:31]
v_mfma_f32_16x16x32_bf16 v[32:35], v[56:59], v[44:47], v[32:35]
s_waitcnt lgkmcnt(2)
v_mfma_f32_16x16x32_bf16 v[36:39], v[48:51], v[44:47], v[36:39]
s_waitcnt lgkmcnt(1)
v_smfmac_f32_16x16x64_bf16 v[40:43], v[20:23], v[176:183], v0
v_max3_f32 v10, v28, v29, v30
s_waitcnt lgkmcnt(0)
v_smfmac_f32_16x16x64_bf16 v[40:43], v[24:27], v[184:191], v0
v_max3_f32 v11, v31, v32, v33
v_max3_f32 v10, v10, v34, v35
v_max3_f32 v11, v11, v36, v37
v_max3_f32 v10, v10, v38, v39
v_max_f32 v10, v10, v11
v_mov_b32 v11, v10
s_nop 1
v_cvt_pk_bf16_f32 v78, v40, v41
v_cvt_pk_bf16_f32 v79, v42, v43
v_permlane32_swap_b32 v10, v11
v_max_f32 v10, v10, v11
v_mov_b32 v11, v10
buffer_store_dwordx4 v[76:79], v1, s[48:51], s26 offen sc1
v_cndmask_b32 v58, 0, v78, s[30:31]
v_cndmask_b32 v59, 0, v79, s[30:31]
v_permlane16_swap_b32 v10, v11
v_max_f32 v10, v10, v11
v_mul_f32 v10, s29, v10
v_pk_fma_f32 v[28:29], v[28:29], s[28:29], v[10:11] op_sel_hi:[1,0,0]
v_pk_fma_f32 v[30:31], v[30:31], s[28:29], v[10:11] op_sel_hi:[1,0,0]
v_pk_fma_f32 v[32:33], v[32:33], s[28:29], v[10:11] op_sel_hi:[1,0,0]
v_pk_fma_f32 v[34:35], v[34:35], s[28:29], v[10:11] op_sel_hi:[1,0,0]
v_exp_f32 v28, v28
v_exp_f32 v29, v29
v_exp_f32 v30, v30
v_exp_f32 v31, v31
v_exp_f32 v32, v32
v_exp_f32 v33, v33
v_exp_f32 v34, v34
v_exp_f32 v35, v35
v_cvt_pk_bf16_f32 v52, v28, v29
v_cvt_pk_bf16_f32 v53, v30, v31
v_cvt_pk_bf16_f32 v54, v32, v33
v_cvt_pk_bf16_f32 v55, v34, v35
v_fma_f32 v36, v36, s28, v10
v_fma_f32 v37, v37, s28, v10
v_mfma_f32_16x16x32_bf16 v[16:19], v[60:63], v[52:55], 0
v_fma_f32 v38, v38, s28, v10
v_fma_f32 v39, v39, s28, v10
s_waitcnt vmcnt(2)
v_mfma_f32_16x16x32_bf16 v[28:31], v[80:83], v[52:55], 0
v_exp_f32 v36, v36
s_waitcnt vmcnt(1)
v_mfma_f32_16x16x32_bf16 v[32:35], v[84:87], v[52:55], 0
v_exp_f32 v37, v37
v_exp_f32 v38, v38
v_exp_f32 v39, v39
v_cvt_pk_bf16_f32 v56, v36, v37
v_cvt_pk_bf16_f32 v57, v38, v39
v_cndmask_b32 v74, v78, 0, s[30:31]
v_cndmask_b32 v75, v79, 0, s[30:31]
v_mfma_f32_16x16x16_bf16 v[16:19], v[64:65], v[56:57], v[16:19]
v_mov_b64 v[40:41], 0
v_mov_b64 v[42:43], 0
v_mfma_f32_16x16x16_bf16 v[28:31], v[58:59], v[56:57], v[28:31]
v_mov_b64 v[36:37], 0
v_mov_b64 v[38:39], 0
v_mfma_f32_16x16x16_bf16 v[32:35], v[74:75], v[56:57], v[32:35]
s_nop 1
v_rcp_f32 v10, v16
ds_read_b128 v[44:47], v1 offset:40960
ds_read_b128 v[48:51], v1 offset:41984
v_pk_mul_f32 v[28:29], v[28:29], v[10:11] op_sel_hi:[1,0]
v_pk_mul_f32 v[30:31], v[30:31], v[10:11] op_sel_hi:[1,0]
s_nop 0
v_pk_mul_f32 v[32:33], v[32:33], v[10:11] op_sel_hi:[1,0]
v_pk_mul_f32 v[34:35], v[34:35], v[10:11] op_sel_hi:[1,0]
v_cvt_pk_bf16_f32 v12, v28, v32
v_cvt_pk_bf16_f32 v13, v29, v33
v_cvt_pk_bf16_f32 v14, v30, v34
v_cvt_pk_bf16_f32 v15, v31, v35
ds_write_b128 v2, v[12:15] offset:22528
ds_read_b128 v[52:55], v3 offset:8192
ds_read_b128 v[56:59], v3 offset:9216
ds_read_b128 v[60:63], v3 offset:16384
ds_read_b128 v[64:67], v3 offset:17408
ds_read_b128 v[68:71], v3 offset:12288
ds_read_b128 v[72:75], v3 offset:13312
v_mov_b64 v[28:29], 0
v_mov_b64 v[30:31], 0
v_smfmac_f32_16x16x64_bf16 v[36:39], v[12:15], v[224:231], v0
s_waitcnt lgkmcnt(6)
s_barrier
ds_read_b128 v[16:19], v2 offset:23040
ds_read_b128 v[20:23], v2 offset:23552
ds_read_b128 v[24:27], v2 offset:24064
v_smfmac_f32_16x16x64_bf16 v[40:43], v[12:15], v[44:51], v0
ds_read_b128 v[44:47], v3 offset:20480
ds_read_b128 v[48:51], v3 offset:21504
s_waitcnt lgkmcnt(9)
v_smfmac_f32_16x16x64_bf16 v[28:31], v[12:15], v[52:59], v0
ds_read_b128 v[52:55], v1 offset:49152
ds_read_b128 v[56:59], v1 offset:50176
s_waitcnt lgkmcnt(6)
v_smfmac_f32_16x16x64_bf16 v[28:31], v[16:19], v[60:67], v0
ds_read_b128 v[60:63], v1 offset:57344
ds_read_b128 v[64:67], v1 offset:58368
s_waitcnt lgkmcnt(7)
v_smfmac_f32_16x16x64_bf16 v[28:31], v[20:23], v[68:75], v0
ds_read_b128 v[68:71], v3 offset:0
ds_read_b128 v[72:75], v3 offset:1024
s_waitcnt lgkmcnt(6)
v_smfmac_f32_16x16x64_bf16 v[28:31], v[24:27], v[44:51], v0
v_smfmac_f32_16x16x64_bf16 v[36:39], v[16:19], v[232:239], v0
v_smfmac_f32_16x16x64_bf16 v[36:39], v[20:23], v[240:247], v0
v_cvt_pk_bf16_f32 v10, v28, v29
v_smfmac_f32_16x16x64_bf16 v[36:39], v[24:27], v[248:255], v0
v_cvt_pk_bf16_f32 v11, v30, v31
buffer_store_dwordx2 v[10:11], v8, s[8:11], s54 offen sc1
s_waitcnt lgkmcnt(4)
v_smfmac_f32_16x16x64_bf16 v[40:43], v[16:19], v[52:59], v0
s_waitcnt lgkmcnt(2)
v_smfmac_f32_16x16x64_bf16 v[40:43], v[20:23], v[60:67], v0
v_cvt_pk_bf16_f32 v10, v36, v37
s_waitcnt lgkmcnt(0)
v_smfmac_f32_16x16x64_bf16 v[40:43], v[24:27], v[68:75], v0
v_cvt_pk_bf16_f32 v11, v38, v39
buffer_store_dwordx2 v[10:11], v8, s[8:11], s53 offen sc1
v_bfe_u32 v65, v2, 4, 3
v_and_b32 v66, 1, v65
v_lshlrev_b32 v66, 4, v66
v_lshrrev_b32 v65, 1, v65
v_mov_b32 v64, 0x3f80
v_lshlrev_b32 v66, v66, v64
v_cvt_pk_bf16_f32 v10, v40, v41
v_cvt_pk_bf16_f32 v11, v42, v43
buffer_store_dwordx2 v[10:11], v8, s[8:11], s52 offen sc1
v_cmp_eq_u32 vcc, 0, v65
s_nop 1
v_cndmask_b32 v60, 0, v66, vcc
v_cmp_eq_u32 vcc, 1, v65
s_nop 1
v_cndmask_b32 v61, 0, v66, vcc
v_cmp_eq_u32 vcc, 2, v65
s_nop 1
v_cndmask_b32 v62, 0, v66, vcc
v_cmp_eq_u32 vcc, 3, v65
s_nop 1
v_cndmask_b32 v63, 0, v66, vcc
v_mov_b64 v[28:29], 0
v_mov_b64 v[30:31], 0
v_mov_b64 v[32:33], 0
v_mov_b64 v[34:35], 0
v_mov_b64 v[40:41], 0
v_mov_b64 v[42:43], 0
v_mov_b64 v[36:37], -1
v_mov_b64 v[38:39], -1
s_add_u32 s18, s18, 1
s_xor_b32 s19, s19, 163840
s_add_u32 s26, s26, 131072
s_xor_b32 s44, s27, 0x202000
s_add_u32 s25, s24, 16777216
s_add_u32 s24, s24, 262144
s_mov_b32 s35, s27
s_mov_b32 s36, 0
s_nop 15
s_nop 15
s_nop 4
buffer_load_dwordx4 v[44:47], v1, s[8:11], s45 offen offset:0 sc1
buffer_load_dwordx4 v[48:51], v1, s[8:11], s45 offen offset:1024 sc1
buffer_load_dwordx4 v[52:55], v1, s[8:11], s45 offen offset:2048 sc1
buffer_load_dwordx4 v[56:59], v1, s[8:11], s45 offen offset:3072 sc1
s_nop 15
s_nop 15
C_s0_red:
buffer_load_dwordx4 v[44:47], v1, s[8:11], s45 offen offset:0 sc1
buffer_load_dwordx4 v[48:51], v1, s[8:11], s45 offen offset:1024 sc1
buffer_load_dwordx4 v[52:55], v1, s[8:11], s45 offen offset:2048 sc1
buffer_load_dwordx4 v[56:59], v1, s[8:11], s45 offen offset:3072 sc1
s_waitcnt vmcnt(7)
v_mfma_f32_16x16x32_bf16 v[64:67], v[44:47], v[60:63], 0
s_waitcnt vmcnt(6)
v_mfma_f32_16x16x32_bf16 v[64:67], v[48:51], v[60:63], v[64:67]
s_waitcnt vmcnt(5)
v_mfma_f32_16x16x32_bf16 v[64:67], v[52:55], v[60:63], v[64:67]
s_waitcnt vmcnt(4)
v_mfma_f32_16x16x32_bf16 v[64:67], v[56:59], v[60:63], v[64:67]
s_nop 7
v_permlane32_swap_b32 v64, v66
v_permlane32_swap_b32 v65, v67
v_add_f32 v64, v64, v66
v_add_f32 v65, v65, v67
v_cmp_u_f32 vcc, v64, v65
v_cvt_pk_bf16_f32 v72, v64, v65
s_cbranch_vccnz C_s0_redslow
C_s0_redok:
buffer_store_dword v72, v9, s[8:11], s20 offen sc1
s_barrier
buffer_store_dword v72, v9, s[8:11], s35 offen sc1
s_add_u32 s37, s20, 0
s_mov_b32 s34, s20
s_add_u32 s4, s4, 32768
s_lshr_b32 s32, s4, 5
s_and_b32 s32, s32, 0x4000
s_lshr_b32 s27, s4, 8
s_and_b32 s27, s27, 0x2000
s_or_b32 s32, s32, s27
s_xor_b32 s32, s32, s47
s_add_u32 s27, s4, s32
s_add_u32 s20, s20, 8192
s_sub_u32 s32, s20, s46
s_cmp_eq_u32 s32, 24576
s_cselect_b32 s20, s46, s20
s_waitcnt vmcnt(5)
ds_read_b128 v[44:47], v3 offset:24576
s_waitcnt vmcnt(4)
ds_read_b128 v[48:51], v3 offset:25600
s_waitcnt vmcnt(3)
ds_read_b128 v[52:55], v3 offset:32768
s_waitcnt vmcnt(2)
ds_read_b128 v[56:59], v3 offset:33792
ds_read_b128 v[60:63], v3 offset:40960
ds_read_b128 v[64:67], v3 offset:41984
s_branch C_s0
C_s0_first:
ds_read_b128 v[12:15], v2 offset:0
ds_read_b128 v[16:19], v2 offset:512
ds_read_b128 v[20:23], v2 offset:1024
ds_read_b128 v[24:27], v2 offset:1536
s_waitcnt lgkmcnt(3)
v_smfmac_f32_16x16x64_bf16 v[28:31], v[12:15], a[0:7], v0
v_smfmac_f32_16x16x64_bf16 v[32:35], v[12:15], a[136:143], v0
v_smfmac_f32_16x16x64_bf16 v[40:43], v[12:15], v[44:51], v0
ds_read_b128 v[12:15], v2 offset:2048
ds_read_b128 v[44:47], v3 offset:49152
s_waitcnt lgkmcnt(4)
v_smfmac_f32_16x16x64_bf16 v[28:31], v[16:19], a[8:15], v0
ds_read_b128 v[48:51], v3 offset:50176
v_smfmac_f32_16x16x64_bf16 v[32:35], v[16:19], a[144:151], v0
v_smfmac_f32_16x16x64_bf16 v[40:43], v[16:19], v[52:59], v0
ds_read_b128 v[16:19], v2 offset:2560
ds_read_b128 v[52:55], v3 offset:57344
s_waitcnt lgkmcnt(6)
v_smfmac_f32_16x16x64_bf16 v[28:31], v[20:23], a[16:23], v0
ds_read_b128 v[56:59], v3 offset:58368
v_smfmac_f32_16x16x64_bf16 v[32:35], v[20:23], a[152:159], v0
v_smfmac_f32_16x16x64_bf16 v[40:43], v[20:23], v[60:67], v0
ds_read_b128 v[20:23], v2 offset:3072
ds_read_b128 v[60:63], v4 offset:0
s_waitcnt lgkmcnt(8)
v_smfmac_f32_16x16x64_bf16 v[28:31], v[24:27], a[24:31], v0
ds_read_b128 v[64:67], v4 offset:1024
v_smfmac_f32_16x16x64_bf16 v[32:35], v[24:27], a[160:167], v0
v_smfmac_f32_16x16x64_bf16 v[40:43], v[24:27], v[96:103], v0
ds_read_b128 v[24:27], v2 offset:3584
s_waitcnt lgkmcnt(7)
v_smfmac_f32_16x16x64_bf16 v[28:31], v[12:15], v[44:51], v0
ds_read_b128 v[44:47], v4 offset:8192
ds_read_b128 v[48:51], v4 offset:9216
v_smfmac_f32_16x16x64_bf16 v[32:35], v[12:15], a[168:175], v0
v_smfmac_f32_16x16x64_bf16 v[40:43], v[12:15], v[104:111], v0
ds_read_b128 v[12:15], v2 offset:4096
s_waitcnt lgkmcnt(9)
v_smfmac_f32_16x16x64_bf16 v[28:31], v[16:19], a[32:39], v0
s_waitcnt lgkmcnt(7)
v_smfmac_f32_16x16x64_bf16 v[32:35], v[16:19], v[52:59], v0
ds_read_b128 v[52:55], v4 offset:16384
ds_read_b128 v[56:59], v4 offset:17408
v_smfmac_f32_16x16x64_bf16 v[40:43], v[16:19], v[112:119], v0
ds_read_b128 v[16:19], v2 offset:4608
s_waitcnt lgkmcnt(9)
v_smfmac_f32_16x16x64_bf16 v[28:31], v[20:23], a[40:47], v0
v_smfmac_f32_16x16x64_bf16 v[32:35], v[20:23], a[176:183], v0
s_waitcnt lgkmcnt(6)
v_smfmac_f32_16x16x64_bf16 v[28:31], v[24:27], v[60:67], v0
ds_read_b128 v[60:63], v4 offset:24576
ds_read_b128 v[64:67], v4 offset:25600
v_smfmac_f32_16x16x64_bf16 v[32:35], v[24:27], a[184:191], v0
s_waitcnt lgkmcnt(5)
v_smfmac_f32_16x16x64_bf16 v[28:31], v[12:15], a[48:55], v0
v_smfmac_f32_16x16x64_bf16 v[32:35], v[12:15], a[192:199], v0
s_waitcnt lgkmcnt(2)
v_smfmac_f32_16x16x64_bf16 v[28:31], v[16:19], a[56:63], v0
v_smfmac_f32_16x16x64_bf16 v[32:35], v[16:19], v[44:51], v0
ds_read_b128 v[44:47], v1 offset:24576
ds_read_b128 v[48:51], v1 offset:25600
s_waitcnt lgkmcnt(0)
s_branch C_s0_mid
C_s0_redslow:
s_add_u32 s36, s36, 1
s_and_b32 s32, s36, 7
s_cmp_lg_u32 s32, 0
s_cbranch_scc1 C_s0_red
s_add_u32 s57, s57, 1
s_cmp_gt_u32 s57, 0x40000
s_cbranch_scc1 C_fail
s_waitcnt vmcnt(0)
v_max3_u32 v10, v44, v45, v46
v_max_u32 v10, v10, v47
v_max3_u32 v10, v10, v48, v49
v_max3_u32 v10, v10, v50, v51
v_max3_u32 v10, v10, v52, v53
v_max3_u32 v10, v10, v54, v55
v_max3_u32 v10, v10, v56, v57
v_max3_u32 v10, v10, v58, v59
v_cmp_eq_u32 vcc, -1, v10
s_cbranch_vccz C_s0_redsum
buffer_load_dwordx4 v[44:47], v1, s[8:11], s45 offen offset:0 sc1
buffer_load_dwordx4 v[48:51], v1, s[8:11], s45 offen offset:1024 sc1
buffer_load_dwordx4 v[52:55], v1, s[8:11], s45 offen offset:2048 sc1
buffer_load_dwordx4 v[56:59], v1, s[8:11], s45 offen offset:3072 sc1
s_branch C_s0_red
C_s0_redsum:
v_mfma_f32_16x16x32_bf16 v[64:67], v[44:47], v[60:63], 0
v_mfma_f32_16x16x32_bf16 v[64:67], v[48:51], v[60:63], v[64:67]
v_mfma_f32_16x16x32_bf16 v[64:67], v[52:55], v[60:63], v[64:67]
v_mfma_f32_16x16x32_bf16 v[64:67], v[56:59], v[60:63], v[64:67]
s_nop 7
v_permlane32_swap_b32 v64, v66
v_permlane32_swap_b32 v65, v67
v_add_f32 v64, v64, v66
v_add_f32 v65, v65, v67
v_cvt_pk_bf16_f32 v72, v64, v65
v_min_u32 v72, -2, v72
s_branch C_s0_redok
C_s0_chkslow:
s_add_u32 s57, s57, 1
s_cmp_gt_u32 s57, 0x40000
s_cbranch_scc1 C_fail
buffer_load_dwordx4 v[68:71], v1, s[8:11], s37 offen offset:0 sc1
s_waitcnt vmcnt(1)
s_branch C_s0_chk
C_s0_rslow:
s_waitcnt vmcnt(0) lgkmcnt(0)
v_max3_u32 v10, v68, v69, v70
v_max_u32 v10, v10, v71
v_cmp_eq_u32 vcc, -1, v10
s_cbranch_vccz C_s0_rgot
s_add_u32 s57, s57, 1
s_cmp_gt_u32 s57, 0x40000
s_cbranch_scc1 C_fail
buffer_load_dwordx4 v[68:71], v1, s[8:11], s44 offen offset:0 sc1
s_branch C_s0_rslow
C_s0_rgot:
ds_write_b128 v1, v[68:71] offset:5120
s_waitcnt lgkmcnt(0)
s_branch C_s0_rok
C_s0_last:
s_waitcnt lgkmcnt(3)
v_smfmac_f32_16x16x64_bf16 v[40:43], v[12:15], v[144:151], v0
ds_read_b128 v[12:15], v2 offset:7168
s_waitcnt lgkmcnt(3)
v_smfmac_f32_16x16x64_bf16 v[40:43], v[16:19], v[152:159], v0
ds_read_b128 v[16:19], v2 offset:7680
s_waitcnt lgkmcnt(3)
v_smfmac_f32_16x16x64_bf16 v[40:43], v[20:23], v[160:167], v0
s_waitcnt lgkmcnt(2)
v_smfmac_f32_16x16x64_bf16 v[40:43], v[24:27], v[168:175], v0
s_waitcnt lgkmcnt(1)
v_smfmac_f32_16x16x64_bf16 v[40:43], v[12:15], v[176:183], v0
s_waitcnt lgkmcnt(0)
v_smfmac_f32_16x16x64_bf16 v[40:43], v[16:19], v[184:191], v0
s_nop 7
v_cvt_pk_bf16_f32 v78, v40, v41
v_cvt_pk_bf16_f32 v79, v42, v43
buffer_store_dwordx4 v[76:79], v1, s[48:51], s26 offen sc1
s_waitcnt vmcnt(0)
s_branch C_exit
C_s1_in:
s_add_u32 s25, s24, 16779264
s_add_u32 s24, s24, 262144
v_mov_b64 v[28:29], 0
v_mov_b64 v[30:31], 0
v_mov_b64 v[32:33], 0
v_mov_b64 v[34:35], 0
v_mov_b64 v[40:41], 0
v_mov_b64 v[42:43], 0
ds_read_b128 v[44:47], v3 offset:26624
ds_read_b128 v[48:51], v3 offset:27648
ds_read_b128 v[52:55], v3 offset:34816
ds_read_b128 v[56:59], v3 offset:35840
ds_read_b128 v[60:63], v3 offset:43008
ds_read_b128 v[64:67], v3 offset:44032
s_waitcnt lgkmcnt(0)
s_barrier
s_branch C_s1_first
C_s1:
s_nop 15
s_nop 3
buffer_load_dwordx4 v[68:71], v1, s[8:11], s37 offen offset:0 sc1
s_nop 15
s_nop 15
buffer_load_dwordx4 v[68:71], v1, s[8:11], s37 offen offset:0 sc1
s_waitcnt vmcnt(1)
C_s1_chk:
v_max3_u32 v10, v68, v69, v70
v_max_u32 v10, v10, v71
v_cmp_eq_u32 vcc, -1, v10
s_cbranch_vccnz C_s1_chkslow
ds_write_b128 v1, v[68:71] offset:1024
buffer_store_dwordx4 v[36:39], v1, s[8:11], s45 offen offset:1024 sc1
buffer_store_dwordx4 v[36:39], v7, s[8:11], s55 offen sc1
buffer_store_dword v36, v9, s[8:11], s21 offen sc1
s_mov_b32 s21, s34
s_waitcnt lgkmcnt(0)
buffer_load_dwordx4 v[68:71], v1, s[8:11], s44 offen offset:1024 sc1
s_barrier
ds_read_b128 v[12:15], v2 offset:0
ds_read_b128 v[16:19], v2 offset:512
ds_read_b128 v[20:23], v2 offset:1024
ds_read_b128 v[24:27], v2 offset:1536
s_waitcnt lgkmcnt(3)
v_smfmac_f32_16x16x64_bf16 v[28:31], v[12:15], a[0:7], v0
v_smfmac_f32_16x16x64_bf16 v[32:35], v[12:15], a[136:143], v0
v_smfmac_f32_16x16x64_bf16 v[40:43], v[12:15], v[44:51], v0
ds_read_b128 v[12:15], v2 offset:2048
ds_read_b128 v[44:47], v3 offset:51200
s_waitcnt lgkmcnt(4)
v_smfmac_f32_16x16x64_bf16 v[28:31], v[16:19], a[8:15], v0
ds_read_b128 v[48:51], v3 offset:52224
v_smfmac_f32_16x16x64_bf16 v[32:35], v[16:19], a[144:151], v0
v_smfmac_f32_16x16x64_bf16 v[40:43], v[16:19], v[52:59], v0
ds_read_b128 v[16:19], v2 offset:2560
ds_read_b128 v[52:55], v3 offset:59392
s_waitcnt lgkmcnt(6)
v_smfmac_f32_16x16x64_bf16 v[28:31], v[20:23], a[16:23], v0
ds_read_b128 v[56:59], v3 offset:60416
v_smfmac_f32_16x16x64_bf16 v[32:35], v[20:23], a[152:159], v0
v_smfmac_f32_16x16x64_bf16 v[40:43], v[20:23], v[60:67], v0
ds_read_b128 v[20:23], v2 offset:3072
ds_read_b128 v[60:63], v4 offset:2048
s_waitcnt lgkmcnt(8)
v_smfmac_f32_16x16x64_bf16 v[28:31], v[24:27], a[24:31], v0
ds_read_b128 v[64:67], v4 offset:3072
v_smfmac_f32_16x16x64_bf16 v[32:35], v[24:27], a[160:167], v0
v_smfmac_f32_16x16x64_bf16 v[40:43], v[24:27], v[96:103], v0
ds_read_b128 v[24:27], v2 offset:3584
s_waitcnt lgkmcnt(7)
v_smfmac_f32_16x16x64_bf16 v[28:31], v[12:15], v[44:51], v0
ds_read_b128 v[44:47], v4 offset:10240
ds_read_b128 v[48:51], v4 offset:11264
v_smfmac_f32_16x16x64_bf16 v[32:35], v[12:15], a[168:175], v0
v_smfmac_f32_16x16x64_bf16 v[40:43], v[12:15], v[104:111], v0
ds_read_b128 v[12:15], v2 offset:4096
s_waitcnt lgkmcnt(9)
v_smfmac_f32_16x16x64_bf16 v[28:31], v[16:19], a[32:39], v0
s_waitcnt lgkmcnt(7)
v_smfmac_f32_16x16x64_bf16 v[32:35], v[16:19], v[52:59], v0
ds_read_b128 v[52:55], v4 offset:18432
ds_read_b128 v[56:59], v4 offset:19456
v_smfmac_f32_16x16x64_bf16 v[40:43], v[16:19], v[112:119], v0
ds_read_b128 v[16:19], v2 offset:4608
s_waitcnt lgkmcnt(9)
v_smfmac_f32_16x16x64_bf16 v[28:31], v[20:23], a[40:47], v0
v_smfmac_f32_16x16x64_bf16 v[32:35], v[20:23], a[176:183], v0
s_waitcnt vmcnt(0)
v_max3_u32 v10, v68, v69, v70
s_waitcnt lgkmcnt(6)
v_smfmac_f32_16x16x64_bf16 v[28:31], v[24:27], v[60:67], v0
v_max_u32 v10, v10, v71
ds_write_b128 v1, v[68:71] offset:6144
v_smfmac_f32_16x16x64_bf16 v[32:35], v[24:27], a[184:191], v0
v_cmp_eq_u32 vcc, -1, v10
ds_read_b128 v[60:63], v4 offset:26624
s_waitcnt lgkmcnt(5)
v_smfmac_f32_16x16x64_bf16 v[28:31], v[12:15], a[48:55], v0
ds_read_b128 v[64:67], v4 offset:27648
v_smfmac_f32_16x16x64_bf16 v[32:35], v[12:15], a[192:199], v0
s_waitcnt lgkmcnt(3)
v_smfmac_f32_16x16x64_bf16 v[28:31], v[16:19], a[56:63], v0
v_smfmac_f32_16x16x64_bf16 v[32:35], v[16:19], v[44:51], v0
ds_read_b128 v[44:47], v1 offset:26624
ds_read_b128 v[48:51], v1 offset:27648
s_cbranch_vccnz C_s1_rslow
C_s1_rok:
s_waitcnt lgkmcnt(4)
s_barrier
C_s1_mid:
v_smfmac_f32_16x16x64_bf16 v[40:43], v[20:23], v[120:127], v0
ds_read_b128 v[20:23], v2 offset:5120
v_smfmac_f32_16x16x64_bf16 v[40:43], v[24:27], v[128:135], v0
ds_read_b128 v[24:27], v2 offset:5632
v_smfmac_f32_16x16x64_bf16 v[40:43], v[12:15], v[136:143], v0
ds_read_b128 v[12:15], v2 offset:6144
v_smfmac_f32_16x16x64_bf16 v[40:43], v[16:19], v[52:59], v0
ds_read_b128 v[16:19], v2 offset:6656
ds_read_b128 v[52:55], v1 offset:34816
s_waitcnt lgkmcnt(4)
v_smfmac_f32_16x16x64_bf16 v[28:31], v[20:23], a[64:71], v0
ds_read_b128 v[56:59], v1 offset:35840
buffer_load_dwordx4 v[80:83], v1, s[8:11], s25 offen offset:0 sc1
v_smfmac_f32_16x16x64_bf16 v[32:35], v[20:23], a[200:207], v0
ds_read_b128 v[20:23], v2 offset:7168
s_waitcnt lgkmcnt(5)
v_smfmac_f32_16x16x64_bf16 v[28:31], v[24:27], a[72:79], v0
buffer_load_dwordx4 v[84:87], v1, s[8:11], s25 offen offset:1024 sc1
v_smfmac_f32_16x16x64_bf16 v[32:35], v[24:27], v[60:67], v0
ds_read_b128 v[24:27], v2 offset:7680
s_waitcnt lgkmcnt(5)
v_smfmac_f32_16x16x64_bf16 v[28:31], v[12:15], a[80:87], v0
v_smfmac_f32_16x16x64_bf16 v[32:35], v[12:15], a[208:215], v0
ds_read_b128 v[12:15], v2 offset:8192
s_waitcnt lgkmcnt(5)
v_smfmac_f32_16x16x64_bf16 v[28:31], v[16:19], a[88:95], v0
v_smfmac_f32_16x16x64_bf16 v[32:35], v[16:19], v[44:51], v0
ds_read_b128 v[16:19], v2 offset:8704
s_waitcnt lgkmcnt(3)
v_smfmac_f32_16x16x64_bf16 v[28:31], v[20:23], a[96:103], v0
v_smfmac_f32_16x16x64_bf16 v[32:35], v[20:23], a[216:223], v0
ds_read_b128 v[20:23], v2 offset:9216
s_waitcnt lgkmcnt(3)
v_smfmac_f32_16x16x64_bf16 v[28:31], v[24:27], v[52:59], v0
v_smfmac_f32_16x16x64_bf16 v[32:35], v[24:27], a[224:231], v0
ds_read_b128 v[24:27], v2 offset:9728
s_waitcnt lgkmcnt(3)
v_smfmac_f32_16x16x64_bf16 v[28:31], v[12:15], a[104:111], v0
ds_read_b128 v[52:55], v1 offset:10240
ds_read_b128 v[56:59], v1 offset:11264
v_smfmac_f32_16x16x64_bf16 v[32:35], v[12:15], a[232:239], v0
ds_read_b128 v[68:71], v1 offset:12288
ds_read_b128 v[72:75], v1 offset:13312
s_waitcnt lgkmcnt(6)
v_smfmac_f32_16x16x64_bf16 v[28:31], v[16:19], a[112:119], v0
s_add_u32 s52, s19, 16384
s_add_u32 s53, s19, 81920
s_waitcnt lgkmcnt(5)
v_smfmac_f32_16x16x64_bf16 v[28:31], v[20:23], a[120:127], v0
s_add_u32 s54, s19, 147456
s_xor_b32 s45, s45, s56
s_waitcnt lgkmcnt(4)
v_smfmac_f32_16x16x64_bf16 v[28:31], v[24:27], a[128:135], v0
s_xor_b32 s55, s55, s58
v_smfmac_f32_16x16x64_bf16 v[32:35], v[16:19], a[240:247], v0
v_smfmac_f32_16x16x64_bf16 v[32:35], v[20:23], a[248:255], v0
v_cvt_pk_bf16_f32 v36, v28, v29
v_smfmac_f32_16x16x64_bf16 v[32:35], v[24:27], v[88:95], v0
v_cvt_pk_bf16_f32 v37, v30, v31
ds_write_b64 v6, v[36:37] offset:18944
v_smfmac_f32_16x16x64_bf16 v[40:43], v[12:15], v[192:199], v0
s_cmp_eq_u32 s18, 63
v_smfmac_f32_16x16x64_bf16 v[40:43], v[16:19], v[200:207], v0
v_cvt_pk_bf16_f32 v76, v32, v33
v_cvt_pk_bf16_f32 v77, v34, v35
ds_write_b64 v6, v[76:77] offset:20992
v_smfmac_f32_16x16x64_bf16 v[40:43], v[20:23], v[208:215], v0
ds_read_b128 v[12:15], v2 offset:5120
ds_read_b128 v[16:19], v2 offset:5632
v_smfmac_f32_16x16x64_bf16 v[40:43], v[24:27], v[216:223], v0
ds_read_b128 v[20:23], v2 offset:6144
ds_read_b128 v[24:27], v2 offset:6656
s_cbranch_scc1 C_s1_last
s_waitcnt lgkmcnt(4)
s_barrier
ds_read_b64_tr_b16 v[44:45], v5 offset:18432
ds_read_b64_tr_b16 v[46:47], v5 offset:18688
ds_read_b64_tr_b16 v[48:49], v5 offset:20480
ds_read_b64_tr_b16 v[50:51], v5 offset:20736
s_waitcnt lgkmcnt(7)
v_smfmac_f32_16x16x64_bf16 v[40:43], v[12:15], v[144:151], v0
ds_read_b64_tr_b16 v[60:61], v5 offset:18944
ds_read_b64_tr_b16 v[62:63], v5 offset:19200
s_waitcnt lgkmcnt(8)
v_smfmac_f32_16x16x64_bf16 v[40:43], v[16:19], v[152:159], v0
ds_read_b64_tr_b16 v[64:65], v5 offset:20992
ds_read_b64_tr_b16 v[66:67], v5 offset:21248
s_waitcnt lgkmcnt(9)
v_smfmac_f32_16x16x64_bf16 v[40:43], v[20:23], v[160:167], v0
ds_read_b64_tr_b16 v[12:13], v5 offset:19456
ds_read_b64_tr_b16 v[14:15], v5 offset:19712
ds_read_b64_tr_b16 v[16:17], v5 offset:21504
s_waitcnt lgkmcnt(11)
v_smfmac_f32_16x16x64_bf16 v[40:43], v[24:27], v[168:175], v0
ds_read_b64_tr_b16 v[18:19], v5 offset:21760
ds_read_b128 v[20:23], v1 offset:14336
ds_read_b128 v[24:27], v1 offset:15360
s_waitcnt lgkmcnt(12)
v_mfma_f32_16x16x32_bf16 v[28:31], v[52:55], v[44:47], 0
ds_read_b128 v[52:55], v1 offset:16384
v_mfma_f32_16x16x32_bf16 v[32:35], v[56:59], v[44:47], 0
ds_read_b128 v[56:59], v1 offset:17408
s_waitcnt lgkmcnt(12)
v_mfma_f32_16x16x32_bf16 v[36:39], v[48:51], v[44:47], 0
ds_read_b64_tr_b16 v[44:45], v5 offset:19968
ds_read_b64_tr_b16 v[46:47], v5 offset:20224
s_waitcnt lgkmcnt(12)
v_mfma_f32_16x16x32_bf16 v[28:31], v[68:71], v[60:63], v[28:31]
ds_read_b64_tr_b16 v[48:49], v5 offset:22016
ds_read_b64_tr_b16 v[50:51], v5 offset:22272
v_mfma_f32_16x16x32_bf16 v[32:35], v[72:75], v[60:63], v[32:35]
s_waitcnt lgkmcnt(12)
v_mfma_f32_16x16x32_bf16 v[36:39], v[64:67], v[60:63], v[36:39]
s_waitcnt lgkmcnt(7)
v_mfma_f32_16x16x32_bf16 v[28:31], v[20:23], v[12:15], v[28:31]
ds_read_b128 v[20:23], v2 offset:7168
v_mov_b64 v[60:61], s[40:41]
s_waitcnt lgkmcnt(7)
v_mfma_f32_16x16x32_bf16 v[32:35], v[24:27], v[12:15], v[32:35]
ds_read_b128 v[24:27], v2 offset:7680
v_mov_b64 v[62:63], s[40:41]
v_mfma_f32_16x16x32_bf16 v[36:39], v[16:19], v[12:15], v[36:39]
v_mov_b64 v[64:65], s[42:43]
s_waitcnt lgkmcnt(4)
v_mfma_f32_16x16x32_bf16 v[28:31], v[52:55], v[44:47], v[28:31]
v_mfma_f32_16x16x32_bf16 v[32:35], v[56:59], v[44:47], v[32:35]
s_waitcnt lgkmcnt(2)
v_mfma_f32_16x16x32_bf16 v[36:39], v[48:51], v[44:47], v[36:39]
s_waitcnt lgkmcnt(1)
v_smfmac_f32_16x16x64_bf16 v[40:43], v[20:23], v[176:183], v0
v_max3_f32 v10, v28, v29, v30
s_waitcnt lgkmcnt(0)
v_smfmac_f32_16x16x64_bf16 v[40:43], v[24:27], v[184:191], v0
v_max3_f32 v11, v31, v32, v33
v_max3_f32 v10, v10, v34, v35
v_max3_f32 v11, v11, v36, v37
v_max3_f32 v10, v10, v38, v39
v_max_f32 v10, v10, v11
v_mov_b32 v11, v10
s_nop 1
v_cvt_pk_bf16_f32 v78, v40, v41
v_cvt_pk_bf16_f32 v79, v42, v43
v_permlane32_swap_b32 v10, v11
v_max_f32 v10, v10, v11
v_mov_b32 v11, v10
buffer_store_dwordx4 v[76:79], v1, s[48:51], s26 offen sc1
v_cndmask_b32 v58, 0, v78, s[30:31]
v_cndmask_b32 v59, 0, v79, s[30:31]
v_permlane16_swap_b32 v10, v11
v_max_f32 v10, v10, v11
v_mul_f32 v10, s29, v10
v_pk_fma_f32 v[28:29], v[28:29], s[28:29], v[10:11] op_sel_hi:[1,0,0]
v_pk_fma_f32 v[30:31], v[30:31], s[28:29], v[10:11] op_sel_hi:[1,0,0]
v_pk_fma_f32 v[32:33], v[32:33], s[28:29], v[10:11] op_sel_hi:[1,0,0]
v_pk_fma_f32 v[34:35], v[34:35], s[28:29], v[10:11] op_sel_hi:[1,0,0]
v_exp_f32 v28, v28
v_exp_f32 v29, v29
v_exp_f32 v30, v30
v_exp_f32 v31, v31
v_exp_f32 v32, v32
v_exp_f32 v33, v33
v_exp_f32 v34, v34
v_exp_f32 v35, v35
v_cvt_pk_bf16_f32 v52, v28, v29
v_cvt_pk_bf16_f32 v53, v30, v31
v_cvt_pk_bf16_f32 v54, v32, v33
v_cvt_pk_bf16_f32 v55, v34, v35
v_fma_f32 v36, v36, s28, v10
v_fma_f32 v37, v37, s28, v10
v_mfma_f32_16x16x32_bf16 v[20:23], v[60:63], v[52:55], 0
v_fma_f32 v38, v38, s28, v10
v_fma_f32 v39, v39, s28, v10
s_waitcnt vmcnt(2)
v_mfma_f32_16x16x32_bf16 v[28:31], v[80:83], v[52:55], 0
v_exp_f32 v36, v36
s_waitcnt vmcnt(1)
v_mfma_f32_16x16x32_bf16 v[32:35], v[84:87], v[52:55], 0
v_exp_f32 v37, v37
v_exp_f32 v38, v38
v_exp_f32 v39, v39
v_cvt_pk_bf16_f32 v56, v36, v37
v_cvt_pk_bf16_f32 v57, v38, v39
v_cndmask_b32 v74, v78, 0, s[30:31]
v_cndmask_b32 v75, v79, 0, s[30:31]
v_mfma_f32_16x16x16_bf16 v[20:23], v[64:65], v[56:57], v[20:23]
v_mov_b64 v[40:41], 0
v_mov_b64 v[42:43], 0
v_mfma_f32_16x16x16_bf16 v[28:31], v[58:59], v[56:57], v[28:31]
v_mov_b64 v[36:37], 0
v_mov_b64 v[38:39], 0
v_mfma_f32_16x16x16_bf16 v[32:35], v[74:75], v[56:57], v[32:35]
s_nop 1
v_rcp_f32 v10, v20
ds_read_b128 v[44:47], v1 offset:51200
ds_read_b128 v[48:51], v1 offset:52224
v_pk_mul_f32 v[28:29], v[28:29], v[10:11] op_sel_hi:[1,0]
v_pk_mul_f32 v[30:31], v[30:31], v[10:11] op_sel_hi:[1,0]
s_nop 0
v_pk_mul_f32 v[32:33], v[32:33], v[10:11] op_sel_hi:[1,0]
v_pk_mul_f32 v[34:35], v[34:35], v[10:11] op_sel_hi:[1,0]
v_cvt_pk_bf16_f32 v16, v28, v32
v_cvt_pk_bf16_f32 v17, v29, v33
v_cvt_pk_bf16_f32 v18, v30, v34
v_cvt_pk_bf16_f32 v19, v31, v35
ds_write_b128 v2, v[16:19] offset:23040
ds_read_b128 v[52:55], v3 offset:18432
ds_read_b128 v[56:59], v3 offset:19456
ds_read_b128 v[60:63], v3 offset:10240
ds_read_b128 v[64:67], v3 offset:11264
ds_read_b128 v[68:71], v3 offset:14336
ds_read_b128 v[72:75], v3 offset:15360
v_mov_b64 v[28:29], 0
v_mov_b64 v[30:31], 0
v_smfmac_f32_16x16x64_bf16 v[36:39], v[16:19], v[232:239], v0
s_waitcnt lgkmcnt(6)
s_barrier
ds_read_b128 v[12:15], v2 offset:22528
ds_read_b128 v[20:23], v2 offset:23552
ds_read_b128 v[24:27], v2 offset:24064
v_smfmac_f32_16x16x64_bf16 v[40:43], v[16:19], v[44:51], v0
ds_read_b128 v[44:47], v3 offset:22528
ds_read_b128 v[48:51], v3 offset:23552
s_waitcnt lgkmcnt(9)
v_smfmac_f32_16x16x64_bf16 v[28:31], v[16:19], v[52:59], v0
ds_read_b128 v[52:55], v1 offset:43008
ds_read_b128 v[56:59], v1 offset:44032
s_waitcnt lgkmcnt(6)
v_smfmac_f32_16x16x64_bf16 v[28:31], v[12:15], v[60:67], v0
ds_read_b128 v[60:63], v1 offset:59392
ds_read_b128 v[64:67], v1 offset:60416
s_waitcnt lgkmcnt(7)
v_smfmac_f32_16x16x64_bf16 v[28:31], v[20:23], v[68:75], v0
ds_read_b128 v[68:71], v3 offset:2048
ds_read_b128 v[72:75], v3 offset:3072
s_waitcnt lgkmcnt(6)
v_smfmac_f32_16x16x64_bf16 v[28:31], v[24:27], v[44:51], v0
v_smfmac_f32_16x16x64_bf16 v[36:39], v[12:15], v[224:231], v0
v_smfmac_f32_16x16x64_bf16 v[36:39], v[20:23], v[240:247], v0
v_cvt_pk_bf16_f32 v10, v28, v29
v_smfmac_f32_16x16x64_bf16 v[36:39], v[24:27], v[248:255], v0
v_cvt_pk_bf16_f32 v11, v30, v31
buffer_store_dwordx2 v[10:11], v8, s[8:11], s54 offen sc1
s_waitcnt lgkmcnt(4)
v_smfmac_f32_16x16x64_bf16 v[40:43], v[12:15], v[52:59], v0
s_waitcnt lgkmcnt(2)
v_smfmac_f32_16x16x64_bf16 v[40:43], v[20:23], v[60:67], v0
v_cvt_pk_bf16_f32 v10, v36, v37
s_waitcnt lgkmcnt(0)
v_smfmac_f32_16x16x64_bf16 v[40:43], v[24:27], v[68:75], v0
v_cvt_pk_bf16_f32 v11, v38, v39
buffer_store_dwordx2 v[10:11], v8, s[8:11], s53 offen sc1
v_bfe_u32 v65, v2, 4, 3
v_and_b32 v66, 1, v65
v_lshlrev_b32 v66, 4, v66
v_lshrrev_b32 v65, 1, v65
v_mov_b32 v64, 0x3f80
v_lshlrev_b32 v66, v66, v64
v_cvt_pk_bf16_f32 v10, v40, v41
v_cvt_pk_bf16_f32 v11, v42, v43
buffer_store_dwordx2 v[10:11], v8, s[8:11], s52 offen sc1
v_cmp_eq_u32 vcc, 0, v65
s_nop 1
v_cndmask_b32 v60, 0, v66, vcc
v_cmp_eq_u32 vcc, 1, v65
s_nop 1
v_cndmask_b32 v61, 0, v66, vcc
v_cmp_eq_u32 vcc, 2, v65
s_nop 1
v_cndmask_b32 v62, 0, v66, vcc
v_cmp_eq_u32 vcc, 3, v65
s_nop 1
v_cndmask_b32 v63, 0, v66, vcc
v_mov_b64 v[28:29], 0
v_mov_b64 v[30:31], 0
v_mov_b64 v[32:33], 0
v_mov_b64 v[34:35], 0
v_mov_b64 v[40:41], 0
v_mov_b64 v[42:43], 0
v_mov_b64 v[36:37], -1
v_mov_b64 v[38:39], -1
s_add_u32 s18, s18, 1
s_xor_b32 s19, s19, 163840
s_add_u32 s26, s26, 131072
s_xor_b32 s44, s27, 0x202000
s_add_u32 s25, s24, 16779264
s_add_u32 s24, s24, 262144
v_lshrrev_b32 v11, 1, v6
s_lshl_b32 s35, s16, 7
s_add_u32 s35, s35, 4096
s_add_u32 s35, s35, s27
s_mov_b32 s36, 0
s_nop 11
buffer_load_dwordx4 v[44:47], v7, s[8:11], s55 offen offset:0 sc1
s_nop 15
s_nop 15
C_s1_red:
buffer_load_dwordx4 v[44:47], v7, s[8:11], s55 offen offset:0 sc1
s_waitcnt vmcnt(1)
v_mfma_f32_16x16x32_bf16 v[64:67], v[44:47], v[60:63], 0
s_nop 7
v_add_f32 v64, v64, v66
v_add_f32 v65, v65, v67
v_mov_b64 v[66:67], v[64:65]
s_nop 1
v_permlane32_swap_b32 v64, v66
v_permlane32_swap_b32 v65, v67
v_add_f32 v64, v64, v66
v_add_f32 v65, v65, v67
v_mov_b64 v[66:67], v[64:65]
s_nop 1
v_permlane16_swap_b32 v64, v66
v_permlane16_swap_b32 v65, v67
v_add_f32 v64, v64, v66
v_add_f32 v65, v65, v67
v_cmp_u_f32 vcc, v64, v65
v_cvt_pk_bf16_f32 v72, v64, v65
s_cbranch_vccnz C_s1_redslow
C_s1_redok:
buffer_store_dword v72, v9, s[8:11], s20 offen sc1
s_barrier
s_mov_b64 exec, 0xff
buffer_store_dword v72, v11, s[8:11], s35 offen sc1
s_mov_b64 exec, -1
s_add_u32 s37, s20, 1024
s_mov_b32 s34, s20
s_add_u32 s4, s4, 32768
s_lshr_b32 s32, s4, 5
s_and_b32 s32, s32, 0x4000
s_lshr_b32 s27, s4, 8
s_and_b32 s27, s27, 0x2000
s_or_b32 s32, s32, s27
s_xor_b32 s32, s32, s47
s_add_u32 s27, s4, s32
s_add_u32 s20, s20, 8192
s_sub_u32 s32, s20, s46
s_cmp_eq_u32 s32, 24576
s_cselect_b32 s20, s46, s20
s_waitcnt vmcnt(2)
ds_read_b128 v[44:47], v3 offset:26624
ds_read_b128 v[48:51], v3 offset:27648
ds_read_b128 v[52:55], v3 offset:34816
ds_read_b128 v[56:59], v3 offset:35840
ds_read_b128 v[60:63], v3 offset:43008
ds_read_b128 v[64:67], v3 offset:44032
s_branch C_s1
C_s1_first:
ds_read_b128 v[12:15], v2 offset:0
ds_read_b128 v[16:19], v2 offset:512
ds_read_b128 v[20:23], v2 offset:1024
ds_read_b128 v[24:27], v2 offset:1536
s_waitcnt lgkmcnt(3)
v_smfmac_f32_16x16x64_bf16 v[28:31], v[12:15], a[0:7], v0
v_smfmac_f32_16x16x64_bf16 v[32:35], v[12:15], a[136:143], v0
v_smfmac_f32_16x16x64_bf16 v[40:43], v[12:15], v[44:51], v0
ds_read_b128 v[12:15], v2 offset:2048
ds_read_b128 v[44:47], v3 offset:51200
s_waitcnt lgkmcnt(4)
v_smfmac_f32_16x16x64_bf16 v[28:31], v[16:19], a[8:15], v0
ds_read_b128 v[48:51], v3 offset:52224
v_smfmac_f32_16x16x64_bf16 v[32:35], v[16:19], a[144:151], v0
v_smfmac_f32_16x16x64_bf16 v[40:43], v[16:19], v[52:59], v0
ds_read_b128 v[16:19], v2 offset:2560
ds_read_b128 v[52:55], v3 offset:59392
s_waitcnt lgkmcnt(6)
v_smfmac_f32_16x16x64_bf16 v[28:31], v[20:23], a[16:23], v0
ds_read_b128 v[56:59], v3 offset:60416
v_smfmac_f32_16x16x64_bf16 v[32:35], v[20:23], a[152:159], v0
v_smfmac_f32_16x16x64_bf16 v[40:43], v[20:23], v[60:67], v0
ds_read_b128 v[20:23], v2 offset:3072
ds_read_b128 v[60:63], v4 offset:2048
s_waitcnt lgkmcnt(8)
v_smfmac_f32_16x16x64_bf16 v[28:31], v[24:27], a[24:31], v0
ds_read_b128 v[64:67], v4 offset:3072
v_smfmac_f32_16x16x64_bf16 v[32:35], v[24:27], a[160:167], v0
v_smfmac_f32_16x16x64_bf16 v[40:43], v[24:27], v[96:103], v0
ds_read_b128 v[24:27], v2 offset:3584
s_waitcnt lgkmcnt(7)
v_smfmac_f32_16x16x64_bf16 v[28:31], v[12:15], v[44:51], v0
ds_read_b128 v[44:47], v4 offset:10240
ds_read_b128 v[48:51], v4 offset:11264
v_smfmac_f32_16x16x64_bf16 v[32:35], v[12:15], a[168:175], v0
v_smfmac_f32_16x16x64_bf16 v[40:43], v[12:15], v[104:111], v0
ds_read_b128 v[12:15], v2 offset:4096
s_waitcnt lgkmcnt(9)
v_smfmac_f32_16x16x64_bf16 v[28:31], v[16:19], a[32:39], v0
s_waitcnt lgkmcnt(7)
v_smfmac_f32_16x16x64_bf16 v[32:35], v[16:19], v[52:59], v0
ds_read_b128 v[52:55], v4 offset:18432
ds_read_b128 v[56:59], v4 offset:19456
v_smfmac_f32_16x16x64_bf16 v[40:43], v[16:19], v[112:119], v0
ds_read_b128 v[16:19], v2 offset:4608
s_waitcnt lgkmcnt(9)
v_smfmac_f32_16x16x64_bf16 v[28:31], v[20:23], a[40:47], v0
v_smfmac_f32_16x16x64_bf16 v[32:35], v[20:23], a[176:183], v0
s_waitcnt lgkmcnt(6)
v_smfmac_f32_16x16x64_bf16 v[28:31], v[24:27], v[60:67], v0
ds_read_b128 v[60:63], v4 offset:26624
ds_read_b128 v[64:67], v4 offset:27648
v_smfmac_f32_16x16x64_bf16 v[32:35], v[24:27], a[184:191], v0
s_waitcnt lgkmcnt(5)
v_smfmac_f32_16x16x64_bf16 v[28:31], v[12:15], a[48:55], v0
v_smfmac_f32_16x16x64_bf16 v[32:35], v[12:15], a[192:199], v0
s_waitcnt lgkmcnt(2)
v_smfmac_f32_16x16x64_bf16 v[28:31], v[16:19], a[56:63], v0
v_smfmac_f32_16x16x64_bf16 v[32:35], v[16:19], v[44:51], v0
ds_read_b128 v[44:47], v1 offset:26624
ds_read_b128 v[48:51], v1 offset:27648
s_waitcnt lgkmcnt(0)
s_branch C_s1_mid
C_s1_redslow:
s_add_u32 s36, s36, 1
s_and_b32 s32, s36, 7
s_cmp_lg_u32 s32, 0
s_cbranch_scc1 C_s1_red
s_add_u32 s57, s57, 1
s_cmp_gt_u32 s57, 0x40000
s_cbranch_scc1 C_fail
s_waitcnt vmcnt(0)
v_max3_u32 v10, v44, v45, v46
v_max_u32 v10, v10, v47
v_cmp_eq_u32 vcc, -1, v10
s_cbranch_vccz C_s1_redsum
buffer_load_dwordx4 v[44:47], v7, s[8:11], s55 offen offset:0 sc1
s_branch C_s1_red
C_s1_redsum:
v_mfma_f32_16x16x32_bf16 v[64:67], v[44:47], v[60:63], 0
s_nop 7
v_add_f32 v64, v64, v66
v_add_f32 v65, v65, v67
v_mov_b64 v[66:67], v[64:65]
s_nop 1
v_permlane32_swap_b32 v64, v66
v_permlane32_swap_b32 v65, v67
v_add_f32 v64, v64, v66
v_add_f32 v65, v65, v67
v_mov_b64 v[66:67], v[64:65]
s_nop 1
v_permlane16_swap_b32 v64, v66
v_permlane16_swap_b32 v65, v67
v_add_f32 v64, v64, v66
v_add_f32 v65, v65, v67
v_cvt_pk_bf16_f32 v72, v64, v65
v_min_u32 v72, -2, v72
s_branch C_s1_redok
C_s1_chkslow:
s_add_u32 s57, s57, 1
s_cmp_gt_u32 s57, 0x40000
s_cbranch_scc1 C_fail
buffer_load_dwordx4 v[68:71], v1, s[8:11], s37 offen offset:0 sc1
s_waitcnt vmcnt(1)
s_branch C_s1_chk
C_s1_rslow:
s_waitcnt vmcnt(0) lgkmcnt(0)
v_max3_u32 v10, v68, v69, v70
v_max_u32 v10, v10, v71
v_cmp_eq_u32 vcc, -1, v10
s_cbranch_vccz C_s1_rgot
s_add_u32 s57, s57, 1
s_cmp_gt_u32 s57, 0x40000
s_cbranch_scc1 C_fail
buffer_load_dwordx4 v[68:71], v1, s[8:11], s44 offen offset:1024 sc1
s_branch C_s1_rslow
C_s1_rgot:
ds_write_b128 v1, v[68:71] offset:6144
s_waitcnt lgkmcnt(0)
s_branch C_s1_rok
C_s1_last:
s_waitcnt lgkmcnt(3)
v_smfmac_f32_16x16x64_bf16 v[40:43], v[12:15], v[144:151], v0
ds_read_b128 v[12:15], v2 offset:7168
s_waitcnt lgkmcnt(3)
v_smfmac_f32_16x16x64_bf16 v[40:43], v[16:19], v[152:159], v0
ds_read_b128 v[16:19], v2 offset:7680
s_waitcnt lgkmcnt(3)
v_smfmac_f32_16x16x64_bf16 v[40:43], v[20:23], v[160:167], v0
s_waitcnt lgkmcnt(2)
v_smfmac_f32_16x16x64_bf16 v[40:43], v[24:27], v[168:175], v0
s_waitcnt lgkmcnt(1)
v_smfmac_f32_16x16x64_bf16 v[40:43], v[12:15], v[176:183], v0
s_waitcnt lgkmcnt(0)
v_smfmac_f32_16x16x64_bf16 v[40:43], v[16:19], v[184:191], v0
s_nop 7
v_cvt_pk_bf16_f32 v78, v40, v41
v_cvt_pk_bf16_f32 v79, v42, v43
buffer_store_dwordx4 v[76:79], v1, s[48:51], s26 offen sc1
s_waitcnt vmcnt(0)
s_branch C_exit
C_s2_in:
s_add_u32 s25, s24, 16781312
s_add_u32 s24, s24, 262144
v_mov_b64 v[28:29], 0
v_mov_b64 v[30:31], 0
v_mov_b64 v[32:33], 0
v_mov_b64 v[34:35], 0
v_mov_b64 v[40:41], 0
v_mov_b64 v[42:43], 0
ds_read_b128 v[44:47], v3 offset:28672
ds_read_b128 v[48:51], v3 offset:29696
ds_read_b128 v[52:55], v3 offset:36864
ds_read_b128 v[56:59], v3 offset:37888
ds_read_b128 v[60:63], v3 offset:45056
ds_read_b128 v[64:67], v3 offset:46080
s_waitcnt lgkmcnt(0)
s_barrier
s_branch C_s2_first
C_s2:
s_nop 15
s_nop 13
buffer_load_dwordx4 v[68:71], v1, s[8:11], s37 offen offset:0 sc1
buffer_load_dwordx4 v[72:75], v1, s[8:11], s37 offen offset:1024 sc1
s_nop 15
s_nop 15
buffer_load_dwordx4 v[68:71], v1, s[8:11], s37 offen offset:0 sc1
buffer_load_dwordx4 v[72:75], v1, s[8:11], s37 offen offset:1024 sc1
s_waitcnt vmcnt(2)
C_s2_chk:
v_max3_u32 v10, v68, v69, v70
v_max_u32 v10, v10, v71
v_max3_u32 v10, v10, v72, v73
v_max3_u32 v10, v10, v74, v75
v_cmp_eq_u32 vcc, -1, v10
s_cbranch_vccnz C_s2_chkslow
ds_write_b128 v1, v[68:71] offset:2048
ds_write_b128 v1, v[72:75] offset:3072
buffer_store_dwordx4 v[36:39], v1, s[8:11], s45 offen offset:2048 sc1
s_mov_b32 s21, s34
s_waitcnt lgkmcnt(0)
s_add_u32 s33, s44, 4096
buffer_load_dwordx4 v[68:71], v7, s[8:11], s33 offen sc1
s_barrier
ds_read_b128 v[12:15], v2 offset:0
ds_read_b128 v[16:19], v2 offset:512
ds_read_b128 v[20:23], v2 offset:1024
ds_read_b128 v[24:27], v2 offset:1536
s_waitcnt lgkmcnt(3)
v_smfmac_f32_16x16x64_bf16 v[28:31], v[12:15], a[0:7], v0
v_smfmac_f32_16x16x64_bf16 v[32:35], v[12:15], a[136:143], v0
v_smfmac_f32_16x16x64_bf16 v[40:43], v[12:15], v[44:51], v0
ds_read_b128 v[12:15], v2 offset:2048
ds_read_b128 v[44:47], v3 offset:53248
s_waitcnt lgkmcnt(4)
v_smfmac_f32_16x16x64_bf16 v[28:31], v[16:19], a[8:15], v0
ds_read_b128 v[48:51], v3 offset:54272
v_smfmac_f32_16x16x64_bf16 v[32:35], v[16:19], a[144:151], v0
v_smfmac_f32_16x16x64_bf16 v[40:43], v[16:19], v[52:59], v0
ds_read_b128 v[16:19], v2 offset:2560
ds_read_b128 v[52:55], v3 offset:61440
s_waitcnt lgkmcnt(6)
v_smfmac_f32_16x16x64_bf16 v[28:31], v[20:23], a[16:23], v0
ds_read_b128 v[56:59], v3 offset:62464
v_smfmac_f32_16x16x64_bf16 v[32:35], v[20:23], a[152:159], v0
v_smfmac_f32_16x16x64_bf16 v[40:43], v[20:23], v[60:67], v0
ds_read_b128 v[20:23], v2 offset:3072
ds_read_b128 v[60:63], v4 offset:4096
s_waitcnt lgkmcnt(8)
v_smfmac_f32_16x16x64_bf16 v[28:31], v[24:27], a[24:31], v0
ds_read_b128 v[64:67], v4 offset:5120
v_smfmac_f32_16x16x64_bf16 v[32:35], v[24:27], a[160:167], v0
v_smfmac_f32_16x16x64_bf16 v[40:43], v[24:27], v[96:103], v0
ds_read_b128 v[24:27], v2 offset:3584
s_waitcnt lgkmcnt(7)
v_smfmac_f32_16x16x64_bf16 v[28:31], v[12:15], v[44:51], v0
ds_read_b128 v[44:47], v4 offset:12288
ds_read_b128 v[48:51], v4 offset:13312
v_smfmac_f32_16x16x64_bf16 v[32:35], v[12:15], a[168:175], v0
v_smfmac_f32_16x16x64_bf16 v[40:43], v[12:15], v[104:111], v0
ds_read_b128 v[12:15], v2 offset:4096
s_waitcnt lgkmcnt(9)
v_smfmac_f32_16x16x64_bf16 v[28:31], v[16:19], a[32:39], v0
s_waitcnt lgkmcnt(7)
v_smfmac_f32_16x16x64_bf16 v[32:35], v[16:19], v[52:59], v0
ds_read_b128 v[52:55], v4 offset:20480
ds_read_b128 v[56:59], v4 offset:21504
v_smfmac_f32_16x16x64_bf16 v[40:43], v[16:19], v[112:119], v0
ds_read_b128 v[16:19], v2 offset:4608
s_waitcnt lgkmcnt(9)
v_smfmac_f32_16x16x64_bf16 v[28:31], v[20:23], a[40:47], v0
v_smfmac_f32_16x16x64_bf16 v[32:35], v[20:23], a[176:183], v0
s_waitcnt vmcnt(0)
v_max3_u32 v10, v68, v69, v70
s_waitcnt lgkmcnt(6)
v_smfmac_f32_16x16x64_bf16 v[28:31], v[24:27], v[60:67], v0
v_max_u32 v10, v10, v71
ds_write_b32 v9, v68 offset:9216
v_smfmac_f32_16x16x64_bf16 v[32:35], v[24:27], a[184:191], v0
ds_write_b32 v9, v69 offset:9232
ds_write_b32 v9, v70 offset:9248
s_waitcnt lgkmcnt(6)
v_smfmac_f32_16x16x64_bf16 v[28:31], v[12:15], a[48:55], v0
ds_write_b32 v9, v71 offset:9264
v_cmp_eq_u32 vcc, -1, v10
v_smfmac_f32_16x16x64_bf16 v[32:35], v[12:15], a[192:199], v0
ds_read_b128 v[60:63], v4 offset:28672
ds_read_b128 v[64:67], v4 offset:29696
s_waitcnt lgkmcnt(6)
v_smfmac_f32_16x16x64_bf16 v[28:31], v[16:19], a[56:63], v0
v_smfmac_f32_16x16x64_bf16 v[32:35], v[16:19], v[44:51], v0
ds_read_b128 v[44:47], v1 offset:28672
ds_read_b128 v[48:51], v1 offset:29696
s_cbranch_vccnz C_s2_rslow
C_s2_rok:
s_waitcnt lgkmcnt(4)
s_barrier
C_s2_mid:
v_smfmac_f32_16x16x64_bf16 v[40:43], v[20:23], v[120:127], v0
ds_read_b128 v[20:23], v2 offset:5120
v_smfmac_f32_16x16x64_bf16 v[40:43], v[24:27], v[128:135], v0
ds_read_b128 v[24:27], v2 offset:5632
v_smfmac_f32_16x16x64_bf16 v[40:43], v[12:15], v[136:143], v0
ds_read_b128 v[12:15], v2 offset:6144
v_smfmac_f32_16x16x64_bf16 v[40:43], v[16:19], v[52:59], v0
ds_read_b128 v[16:19], v2 offset:6656
ds_read_b128 v[52:55], v1 offset:36864
s_waitcnt lgkmcnt(4)
v_smfmac_f32_16x16x64_bf16 v[28:31], v[20:23], a[64:71], v0
ds_read_b128 v[56:59], v1 offset:37888
v_mov_b32 v11, s18
v_smfmac_f32_16x16x64_bf16 v[32:35], v[20:23], a[200:207], v0
ds_read_b128 v[20:23], v2 offset:7168
buffer_load_dwordx4 v[80:83], v1, s[8:11], s25 offen offset:0 sc1
s_waitcnt lgkmcnt(5)
v_smfmac_f32_16x16x64_bf16 v[28:31], v[24:27], a[72:79], v0
buffer_load_dwordx4 v[84:87], v1, s[8:11], s25 offen offset:1024 sc1
v_smfmac_f32_16x16x64_bf16 v[32:35], v[24:27], v[60:67], v0
ds_read_b128 v[24:27], v2 offset:7680
s_waitcnt lgkmcnt(5)
v_smfmac_f32_16x16x64_bf16 v[28:31], v[12:15], a[80:87], v0
v_smfmac_f32_16x16x64_bf16 v[32:35], v[12:15], a[208:215], v0
ds_read_b128 v[12:15], v2 offset:8192
s_waitcnt lgkmcnt(5)
v_smfmac_f32_16x16x64_bf16 v[28:31], v[16:19], a[88:95], v0
v_smfmac_f32_16x16x64_bf16 v[32:35], v[16:19], v[44:51], v0
ds_read_b128 v[16:19], v2 offset:8704
s_waitcnt lgkmcnt(3)
v_smfmac_f32_16x16x64_bf16 v[28:31], v[20:23], a[96:103], v0
v_smfmac_f32_16x16x64_bf16 v[32:35], v[20:23], a[216:223], v0
ds_read_b128 v[20:23], v2 offset:9216
s_waitcnt lgkmcnt(3)
v_smfmac_f32_16x16x64_bf16 v[28:31], v[24:27], v[52:59], v0
v_smfmac_f32_16x16x64_bf16 v[32:35], v[24:27], a[224:231], v0
ds_read_b128 v[24:27], v2 offset:9728
s_waitcnt lgkmcnt(3)
v_smfmac_f32_16x16x64_bf16 v[28:31], v[12:15], a[104:111], v0
ds_read_b128 v[52:55], v1 offset:10240
ds_read_b128 v[56:59], v1 offset:11264
v_smfmac_f32_16x16x64_bf16 v[32:35], v[12:15], a[232:239], v0
ds_read_b128 v[68:71], v1 offset:12288
ds_read_b128 v[72:75], v1 offset:13312
s_waitcnt lgkmcnt(6)
v_smfmac_f32_16x16x64_bf16 v[28:31], v[16:19], a[112:119], v0
s_add_u32 s52, s19, 32768
s_add_u32 s53, s19, 98304
s_waitcnt lgkmcnt(5)
v_smfmac_f32_16x16x64_bf16 v[28:31], v[20:23], a[120:127], v0
s_xor_b32 s45, s45, s56
s_waitcnt lgkmcnt(4)
v_smfmac_f32_16x16x64_bf16 v[28:31], v[24:27], a[128:135], v0
v_smfmac_f32_16x16x64_bf16 v[32:35], v[16:19], a[240:247], v0
v_smfmac_f32_16x16x64_bf16 v[32:35], v[20:23], a[248:255], v0
v_cvt_pk_bf16_f32 v36, v28, v29
v_smfmac_f32_16x16x64_bf16 v[32:35], v[24:27], v[88:95], v0
v_cvt_pk_bf16_f32 v37, v30, v31
ds_write_b64 v6, v[36:37] offset:19456
v_smfmac_f32_16x16x64_bf16 v[40:43], v[12:15], v[192:199], v0
s_cmp_eq_u32 s18, 63
v_smfmac_f32_16x16x64_bf16 v[40:43], v[16:19], v[200:207], v0
v_cvt_pk_bf16_f32 v76, v32, v33
v_cvt_pk_bf16_f32 v77, v34, v35
ds_write_b64 v6, v[76:77] offset:21504
v_smfmac_f32_16x16x64_bf16 v[40:43], v[20:23], v[208:215], v0
ds_read_b128 v[12:15], v2 offset:5120
ds_read_b128 v[16:19], v2 offset:5632
v_smfmac_f32_16x16x64_bf16 v[40:43], v[24:27], v[216:223], v0
ds_read_b128 v[20:23], v2 offset:6144
ds_read_b128 v[24:27], v2 offset:6656
s_cbranch_scc1 C_s2_last
buffer_store_dword v11, off, s[48:51], s22 sc1
s_waitcnt lgkmcnt(4)
s_barrier
ds_read_b64_tr_b16 v[44:45], v5 offset:18432
ds_read_b64_tr_b16 v[46:47], v5 offset:18688
ds_read_b64_tr_b16 v[48:49], v5 offset:20480
ds_read_b64_tr_b16 v[50:51], v5 offset:20736
s_waitcnt lgkmcnt(7)
v_smfmac_f32_16x16x64_bf16 v[40:43], v[12:15], v[144:151], v0
ds_read_b64_tr_b16 v[60:61], v5 offset:18944
ds_read_b64_tr_b16 v[62:63], v5 offset:19200
s_waitcnt lgkmcnt(8)
v_smfmac_f32_16x16x64_bf16 v[40:43], v[16:19], v[152:159], v0
ds_read_b64_tr_b16 v[64:65], v5 offset:20992
ds_read_b64_tr_b16 v[66:67], v5 offset:21248
s_waitcnt lgkmcnt(9)
v_smfmac_f32_16x16x64_bf16 v[40:43], v[20:23], v[160:167], v0
ds_read_b64_tr_b16 v[12:13], v5 offset:19456
ds_read_b64_tr_b16 v[14:15], v5 offset:19712
ds_read_b64_tr_b16 v[16:17], v5 offset:21504
s_waitcnt lgkmcnt(11)
v_smfmac_f32_16x16x64_bf16 v[40:43], v[24:27], v[168:175], v0
ds_read_b64_tr_b16 v[18:19], v5 offset:21760
ds_read_b128 v[20:23], v1 offset:14336
ds_read_b128 v[24:27], v1 offset:15360
s_waitcnt lgkmcnt(12)
v_mfma_f32_16x16x32_bf16 v[28:31], v[52:55], v[44:47], 0
ds_read_b128 v[52:55], v1 offset:16384
v_mfma_f32_16x16x32_bf16 v[32:35], v[56:59], v[44:47], 0
ds_read_b128 v[56:59], v1 offset:17408
s_waitcnt lgkmcnt(12)
v_mfma_f32_16x16x32_bf16 v[36:39], v[48:51], v[44:47], 0
ds_read_b64_tr_b16 v[44:45], v5 offset:19968
ds_read_b64_tr_b16 v[46:47], v5 offset:20224
s_waitcnt lgkmcnt(12)
v_mfma_f32_16x16x32_bf16 v[28:31], v[68:71], v[60:63], v[28:31]
ds_read_b64_tr_b16 v[48:49], v5 offset:22016
ds_read_b64_tr_b16 v[50:51], v5 offset:22272
v_mfma_f32_16x16x32_bf16 v[32:35], v[72:75], v[60:63], v[32:35]
s_waitcnt lgkmcnt(12)
v_mfma_f32_16x16x32_bf16 v[36:39], v[64:67], v[60:63], v[36:39]
s_waitcnt lgkmcnt(7)
v_mfma_f32_16x16x32_bf16 v[28:31], v[20:23], v[12:15], v[28:31]
ds_read_b128 v[20:23], v2 offset:7168
v_mov_b64 v[60:61], s[40:41]
s_waitcnt lgkmcnt(7)
v_mfma_f32_16x16x32_bf16 v[32:35], v[24:27], v[12:15], v[32:35]
ds_read_b128 v[24:27], v2 offset:7680
v_mov_b64 v[62:63], s[40:41]
v_mfma_f32_16x16x32_bf16 v[36:39], v[16:19], v[12:15], v[36:39]
v_mov_b64 v[64:65], s[42:43]
s_waitcnt lgkmcnt(4)
v_mfma_f32_16x16x32_bf16 v[28:31], v[52:55], v[44:47], v[28:31]
v_mfma_f32_16x16x32_bf16 v[32:35], v[56:59], v[44:47], v[32:35]
s_waitcnt lgkmcnt(2)
v_mfma_f32_16x16x32_bf16 v[36:39], v[48:51], v[44:47], v[36:39]
s_waitcnt lgkmcnt(1)
v_smfmac_f32_16x16x64_bf16 v[40:43], v[20:23], v[176:183], v0
v_max3_f32 v10, v28, v29, v30
s_waitcnt lgkmcnt(0)
v_smfmac_f32_16x16x64_bf16 v[40:43], v[24:27], v[184:191], v0
v_max3_f32 v11, v31, v32, v33
v_max3_f32 v10, v10, v34, v35
v_max3_f32 v11, v11, v36, v37
v_max3_f32 v10, v10, v38, v39
v_max_f32 v10, v10, v11
v_mov_b32 v11, v10
s_nop 1
v_cvt_pk_bf16_f32 v78, v40, v41
v_cvt_pk_bf16_f32 v79, v42, v43
v_permlane32_swap_b32 v10, v11
v_max_f32 v10, v10, v11
v_mov_b32 v11, v10
buffer_store_dwordx4 v[76:79], v1, s[48:51], s26 offen sc1
v_cndmask_b32 v58, 0, v78, s[30:31]
v_cndmask_b32 v59, 0, v79, s[30:31]
v_permlane16_swap_b32 v10, v11
v_max_f32 v10, v10, v11
v_mul_f32 v10, s29, v10
v_pk_fma_f32 v[28:29], v[28:29], s[28:29], v[10:11] op_sel_hi:[1,0,0]
v_pk_fma_f32 v[30:31], v[30:31], s[28:29], v[10:11] op_sel_hi:[1,0,0]
v_pk_fma_f32 v[32:33], v[32:33], s[28:29], v[10:11] op_sel_hi:[1,0,0]
v_pk_fma_f32 v[34:35], v[34:35], s[28:29], v[10:11] op_sel_hi:[1,0,0]
v_exp_f32 v28, v28
v_exp_f32 v29, v29
v_exp_f32 v30, v30
v_exp_f32 v31, v31
v_exp_f32 v32, v32
v_exp_f32 v33, v33
v_exp_f32 v34, v34
v_exp_f32 v35, v35
v_cvt_pk_bf16_f32 v52, v28, v29
v_cvt_pk_bf16_f32 v53, v30, v31
v_cvt_pk_bf16_f32 v54, v32, v33
v_cvt_pk_bf16_f32 v55, v34, v35
v_fma_f32 v36, v36, s28, v10
v_fma_f32 v37, v37, s28, v10
v_mfma_f32_16x16x32_bf16 v[24:27], v[60:63], v[52:55], 0
v_fma_f32 v38, v38, s28, v10
v_fma_f32 v39, v39, s28, v10
s_waitcnt vmcnt(3)
v_mfma_f32_16x16x32_bf16 v[28:31], v[80:83], v[52:55], 0
v_exp_f32 v36, v36
s_waitcnt vmcnt(2)
v_mfma_f32_16x16x32_bf16 v[32:35], v[84:87], v[52:55], 0
v_exp_f32 v37, v37
v_exp_f32 v38, v38
v_exp_f32 v39, v39
v_cvt_pk_bf16_f32 v56, v36, v37
v_cvt_pk_bf16_f32 v57, v38, v39
v_cndmask_b32 v74, v78, 0, s[30:31]
v_cndmask_b32 v75, v79, 0, s[30:31]
v_mfma_f32_16x16x16_bf16 v[24:27], v[64:65], v[56:57], v[24:27]
v_mov_b64 v[40:41], 0
v_mov_b64 v[42:43], 0
v_mfma_f32_16x16x16_bf16 v[28:31], v[58:59], v[56:57], v[28:31]
v_mov_b64 v[36:37], 0
v_mov_b64 v[38:39], 0
v_mfma_f32_16x16x16_bf16 v[32:35], v[74:75], v[56:57], v[32:35]
s_nop 1
v_rcp_f32 v10, v24
ds_read_b128 v[44:47], v1 offset:61440
ds_read_b128 v[48:51], v1 offset:62464
v_pk_mul_f32 v[28:29], v[28:29], v[10:11] op_sel_hi:[1,0]
v_pk_mul_f32 v[30:31], v[30:31], v[10:11] op_sel_hi:[1,0]
s_nop 0
v_pk_mul_f32 v[32:33], v[32:33], v[10:11] op_sel_hi:[1,0]
v_pk_mul_f32 v[34:35], v[34:35], v[10:11] op_sel_hi:[1,0]
v_cvt_pk_bf16_f32 v20, v28, v32
v_cvt_pk_bf16_f32 v21, v29, v33
v_cvt_pk_bf16_f32 v22, v30, v34
v_cvt_pk_bf16_f32 v23, v31, v35
ds_write_b128 v2, v[20:23] offset:23552
ds_read_b128 v[52:55], v1 offset:45056
ds_read_b128 v[56:59], v1 offset:46080
ds_read_b128 v[60:63], v1 offset:53248
ds_read_b128 v[64:67], v1 offset:54272
ds_read_b128 v[68:71], v3 offset:4096
ds_read_b128 v[72:75], v3 offset:5120
v_mov_b64 v[28:29], 0
v_mov_b64 v[30:31], 0
v_smfmac_f32_16x16x64_bf16 v[36:39], v[20:23], v[240:247], v0
s_waitcnt lgkmcnt(6)
s_barrier
ds_read_b128 v[12:15], v2 offset:22528
ds_read_b128 v[16:19], v2 offset:23040
ds_read_b128 v[24:27], v2 offset:24064
v_smfmac_f32_16x16x64_bf16 v[40:43], v[20:23], v[44:51], v0
s_mov_b32 m0, 10240
s_nop 0
buffer_load_dwordx4 v1, s[8:11], s24 offen offset:0 sc1 lds
buffer_load_dwordx4 v1, s[8:11], s24 offen offset:1024 sc1 lds
buffer_load_dwordx4 v1, s[8:11], s24 offen offset:2048 sc1 lds
buffer_load_dwordx4 v1, s[8:11], s24 offen offset:3072 sc1 lds
s_waitcnt lgkmcnt(2)
v_smfmac_f32_16x16x64_bf16 v[40:43], v[12:15], v[52:59], v0
s_waitcnt lgkmcnt(1)
v_smfmac_f32_16x16x64_bf16 v[40:43], v[16:19], v[60:67], v0
s_waitcnt lgkmcnt(0)
v_smfmac_f32_16x16x64_bf16 v[40:43], v[24:27], v[68:75], v0
v_smfmac_f32_16x16x64_bf16 v[36:39], v[12:15], v[224:231], v0
v_smfmac_f32_16x16x64_bf16 v[36:39], v[16:19], v[232:239], v0
v_cvt_pk_bf16_f32 v10, v40, v41
v_smfmac_f32_16x16x64_bf16 v[36:39], v[24:27], v[248:255], v0
v_cvt_pk_bf16_f32 v11, v42, v43
buffer_store_dwordx2 v[10:11], v8, s[8:11], s52 offen sc1
s_nop 5
v_cvt_pk_bf16_f32 v10, v36, v37
v_cvt_pk_bf16_f32 v11, v38, v39
buffer_store_dwordx2 v[10:11], v8, s[8:11], s53 offen sc1
v_mov_b64 v[28:29], 0
v_mov_b64 v[30:31], 0
v_mov_b64 v[32:33], 0
v_mov_b64 v[34:35], 0
v_mov_b64 v[40:41], 0
v_mov_b64 v[42:43], 0
v_mov_b64 v[36:37], -1
v_mov_b64 v[38:39], -1
s_add_u32 s18, s18, 1
s_xor_b32 s19, s19, 163840
s_add_u32 s26, s26, 131072
s_xor_b32 s44, s27, 0x202000
s_add_u32 s25, s24, 16781312
s_add_u32 s24, s24, 262144
ds_read_b128 v[44:47], v3 offset:28672
ds_read_b128 v[48:51], v3 offset:29696
ds_read_b128 v[52:55], v3 offset:36864
ds_read_b128 v[56:59], v3 offset:37888
ds_read_b128 v[60:63], v3 offset:45056
ds_read_b128 v[64:67], v3 offset:46080
s_waitcnt vmcnt(2)
s_barrier
s_add_u32 s37, s20, 2048
s_mov_b32 s34, s20
s_add_u32 s4, s4, 32768
s_lshr_b32 s32, s4, 5
s_and_b32 s32, s32, 0x4000
s_lshr_b32 s27, s4, 8
s_and_b32 s27, s27, 0x2000
s_or_b32 s32, s32, s27
s_xor_b32 s32, s32, s47
s_add_u32 s27, s4, s32
s_add_u32 s20, s20, 8192
s_sub_u32 s32, s20, s46
s_cmp_eq_u32 s32, 24576
s_cselect_b32 s20, s46, s20
s_branch C_s2
C_s2_first:
ds_read_b128 v[12:15], v2 offset:0
ds_read_b128 v[16:19], v2 offset:512
ds_read_b128 v[20:23], v2 offset:1024
ds_read_b128 v[24:27], v2 offset:1536
s_waitcnt lgkmcnt(3)
v_smfmac_f32_16x16x64_bf16 v[28:31], v[12:15], a[0:7], v0
v_smfmac_f32_16x16x64_bf16 v[32:35], v[12:15], a[136:143], v0
v_smfmac_f32_16x16x64_bf16 v[40:43], v[12:15], v[44:51], v0
ds_read_b128 v[12:15], v2 offset:2048
ds_read_b128 v[44:47], v3 offset:53248
s_waitcnt lgkmcnt(4)
v_smfmac_f32_16x16x64_bf16 v[28:31], v[16:19], a[8:15], v0
ds_read_b128 v[48:51], v3 offset:54272
v_smfmac_f32_16x16x64_bf16 v[32:35], v[16:19], a[144:151], v0
v_smfmac_f32_16x16x64_bf16 v[40:43], v[16:19], v[52:59], v0
ds_read_b128 v[16:19], v2 offset:2560
ds_read_b128 v[52:55], v3 offset:61440
s_waitcnt lgkmcnt(6)
v_smfmac_f32_16x16x64_bf16 v[28:31], v[20:23], a[16:23], v0
ds_read_b128 v[56:59], v3 offset:62464
v_smfmac_f32_16x16x64_bf16 v[32:35], v[20:23], a[152:159], v0
v_smfmac_f32_16x16x64_bf16 v[40:43], v[20:23], v[60:67], v0
ds_read_b128 v[20:23], v2 offset:3072
ds_read_b128 v[60:63], v4 offset:4096
s_waitcnt lgkmcnt(8)
v_smfmac_f32_16x16x64_bf16 v[28:31], v[24:27], a[24:31], v0
ds_read_b128 v[64:67], v4 offset:5120
v_smfmac_f32_16x16x64_bf16 v[32:35], v[24:27], a[160:167], v0
v_smfmac_f32_16x16x64_bf16 v[40:43], v[24:27], v[96:103], v0
ds_read_b128 v[24:27], v2 offset:3584
s_waitcnt lgkmcnt(7)
v_smfmac_f32_16x16x64_bf16 v[28:31], v[12:15], v[44:51], v0
ds_read_b128 v[44:47], v4 offset:12288
ds_read_b128 v[48:51], v4 offset:13312
v_smfmac_f32_16x16x64_bf16 v[32:35], v[12:15], a[168:175], v0
v_smfmac_f32_16x16x64_bf16 v[40:43], v[12:15], v[104:111], v0
ds_read_b128 v[12:15], v2 offset:4096
s_waitcnt lgkmcnt(9)
v_smfmac_f32_16x16x64_bf16 v[28:31], v[16:19], a[32:39], v0
s_waitcnt lgkmcnt(7)
v_smfmac_f32_16x16x64_bf16 v[32:35], v[16:19], v[52:59], v0
ds_read_b128 v[52:55], v4 offset:20480
ds_read_b128 v[56:59], v4 offset:21504
v_smfmac_f32_16x16x64_bf16 v[40:43], v[16:19], v[112:119], v0
ds_read_b128 v[16:19], v2 offset:4608
s_waitcnt lgkmcnt(9)
v_smfmac_f32_16x16x64_bf16 v[28:31], v[20:23], a[40:47], v0
v_smfmac_f32_16x16x64_bf16 v[32:35], v[20:23], a[176:183], v0
s_waitcnt lgkmcnt(6)
v_smfmac_f32_16x16x64_bf16 v[28:31], v[24:27], v[60:67], v0
ds_read_b128 v[60:63], v4 offset:28672
ds_read_b128 v[64:67], v4 offset:29696
v_smfmac_f32_16x16x64_bf16 v[32:35], v[24:27], a[184:191], v0
s_waitcnt lgkmcnt(5)
v_smfmac_f32_16x16x64_bf16 v[28:31], v[12:15], a[48:55], v0
v_smfmac_f32_16x16x64_bf16 v[32:35], v[12:15], a[192:199], v0
s_waitcnt lgkmcnt(2)
v_smfmac_f32_16x16x64_bf16 v[28:31], v[16:19], a[56:63], v0
v_smfmac_f32_16x16x64_bf16 v[32:35], v[16:19], v[44:51], v0
ds_read_b128 v[44:47], v1 offset:28672
ds_read_b128 v[48:51], v1 offset:29696
s_waitcnt lgkmcnt(0)
s_branch C_s2_mid
C_s2_chkslow:
s_add_u32 s57, s57, 1
s_cmp_gt_u32 s57, 0x40000
s_cbranch_scc1 C_fail
buffer_load_dwordx4 v[68:71], v1, s[8:11], s37 offen offset:0 sc1
buffer_load_dwordx4 v[72:75], v1, s[8:11], s37 offen offset:1024 sc1
s_waitcnt vmcnt(2)
s_branch C_s2_chk
C_s2_rslow:
s_waitcnt vmcnt(0) lgkmcnt(0)
v_max3_u32 v10, v68, v69, v70
v_max_u32 v10, v10, v71
v_cmp_eq_u32 vcc, -1, v10
s_cbranch_vccz C_s2_rgot
s_add_u32 s57, s57, 1
s_cmp_gt_u32 s57, 0x40000
s_cbranch_scc1 C_fail
s_add_u32 s33, s44, 4096
buffer_load_dwordx4 v[68:71], v7, s[8:11], s33 offen sc1
s_branch C_s2_rslow
C_s2_rgot:
ds_write_b32 v9, v68 offset:9216
ds_write_b32 v9, v69 offset:9232
ds_write_b32 v9, v70 offset:9248
ds_write_b32 v9, v71 offset:9264
s_waitcnt lgkmcnt(0)
s_branch C_s2_rok
C_s2_last:
s_waitcnt lgkmcnt(3)
v_smfmac_f32_16x16x64_bf16 v[40:43], v[12:15], v[144:151], v0
ds_read_b128 v[12:15], v2 offset:7168
s_waitcnt lgkmcnt(3)
v_smfmac_f32_16x16x64_bf16 v[40:43], v[16:19], v[152:159], v0
ds_read_b128 v[16:19], v2 offset:7680
s_waitcnt lgkmcnt(3)
v_smfmac_f32_16x16x64_bf16 v[40:43], v[20:23], v[160:167], v0
s_waitcnt lgkmcnt(2)
v_smfmac_f32_16x16x64_bf16 v[40:43], v[24:27], v[168:175], v0
s_waitcnt lgkmcnt(1)
v_smfmac_f32_16x16x64_bf16 v[40:43], v[12:15], v[176:183], v0
s_waitcnt lgkmcnt(0)
v_smfmac_f32_16x16x64_bf16 v[40:43], v[16:19], v[184:191], v0
s_nop 7
v_cvt_pk_bf16_f32 v78, v40, v41
v_cvt_pk_bf16_f32 v79, v42, v43
buffer_store_dwordx4 v[76:79], v1, s[48:51], s26 offen sc1
s_waitcnt vmcnt(0)
s_branch C_exit
C_s3_in:
s_add_u32 s25, s24, 16783360
s_add_u32 s24, s24, 262144
v_mov_b64 v[28:29], 0
v_mov_b64 v[30:31], 0
v_mov_b64 v[32:33], 0
v_mov_b64 v[34:35], 0
v_mov_b64 v[40:41], 0
v_mov_b64 v[42:43], 0
ds_read_b128 v[44:47], v3 offset:30720
ds_read_b128 v[48:51], v3 offset:31744
ds_read_b128 v[52:55], v3 offset:38912
ds_read_b128 v[56:59], v3 offset:39936
ds_read_b128 v[60:63], v3 offset:47104
ds_read_b128 v[64:67], v3 offset:48128
s_waitcnt lgkmcnt(0)
s_barrier
s_branch C_s3_first
C_s3:
s_nop 15
s_nop 10
buffer_load_dwordx4 v[68:71], v1, s[8:11], s37 offen offset:0 sc1
s_nop 15
s_nop 15
buffer_load_dwordx4 v[68:71], v1, s[8:11], s37 offen offset:0 sc1
s_waitcnt vmcnt(1)
C_s3_chk:
v_max3_u32 v10, v68, v69, v70
v_max_u32 v10, v10, v71
v_cmp_eq_u32 vcc, -1, v10
s_cbranch_vccnz C_s3_chkslow
ds_write_b128 v1, v[68:71] offset:4096
buffer_store_dwordx4 v[36:39], v1, s[8:11], s45 offen offset:3072 sc1
s_mov_b32 s21, s34
s_waitcnt lgkmcnt(0)
buffer_load_dwordx4 v[68:71], v1, s[8:11], s44 offen offset:2048 sc1
buffer_load_dwordx4 v[72:75], v1, s[8:11], s44 offen offset:3072 sc1
s_barrier
ds_read_b128 v[12:15], v2 offset:0
ds_read_b128 v[16:19], v2 offset:512
ds_read_b128 v[20:23], v2 offset:1024
ds_read_b128 v[24:27], v2 offset:1536
s_waitcnt lgkmcnt(3)
v_smfmac_f32_16x16x64_bf16 v[28:31], v[12:15], a[0:7], v0
v_smfmac_f32_16x16x64_bf16 v[32:35], v[12:15], a[136:143], v0
v_smfmac_f32_16x16x64_bf16 v[40:43], v[12:15], v[44:51], v0
ds_read_b128 v[12:15], v2 offset:2048
ds_read_b128 v[44:47], v3 offset:55296
s_waitcnt lgkmcnt(4)
v_smfmac_f32_16x16x64_bf16 v[28:31], v[16:19], a[8:15], v0
ds_read_b128 v[48:51], v3 offset:56320
v_smfmac_f32_16x16x64_bf16 v[32:35], v[16:19], a[144:151], v0
v_smfmac_f32_16x16x64_bf16 v[40:43], v[16:19], v[52:59], v0
ds_read_b128 v[16:19], v2 offset:2560
ds_read_b128 v[52:55], v3 offset:63488
s_waitcnt lgkmcnt(6)
v_smfmac_f32_16x16x64_bf16 v[28:31], v[20:23], a[16:23], v0
ds_read_b128 v[56:59], v3 offset:64512
v_smfmac_f32_16x16x64_bf16 v[32:35], v[20:23], a[152:159], v0
v_smfmac_f32_16x16x64_bf16 v[40:43], v[20:23], v[60:67], v0
ds_read_b128 v[20:23], v2 offset:3072
ds_read_b128 v[60:63], v4 offset:6144
s_waitcnt lgkmcnt(8)
v_smfmac_f32_16x16x64_bf16 v[28:31], v[24:27], a[24:31], v0
ds_read_b128 v[64:67], v4 offset:7168
v_smfmac_f32_16x16x64_bf16 v[32:35], v[24:27], a[160:167], v0
v_smfmac_f32_16x16x64_bf16 v[40:43], v[24:27], v[96:103], v0
ds_read_b128 v[24:27], v2 offset:3584
s_waitcnt lgkmcnt(7)
v_smfmac_f32_16x16x64_bf16 v[28:31], v[12:15], v[44:51], v0
ds_read_b128 v[44:47], v4 offset:14336
ds_read_b128 v[48:51], v4 offset:15360
v_smfmac_f32_16x16x64_bf16 v[32:35], v[12:15], a[168:175], v0
v_smfmac_f32_16x16x64_bf16 v[40:43], v[12:15], v[104:111], v0
ds_read_b128 v[12:15], v2 offset:4096
s_waitcnt lgkmcnt(9)
v_smfmac_f32_16x16x64_bf16 v[28:31], v[16:19], a[32:39], v0
s_waitcnt lgkmcnt(7)
v_smfmac_f32_16x16x64_bf16 v[32:35], v[16:19], v[52:59], v0
ds_read_b128 v[52:55], v4 offset:22528
ds_read_b128 v[56:59], v4 offset:23552
v_smfmac_f32_16x16x64_bf16 v[40:43], v[16:19], v[112:119], v0
ds_read_b128 v[16:19], v2 offset:4608
s_waitcnt lgkmcnt(9)
v_smfmac_f32_16x16x64_bf16 v[28:31], v[20:23], a[40:47], v0
v_smfmac_f32_16x16x64_bf16 v[32:35], v[20:23], a[176:183], v0
s_waitcnt vmcnt(0)
v_max3_u32 v10, v68, v69, v70
s_waitcnt lgkmcnt(6)
v_smfmac_f32_16x16x64_bf16 v[28:31], v[24:27], v[60:67], v0
v_max_u32 v10, v10, v71
ds_write_b128 v1, v[68:71] offset:7168
v_smfmac_f32_16x16x64_bf16 v[32:35], v[24:27], a[184:191], v0
v_max3_u32 v10, v10, v72, v73
s_waitcnt lgkmcnt(4)
v_smfmac_f32_16x16x64_bf16 v[28:31], v[12:15], a[48:55], v0
v_max3_u32 v10, v10, v74, v75
ds_write_b128 v1, v[72:75] offset:8192
v_smfmac_f32_16x16x64_bf16 v[32:35], v[12:15], a[192:199], v0
v_cmp_eq_u32 vcc, -1, v10
ds_read_b128 v[60:63], v4 offset:30720
s_waitcnt lgkmcnt(3)
v_smfmac_f32_16x16x64_bf16 v[28:31], v[16:19], a[56:63], v0
ds_read_b128 v[64:67], v4 offset:31744
v_smfmac_f32_16x16x64_bf16 v[32:35], v[16:19], v[44:51], v0
ds_read_b128 v[44:47], v1 offset:30720
ds_read_b128 v[48:51], v1 offset:31744
s_cbranch_vccnz C_s3_rslow
C_s3_rok:
s_waitcnt lgkmcnt(4)
s_barrier
C_s3_mid:
v_smfmac_f32_16x16x64_bf16 v[40:43], v[20:23], v[120:127], v0
ds_read_b128 v[20:23], v2 offset:5120
v_smfmac_f32_16x16x64_bf16 v[40:43], v[24:27], v[128:135], v0
ds_read_b128 v[24:27], v2 offset:5632
v_smfmac_f32_16x16x64_bf16 v[40:43], v[12:15], v[136:143], v0
ds_read_b128 v[12:15], v2 offset:6144
v_smfmac_f32_16x16x64_bf16 v[40:43], v[16:19], v[52:59], v0
ds_read_b128 v[16:19], v2 offset:6656
ds_read_b128 v[52:55], v1 offset:38912
s_cmp_ge_u32 s18, s59
s_cbranch_scc1 C_s3_wait
C_s3_waited:
s_waitcnt lgkmcnt(4)
v_smfmac_f32_16x16x64_bf16 v[28:31], v[20:23], a[64:71], v0
ds_read_b128 v[56:59], v1 offset:39936
buffer_load_dwordx4 v[80:83], v1, s[8:11], s25 offen offset:0 sc1
v_smfmac_f32_16x16x64_bf16 v[32:35], v[20:23], a[200:207], v0
ds_read_b128 v[20:23], v2 offset:7168
s_waitcnt lgkmcnt(5)
v_smfmac_f32_16x16x64_bf16 v[28:31], v[24:27], a[72:79], v0
buffer_load_dwordx4 v[84:87], v1, s[8:11], s25 offen offset:1024 sc1
v_smfmac_f32_16x16x64_bf16 v[32:35], v[24:27], v[60:67], v0
ds_read_b128 v[24:27], v2 offset:7680
s_waitcnt lgkmcnt(5)
v_smfmac_f32_16x16x64_bf16 v[28:31], v[12:15], a[80:87], v0
v_smfmac_f32_16x16x64_bf16 v[32:35], v[12:15], a[208:215], v0
ds_read_b128 v[12:15], v2 offset:8192
s_waitcnt lgkmcnt(5)
v_smfmac_f32_16x16x64_bf16 v[28:31], v[16:19], a[88:95], v0
v_smfmac_f32_16x16x64_bf16 v[32:35], v[16:19], v[44:51], v0
ds_read_b128 v[16:19], v2 offset:8704
s_waitcnt lgkmcnt(3)
v_smfmac_f32_16x16x64_bf16 v[28:31], v[20:23], a[96:103], v0
v_smfmac_f32_16x16x64_bf16 v[32:35], v[20:23], a[216:223], v0
ds_read_b128 v[20:23], v2 offset:9216
s_waitcnt lgkmcnt(3)
v_smfmac_f32_16x16x64_bf16 v[28:31], v[24:27], v[52:59], v0
v_smfmac_f32_16x16x64_bf16 v[32:35], v[24:27], a[224:231], v0
ds_read_b128 v[24:27], v2 offset:9728
s_waitcnt lgkmcnt(3)
v_smfmac_f32_16x16x64_bf16 v[28:31], v[12:15], a[104:111], v0
ds_read_b128 v[52:55], v1 offset:10240
ds_read_b128 v[56:59], v1 offset:11264
v_smfmac_f32_16x16x64_bf16 v[32:35], v[12:15], a[232:239], v0
ds_read_b128 v[68:71], v1 offset:12288
ds_read_b128 v[72:75], v1 offset:13312
s_waitcnt lgkmcnt(6)
v_smfmac_f32_16x16x64_bf16 v[28:31], v[16:19], a[112:119], v0
s_add_u32 s52, s19, 49152
s_add_u32 s53, s19, 114688
s_waitcnt lgkmcnt(5)
v_smfmac_f32_16x16x64_bf16 v[28:31], v[20:23], a[120:127], v0
s_xor_b32 s45, s45, s56
s_waitcnt lgkmcnt(4)
v_smfmac_f32_16x16x64_bf16 v[28:31], v[24:27], a[128:135], v0
v_smfmac_f32_16x16x64_bf16 v[32:35], v[16:19], a[240:247], v0
v_smfmac_f32_16x16x64_bf16 v[32:35], v[20:23], a[248:255], v0
v_cvt_pk_bf16_f32 v36, v28, v29
v_smfmac_f32_16x16x64_bf16 v[32:35], v[24:27], v[88:95], v0
v_cvt_pk_bf16_f32 v37, v30, v31
ds_write_b64 v6, v[36:37] offset:19968
v_smfmac_f32_16x16x64_bf16 v[40:43], v[12:15], v[192:199], v0
s_cmp_eq_u32 s18, 63
v_smfmac_f32_16x16x64_bf16 v[40:43], v[16:19], v[200:207], v0
v_cvt_pk_bf16_f32 v76, v32, v33
v_cvt_pk_bf16_f32 v77, v34, v35
ds_write_b64 v6, v[76:77] offset:22016
v_smfmac_f32_16x16x64_bf16 v[40:43], v[20:23], v[208:215], v0
ds_read_b128 v[12:15], v2 offset:5120
ds_read_b128 v[16:19], v2 offset:5632
v_smfmac_f32_16x16x64_bf16 v[40:43], v[24:27], v[216:223], v0
ds_read_b128 v[20:23], v2 offset:6144
ds_read_b128 v[24:27], v2 offset:6656
s_cbranch_scc1 C_s3_last
buffer_load_dword v7, v9, s[8:11], s24 offen sc1
s_mov_b64 exec, 7
buffer_load_dword v7, v6, s[8:11], s5 offen sc1
s_mov_b64 exec, -1
s_waitcnt lgkmcnt(4)
s_barrier
ds_read_b64_tr_b16 v[44:45], v5 offset:18432
ds_read_b64_tr_b16 v[46:47], v5 offset:18688
ds_read_b64_tr_b16 v[48:49], v5 offset:20480
ds_read_b64_tr_b16 v[50:51], v5 offset:20736
s_waitcnt lgkmcnt(7)
v_smfmac_f32_16x16x64_bf16 v[40:43], v[12:15], v[144:151], v0
ds_read_b64_tr_b16 v[60:61], v5 offset:18944
ds_read_b64_tr_b16 v[62:63], v5 offset:19200
s_waitcnt lgkmcnt(8)
v_smfmac_f32_16x16x64_bf16 v[40:43], v[16:19], v[152:159], v0
ds_read_b64_tr_b16 v[64:65], v5 offset:20992
ds_read_b64_tr_b16 v[66:67], v5 offset:21248
s_waitcnt lgkmcnt(9)
v_smfmac_f32_16x16x64_bf16 v[40:43], v[20:23], v[160:167], v0
ds_read_b64_tr_b16 v[12:13], v5 offset:19456
ds_read_b64_tr_b16 v[14:15], v5 offset:19712
ds_read_b64_tr_b16 v[16:17], v5 offset:21504
s_waitcnt lgkmcnt(11)
v_smfmac_f32_16x16x64_bf16 v[40:43], v[24:27], v[168:175], v0
ds_read_b64_tr_b16 v[18:19], v5 offset:21760
ds_read_b128 v[20:23], v1 offset:14336
ds_read_b128 v[24:27], v1 offset:15360
s_waitcnt lgkmcnt(12)
v_mfma_f32_16x16x32_bf16 v[28:31], v[52:55], v[44:47], 0
ds_read_b128 v[52:55], v1 offset:16384
v_mfma_f32_16x16x32_bf16 v[32:35], v[56:59], v[44:47], 0
ds_read_b128 v[56:59], v1 offset:17408
s_waitcnt lgkmcnt(12)
v_mfma_f32_16x16x32_bf16 v[36:39], v[48:51], v[44:47], 0
ds_read_b64_tr_b16 v[44:45], v5 offset:19968
ds_read_b64_tr_b16 v[46:47], v5 offset:20224
s_waitcnt lgkmcnt(12)
v_mfma_f32_16x16x32_bf16 v[28:31], v[68:71], v[60:63], v[28:31]
ds_read_b64_tr_b16 v[48:49], v5 offset:22016
ds_read_b64_tr_b16 v[50:51], v5 offset:22272
v_mfma_f32_16x16x32_bf16 v[32:35], v[72:75], v[60:63], v[32:35]
s_waitcnt lgkmcnt(12)
v_mfma_f32_16x16x32_bf16 v[36:39], v[64:67], v[60:63], v[36:39]
s_waitcnt lgkmcnt(7)
v_mfma_f32_16x16x32_bf16 v[28:31], v[20:23], v[12:15], v[28:31]
ds_read_b128 v[20:23], v2 offset:7168
v_mov_b64 v[60:61], s[40:41]
s_waitcnt lgkmcnt(7)
v_mfma_f32_16x16x32_bf16 v[32:35], v[24:27], v[12:15], v[32:35]
ds_read_b128 v[24:27], v2 offset:7680
v_mov_b64 v[62:63], s[40:41]
v_mfma_f32_16x16x32_bf16 v[36:39], v[16:19], v[12:15], v[36:39]
v_mov_b64 v[64:65], s[42:43]
s_waitcnt lgkmcnt(4)
v_mfma_f32_16x16x32_bf16 v[28:31], v[52:55], v[44:47], v[28:31]
v_mfma_f32_16x16x32_bf16 v[32:35], v[56:59], v[44:47], v[32:35]
s_waitcnt lgkmcnt(2)
v_mfma_f32_16x16x32_bf16 v[36:39], v[48:51], v[44:47], v[36:39]
s_waitcnt lgkmcnt(1)
v_smfmac_f32_16x16x64_bf16 v[40:43], v[20:23], v[176:183], v0
v_max3_f32 v10, v28, v29, v30
s_waitcnt lgkmcnt(0)
v_smfmac_f32_16x16x64_bf16 v[40:43], v[24:27], v[184:191], v0
v_max3_f32 v11, v31, v32, v33
v_max3_f32 v10, v10, v34, v35
v_max3_f32 v11, v11, v36, v37
v_max3_f32 v10, v10, v38, v39
v_max_f32 v10, v10, v11
v_mov_b32 v11, v10
s_nop 1
v_cvt_pk_bf16_f32 v78, v40, v41
v_cvt_pk_bf16_f32 v79, v42, v43
v_permlane32_swap_b32 v10, v11
v_max_f32 v10, v10, v11
v_mov_b32 v11, v10
buffer_store_dwordx4 v[76:79], v1, s[48:51], s26 offen sc1
v_cndmask_b32 v58, 0, v78, s[30:31]
v_cndmask_b32 v59, 0, v79, s[30:31]
v_permlane16_swap_b32 v10, v11
v_max_f32 v10, v10, v11
v_mul_f32 v10, s29, v10
v_pk_fma_f32 v[28:29], v[28:29], s[28:29], v[10:11] op_sel_hi:[1,0,0]
v_pk_fma_f32 v[30:31], v[30:31], s[28:29], v[10:11] op_sel_hi:[1,0,0]
v_pk_fma_f32 v[32:33], v[32:33], s[28:29], v[10:11] op_sel_hi:[1,0,0]
v_pk_fma_f32 v[34:35], v[34:35], s[28:29], v[10:11] op_sel_hi:[1,0,0]
v_exp_f32 v28, v28
v_exp_f32 v29, v29
v_exp_f32 v30, v30
v_exp_f32 v31, v31
v_exp_f32 v32, v32
v_exp_f32 v33, v33
v_exp_f32 v34, v34
v_exp_f32 v35, v35
v_cvt_pk_bf16_f32 v52, v28, v29
v_cvt_pk_bf16_f32 v53, v30, v31
v_cvt_pk_bf16_f32 v54, v32, v33
v_cvt_pk_bf16_f32 v55, v34, v35
v_fma_f32 v36, v36, s28, v10
v_fma_f32 v37, v37, s28, v10
v_mfma_f32_16x16x32_bf16 v[12:15], v[60:63], v[52:55], 0
v_fma_f32 v38, v38, s28, v10
v_fma_f32 v39, v39, s28, v10
s_waitcnt vmcnt(4)
v_mfma_f32_16x16x32_bf16 v[28:31], v[80:83], v[52:55], 0
v_exp_f32 v36, v36
s_waitcnt vmcnt(3)
v_mfma_f32_16x16x32_bf16 v[32:35], v[84:87], v[52:55], 0
v_exp_f32 v37, v37
v_exp_f32 v38, v38
v_exp_f32 v39, v39
v_cvt_pk_bf16_f32 v56, v36, v37
v_cvt_pk_bf16_f32 v57, v38, v39
v_cndmask_b32 v74, v78, 0, s[30:31]
v_cndmask_b32 v75, v79, 0, s[30:31]
v_mfma_f32_16x16x16_bf16 v[12:15], v[64:65], v[56:57], v[12:15]
v_mov_b64 v[40:41], 0
v_mov_b64 v[42:43], 0
v_mfma_f32_16x16x16_bf16 v[28:31], v[58:59], v[56:57], v[28:31]
v_mov_b64 v[36:37], 0
v_mov_b64 v[38:39], 0
v_mfma_f32_16x16x16_bf16 v[32:35], v[74:75], v[56:57], v[32:35]
s_nop 1
v_rcp_f32 v10, v12
ds_read_b128 v[44:47], v3 offset:6144
ds_read_b128 v[48:51], v3 offset:7168
v_pk_mul_f32 v[28:29], v[28:29], v[10:11] op_sel_hi:[1,0]
v_pk_mul_f32 v[30:31], v[30:31], v[10:11] op_sel_hi:[1,0]
s_nop 0
v_pk_mul_f32 v[32:33], v[32:33], v[10:11] op_sel_hi:[1,0]
v_pk_mul_f32 v[34:35], v[34:35], v[10:11] op_sel_hi:[1,0]
v_cvt_pk_bf16_f32 v24, v28, v32
v_cvt_pk_bf16_f32 v25, v29, v33
v_cvt_pk_bf16_f32 v26, v30, v34
v_cvt_pk_bf16_f32 v27, v31, v35
ds_write_b128 v2, v[24:27] offset:24064
ds_read_b128 v[52:55], v1 offset:47104
ds_read_b128 v[56:59], v1 offset:48128
ds_read_b128 v[60:63], v1 offset:55296
ds_read_b128 v[64:67], v1 offset:56320
ds_read_b128 v[68:71], v1 offset:63488
ds_read_b128 v[72:75], v1 offset:64512
v_mov_b64 v[28:29], 0
v_mov_b64 v[30:31], 0
v_smfmac_f32_16x16x64_bf16 v[36:39], v[24:27], v[248:255], v0
s_waitcnt lgkmcnt(6)
s_barrier
ds_read_b128 v[12:15], v2 offset:22528
ds_read_b128 v[16:19], v2 offset:23040
ds_read_b128 v[20:23], v2 offset:23552
v_smfmac_f32_16x16x64_bf16 v[40:43], v[24:27], v[44:51], v0
s_mov_b32 m0, 14336
s_add_u32 s32, s24, 4096
buffer_load_dwordx4 v1, s[8:11], s32 offen offset:0 sc1 lds
buffer_load_dwordx4 v1, s[8:11], s32 offen offset:1024 sc1 lds
buffer_load_dwordx4 v1, s[8:11], s32 offen offset:2048 sc1 lds
buffer_load_dwordx4 v1, s[8:11], s32 offen offset:3072 sc1 lds
s_waitcnt lgkmcnt(2)
v_smfmac_f32_16x16x64_bf16 v[40:43], v[12:15], v[52:59], v0
s_waitcnt lgkmcnt(1)
v_smfmac_f32_16x16x64_bf16 v[40:43], v[16:19], v[60:67], v0
s_waitcnt lgkmcnt(0)
v_smfmac_f32_16x16x64_bf16 v[40:43], v[20:23], v[68:75], v0
v_smfmac_f32_16x16x64_bf16 v[36:39], v[12:15], v[224:231], v0
v_smfmac_f32_16x16x64_bf16 v[36:39], v[16:19], v[232:239], v0
v_cvt_pk_bf16_f32 v10, v40, v41
v_smfmac_f32_16x16x64_bf16 v[36:39], v[20:23], v[240:247], v0
v_cvt_pk_bf16_f32 v11, v42, v43
buffer_store_dwordx2 v[10:11], v8, s[8:11], s52 offen sc1
s_nop 5
v_cvt_pk_bf16_f32 v10, v36, v37
v_cvt_pk_bf16_f32 v11, v38, v39
buffer_store_dwordx2 v[10:11], v8, s[8:11], s53 offen sc1
v_mov_b64 v[28:29], 0
v_mov_b64 v[30:31], 0
v_mov_b64 v[32:33], 0
v_mov_b64 v[34:35], 0
v_mov_b64 v[40:41], 0
v_mov_b64 v[42:43], 0
v_mov_b64 v[36:37], -1
v_mov_b64 v[38:39], -1
s_add_u32 s18, s18, 1
s_xor_b32 s19, s19, 163840
s_add_u32 s26, s26, 131072
s_xor_b32 s44, s27, 0x202000
s_add_u32 s25, s24, 16783360
s_add_u32 s24, s24, 262144
ds_read_b128 v[44:47], v3 offset:30720
ds_read_b128 v[48:51], v3 offset:31744
ds_read_b128 v[52:55], v3 offset:38912
ds_read_b128 v[56:59], v3 offset:39936
ds_read_b128 v[60:63], v3 offset:47104
ds_read_b128 v[64:67], v3 offset:48128
s_waitcnt vmcnt(2)
s_barrier
s_add_u32 s37, s20, 4096
s_mov_b32 s34, s20
s_add_u32 s4, s4, 32768
s_lshr_b32 s32, s4, 5
s_and_b32 s32, s32, 0x4000
s_lshr_b32 s27, s4, 8
s_and_b32 s27, s27, 0x2000
s_or_b32 s32, s32, s27
s_xor_b32 s32, s32, s47
s_add_u32 s27, s4, s32
s_add_u32 s20, s20, 8192
s_sub_u32 s32, s20, s46
s_cmp_eq_u32 s32, 24576
s_cselect_b32 s20, s46, s20
s_branch C_s3
C_s3_first:
ds_read_b128 v[12:15], v2 offset:0
ds_read_b128 v[16:19], v2 offset:512
ds_read_b128 v[20:23], v2 offset:1024
ds_read_b128 v[24:27], v2 offset:1536
s_waitcnt lgkmcnt(3)
v_smfmac_f32_16x16x64_bf16 v[28:31], v[12:15], a[0:7], v0
v_smfmac_f32_16x16x64_bf16 v[32:35], v[12:15], a[136:143], v0
v_smfmac_f32_16x16x64_bf16 v[40:43], v[12:15], v[44:51], v0
ds_read_b128 v[12:15], v2 offset:2048
ds_read_b128 v[44:47], v3 offset:55296
s_waitcnt lgkmcnt(4)
v_smfmac_f32_16x16x64_bf16 v[28:31], v[16:19], a[8:15], v0
ds_read_b128 v[48:51], v3 offset:56320
v_smfmac_f32_16x16x64_bf16 v[32:35], v[16:19], a[144:151], v0
v_smfmac_f32_16x16x64_bf16 v[40:43], v[16:19], v[52:59], v0
ds_read_b128 v[16:19], v2 offset:2560
ds_read_b128 v[52:55], v3 offset:63488
s_waitcnt lgkmcnt(6)
v_smfmac_f32_16x16x64_bf16 v[28:31], v[20:23], a[16:23], v0
ds_read_b128 v[56:59], v3 offset:64512
v_smfmac_f32_16x16x64_bf16 v[32:35], v[20:23], a[152:159], v0
v_smfmac_f32_16x16x64_bf16 v[40:43], v[20:23], v[60:67], v0
ds_read_b128 v[20:23], v2 offset:3072
ds_read_b128 v[60:63], v4 offset:6144
s_waitcnt lgkmcnt(8)
v_smfmac_f32_16x16x64_bf16 v[28:31], v[24:27], a[24:31], v0
ds_read_b128 v[64:67], v4 offset:7168
v_smfmac_f32_16x16x64_bf16 v[32:35], v[24:27], a[160:167], v0
v_smfmac_f32_16x16x64_bf16 v[40:43], v[24:27], v[96:103], v0
ds_read_b128 v[24:27], v2 offset:3584
s_waitcnt lgkmcnt(7)
v_smfmac_f32_16x16x64_bf16 v[28:31], v[12:15], v[44:51], v0
ds_read_b128 v[44:47], v4 offset:14336
ds_read_b128 v[48:51], v4 offset:15360
v_smfmac_f32_16x16x64_bf16 v[32:35], v[12:15], a[168:175], v0
v_smfmac_f32_16x16x64_bf16 v[40:43], v[12:15], v[104:111], v0
ds_read_b128 v[12:15], v2 offset:4096
s_waitcnt lgkmcnt(9)
v_smfmac_f32_16x16x64_bf16 v[28:31], v[16:19], a[32:39], v0
s_waitcnt lgkmcnt(7)
v_smfmac_f32_16x16x64_bf16 v[32:35], v[16:19], v[52:59], v0
ds_read_b128 v[52:55], v4 offset:22528
ds_read_b128 v[56:59], v4 offset:23552
v_smfmac_f32_16x16x64_bf16 v[40:43], v[16:19], v[112:119], v0
ds_read_b128 v[16:19], v2 offset:4608
s_waitcnt lgkmcnt(9)
v_smfmac_f32_16x16x64_bf16 v[28:31], v[20:23], a[40:47], v0
v_smfmac_f32_16x16x64_bf16 v[32:35], v[20:23], a[176:183], v0
s_waitcnt lgkmcnt(6)
v_smfmac_f32_16x16x64_bf16 v[28:31], v[24:27], v[60:67], v0
ds_read_b128 v[60:63], v4 offset:30720
ds_read_b128 v[64:67], v4 offset:31744
v_smfmac_f32_16x16x64_bf16 v[32:35], v[24:27], a[184:191], v0
s_waitcnt lgkmcnt(5)
v_smfmac_f32_16x16x64_bf16 v[28:31], v[12:15], a[48:55], v0
v_smfmac_f32_16x16x64_bf16 v[32:35], v[12:15], a[192:199], v0
s_waitcnt lgkmcnt(2)
v_smfmac_f32_16x16x64_bf16 v[28:31], v[16:19], a[56:63], v0
v_smfmac_f32_16x16x64_bf16 v[32:35], v[16:19], v[44:51], v0
ds_read_b128 v[44:47], v1 offset:30720
ds_read_b128 v[48:51], v1 offset:31744
s_waitcnt lgkmcnt(0)
s_branch C_s3_mid
C_s3_wait:
C_s3_wl:
v_readlane_b32 s33, v7, 0
v_readlane_b32 s38, v7, 1
v_readlane_b32 s39, v7, 2
s_lshl_b32 s33, s33, 1
s_lshl_b32 s38, s38, 1
s_add_u32 s38, s38, 1
s_min_u32 s33, s33, s38
s_cmp_ge_u32 s33, 64
s_cselect_b32 s33, 0x100, s33
s_sub_u32 s59, s33, 1
s_cmp_eq_u32 s39, 1
s_cselect_b32 s38, 0x100, 8
s_min_i32 s59, s59, s38
s_cmp_gt_i32 s59, s18
s_cbranch_scc1 C_s3_wl_ok
s_add_u32 s57, s57, 1
s_cmp_gt_u32 s57, 0x40000
s_cbranch_scc1 C_fail
s_sleep 2
buffer_load_dword v7, v6, s[8:11], s5 offen sc1
s_waitcnt vmcnt(0)
s_branch C_s3_wl
C_s3_wl_ok:
s_branch C_s3_waited
C_s3_chkslow:
s_add_u32 s57, s57, 1
s_cmp_gt_u32 s57, 0x40000
s_cbranch_scc1 C_fail
buffer_load_dwordx4 v[68:71], v1, s[8:11], s37 offen offset:0 sc1
s_waitcnt vmcnt(1)
s_branch C_s3_chk
C_s3_rslow:
s_waitcnt vmcnt(0) lgkmcnt(0)
v_max3_u32 v10, v68, v69, v70
v_max_u32 v10, v10, v71
v_max3_u32 v10, v10, v72, v73
v_max3_u32 v10, v10, v74, v75
v_cmp_eq_u32 vcc, -1, v10
s_cbranch_vccz C_s3_rgot
s_add_u32 s57, s57, 1
s_cmp_gt_u32 s57, 0x40000
s_cbranch_scc1 C_fail
buffer_load_dwordx4 v[68:71], v1, s[8:11], s44 offen offset:2048 sc1
buffer_load_dwordx4 v[72:75], v1, s[8:11], s44 offen offset:3072 sc1
s_branch C_s3_rslow
C_s3_rgot:
ds_write_b128 v1, v[68:71] offset:7168
ds_write_b128 v1, v[72:75] offset:8192
s_waitcnt lgkmcnt(0)
s_branch C_s3_rok
C_s3_last:
s_waitcnt lgkmcnt(3)
v_smfmac_f32_16x16x64_bf16 v[40:43], v[12:15], v[144:151], v0
ds_read_b128 v[12:15], v2 offset:7168
s_waitcnt lgkmcnt(3)
v_smfmac_f32_16x16x64_bf16 v[40:43], v[16:19], v[152:159], v0
ds_read_b128 v[16:19], v2 offset:7680
s_waitcnt lgkmcnt(3)
v_smfmac_f32_16x16x64_bf16 v[40:43], v[20:23], v[160:167], v0
s_waitcnt lgkmcnt(2)
v_smfmac_f32_16x16x64_bf16 v[40:43], v[24:27], v[168:175], v0
s_waitcnt lgkmcnt(1)
v_smfmac_f32_16x16x64_bf16 v[40:43], v[12:15], v[176:183], v0
s_waitcnt lgkmcnt(0)
v_smfmac_f32_16x16x64_bf16 v[40:43], v[16:19], v[184:191], v0
s_nop 7
v_cvt_pk_bf16_f32 v78, v40, v41
v_cvt_pk_bf16_f32 v79, v42, v43
buffer_store_dwordx4 v[76:79], v1, s[48:51], s26 offen sc1
s_waitcnt vmcnt(0)
s_branch C_exit
C_fail:
s_mov_b32 s18, 0xdead
C_exit:
s_endpgm
.fill 2048, 4, 0xbf800000
.section .rodata,"a"
.p2align 6
.amdhsa_kernel parallel_sum__memory_aug_recurrent_mem_tr__dense_activation_gelu__prompt_kernel
  .amdhsa_next_free_vgpr 512
  .amdhsa_next_free_sgpr 102
  .amdhsa_accum_offset 256
  .amdhsa_group_segment_fixed_size 0
  .amdhsa_kernarg_size 120
  .amdhsa_user_sgpr_count 2
  .amdhsa_user_sgpr_kernarg_segment_ptr 1
  .amdhsa_system_sgpr_workgroup_id_x 1
.end_amdhsa_kernel
```
